```python
import torch

def _softmax(x, axis=-1):
    return torch.softmax(x, dim=axis)
def _gelu(x):
    return torch.nn.functional.gelu(x, approximate="tanh")
def _silu(x):
    return torch.nn.functional.silu(x)
def _sigmoid(x):
    return torch.sigmoid(x)
def _layernorm(x, axis=-1, eps=1e-5):
    m = x.mean(dim=axis, keepdim=True)
    v = x.var(dim=axis, keepdim=True, unbiased=False)
    return (x - m) / torch.sqrt(v + eps)
def _scatter_add(tgt, idx, src, axis=0):
    return tgt.clone().index_add_(axis, idx, src)
def _segment_sum(src, seg, n):
    out = torch.zeros((n,) + src.shape[1:], dtype=src.dtype)
    return out.index_add_(0, seg, src)
def _pad(x, pw):
    flat = tuple(v for pair in reversed(pw) for v in pair)
    return torch.nn.functional.pad(x, flat)

kernel_name = 'concat_heads__mha_block_cached__mha_block_cached__near_ridge'

def setup_inputs():

    _w = (lambda a: (lambda t: t.to(torch.bfloat16) if t.is_floating_point() else t)(torch.as_tensor(a)))
    def _A_setup():
        B, Sq, D = 8, 144, 448
        H, Sk, Dh = 16, 512, 256
        return {
            "x": _w((lambda *s: torch.randn(*s, dtype=torch.bfloat16) * 0.8)(B, Sq, D)),
            "k_cache": _w((lambda *s: torch.randn(*s, dtype=torch.bfloat16) * 0.8)(B, H, Sk, Dh)),
            "v_cache": _w((lambda *s: torch.randn(*s, dtype=torch.bfloat16) * 0.05)(B, H, Sk, Dh)),
            "wq": _w((lambda *s: torch.randn(*s, dtype=torch.bfloat16) * 0.8)(D, H * Dh) * (D ** -0.5)),
            "wo": _w((lambda *s: torch.randn(*s, dtype=torch.bfloat16) * 0.05)(H * Dh, D) * ((H * Dh) ** -0.5)),
        }
    _A_in = _A_setup()

    def _B_setup():
        B, Sq, D = 8, 144, 448
        H, Sk, Dh = 16, 512, 256
        return {
            "x": _w((lambda *s: torch.randn(*s, dtype=torch.bfloat16) * 0.8)(B, Sq, D)),
            "k_cache": _w((lambda *s: torch.randn(*s, dtype=torch.bfloat16) * 0.8)(B, H, Sk, Dh)),
            "v_cache": _w((lambda *s: torch.randn(*s, dtype=torch.bfloat16) * 0.05)(B, H, Sk, Dh)),
            "wq": _w((lambda *s: torch.randn(*s, dtype=torch.bfloat16) * 0.8)(D, H * Dh) * (D ** -0.5)),
            "wo": _w((lambda *s: torch.randn(*s, dtype=torch.bfloat16) * 0.05)(H * Dh, D) * ((H * Dh) ** -0.5)),
        }
    _B_in = _B_setup()

    return {
        "A_x": _A_in["x"],
        "A_k_cache": _A_in["k_cache"],
        "A_v_cache": _A_in["v_cache"],
        "A_wq": _A_in["wq"],
        "A_wo": _A_in["wo"],
        "B_x": _B_in["x"],
        "B_k_cache": _B_in["k_cache"],
        "B_v_cache": _B_in["v_cache"],
        "B_wq": _B_in["wq"],
        "B_wo": _B_in["wo"],
    }

def reference(A_x, A_k_cache, A_v_cache, A_wq, A_wo, B_x, B_k_cache, B_v_cache, B_wq, B_wo):
    def _A_ref(x, k_cache, v_cache, wq, wo):
        B, Sq, D = x.shape
        H, Dh = 16, 256
        q = (lambda x, *d: x.permute(*d))((x @ wq).reshape(B, Sq, H, Dh), 0, 2, 1, 3)
        scores = torch.einsum("bhqd,bhkd->bhqk", q, k_cache) * (Dh ** -0.5)
        p = _softmax(scores, axis=-1)
        o = torch.einsum("bhqk,bhkd->bhqd", p, v_cache)
        return (lambda x, *d: x.permute(*d))(o, 0, 2, 1, 3).reshape(B, Sq, H * Dh) @ wo

    def _B_ref(x, k_cache, v_cache, wq, wo):
        B, Sq, D = x.shape
        H, Dh = 16, 256
        q = (lambda x, *d: x.permute(*d))((x @ wq).reshape(B, Sq, H, Dh), 0, 2, 1, 3)
        scores = torch.einsum("bhqd,bhkd->bhqk", q, k_cache) * (Dh ** -0.5)
        p = _softmax(scores, axis=-1)
        o = torch.einsum("bhqk,bhkd->bhqd", p, v_cache)
        return (lambda x, *d: x.permute(*d))(o, 0, 2, 1, 3).reshape(B, Sq, H * Dh) @ wo

    a = _A_ref(A_x, A_k_cache, A_v_cache, A_wq, A_wo)
    b = _B_ref(B_x, B_k_cache, B_v_cache, B_wq, B_wo)
    return torch.concatenate([a, b], axis=-1)
```

```asm
; @launch kernel=concat_heads__mha_block_cached__mha_block_cached__near_ridge_kernel grid=(256,1,1) block=(256,1,1) lds=163840
; @launch kernel=reduce_kernel grid=(560,1,1) block=(256,1,1) lds=0
.amdgcn_target "amdgcn-amd-amdhsa--gfx950"
.text
.globl concat_heads__mha_block_cached__mha_block_cached__near_ridge_kernel
.p2align 8
.type concat_heads__mha_block_cached__mha_block_cached__near_ridge_kernel,@function
concat_heads__mha_block_cached__mha_block_cached__near_ridge_kernel:
    s_cmp_lt_u32 s2, 256
    s_cbranch_scc1 L_start
    s_endpgm
L_start:
    s_and_b32 s6, s2, 15
    s_lshr_b32 s5, s2, 4
    s_and_b32 s5, s5, 7
    s_lshr_b32 s4, s2, 7
    s_mul_i32 s43, s4, 40
    s_add_u32 s64, s0, s43
    s_addc_u32 s65, s1, 0
    s_load_dwordx8 s[52:59], s[64:65], 0
    s_load_dwordx2 s[60:61], s[64:65], 32
    s_load_dwordx2 s[62:63], s[0:1], 96
    v_lshrrev_b32 v2, 6, v0
    v_and_b32 v1, 63, v0
    s_nop 1
    v_readfirstlane_b32 s7, v2
    s_lshl_b32 s32, s7, 12
    s_mov_b32 s33, 0x3db8aa3b
    s_mov_b32 s34, 0x41000000
    s_lshl_b32 s43, s5, 4
    s_or_b32 s43, s43, s6
    s_lshl_b32 s36, s43, 18
    s_lshl_b32 s44, s4, 7
    s_or_b32 s44, s44, s43
    s_mul_i32 s39, s44, 143360
    s_lshl_b32 s37, s6, 9
    s_mul_i32 s38, s6, 229376
    s_mul_i32 s35, s5, 129024
    v_and_b32 v2, 31, v1
    v_lshrrev_b32 v3, 5, v1
    v_and_b32 v4, 15, v1
    v_bfe_u32 v5, v1, 2, 2
    v_and_b32 v6, 3, v1
    v_bfe_u32 v7, v1, 4, 1
    v_xor_b32 v8, v3, v4
    v_lshlrev_b32 v8, 4, v8
    v_lshl_add_u32 v10, v2, 9, v8
    v_lshl_add_u32 v124, v4, 10, v8
    v_add_u32 v124, 114688, v124
    v_lshl_add_u32 v8, v3, 2, v5
    v_lshlrev_b32 v8, 9, v8
    v_lshlrev_b32 v9, 6, v5
    v_lshl_add_u32 v9, v7, 5, v9
    v_add_u32 v8, v8, v9
    v_lshrrev_b32 v40, 1, v6
    v_and_b32 v41, 1, v6
    v_lshl_add_u32 v18, v40, 4, v8
    v_lshl_add_u32 v18, v41, 3, v18
    v_lshl_add_u32 v8, v3, 3, v5
    v_lshlrev_b32 v8, 9, v8
    v_add_u32 v8, v8, v9
    v_lshl_add_u32 v112, v41, 4, v8
    v_lshl_add_u32 v112, v40, 3, v112
    v_xor_b32 v113, 64, v112
    v_xor_b32 v19, 64, v18
    v_xor_b32 v114, 128, v112
    v_xor_b32 v20, 128, v18
    v_xor_b32 v115, 192, v112
    v_xor_b32 v21, 192, v18
    v_add_u32 v116, 0x10000, v112
    v_add_u32 v117, 0x10000, v113
    v_add_u32 v118, 0x10000, v114
    v_add_u32 v119, 0x10000, v115
    v_xor_b32 v11, 32, v10
    v_xor_b32 v12, 64, v10
    v_xor_b32 v13, 96, v10
    v_xor_b32 v14, 128, v10
    v_xor_b32 v15, 160, v10
    v_xor_b32 v16, 192, v10
    v_xor_b32 v17, 224, v10
    s_lshl_b32 s43, s7, 1
    s_add_u32 s43, s43, 0
    s_and_b32 s44, s43, 3
    s_lshl_b32 s44, s44, 6
    s_lshr_b32 s43, s43, 2
    s_lshl_b32 s43, s43, 8
    v_xor_b32 v120, s44, v112
    v_add_u32 v120, s43, v120
    v_add_u32 v122, 0x10000, v120
    s_lshl_b32 s43, s7, 1
    s_add_u32 s43, s43, 1
    s_and_b32 s44, s43, 3
    s_lshl_b32 s44, s44, 6
    s_lshr_b32 s43, s43, 2
    s_lshl_b32 s43, s43, 8
    v_xor_b32 v121, s44, v112
    v_add_u32 v121, s43, v121
    v_add_u32 v123, 0x10000, v121
    v_lshlrev_b32 v8, 2, v3
    v_xor_b32 v42, v2, v8
    v_xor_b32 v43, 8, v42
    v_lshlrev_b32 v42, 4, v42
    v_lshlrev_b32 v43, 4, v43
    s_lshl_b32 s43, s7, 3
    v_add_u32 v8, s43, v3
    v_lshl_add_u32 v26, v8, 9, v42
    v_lshl_add_u32 v27, v8, 9, v43
    v_add_u32 v9, 0, v8
    v_lshl_add_u32 v36, v9, 13, v42
    s_movk_i32 s44, 896
    v_mad_u32_u24 v28, v9, s44, v42
    s_and_b32 s44, s7, 1
    s_lshl_b32 s44, s44, 3
    s_add_u32 s44, s44, 0
    v_add_u32 v9, s44, v3
    v_xor_b32 v9, v2, v9
    v_lshlrev_b32 v9, 4, v9
    v_lshl_add_u32 v22, v8, 9, v9
    v_add_u32 v9, 2, v8
    v_lshl_add_u32 v37, v9, 13, v43
    v_subrev_u32 v37, 1024, v37
    s_movk_i32 s44, 896
    v_mad_u32_u24 v29, v9, s44, v43
    v_subrev_u32 v29, 1024, v29
    s_and_b32 s44, s7, 1
    s_lshl_b32 s44, s44, 3
    s_add_u32 s44, s44, 2
    v_add_u32 v9, s44, v3
    v_xor_b32 v9, v2, v9
    v_lshlrev_b32 v9, 4, v9
    v_lshl_add_u32 v23, v8, 9, v9
    v_add_u32 v9, 4, v8
    v_lshl_add_u32 v38, v9, 13, v42
    v_subrev_u32 v38, 2048, v38
    s_movk_i32 s44, 896
    v_mad_u32_u24 v30, v9, s44, v42
    v_subrev_u32 v30, 2048, v30
    s_and_b32 s44, s7, 1
    s_lshl_b32 s44, s44, 3
    s_add_u32 s44, s44, 4
    v_add_u32 v9, s44, v3
    v_xor_b32 v9, v2, v9
    v_lshlrev_b32 v9, 4, v9
    v_lshl_add_u32 v24, v8, 9, v9
    v_add_u32 v9, 6, v8
    v_lshl_add_u32 v39, v9, 13, v43
    v_subrev_u32 v39, 3072, v39
    s_movk_i32 s44, 896
    v_mad_u32_u24 v31, v9, s44, v43
    v_subrev_u32 v31, 3072, v31
    s_and_b32 s44, s7, 1
    s_lshl_b32 s44, s44, 3
    s_add_u32 s44, s44, 6
    v_add_u32 v9, s44, v3
    v_xor_b32 v9, v2, v9
    v_lshlrev_b32 v9, 4, v9
    v_lshl_add_u32 v25, v8, 9, v9
    v_lshrrev_b32 v8, 3, v1
    v_lshrrev_b32 v9, 1, v8
    v_and_b32 v40, 7, v1
    v_xor_b32 v40, v40, v9
    v_xor_b32 v41, 4, v40
    v_lshlrev_b32 v40, 4, v40
    v_lshlrev_b32 v41, 4, v41
    s_movk_i32 s44, 896
    v_mad_u32_u24 v126, v8, s44, v40
    v_mad_u32_u24 v127, v8, s44, v41
    v_bfe_u32 v9, v2, 1, 3
    v_xor_b32 v9, v9, v3
    v_lshlrev_b32 v9, 4, v9
    v_lshl_add_u32 v125, v2, 7, v9
    v_add_u32 v125, s32, v125
    s_waitcnt lgkmcnt(0)
    s_mov_b32 s8, s52
    s_and_b32 s9, s53, 0xffff
    s_mov_b32 s10, 1032192
    s_mov_b32 s11, 0x20000
    s_mov_b32 s12, s54
    s_and_b32 s13, s55, 0xffff
    s_mov_b32 s14, 33554432
    s_mov_b32 s15, 0x20000
    s_mov_b32 s16, s56
    s_and_b32 s17, s57, 0xffff
    s_mov_b32 s18, 33554432
    s_mov_b32 s19, 0x20000
    s_mov_b32 s20, s58
    s_and_b32 s21, s59, 0xffff
    s_mov_b32 s22, 3670016
    s_mov_b32 s23, 0x20000
    s_mov_b32 s24, s60
    s_and_b32 s25, s61, 0xffff
    s_mov_b32 s26, 3670016
    s_mov_b32 s27, 0x20000
    s_mov_b32 s28, s62
    s_and_b32 s29, s63, 0xffff
    s_mov_b32 s30, 268435456
    s_mov_b32 s31, 0x20000
    s_mul_i32 s45, s5, 129024
    s_add_u32 s45, s45, 114688
    s_lshl_b32 s43, s7, 2
    s_add_u32 s43, s43, 0
    v_xor_b32 v2, s43, v1
    v_lshlrev_b32 v2, 4, v2
    s_mul_i32 s44, s43, 896
    v_add_u32 v2, s44, v2
    s_lshl_b32 s43, s43, 10
    s_add_u32 s43, s43, 114688
    s_mov_b32 m0, s43
    s_nop 0
    buffer_load_dwordx4 v2, s[8:11], s45 offen lds
    s_lshl_b32 s43, s7, 2
    s_add_u32 s43, s43, 1
    v_xor_b32 v2, s43, v1
    v_lshlrev_b32 v2, 4, v2
    s_mul_i32 s44, s43, 896
    v_add_u32 v2, s44, v2
    s_lshl_b32 s43, s43, 10
    s_add_u32 s43, s43, 114688
    s_mov_b32 m0, s43
    s_nop 0
    buffer_load_dwordx4 v2, s[8:11], s45 offen lds
    s_lshl_b32 s43, s7, 2
    s_add_u32 s43, s43, 2
    v_xor_b32 v2, s43, v1
    v_lshlrev_b32 v2, 4, v2
    s_mul_i32 s44, s43, 896
    v_add_u32 v2, s44, v2
    s_lshl_b32 s43, s43, 10
    s_add_u32 s43, s43, 114688
    s_mov_b32 m0, s43
    s_nop 0
    buffer_load_dwordx4 v2, s[8:11], s45 offen lds
    s_lshl_b32 s43, s7, 2
    s_add_u32 s43, s43, 3
    v_xor_b32 v2, s43, v1
    v_lshlrev_b32 v2, 4, v2
    s_mul_i32 s44, s43, 896
    v_add_u32 v2, s44, v2
    s_lshl_b32 s43, s43, 10
    s_add_u32 s43, s43, 114688
    s_mov_b32 m0, s43
    s_nop 0
    buffer_load_dwordx4 v2, s[8:11], s45 offen lds
    s_mul_i32 s45, s7, 28672
    s_add_u32 s45, s45, s35
    s_add_u32 s45, s45, 0
    s_add_u32 s43, s32, 131072
    s_mov_b32 m0, s43
    s_add_u32 s44, s45, 0
    buffer_load_dwordx4 v126, s[8:11], s44 offen lds
    s_add_u32 s43, s32, 132096
    s_mov_b32 m0, s43
    s_add_u32 s44, s45, 7168
    buffer_load_dwordx4 v127, s[8:11], s44 offen lds
    s_add_u32 s43, s32, 133120
    s_mov_b32 m0, s43
    s_add_u32 s44, s45, 14336
    buffer_load_dwordx4 v126, s[8:11], s44 offen lds
    s_add_u32 s43, s32, 134144
    s_mov_b32 m0, s43
    s_add_u32 s44, s45, 21504
    buffer_load_dwordx4 v127, s[8:11], s44 offen lds
    s_add_u32 s43, s32, 0
    s_mov_b32 m0, s43
    s_add_u32 s44, s37, 0
    buffer_load_dwordx4 v36, s[20:23], s44 offen offset:0 lds
    buffer_load_dwordx4 v37, s[20:23], s44 offen offset:1024 lds
    buffer_load_dwordx4 v38, s[20:23], s44 offen offset:2048 lds
    buffer_load_dwordx4 v39, s[20:23], s44 offen offset:3072 lds
    s_add_u32 s43, s32, 16384
    s_mov_b32 m0, s43
    s_add_u32 s44, s37, 262144
    buffer_load_dwordx4 v36, s[20:23], s44 offen offset:0 lds
    buffer_load_dwordx4 v37, s[20:23], s44 offen offset:1024 lds
    buffer_load_dwordx4 v38, s[20:23], s44 offen offset:2048 lds
    buffer_load_dwordx4 v39, s[20:23], s44 offen offset:3072 lds
    s_add_u32 s43, s32, 32768
    s_mov_b32 m0, s43
    s_add_u32 s44, s37, 524288
    buffer_load_dwordx4 v36, s[20:23], s44 offen offset:0 lds
    buffer_load_dwordx4 v37, s[20:23], s44 offen offset:1024 lds
    buffer_load_dwordx4 v38, s[20:23], s44 offen offset:2048 lds
    buffer_load_dwordx4 v39, s[20:23], s44 offen offset:3072 lds
    s_add_u32 s43, s32, 49152
    s_mov_b32 m0, s43
    s_add_u32 s44, s37, 786432
    buffer_load_dwordx4 v36, s[20:23], s44 offen offset:0 lds
    buffer_load_dwordx4 v37, s[20:23], s44 offen offset:1024 lds
    buffer_load_dwordx4 v38, s[20:23], s44 offen offset:2048 lds
    buffer_load_dwordx4 v39, s[20:23], s44 offen offset:3072 lds
    s_add_u32 s43, s32, 65536
    s_mov_b32 m0, s43
    s_add_u32 s44, s37, 1048576
    buffer_load_dwordx4 v36, s[20:23], s44 offen offset:0 lds
    buffer_load_dwordx4 v37, s[20:23], s44 offen offset:1024 lds
    buffer_load_dwordx4 v38, s[20:23], s44 offen offset:2048 lds
    buffer_load_dwordx4 v39, s[20:23], s44 offen offset:3072 lds
    s_add_u32 s43, s32, 81920
    s_mov_b32 m0, s43
    s_add_u32 s44, s37, 1310720
    buffer_load_dwordx4 v36, s[20:23], s44 offen offset:0 lds
    buffer_load_dwordx4 v37, s[20:23], s44 offen offset:1024 lds
    buffer_load_dwordx4 v38, s[20:23], s44 offen offset:2048 lds
    buffer_load_dwordx4 v39, s[20:23], s44 offen offset:3072 lds
    s_mul_i32 s45, s7, 28672
    s_add_u32 s45, s45, s35
    s_add_u32 s45, s45, 128
    s_add_u32 s43, s32, 147456
    s_mov_b32 m0, s43
    s_add_u32 s44, s45, 0
    buffer_load_dwordx4 v126, s[8:11], s44 offen lds
    s_add_u32 s43, s32, 148480
    s_mov_b32 m0, s43
    s_add_u32 s44, s45, 7168
    buffer_load_dwordx4 v127, s[8:11], s44 offen lds
    s_add_u32 s43, s32, 149504
    s_mov_b32 m0, s43
    s_add_u32 s44, s45, 14336
    buffer_load_dwordx4 v126, s[8:11], s44 offen lds
    s_add_u32 s43, s32, 150528
    s_mov_b32 m0, s43
    s_add_u32 s44, s45, 21504
    buffer_load_dwordx4 v127, s[8:11], s44 offen lds
    s_waitcnt vmcnt(20)
    s_barrier
    s_add_u32 s43, s32, 98304
    s_mov_b32 m0, s43
    s_add_u32 s44, s37, 1572864
    buffer_load_dwordx4 v36, s[20:23], s44 offen offset:0 lds
    buffer_load_dwordx4 v37, s[20:23], s44 offen offset:1024 lds
    buffer_load_dwordx4 v38, s[20:23], s44 offen offset:2048 lds
    buffer_load_dwordx4 v39, s[20:23], s44 offen offset:3072 lds
    v_xor_b32 v2, 0, v124
    ds_read_b128 v[104:107], v2 offset:0
    v_xor_b32 v3, 0, v125
    v_add_u32 v3, 131072, v3
    ds_read_b128 a[0:3], v3
    ds_read_b64_tr_b16 v[40:41], v112 offset:0
    ds_read_b64_tr_b16 v[42:43], v112 offset:2048
    ds_read_b64_tr_b16 v[44:45], v113 offset:0
    ds_read_b64_tr_b16 v[46:47], v113 offset:2048
    ds_read_b64_tr_b16 v[48:49], v114 offset:0
    ds_read_b64_tr_b16 v[50:51], v114 offset:2048
    ds_read_b64_tr_b16 v[52:53], v115 offset:0
    ds_read_b64_tr_b16 v[54:55], v115 offset:2048
    ds_read_b64_tr_b16 v[56:57], v112 offset:256
    ds_read_b64_tr_b16 v[58:59], v112 offset:2304
    ds_read_b64_tr_b16 v[60:61], v113 offset:256
    ds_read_b64_tr_b16 v[62:63], v113 offset:2304
    ds_read_b64_tr_b16 v[64:65], v114 offset:256
    ds_read_b64_tr_b16 v[66:67], v114 offset:2304
    ds_read_b64_tr_b16 v[68:69], v115 offset:256
    ds_read_b64_tr_b16 v[70:71], v115 offset:2304
    s_waitcnt lgkmcnt(12)
    v_mfma_f32_32x32x16_bf16 v[128:143], v[40:43], a[0:3], 0
    ds_read_b64_tr_b16 v[40:41], v120 offset:0
    ds_read_b64_tr_b16 v[42:43], v120 offset:2048
    v_mfma_f32_32x32x16_bf16 v[144:159], v[44:47], a[0:3], 0
    ds_read_b64_tr_b16 v[44:45], v121 offset:0
    ds_read_b64_tr_b16 v[46:47], v121 offset:2048
    s_waitcnt lgkmcnt(12)
    v_mfma_f32_32x32x16_bf16 v[160:175], v[48:51], a[0:3], 0
    v_xor_b32 v2, 32, v124
    ds_read_b128 v[108:111], v2 offset:0
    v_xor_b32 v3, 32, v125
    v_add_u32 v3, 131072, v3
    ds_read_b128 a[4:7], v3
    ds_read_b64_tr_b16 v[48:49], v112 offset:8192
    ds_read_b64_tr_b16 v[50:51], v112 offset:10240
    v_mfma_f32_32x32x16_bf16 v[176:191], v[52:55], a[0:3], 0
    ds_read_b64_tr_b16 v[52:53], v113 offset:8192
    ds_read_b64_tr_b16 v[54:55], v113 offset:10240
    s_waitcnt lgkmcnt(14)
    v_mfma_f32_32x32x16_bf16 v[192:207], v[56:59], a[0:3], 0
    ds_read_b64_tr_b16 v[56:57], v114 offset:8192
    ds_read_b64_tr_b16 v[58:59], v114 offset:10240
    v_mfma_f32_32x32x16_bf16 v[208:223], v[60:63], a[0:3], 0
    ds_read_b64_tr_b16 v[60:61], v115 offset:8192
    ds_read_b64_tr_b16 v[62:63], v115 offset:10240
    s_waitcnt lgkmcnt(14)
    v_mfma_f32_32x32x16_bf16 v[224:239], v[64:67], a[0:3], 0
    ds_read_b64_tr_b16 v[64:65], v112 offset:8448
    ds_read_b64_tr_b16 v[66:67], v112 offset:10496
    v_mfma_f32_32x32x16_bf16 v[240:255], v[68:71], a[0:3], 0
    ds_read_b64_tr_b16 v[68:69], v113 offset:8448
    ds_read_b64_tr_b16 v[70:71], v113 offset:10496
    s_waitcnt lgkmcnt(14)
    v_mfma_f32_32x32x16_bf16 v[72:87], v[40:43], v[104:107], 0
    ds_read_b64_tr_b16 v[40:41], v114 offset:8448
    ds_read_b64_tr_b16 v[42:43], v114 offset:10496
    v_mfma_f32_32x32x16_bf16 v[88:103], v[44:47], v[104:107], 0
    ds_read_b64_tr_b16 v[44:45], v115 offset:8448
    ds_read_b64_tr_b16 v[46:47], v115 offset:10496
    s_waitcnt lgkmcnt(12)
    v_mfma_f32_32x32x16_bf16 v[128:143], v[48:51], a[4:7], v[128:143]
    ds_read_b64_tr_b16 v[48:49], v120 offset:8192
    ds_read_b64_tr_b16 v[50:51], v120 offset:10240
    v_mfma_f32_32x32x16_bf16 v[144:159], v[52:55], a[4:7], v[144:159]
    ds_read_b64_tr_b16 v[52:53], v121 offset:8192
    ds_read_b64_tr_b16 v[54:55], v121 offset:10240
    s_waitcnt lgkmcnt(12)
    v_mfma_f32_32x32x16_bf16 v[160:175], v[56:59], a[4:7], v[160:175]
    v_xor_b32 v2, 64, v124
    ds_read_b128 v[104:107], v2 offset:0
    v_xor_b32 v3, 64, v125
    v_add_u32 v3, 131072, v3
    ds_read_b128 a[0:3], v3
    ds_read_b64_tr_b16 v[56:57], v112 offset:16384
    ds_read_b64_tr_b16 v[58:59], v112 offset:18432
    v_mfma_f32_32x32x16_bf16 v[176:191], v[60:63], a[4:7], v[176:191]
    ds_read_b64_tr_b16 v[60:61], v113 offset:16384
    ds_read_b64_tr_b16 v[62:63], v113 offset:18432
    s_waitcnt lgkmcnt(14)
    v_mfma_f32_32x32x16_bf16 v[192:207], v[64:67], a[4:7], v[192:207]
    ds_read_b64_tr_b16 v[64:65], v114 offset:16384
    ds_read_b64_tr_b16 v[66:67], v114 offset:18432
    v_mfma_f32_32x32x16_bf16 v[208:223], v[68:71], a[4:7], v[208:223]
    ds_read_b64_tr_b16 v[68:69], v115 offset:16384
    ds_read_b64_tr_b16 v[70:71], v115 offset:18432
    s_waitcnt lgkmcnt(14)
    v_mfma_f32_32x32x16_bf16 v[224:239], v[40:43], a[4:7], v[224:239]
    ds_read_b64_tr_b16 v[40:41], v112 offset:16640
    ds_read_b64_tr_b16 v[42:43], v112 offset:18688
    v_mfma_f32_32x32x16_bf16 v[240:255], v[44:47], a[4:7], v[240:255]
    ds_read_b64_tr_b16 v[44:45], v113 offset:16640
    ds_read_b64_tr_b16 v[46:47], v113 offset:18688
    s_waitcnt lgkmcnt(14)
    v_mfma_f32_32x32x16_bf16 v[72:87], v[48:51], v[108:111], v[72:87]
    ds_read_b64_tr_b16 v[48:49], v114 offset:16640
    ds_read_b64_tr_b16 v[50:51], v114 offset:18688
    v_mfma_f32_32x32x16_bf16 v[88:103], v[52:55], v[108:111], v[88:103]
    ds_read_b64_tr_b16 v[52:53], v115 offset:16640
    ds_read_b64_tr_b16 v[54:55], v115 offset:18688
    s_waitcnt vmcnt(4)
    s_barrier
    s_add_u32 s43, s32, 0
    s_mov_b32 m0, s43
    s_add_u32 s44, s37, 1835008
    buffer_load_dwordx4 v36, s[20:23], s44 offen offset:0 lds
    buffer_load_dwordx4 v37, s[20:23], s44 offen offset:1024 lds
    buffer_load_dwordx4 v38, s[20:23], s44 offen offset:2048 lds
    buffer_load_dwordx4 v39, s[20:23], s44 offen offset:3072 lds
    s_waitcnt lgkmcnt(12)
    v_mfma_f32_32x32x16_bf16 v[128:143], v[56:59], a[0:3], v[128:143]
    ds_read_b64_tr_b16 v[56:57], v120 offset:16384
    ds_read_b64_tr_b16 v[58:59], v120 offset:18432
    v_mfma_f32_32x32x16_bf16 v[144:159], v[60:63], a[0:3], v[144:159]
    ds_read_b64_tr_b16 v[60:61], v121 offset:16384
    ds_read_b64_tr_b16 v[62:63], v121 offset:18432
    s_waitcnt lgkmcnt(12)
    v_mfma_f32_32x32x16_bf16 v[160:175], v[64:67], a[0:3], v[160:175]
    v_xor_b32 v2, 96, v124
    ds_read_b128 v[108:111], v2 offset:0
    v_xor_b32 v3, 96, v125
    v_add_u32 v3, 131072, v3
    ds_read_b128 a[4:7], v3
    ds_read_b64_tr_b16 v[64:65], v112 offset:24576
    ds_read_b64_tr_b16 v[66:67], v112 offset:26624
    v_mfma_f32_32x32x16_bf16 v[176:191], v[68:71], a[0:3], v[176:191]
    ds_read_b64_tr_b16 v[68:69], v113 offset:24576
    ds_read_b64_tr_b16 v[70:71], v113 offset:26624
    s_waitcnt lgkmcnt(14)
    v_mfma_f32_32x32x16_bf16 v[192:207], v[40:43], a[0:3], v[192:207]
    ds_read_b64_tr_b16 v[40:41], v114 offset:24576
    ds_read_b64_tr_b16 v[42:43], v114 offset:26624
    v_mfma_f32_32x32x16_bf16 v[208:223], v[44:47], a[0:3], v[208:223]
    ds_read_b64_tr_b16 v[44:45], v115 offset:24576
    ds_read_b64_tr_b16 v[46:47], v115 offset:26624
    s_waitcnt lgkmcnt(14)
    v_mfma_f32_32x32x16_bf16 v[224:239], v[48:51], a[0:3], v[224:239]
    ds_read_b64_tr_b16 v[48:49], v112 offset:24832
    ds_read_b64_tr_b16 v[50:51], v112 offset:26880
    v_mfma_f32_32x32x16_bf16 v[240:255], v[52:55], a[0:3], v[240:255]
    ds_read_b64_tr_b16 v[52:53], v113 offset:24832
    ds_read_b64_tr_b16 v[54:55], v113 offset:26880
    s_waitcnt lgkmcnt(14)
    v_mfma_f32_32x32x16_bf16 v[72:87], v[56:59], v[104:107], v[72:87]
    ds_read_b64_tr_b16 v[56:57], v114 offset:24832
    ds_read_b64_tr_b16 v[58:59], v114 offset:26880
    v_mfma_f32_32x32x16_bf16 v[88:103], v[60:63], v[104:107], v[88:103]
    ds_read_b64_tr_b16 v[60:61], v115 offset:24832
    ds_read_b64_tr_b16 v[62:63], v115 offset:26880
    s_waitcnt lgkmcnt(12)
    v_mfma_f32_32x32x16_bf16 v[128:143], v[64:67], a[4:7], v[128:143]
    ds_read_b64_tr_b16 v[64:65], v120 offset:24576
    ds_read_b64_tr_b16 v[66:67], v120 offset:26624
    v_mfma_f32_32x32x16_bf16 v[144:159], v[68:71], a[4:7], v[144:159]
    ds_read_b64_tr_b16 v[68:69], v121 offset:24576
    ds_read_b64_tr_b16 v[70:71], v121 offset:26624
    s_waitcnt lgkmcnt(12)
    v_mfma_f32_32x32x16_bf16 v[160:175], v[40:43], a[4:7], v[160:175]
    v_xor_b32 v2, 128, v124
    ds_read_b128 v[104:107], v2 offset:0
    v_xor_b32 v3, 0, v125
    v_add_u32 v3, 147456, v3
    ds_read_b128 a[0:3], v3
    ds_read_b64_tr_b16 v[40:41], v112 offset:32768
    ds_read_b64_tr_b16 v[42:43], v112 offset:34816
    v_mfma_f32_32x32x16_bf16 v[176:191], v[44:47], a[4:7], v[176:191]
    ds_read_b64_tr_b16 v[44:45], v113 offset:32768
    ds_read_b64_tr_b16 v[46:47], v113 offset:34816
    s_waitcnt lgkmcnt(14)
    v_mfma_f32_32x32x16_bf16 v[192:207], v[48:51], a[4:7], v[192:207]
    ds_read_b64_tr_b16 v[48:49], v114 offset:32768
    ds_read_b64_tr_b16 v[50:51], v114 offset:34816
    v_mfma_f32_32x32x16_bf16 v[208:223], v[52:55], a[4:7], v[208:223]
    ds_read_b64_tr_b16 v[52:53], v115 offset:32768
    ds_read_b64_tr_b16 v[54:55], v115 offset:34816
    s_waitcnt lgkmcnt(14)
    v_mfma_f32_32x32x16_bf16 v[224:239], v[56:59], a[4:7], v[224:239]
    ds_read_b64_tr_b16 v[56:57], v112 offset:33024
    ds_read_b64_tr_b16 v[58:59], v112 offset:35072
    v_mfma_f32_32x32x16_bf16 v[240:255], v[60:63], a[4:7], v[240:255]
    ds_read_b64_tr_b16 v[60:61], v113 offset:33024
    ds_read_b64_tr_b16 v[62:63], v113 offset:35072
    s_waitcnt lgkmcnt(14)
    v_mfma_f32_32x32x16_bf16 v[72:87], v[64:67], v[108:111], v[72:87]
    ds_read_b64_tr_b16 v[64:65], v114 offset:33024
    ds_read_b64_tr_b16 v[66:67], v114 offset:35072
    v_mfma_f32_32x32x16_bf16 v[88:103], v[68:71], v[108:111], v[88:103]
    ds_read_b64_tr_b16 v[68:69], v115 offset:33024
    ds_read_b64_tr_b16 v[70:71], v115 offset:35072
    s_waitcnt vmcnt(20)
    s_barrier
    s_add_u32 s43, s32, 16384
    s_mov_b32 m0, s43
    s_add_u32 s44, s37, 2097152
    buffer_load_dwordx4 v36, s[20:23], s44 offen offset:0 lds
    buffer_load_dwordx4 v37, s[20:23], s44 offen offset:1024 lds
    buffer_load_dwordx4 v38, s[20:23], s44 offen offset:2048 lds
    buffer_load_dwordx4 v39, s[20:23], s44 offen offset:3072 lds
    s_mul_i32 s45, s7, 28672
    s_add_u32 s45, s45, s35
    s_add_u32 s45, s45, 256
    s_add_u32 s43, s32, 131072
    s_mov_b32 m0, s43
    s_add_u32 s44, s45, 0
    buffer_load_dwordx4 v126, s[8:11], s44 offen lds
    s_add_u32 s43, s32, 132096
    s_mov_b32 m0, s43
    s_add_u32 s44, s45, 7168
    buffer_load_dwordx4 v127, s[8:11], s44 offen lds
    s_add_u32 s43, s32, 133120
    s_mov_b32 m0, s43
    s_add_u32 s44, s45, 14336
    buffer_load_dwordx4 v126, s[8:11], s44 offen lds
    s_add_u32 s43, s32, 134144
    s_mov_b32 m0, s43
    s_add_u32 s44, s45, 21504
    buffer_load_dwordx4 v127, s[8:11], s44 offen lds
    s_waitcnt lgkmcnt(12)
    v_mfma_f32_32x32x16_bf16 v[128:143], v[40:43], a[0:3], v[128:143]
    ds_read_b64_tr_b16 v[40:41], v120 offset:32768
    ds_read_b64_tr_b16 v[42:43], v120 offset:34816
    v_mfma_f32_32x32x16_bf16 v[144:159], v[44:47], a[0:3], v[144:159]
    ds_read_b64_tr_b16 v[44:45], v121 offset:32768
    ds_read_b64_tr_b16 v[46:47], v121 offset:34816
    s_waitcnt lgkmcnt(12)
    v_mfma_f32_32x32x16_bf16 v[160:175], v[48:51], a[0:3], v[160:175]
    v_xor_b32 v2, 160, v124
    ds_read_b128 v[108:111], v2 offset:0
    v_xor_b32 v3, 32, v125
    v_add_u32 v3, 147456, v3
    ds_read_b128 a[4:7], v3
    ds_read_b64_tr_b16 v[48:49], v112 offset:40960
    ds_read_b64_tr_b16 v[50:51], v112 offset:43008
    v_mfma_f32_32x32x16_bf16 v[176:191], v[52:55], a[0:3], v[176:191]
    ds_read_b64_tr_b16 v[52:53], v113 offset:40960
    ds_read_b64_tr_b16 v[54:55], v113 offset:43008
    s_waitcnt lgkmcnt(14)
    v_mfma_f32_32x32x16_bf16 v[192:207], v[56:59], a[0:3], v[192:207]
    ds_read_b64_tr_b16 v[56:57], v114 offset:40960
    ds_read_b64_tr_b16 v[58:59], v114 offset:43008
    v_mfma_f32_32x32x16_bf16 v[208:223], v[60:63], a[0:3], v[208:223]
    ds_read_b64_tr_b16 v[60:61], v115 offset:40960
    ds_read_b64_tr_b16 v[62:63], v115 offset:43008
    s_waitcnt lgkmcnt(14)
    v_mfma_f32_32x32x16_bf16 v[224:239], v[64:67], a[0:3], v[224:239]
    ds_read_b64_tr_b16 v[64:65], v112 offset:41216
    ds_read_b64_tr_b16 v[66:67], v112 offset:43264
    v_mfma_f32_32x32x16_bf16 v[240:255], v[68:71], a[0:3], v[240:255]
    ds_read_b64_tr_b16 v[68:69], v113 offset:41216
    ds_read_b64_tr_b16 v[70:71], v113 offset:43264
    s_waitcnt lgkmcnt(14)
    v_mfma_f32_32x32x16_bf16 v[72:87], v[40:43], v[104:107], v[72:87]
    ds_read_b64_tr_b16 v[40:41], v114 offset:41216
    ds_read_b64_tr_b16 v[42:43], v114 offset:43264
    v_mfma_f32_32x32x16_bf16 v[88:103], v[44:47], v[104:107], v[88:103]
    ds_read_b64_tr_b16 v[44:45], v115 offset:41216
    ds_read_b64_tr_b16 v[46:47], v115 offset:43264
    s_waitcnt lgkmcnt(12)
    v_mfma_f32_32x32x16_bf16 v[128:143], v[48:51], a[4:7], v[128:143]
    ds_read_b64_tr_b16 v[48:49], v120 offset:40960
    ds_read_b64_tr_b16 v[50:51], v120 offset:43008
    v_mfma_f32_32x32x16_bf16 v[144:159], v[52:55], a[4:7], v[144:159]
    ds_read_b64_tr_b16 v[52:53], v121 offset:40960
    ds_read_b64_tr_b16 v[54:55], v121 offset:43008
    s_waitcnt lgkmcnt(12)
    v_mfma_f32_32x32x16_bf16 v[160:175], v[56:59], a[4:7], v[160:175]
    v_xor_b32 v2, 192, v124
    ds_read_b128 v[104:107], v2 offset:0
    v_xor_b32 v3, 64, v125
    v_add_u32 v3, 147456, v3
    ds_read_b128 a[0:3], v3
    ds_read_b64_tr_b16 v[56:57], v112 offset:49152
    ds_read_b64_tr_b16 v[58:59], v112 offset:51200
    v_mfma_f32_32x32x16_bf16 v[176:191], v[60:63], a[4:7], v[176:191]
    ds_read_b64_tr_b16 v[60:61], v113 offset:49152
    ds_read_b64_tr_b16 v[62:63], v113 offset:51200
    s_waitcnt lgkmcnt(14)
    v_mfma_f32_32x32x16_bf16 v[192:207], v[64:67], a[4:7], v[192:207]
    ds_read_b64_tr_b16 v[64:65], v114 offset:49152
    ds_read_b64_tr_b16 v[66:67], v114 offset:51200
    v_mfma_f32_32x32x16_bf16 v[208:223], v[68:71], a[4:7], v[208:223]
    ds_read_b64_tr_b16 v[68:69], v115 offset:49152
    ds_read_b64_tr_b16 v[70:71], v115 offset:51200
    s_waitcnt lgkmcnt(14)
    v_mfma_f32_32x32x16_bf16 v[224:239], v[40:43], a[4:7], v[224:239]
    ds_read_b64_tr_b16 v[40:41], v112 offset:49408
    ds_read_b64_tr_b16 v[42:43], v112 offset:51456
    v_mfma_f32_32x32x16_bf16 v[240:255], v[44:47], a[4:7], v[240:255]
    ds_read_b64_tr_b16 v[44:45], v113 offset:49408
    ds_read_b64_tr_b16 v[46:47], v113 offset:51456
    s_waitcnt lgkmcnt(14)
    v_mfma_f32_32x32x16_bf16 v[72:87], v[48:51], v[108:111], v[72:87]
    ds_read_b64_tr_b16 v[48:49], v114 offset:49408
    ds_read_b64_tr_b16 v[50:51], v114 offset:51456
    v_mfma_f32_32x32x16_bf16 v[88:103], v[52:55], v[108:111], v[88:103]
    ds_read_b64_tr_b16 v[52:53], v115 offset:49408
    ds_read_b64_tr_b16 v[54:55], v115 offset:51456
    s_waitcnt vmcnt(0)
    s_barrier
    s_add_u32 s43, s32, 32768
    s_mov_b32 m0, s43
    s_add_u32 s44, s37, 2359296
    buffer_load_dwordx4 v36, s[20:23], s44 offen offset:0 lds
    buffer_load_dwordx4 v37, s[20:23], s44 offen offset:1024 lds
    buffer_load_dwordx4 v38, s[20:23], s44 offen offset:2048 lds
    buffer_load_dwordx4 v39, s[20:23], s44 offen offset:3072 lds
    s_waitcnt lgkmcnt(12)
    v_mfma_f32_32x32x16_bf16 v[128:143], v[56:59], a[0:3], v[128:143]
    ds_read_b64_tr_b16 v[56:57], v120 offset:49152
    ds_read_b64_tr_b16 v[58:59], v120 offset:51200
    v_mfma_f32_32x32x16_bf16 v[144:159], v[60:63], a[0:3], v[144:159]
    ds_read_b64_tr_b16 v[60:61], v121 offset:49152
    ds_read_b64_tr_b16 v[62:63], v121 offset:51200
    s_waitcnt lgkmcnt(12)
    v_mfma_f32_32x32x16_bf16 v[160:175], v[64:67], a[0:3], v[160:175]
    v_xor_b32 v2, 224, v124
    ds_read_b128 v[108:111], v2 offset:0
    v_xor_b32 v3, 96, v125
    v_add_u32 v3, 147456, v3
    ds_read_b128 a[4:7], v3
    ds_read_b64_tr_b16 v[64:65], v112 offset:57344
    ds_read_b64_tr_b16 v[66:67], v112 offset:59392
    v_mfma_f32_32x32x16_bf16 v[176:191], v[68:71], a[0:3], v[176:191]
    ds_read_b64_tr_b16 v[68:69], v113 offset:57344
    ds_read_b64_tr_b16 v[70:71], v113 offset:59392
    s_waitcnt lgkmcnt(14)
    v_mfma_f32_32x32x16_bf16 v[192:207], v[40:43], a[0:3], v[192:207]
    ds_read_b64_tr_b16 v[40:41], v114 offset:57344
    ds_read_b64_tr_b16 v[42:43], v114 offset:59392
    v_mfma_f32_32x32x16_bf16 v[208:223], v[44:47], a[0:3], v[208:223]
    ds_read_b64_tr_b16 v[44:45], v115 offset:57344
    ds_read_b64_tr_b16 v[46:47], v115 offset:59392
    s_waitcnt lgkmcnt(14)
    v_mfma_f32_32x32x16_bf16 v[224:239], v[48:51], a[0:3], v[224:239]
    ds_read_b64_tr_b16 v[48:49], v112 offset:57600
    ds_read_b64_tr_b16 v[50:51], v112 offset:59648
    v_mfma_f32_32x32x16_bf16 v[240:255], v[52:55], a[0:3], v[240:255]
    ds_read_b64_tr_b16 v[52:53], v113 offset:57600
    ds_read_b64_tr_b16 v[54:55], v113 offset:59648
    s_waitcnt lgkmcnt(14)
    v_mfma_f32_32x32x16_bf16 v[72:87], v[56:59], v[104:107], v[72:87]
    ds_read_b64_tr_b16 v[56:57], v114 offset:57600
    ds_read_b64_tr_b16 v[58:59], v114 offset:59648
    v_mfma_f32_32x32x16_bf16 v[88:103], v[60:63], v[104:107], v[88:103]
    ds_read_b64_tr_b16 v[60:61], v115 offset:57600
    ds_read_b64_tr_b16 v[62:63], v115 offset:59648
    s_waitcnt lgkmcnt(12)
    v_mfma_f32_32x32x16_bf16 v[128:143], v[64:67], a[4:7], v[128:143]
    ds_read_b64_tr_b16 v[64:65], v120 offset:57344
    ds_read_b64_tr_b16 v[66:67], v120 offset:59392
    v_mfma_f32_32x32x16_bf16 v[144:159], v[68:71], a[4:7], v[144:159]
    ds_read_b64_tr_b16 v[68:69], v121 offset:57344
    ds_read_b64_tr_b16 v[70:71], v121 offset:59392
    s_waitcnt lgkmcnt(12)
    v_mfma_f32_32x32x16_bf16 v[160:175], v[40:43], a[4:7], v[160:175]
    v_xor_b32 v2, 0, v124
    ds_read_b128 v[104:107], v2 offset:256
    v_xor_b32 v3, 0, v125
    v_add_u32 v3, 131072, v3
    ds_read_b128 a[0:3], v3
    ds_read_b64_tr_b16 v[40:41], v116 offset:0
    ds_read_b64_tr_b16 v[42:43], v116 offset:2048
    v_mfma_f32_32x32x16_bf16 v[176:191], v[44:47], a[4:7], v[176:191]
    ds_read_b64_tr_b16 v[44:45], v117 offset:0
    ds_read_b64_tr_b16 v[46:47], v117 offset:2048
    s_waitcnt lgkmcnt(14)
    v_mfma_f32_32x32x16_bf16 v[192:207], v[48:51], a[4:7], v[192:207]
    ds_read_b64_tr_b16 v[48:49], v118 offset:0
    ds_read_b64_tr_b16 v[50:51], v118 offset:2048
    v_mfma_f32_32x32x16_bf16 v[208:223], v[52:55], a[4:7], v[208:223]
    ds_read_b64_tr_b16 v[52:53], v119 offset:0
    ds_read_b64_tr_b16 v[54:55], v119 offset:2048
    s_waitcnt lgkmcnt(14)
    v_mfma_f32_32x32x16_bf16 v[224:239], v[56:59], a[4:7], v[224:239]
    ds_read_b64_tr_b16 v[56:57], v116 offset:256
    ds_read_b64_tr_b16 v[58:59], v116 offset:2304
    v_mfma_f32_32x32x16_bf16 v[240:255], v[60:63], a[4:7], v[240:255]
    ds_read_b64_tr_b16 v[60:61], v117 offset:256
    ds_read_b64_tr_b16 v[62:63], v117 offset:2304
    s_waitcnt lgkmcnt(14)
    v_mfma_f32_32x32x16_bf16 v[72:87], v[64:67], v[108:111], v[72:87]
    ds_read_b64_tr_b16 v[64:65], v118 offset:256
    ds_read_b64_tr_b16 v[66:67], v118 offset:2304
    v_mfma_f32_32x32x16_bf16 v[88:103], v[68:71], v[108:111], v[88:103]
    ds_read_b64_tr_b16 v[68:69], v119 offset:256
    ds_read_b64_tr_b16 v[70:71], v119 offset:2304
    s_waitcnt vmcnt(24)
    s_barrier
    s_add_u32 s43, s32, 49152
    s_mov_b32 m0, s43
    s_add_u32 s44, s37, 2621440
    buffer_load_dwordx4 v36, s[20:23], s44 offen offset:0 lds
    buffer_load_dwordx4 v37, s[20:23], s44 offen offset:1024 lds
    buffer_load_dwordx4 v38, s[20:23], s44 offen offset:2048 lds
    buffer_load_dwordx4 v39, s[20:23], s44 offen offset:3072 lds
    s_mul_i32 s45, s7, 28672
    s_add_u32 s45, s45, s35
    s_add_u32 s45, s45, 384
    s_add_u32 s43, s32, 147456
    s_mov_b32 m0, s43
    s_add_u32 s44, s45, 0
    buffer_load_dwordx4 v126, s[8:11], s44 offen lds
    s_add_u32 s43, s32, 148480
    s_mov_b32 m0, s43
    s_add_u32 s44, s45, 7168
    buffer_load_dwordx4 v127, s[8:11], s44 offen lds
    s_add_u32 s43, s32, 149504
    s_mov_b32 m0, s43
    s_add_u32 s44, s45, 14336
    buffer_load_dwordx4 v126, s[8:11], s44 offen lds
    s_add_u32 s43, s32, 150528
    s_mov_b32 m0, s43
    s_add_u32 s44, s45, 21504
    buffer_load_dwordx4 v127, s[8:11], s44 offen lds
    s_waitcnt lgkmcnt(12)
    v_mfma_f32_32x32x16_bf16 v[128:143], v[40:43], a[0:3], v[128:143]
    ds_read_b64_tr_b16 v[40:41], v122 offset:0
    ds_read_b64_tr_b16 v[42:43], v122 offset:2048
    v_mfma_f32_32x32x16_bf16 v[144:159], v[44:47], a[0:3], v[144:159]
    ds_read_b64_tr_b16 v[44:45], v123 offset:0
    ds_read_b64_tr_b16 v[46:47], v123 offset:2048
    s_waitcnt lgkmcnt(12)
    v_mfma_f32_32x32x16_bf16 v[160:175], v[48:51], a[0:3], v[160:175]
    v_xor_b32 v2, 32, v124
    ds_read_b128 v[108:111], v2 offset:256
    v_xor_b32 v3, 32, v125
    v_add_u32 v3, 131072, v3
    ds_read_b128 a[4:7], v3
    ds_read_b64_tr_b16 v[48:49], v116 offset:8192
    ds_read_b64_tr_b16 v[50:51], v116 offset:10240
    v_mfma_f32_32x32x16_bf16 v[176:191], v[52:55], a[0:3], v[176:191]
    ds_read_b64_tr_b16 v[52:53], v117 offset:8192
    ds_read_b64_tr_b16 v[54:55], v117 offset:10240
    s_waitcnt lgkmcnt(14)
    v_mfma_f32_32x32x16_bf16 v[192:207], v[56:59], a[0:3], v[192:207]
    ds_read_b64_tr_b16 v[56:57], v118 offset:8192
    ds_read_b64_tr_b16 v[58:59], v118 offset:10240
    v_mfma_f32_32x32x16_bf16 v[208:223], v[60:63], a[0:3], v[208:223]
    ds_read_b64_tr_b16 v[60:61], v119 offset:8192
    ds_read_b64_tr_b16 v[62:63], v119 offset:10240
    s_waitcnt lgkmcnt(14)
    v_mfma_f32_32x32x16_bf16 v[224:239], v[64:67], a[0:3], v[224:239]
    ds_read_b64_tr_b16 v[64:65], v116 offset:8448
    ds_read_b64_tr_b16 v[66:67], v116 offset:10496
    v_mfma_f32_32x32x16_bf16 v[240:255], v[68:71], a[0:3], v[240:255]
    ds_read_b64_tr_b16 v[68:69], v117 offset:8448
    ds_read_b64_tr_b16 v[70:71], v117 offset:10496
    s_waitcnt lgkmcnt(14)
    v_mfma_f32_32x32x16_bf16 v[72:87], v[40:43], v[104:107], v[72:87]
    ds_read_b64_tr_b16 v[40:41], v118 offset:8448
    ds_read_b64_tr_b16 v[42:43], v118 offset:10496
    v_mfma_f32_32x32x16_bf16 v[88:103], v[44:47], v[104:107], v[88:103]
    ds_read_b64_tr_b16 v[44:45], v119 offset:8448
    ds_read_b64_tr_b16 v[46:47], v119 offset:10496
    s_waitcnt lgkmcnt(12)
    v_mfma_f32_32x32x16_bf16 v[128:143], v[48:51], a[4:7], v[128:143]
    ds_read_b64_tr_b16 v[48:49], v122 offset:8192
    ds_read_b64_tr_b16 v[50:51], v122 offset:10240
    v_mfma_f32_32x32x16_bf16 v[144:159], v[52:55], a[4:7], v[144:159]
    ds_read_b64_tr_b16 v[52:53], v123 offset:8192
    ds_read_b64_tr_b16 v[54:55], v123 offset:10240
    s_waitcnt lgkmcnt(12)
    v_mfma_f32_32x32x16_bf16 v[160:175], v[56:59], a[4:7], v[160:175]
    v_xor_b32 v2, 64, v124
    ds_read_b128 v[104:107], v2 offset:256
    v_xor_b32 v3, 64, v125
    v_add_u32 v3, 131072, v3
    ds_read_b128 a[0:3], v3
    ds_read_b64_tr_b16 v[56:57], v116 offset:16384
    ds_read_b64_tr_b16 v[58:59], v116 offset:18432
    v_mfma_f32_32x32x16_bf16 v[176:191], v[60:63], a[4:7], v[176:191]
    ds_read_b64_tr_b16 v[60:61], v117 offset:16384
    ds_read_b64_tr_b16 v[62:63], v117 offset:18432
    s_waitcnt lgkmcnt(14)
    v_mfma_f32_32x32x16_bf16 v[192:207], v[64:67], a[4:7], v[192:207]
    ds_read_b64_tr_b16 v[64:65], v118 offset:16384
    ds_read_b64_tr_b16 v[66:67], v118 offset:18432
    v_mfma_f32_32x32x16_bf16 v[208:223], v[68:71], a[4:7], v[208:223]
    ds_read_b64_tr_b16 v[68:69], v119 offset:16384
    ds_read_b64_tr_b16 v[70:71], v119 offset:18432
    s_waitcnt lgkmcnt(14)
    v_mfma_f32_32x32x16_bf16 v[224:239], v[40:43], a[4:7], v[224:239]
    ds_read_b64_tr_b16 v[40:41], v116 offset:16640
    ds_read_b64_tr_b16 v[42:43], v116 offset:18688
    v_mfma_f32_32x32x16_bf16 v[240:255], v[44:47], a[4:7], v[240:255]
    ds_read_b64_tr_b16 v[44:45], v117 offset:16640
    ds_read_b64_tr_b16 v[46:47], v117 offset:18688
    s_waitcnt lgkmcnt(14)
    v_mfma_f32_32x32x16_bf16 v[72:87], v[48:51], v[108:111], v[72:87]
    ds_read_b64_tr_b16 v[48:49], v118 offset:16640
    ds_read_b64_tr_b16 v[50:51], v118 offset:18688
    v_mfma_f32_32x32x16_bf16 v[88:103], v[52:55], v[108:111], v[88:103]
    ds_read_b64_tr_b16 v[52:53], v119 offset:16640
    ds_read_b64_tr_b16 v[54:55], v119 offset:18688
    s_waitcnt vmcnt(0)
    s_barrier
    s_add_u32 s43, s32, 65536
    s_mov_b32 m0, s43
    s_add_u32 s44, s37, 2883584
    buffer_load_dwordx4 v36, s[20:23], s44 offen offset:0 lds
    buffer_load_dwordx4 v37, s[20:23], s44 offen offset:1024 lds
    buffer_load_dwordx4 v38, s[20:23], s44 offen offset:2048 lds
    buffer_load_dwordx4 v39, s[20:23], s44 offen offset:3072 lds
    s_waitcnt lgkmcnt(12)
    v_mfma_f32_32x32x16_bf16 v[128:143], v[56:59], a[0:3], v[128:143]
    ds_read_b64_tr_b16 v[56:57], v122 offset:16384
    ds_read_b64_tr_b16 v[58:59], v122 offset:18432
    v_mfma_f32_32x32x16_bf16 v[144:159], v[60:63], a[0:3], v[144:159]
    ds_read_b64_tr_b16 v[60:61], v123 offset:16384
    ds_read_b64_tr_b16 v[62:63], v123 offset:18432
    s_waitcnt lgkmcnt(12)
    v_mfma_f32_32x32x16_bf16 v[160:175], v[64:67], a[0:3], v[160:175]
    v_xor_b32 v2, 96, v124
    ds_read_b128 v[108:111], v2 offset:256
    v_xor_b32 v3, 96, v125
    v_add_u32 v3, 131072, v3
    ds_read_b128 a[4:7], v3
    ds_read_b64_tr_b16 v[64:65], v116 offset:24576
    ds_read_b64_tr_b16 v[66:67], v116 offset:26624
    v_mfma_f32_32x32x16_bf16 v[176:191], v[68:71], a[0:3], v[176:191]
    ds_read_b64_tr_b16 v[68:69], v117 offset:24576
    ds_read_b64_tr_b16 v[70:71], v117 offset:26624
    s_waitcnt lgkmcnt(14)
    v_mfma_f32_32x32x16_bf16 v[192:207], v[40:43], a[0:3], v[192:207]
    ds_read_b64_tr_b16 v[40:41], v118 offset:24576
    ds_read_b64_tr_b16 v[42:43], v118 offset:26624
    v_mfma_f32_32x32x16_bf16 v[208:223], v[44:47], a[0:3], v[208:223]
    ds_read_b64_tr_b16 v[44:45], v119 offset:24576
    ds_read_b64_tr_b16 v[46:47], v119 offset:26624
    s_waitcnt lgkmcnt(14)
    v_mfma_f32_32x32x16_bf16 v[224:239], v[48:51], a[0:3], v[224:239]
    ds_read_b64_tr_b16 v[48:49], v116 offset:24832
    ds_read_b64_tr_b16 v[50:51], v116 offset:26880
    v_mfma_f32_32x32x16_bf16 v[240:255], v[52:55], a[0:3], v[240:255]
    ds_read_b64_tr_b16 v[52:53], v117 offset:24832
    ds_read_b64_tr_b16 v[54:55], v117 offset:26880
    s_waitcnt lgkmcnt(14)
    v_mfma_f32_32x32x16_bf16 v[72:87], v[56:59], v[104:107], v[72:87]
    ds_read_b64_tr_b16 v[56:57], v118 offset:24832
    ds_read_b64_tr_b16 v[58:59], v118 offset:26880
    v_mfma_f32_32x32x16_bf16 v[88:103], v[60:63], v[104:107], v[88:103]
    ds_read_b64_tr_b16 v[60:61], v119 offset:24832
    ds_read_b64_tr_b16 v[62:63], v119 offset:26880
    s_waitcnt lgkmcnt(12)
    v_mfma_f32_32x32x16_bf16 v[128:143], v[64:67], a[4:7], v[128:143]
    ds_read_b64_tr_b16 v[64:65], v122 offset:24576
    ds_read_b64_tr_b16 v[66:67], v122 offset:26624
    v_mfma_f32_32x32x16_bf16 v[144:159], v[68:71], a[4:7], v[144:159]
    ds_read_b64_tr_b16 v[68:69], v123 offset:24576
    ds_read_b64_tr_b16 v[70:71], v123 offset:26624
    s_waitcnt lgkmcnt(12)
    v_mfma_f32_32x32x16_bf16 v[160:175], v[40:43], a[4:7], v[160:175]
    v_xor_b32 v2, 128, v124
    ds_read_b128 v[104:107], v2 offset:256
    v_xor_b32 v3, 0, v125
    v_add_u32 v3, 147456, v3
    ds_read_b128 a[0:3], v3
    ds_read_b64_tr_b16 v[40:41], v116 offset:32768
    ds_read_b64_tr_b16 v[42:43], v116 offset:34816
    v_mfma_f32_32x32x16_bf16 v[176:191], v[44:47], a[4:7], v[176:191]
    ds_read_b64_tr_b16 v[44:45], v117 offset:32768
    ds_read_b64_tr_b16 v[46:47], v117 offset:34816
    s_waitcnt lgkmcnt(14)
    v_mfma_f32_32x32x16_bf16 v[192:207], v[48:51], a[4:7], v[192:207]
    ds_read_b64_tr_b16 v[48:49], v118 offset:32768
    ds_read_b64_tr_b16 v[50:51], v118 offset:34816
    v_mfma_f32_32x32x16_bf16 v[208:223], v[52:55], a[4:7], v[208:223]
    ds_read_b64_tr_b16 v[52:53], v119 offset:32768
    ds_read_b64_tr_b16 v[54:55], v119 offset:34816
    s_waitcnt lgkmcnt(14)
    v_mfma_f32_32x32x16_bf16 v[224:239], v[56:59], a[4:7], v[224:239]
    ds_read_b64_tr_b16 v[56:57], v116 offset:33024
    ds_read_b64_tr_b16 v[58:59], v116 offset:35072
    v_mfma_f32_32x32x16_bf16 v[240:255], v[60:63], a[4:7], v[240:255]
    ds_read_b64_tr_b16 v[60:61], v117 offset:33024
    ds_read_b64_tr_b16 v[62:63], v117 offset:35072
    s_waitcnt lgkmcnt(14)
    v_mfma_f32_32x32x16_bf16 v[72:87], v[64:67], v[108:111], v[72:87]
    ds_read_b64_tr_b16 v[64:65], v118 offset:33024
    ds_read_b64_tr_b16 v[66:67], v118 offset:35072
    v_mfma_f32_32x32x16_bf16 v[88:103], v[68:71], v[108:111], v[88:103]
    ds_read_b64_tr_b16 v[68:69], v119 offset:33024
    ds_read_b64_tr_b16 v[70:71], v119 offset:35072
    s_waitcnt vmcnt(24)
    s_barrier
    s_add_u32 s43, s32, 81920
    s_mov_b32 m0, s43
    s_add_u32 s44, s37, 3145728
    buffer_load_dwordx4 v36, s[20:23], s44 offen offset:0 lds
    buffer_load_dwordx4 v37, s[20:23], s44 offen offset:1024 lds
    buffer_load_dwordx4 v38, s[20:23], s44 offen offset:2048 lds
    buffer_load_dwordx4 v39, s[20:23], s44 offen offset:3072 lds
    s_mul_i32 s45, s7, 28672
    s_add_u32 s45, s45, s35
    s_add_u32 s45, s45, 512
    s_add_u32 s43, s32, 131072
    s_mov_b32 m0, s43
    s_add_u32 s44, s45, 0
    buffer_load_dwordx4 v126, s[8:11], s44 offen lds
    s_add_u32 s43, s32, 132096
    s_mov_b32 m0, s43
    s_add_u32 s44, s45, 7168
    buffer_load_dwordx4 v127, s[8:11], s44 offen lds
    s_add_u32 s43, s32, 133120
    s_mov_b32 m0, s43
    s_add_u32 s44, s45, 14336
    buffer_load_dwordx4 v126, s[8:11], s44 offen lds
    s_add_u32 s43, s32, 134144
    s_mov_b32 m0, s43
    s_add_u32 s44, s45, 21504
    buffer_load_dwordx4 v127, s[8:11], s44 offen lds
    s_waitcnt lgkmcnt(12)
    v_mfma_f32_32x32x16_bf16 v[128:143], v[40:43], a[0:3], v[128:143]
    ds_read_b64_tr_b16 v[40:41], v122 offset:32768
    ds_read_b64_tr_b16 v[42:43], v122 offset:34816
    v_mfma_f32_32x32x16_bf16 v[144:159], v[44:47], a[0:3], v[144:159]
    ds_read_b64_tr_b16 v[44:45], v123 offset:32768
    ds_read_b64_tr_b16 v[46:47], v123 offset:34816
    s_waitcnt lgkmcnt(12)
    v_mfma_f32_32x32x16_bf16 v[160:175], v[48:51], a[0:3], v[160:175]
    v_xor_b32 v2, 160, v124
    ds_read_b128 v[108:111], v2 offset:256
    v_xor_b32 v3, 32, v125
    v_add_u32 v3, 147456, v3
    ds_read_b128 a[4:7], v3
    ds_read_b64_tr_b16 v[48:49], v116 offset:40960
    ds_read_b64_tr_b16 v[50:51], v116 offset:43008
    v_mfma_f32_32x32x16_bf16 v[176:191], v[52:55], a[0:3], v[176:191]
    ds_read_b64_tr_b16 v[52:53], v117 offset:40960
    ds_read_b64_tr_b16 v[54:55], v117 offset:43008
    s_waitcnt lgkmcnt(14)
    v_mfma_f32_32x32x16_bf16 v[192:207], v[56:59], a[0:3], v[192:207]
    ds_read_b64_tr_b16 v[56:57], v118 offset:40960
    ds_read_b64_tr_b16 v[58:59], v118 offset:43008
    v_mfma_f32_32x32x16_bf16 v[208:223], v[60:63], a[0:3], v[208:223]
    ds_read_b64_tr_b16 v[60:61], v119 offset:40960
    ds_read_b64_tr_b16 v[62:63], v119 offset:43008
    s_waitcnt lgkmcnt(14)
    v_mfma_f32_32x32x16_bf16 v[224:239], v[64:67], a[0:3], v[224:239]
    ds_read_b64_tr_b16 v[64:65], v116 offset:41216
    ds_read_b64_tr_b16 v[66:67], v116 offset:43264
    v_mfma_f32_32x32x16_bf16 v[240:255], v[68:71], a[0:3], v[240:255]
    ds_read_b64_tr_b16 v[68:69], v117 offset:41216
    ds_read_b64_tr_b16 v[70:71], v117 offset:43264
    s_waitcnt lgkmcnt(14)
    v_mfma_f32_32x32x16_bf16 v[72:87], v[40:43], v[104:107], v[72:87]
    ds_read_b64_tr_b16 v[40:41], v118 offset:41216
    ds_read_b64_tr_b16 v[42:43], v118 offset:43264
    v_mfma_f32_32x32x16_bf16 v[88:103], v[44:47], v[104:107], v[88:103]
    ds_read_b64_tr_b16 v[44:45], v119 offset:41216
    ds_read_b64_tr_b16 v[46:47], v119 offset:43264
    s_waitcnt lgkmcnt(12)
    v_mfma_f32_32x32x16_bf16 v[128:143], v[48:51], a[4:7], v[128:143]
    ds_read_b64_tr_b16 v[48:49], v122 offset:40960
    ds_read_b64_tr_b16 v[50:51], v122 offset:43008
    v_mfma_f32_32x32x16_bf16 v[144:159], v[52:55], a[4:7], v[144:159]
    ds_read_b64_tr_b16 v[52:53], v123 offset:40960
    ds_read_b64_tr_b16 v[54:55], v123 offset:43008
    s_waitcnt lgkmcnt(12)
    v_mfma_f32_32x32x16_bf16 v[160:175], v[56:59], a[4:7], v[160:175]
    v_xor_b32 v2, 192, v124
    ds_read_b128 v[104:107], v2 offset:256
    v_xor_b32 v3, 64, v125
    v_add_u32 v3, 147456, v3
    ds_read_b128 a[0:3], v3
    ds_read_b64_tr_b16 v[56:57], v112 offset:0
    ds_read_b64_tr_b16 v[58:59], v112 offset:2048
    v_mfma_f32_32x32x16_bf16 v[176:191], v[60:63], a[4:7], v[176:191]
    ds_read_b64_tr_b16 v[60:61], v113 offset:0
    ds_read_b64_tr_b16 v[62:63], v113 offset:2048
    s_waitcnt lgkmcnt(14)
    v_mfma_f32_32x32x16_bf16 v[192:207], v[64:67], a[4:7], v[192:207]
    ds_read_b64_tr_b16 v[64:65], v114 offset:0
    ds_read_b64_tr_b16 v[66:67], v114 offset:2048
    v_mfma_f32_32x32x16_bf16 v[208:223], v[68:71], a[4:7], v[208:223]
    ds_read_b64_tr_b16 v[68:69], v115 offset:0
    ds_read_b64_tr_b16 v[70:71], v115 offset:2048
    s_waitcnt lgkmcnt(14)
    v_mfma_f32_32x32x16_bf16 v[224:239], v[40:43], a[4:7], v[224:239]
    ds_read_b64_tr_b16 v[40:41], v112 offset:256
    ds_read_b64_tr_b16 v[42:43], v112 offset:2304
    v_mfma_f32_32x32x16_bf16 v[240:255], v[44:47], a[4:7], v[240:255]
    ds_read_b64_tr_b16 v[44:45], v113 offset:256
    ds_read_b64_tr_b16 v[46:47], v113 offset:2304
    s_waitcnt lgkmcnt(14)
    v_mfma_f32_32x32x16_bf16 v[72:87], v[48:51], v[108:111], v[72:87]
    ds_read_b64_tr_b16 v[48:49], v114 offset:256
    ds_read_b64_tr_b16 v[50:51], v114 offset:2304
    v_mfma_f32_32x32x16_bf16 v[88:103], v[52:55], v[108:111], v[88:103]
    ds_read_b64_tr_b16 v[52:53], v115 offset:256
    ds_read_b64_tr_b16 v[54:55], v115 offset:2304
    s_waitcnt vmcnt(0)
    s_barrier
    s_add_u32 s43, s32, 98304
    s_mov_b32 m0, s43
    s_add_u32 s44, s37, 3407872
    buffer_load_dwordx4 v36, s[20:23], s44 offen offset:0 lds
    buffer_load_dwordx4 v37, s[20:23], s44 offen offset:1024 lds
    buffer_load_dwordx4 v38, s[20:23], s44 offen offset:2048 lds
    buffer_load_dwordx4 v39, s[20:23], s44 offen offset:3072 lds
    s_waitcnt lgkmcnt(12)
    v_mfma_f32_32x32x16_bf16 v[128:143], v[56:59], a[0:3], v[128:143]
    ds_read_b64_tr_b16 v[56:57], v120 offset:0
    ds_read_b64_tr_b16 v[58:59], v120 offset:2048
    v_mfma_f32_32x32x16_bf16 v[144:159], v[60:63], a[0:3], v[144:159]
    ds_read_b64_tr_b16 v[60:61], v121 offset:0
    ds_read_b64_tr_b16 v[62:63], v121 offset:2048
    s_waitcnt lgkmcnt(12)
    v_mfma_f32_32x32x16_bf16 v[160:175], v[64:67], a[0:3], v[160:175]
    v_xor_b32 v2, 224, v124
    ds_read_b128 v[108:111], v2 offset:256
    v_xor_b32 v3, 96, v125
    v_add_u32 v3, 147456, v3
    ds_read_b128 a[4:7], v3
    ds_read_b64_tr_b16 v[64:65], v112 offset:8192
    ds_read_b64_tr_b16 v[66:67], v112 offset:10240
    v_mfma_f32_32x32x16_bf16 v[176:191], v[68:71], a[0:3], v[176:191]
    ds_read_b64_tr_b16 v[68:69], v113 offset:8192
    ds_read_b64_tr_b16 v[70:71], v113 offset:10240
    s_waitcnt lgkmcnt(14)
    v_mfma_f32_32x32x16_bf16 v[192:207], v[40:43], a[0:3], v[192:207]
    ds_read_b64_tr_b16 v[40:41], v114 offset:8192
    ds_read_b64_tr_b16 v[42:43], v114 offset:10240
    v_mfma_f32_32x32x16_bf16 v[208:223], v[44:47], a[0:3], v[208:223]
    ds_read_b64_tr_b16 v[44:45], v115 offset:8192
    ds_read_b64_tr_b16 v[46:47], v115 offset:10240
    s_waitcnt lgkmcnt(14)
    v_mfma_f32_32x32x16_bf16 v[224:239], v[48:51], a[0:3], v[224:239]
    ds_read_b64_tr_b16 v[48:49], v112 offset:8448
    ds_read_b64_tr_b16 v[50:51], v112 offset:10496
    v_mfma_f32_32x32x16_bf16 v[240:255], v[52:55], a[0:3], v[240:255]
    ds_read_b64_tr_b16 v[52:53], v113 offset:8448
    ds_read_b64_tr_b16 v[54:55], v113 offset:10496
    s_waitcnt lgkmcnt(14)
    v_mfma_f32_32x32x16_bf16 v[72:87], v[56:59], v[104:107], v[72:87]
    ds_read_b64_tr_b16 v[56:57], v114 offset:8448
    ds_read_b64_tr_b16 v[58:59], v114 offset:10496
    v_mfma_f32_32x32x16_bf16 v[88:103], v[60:63], v[104:107], v[88:103]
    ds_read_b64_tr_b16 v[60:61], v115 offset:8448
    ds_read_b64_tr_b16 v[62:63], v115 offset:10496
    s_waitcnt lgkmcnt(12)
    v_mfma_f32_32x32x16_bf16 v[128:143], v[64:67], a[4:7], v[128:143]
    ds_read_b64_tr_b16 v[64:65], v120 offset:8192
    ds_read_b64_tr_b16 v[66:67], v120 offset:10240
    v_mfma_f32_32x32x16_bf16 v[144:159], v[68:71], a[4:7], v[144:159]
    ds_read_b64_tr_b16 v[68:69], v121 offset:8192
    ds_read_b64_tr_b16 v[70:71], v121 offset:10240
    s_waitcnt lgkmcnt(12)
    v_mfma_f32_32x32x16_bf16 v[160:175], v[40:43], a[4:7], v[160:175]
    v_xor_b32 v2, 0, v124
    ds_read_b128 v[104:107], v2 offset:512
    v_xor_b32 v3, 0, v125
    v_add_u32 v3, 131072, v3
    ds_read_b128 a[0:3], v3
    ds_read_b64_tr_b16 v[40:41], v112 offset:16384
    ds_read_b64_tr_b16 v[42:43], v112 offset:18432
    v_mfma_f32_32x32x16_bf16 v[176:191], v[44:47], a[4:7], v[176:191]
    ds_read_b64_tr_b16 v[44:45], v113 offset:16384
    ds_read_b64_tr_b16 v[46:47], v113 offset:18432
    s_waitcnt lgkmcnt(14)
    v_mfma_f32_32x32x16_bf16 v[192:207], v[48:51], a[4:7], v[192:207]
    ds_read_b64_tr_b16 v[48:49], v114 offset:16384
    ds_read_b64_tr_b16 v[50:51], v114 offset:18432
    v_mfma_f32_32x32x16_bf16 v[208:223], v[52:55], a[4:7], v[208:223]
    ds_read_b64_tr_b16 v[52:53], v115 offset:16384
    ds_read_b64_tr_b16 v[54:55], v115 offset:18432
    s_waitcnt lgkmcnt(14)
    v_mfma_f32_32x32x16_bf16 v[224:239], v[56:59], a[4:7], v[224:239]
    ds_read_b64_tr_b16 v[56:57], v112 offset:16640
    ds_read_b64_tr_b16 v[58:59], v112 offset:18688
    v_mfma_f32_32x32x16_bf16 v[240:255], v[60:63], a[4:7], v[240:255]
    ds_read_b64_tr_b16 v[60:61], v113 offset:16640
    ds_read_b64_tr_b16 v[62:63], v113 offset:18688
    s_waitcnt lgkmcnt(14)
    v_mfma_f32_32x32x16_bf16 v[72:87], v[64:67], v[108:111], v[72:87]
    ds_read_b64_tr_b16 v[64:65], v114 offset:16640
    ds_read_b64_tr_b16 v[66:67], v114 offset:18688
    v_mfma_f32_32x32x16_bf16 v[88:103], v[68:71], v[108:111], v[88:103]
    ds_read_b64_tr_b16 v[68:69], v115 offset:16640
    ds_read_b64_tr_b16 v[70:71], v115 offset:18688
    s_waitcnt vmcnt(24)
    s_barrier
    s_add_u32 s43, s32, 0
    s_mov_b32 m0, s43
    s_add_u32 s44, s36, 0
    buffer_load_dwordx4 v22, s[12:15], s44 offen offset:0 lds
    buffer_load_dwordx4 v23, s[12:15], s44 offen offset:1024 lds
    buffer_load_dwordx4 v24, s[12:15], s44 offen offset:2048 lds
    buffer_load_dwordx4 v25, s[12:15], s44 offen offset:3072 lds
    s_mul_i32 s45, s7, 28672
    s_add_u32 s45, s45, s35
    s_add_u32 s45, s45, 640
    s_add_u32 s43, s32, 147456
    s_mov_b32 m0, s43
    s_add_u32 s44, s45, 0
    buffer_load_dwordx4 v126, s[8:11], s44 offen lds
    s_add_u32 s43, s32, 148480
    s_mov_b32 m0, s43
    s_add_u32 s44, s45, 7168
    buffer_load_dwordx4 v127, s[8:11], s44 offen lds
    s_add_u32 s43, s32, 149504
    s_mov_b32 m0, s43
    s_add_u32 s44, s45, 14336
    buffer_load_dwordx4 v126, s[8:11], s44 offen lds
    s_add_u32 s43, s32, 150528
    s_mov_b32 m0, s43
    s_add_u32 s44, s45, 21504
    buffer_load_dwordx4 v127, s[8:11], s44 offen lds
    s_waitcnt lgkmcnt(12)
    v_mfma_f32_32x32x16_bf16 v[128:143], v[40:43], a[0:3], v[128:143]
    ds_read_b64_tr_b16 v[40:41], v120 offset:16384
    ds_read_b64_tr_b16 v[42:43], v120 offset:18432
    v_mfma_f32_32x32x16_bf16 v[144:159], v[44:47], a[0:3], v[144:159]
    ds_read_b64_tr_b16 v[44:45], v121 offset:16384
    ds_read_b64_tr_b16 v[46:47], v121 offset:18432
    s_waitcnt lgkmcnt(12)
    v_mfma_f32_32x32x16_bf16 v[160:175], v[48:51], a[0:3], v[160:175]
    v_xor_b32 v2, 32, v124
    ds_read_b128 v[108:111], v2 offset:512
    v_xor_b32 v3, 32, v125
    v_add_u32 v3, 131072, v3
    ds_read_b128 a[4:7], v3
    ds_read_b64_tr_b16 v[48:49], v112 offset:24576
    ds_read_b64_tr_b16 v[50:51], v112 offset:26624
    v_mfma_f32_32x32x16_bf16 v[176:191], v[52:55], a[0:3], v[176:191]
    ds_read_b64_tr_b16 v[52:53], v113 offset:24576
    ds_read_b64_tr_b16 v[54:55], v113 offset:26624
    s_waitcnt lgkmcnt(14)
    v_mfma_f32_32x32x16_bf16 v[192:207], v[56:59], a[0:3], v[192:207]
    ds_read_b64_tr_b16 v[56:57], v114 offset:24576
    ds_read_b64_tr_b16 v[58:59], v114 offset:26624
    v_mfma_f32_32x32x16_bf16 v[208:223], v[60:63], a[0:3], v[208:223]
    ds_read_b64_tr_b16 v[60:61], v115 offset:24576
    ds_read_b64_tr_b16 v[62:63], v115 offset:26624
    s_waitcnt lgkmcnt(14)
    v_mfma_f32_32x32x16_bf16 v[224:239], v[64:67], a[0:3], v[224:239]
    ds_read_b64_tr_b16 v[64:65], v112 offset:24832
    ds_read_b64_tr_b16 v[66:67], v112 offset:26880
    v_mfma_f32_32x32x16_bf16 v[240:255], v[68:71], a[0:3], v[240:255]
    ds_read_b64_tr_b16 v[68:69], v113 offset:24832
    ds_read_b64_tr_b16 v[70:71], v113 offset:26880
    s_waitcnt lgkmcnt(14)
    v_mfma_f32_32x32x16_bf16 v[72:87], v[40:43], v[104:107], v[72:87]
    ds_read_b64_tr_b16 v[40:41], v114 offset:24832
    ds_read_b64_tr_b16 v[42:43], v114 offset:26880
    v_mfma_f32_32x32x16_bf16 v[88:103], v[44:47], v[104:107], v[88:103]
    ds_read_b64_tr_b16 v[44:45], v115 offset:24832
    ds_read_b64_tr_b16 v[46:47], v115 offset:26880
    s_waitcnt lgkmcnt(12)
    v_mfma_f32_32x32x16_bf16 v[128:143], v[48:51], a[4:7], v[128:143]
    ds_read_b64_tr_b16 v[48:49], v120 offset:24576
    ds_read_b64_tr_b16 v[50:51], v120 offset:26624
    v_mfma_f32_32x32x16_bf16 v[144:159], v[52:55], a[4:7], v[144:159]
    ds_read_b64_tr_b16 v[52:53], v121 offset:24576
    ds_read_b64_tr_b16 v[54:55], v121 offset:26624
    s_waitcnt lgkmcnt(12)
    v_mfma_f32_32x32x16_bf16 v[160:175], v[56:59], a[4:7], v[160:175]
    v_xor_b32 v2, 64, v124
    ds_read_b128 v[104:107], v2 offset:512
    v_xor_b32 v3, 64, v125
    v_add_u32 v3, 131072, v3
    ds_read_b128 a[0:3], v3
    ds_read_b64_tr_b16 v[56:57], v112 offset:32768
    ds_read_b64_tr_b16 v[58:59], v112 offset:34816
    v_mfma_f32_32x32x16_bf16 v[176:191], v[60:63], a[4:7], v[176:191]
    ds_read_b64_tr_b16 v[60:61], v113 offset:32768
    ds_read_b64_tr_b16 v[62:63], v113 offset:34816
    s_waitcnt lgkmcnt(14)
    v_mfma_f32_32x32x16_bf16 v[192:207], v[64:67], a[4:7], v[192:207]
    ds_read_b64_tr_b16 v[64:65], v114 offset:32768
    ds_read_b64_tr_b16 v[66:67], v114 offset:34816
    v_mfma_f32_32x32x16_bf16 v[208:223], v[68:71], a[4:7], v[208:223]
    ds_read_b64_tr_b16 v[68:69], v115 offset:32768
    ds_read_b64_tr_b16 v[70:71], v115 offset:34816
    s_waitcnt lgkmcnt(14)
    v_mfma_f32_32x32x16_bf16 v[224:239], v[40:43], a[4:7], v[224:239]
    ds_read_b64_tr_b16 v[40:41], v112 offset:33024
    ds_read_b64_tr_b16 v[42:43], v112 offset:35072
    v_mfma_f32_32x32x16_bf16 v[240:255], v[44:47], a[4:7], v[240:255]
    ds_read_b64_tr_b16 v[44:45], v113 offset:33024
    ds_read_b64_tr_b16 v[46:47], v113 offset:35072
    s_waitcnt lgkmcnt(14)
    v_mfma_f32_32x32x16_bf16 v[72:87], v[48:51], v[108:111], v[72:87]
    ds_read_b64_tr_b16 v[48:49], v114 offset:33024
    ds_read_b64_tr_b16 v[50:51], v114 offset:35072
    v_mfma_f32_32x32x16_bf16 v[88:103], v[52:55], v[108:111], v[88:103]
    ds_read_b64_tr_b16 v[52:53], v115 offset:33024
    ds_read_b64_tr_b16 v[54:55], v115 offset:35072
    s_waitcnt vmcnt(0)
    s_barrier
    s_add_u32 s43, s32, 16384
    s_mov_b32 m0, s43
    s_add_u32 s44, s36, 16384
    buffer_load_dwordx4 v22, s[12:15], s44 offen offset:0 lds
    buffer_load_dwordx4 v23, s[12:15], s44 offen offset:1024 lds
    buffer_load_dwordx4 v24, s[12:15], s44 offen offset:2048 lds
    buffer_load_dwordx4 v25, s[12:15], s44 offen offset:3072 lds
    s_waitcnt lgkmcnt(12)
    v_mfma_f32_32x32x16_bf16 v[128:143], v[56:59], a[0:3], v[128:143]
    ds_read_b64_tr_b16 v[56:57], v120 offset:32768
    ds_read_b64_tr_b16 v[58:59], v120 offset:34816
    v_mfma_f32_32x32x16_bf16 v[144:159], v[60:63], a[0:3], v[144:159]
    ds_read_b64_tr_b16 v[60:61], v121 offset:32768
    ds_read_b64_tr_b16 v[62:63], v121 offset:34816
    s_waitcnt lgkmcnt(12)
    v_mfma_f32_32x32x16_bf16 v[160:175], v[64:67], a[0:3], v[160:175]
    v_xor_b32 v2, 96, v124
    ds_read_b128 v[108:111], v2 offset:512
    v_xor_b32 v3, 96, v125
    v_add_u32 v3, 131072, v3
    ds_read_b128 a[4:7], v3
    ds_read_b64_tr_b16 v[64:65], v112 offset:40960
    ds_read_b64_tr_b16 v[66:67], v112 offset:43008
    v_mfma_f32_32x32x16_bf16 v[176:191], v[68:71], a[0:3], v[176:191]
    ds_read_b64_tr_b16 v[68:69], v113 offset:40960
    ds_read_b64_tr_b16 v[70:71], v113 offset:43008
    s_waitcnt lgkmcnt(14)
    v_mfma_f32_32x32x16_bf16 v[192:207], v[40:43], a[0:3], v[192:207]
    ds_read_b64_tr_b16 v[40:41], v114 offset:40960
    ds_read_b64_tr_b16 v[42:43], v114 offset:43008
    v_mfma_f32_32x32x16_bf16 v[208:223], v[44:47], a[0:3], v[208:223]
    ds_read_b64_tr_b16 v[44:45], v115 offset:40960
    ds_read_b64_tr_b16 v[46:47], v115 offset:43008
    s_waitcnt lgkmcnt(14)
    v_mfma_f32_32x32x16_bf16 v[224:239], v[48:51], a[0:3], v[224:239]
    ds_read_b64_tr_b16 v[48:49], v112 offset:41216
    ds_read_b64_tr_b16 v[50:51], v112 offset:43264
    v_mfma_f32_32x32x16_bf16 v[240:255], v[52:55], a[0:3], v[240:255]
    ds_read_b64_tr_b16 v[52:53], v113 offset:41216
    ds_read_b64_tr_b16 v[54:55], v113 offset:43264
    s_waitcnt lgkmcnt(14)
    v_mfma_f32_32x32x16_bf16 v[72:87], v[56:59], v[104:107], v[72:87]
    ds_read_b64_tr_b16 v[56:57], v114 offset:41216
    ds_read_b64_tr_b16 v[58:59], v114 offset:43264
    v_mfma_f32_32x32x16_bf16 v[88:103], v[60:63], v[104:107], v[88:103]
    ds_read_b64_tr_b16 v[60:61], v115 offset:41216
    ds_read_b64_tr_b16 v[62:63], v115 offset:43264
    s_waitcnt lgkmcnt(12)
    v_mfma_f32_32x32x16_bf16 v[128:143], v[64:67], a[4:7], v[128:143]
    ds_read_b64_tr_b16 v[64:65], v120 offset:40960
    ds_read_b64_tr_b16 v[66:67], v120 offset:43008
    v_mfma_f32_32x32x16_bf16 v[144:159], v[68:71], a[4:7], v[144:159]
    ds_read_b64_tr_b16 v[68:69], v121 offset:40960
    ds_read_b64_tr_b16 v[70:71], v121 offset:43008
    s_waitcnt lgkmcnt(12)
    v_mfma_f32_32x32x16_bf16 v[160:175], v[40:43], a[4:7], v[160:175]
    v_xor_b32 v2, 128, v124
    ds_read_b128 v[104:107], v2 offset:512
    v_xor_b32 v3, 0, v125
    v_add_u32 v3, 147456, v3
    ds_read_b128 a[0:3], v3
    ds_read_b64_tr_b16 v[40:41], v112 offset:49152
    ds_read_b64_tr_b16 v[42:43], v112 offset:51200
    v_mfma_f32_32x32x16_bf16 v[176:191], v[44:47], a[4:7], v[176:191]
    ds_read_b64_tr_b16 v[44:45], v113 offset:49152
    ds_read_b64_tr_b16 v[46:47], v113 offset:51200
    s_waitcnt lgkmcnt(14)
    v_mfma_f32_32x32x16_bf16 v[192:207], v[48:51], a[4:7], v[192:207]
    ds_read_b64_tr_b16 v[48:49], v114 offset:49152
    ds_read_b64_tr_b16 v[50:51], v114 offset:51200
    v_mfma_f32_32x32x16_bf16 v[208:223], v[52:55], a[4:7], v[208:223]
    ds_read_b64_tr_b16 v[52:53], v115 offset:49152
    ds_read_b64_tr_b16 v[54:55], v115 offset:51200
    s_waitcnt lgkmcnt(14)
    v_mfma_f32_32x32x16_bf16 v[224:239], v[56:59], a[4:7], v[224:239]
    ds_read_b64_tr_b16 v[56:57], v112 offset:49408
    ds_read_b64_tr_b16 v[58:59], v112 offset:51456
    v_mfma_f32_32x32x16_bf16 v[240:255], v[60:63], a[4:7], v[240:255]
    ds_read_b64_tr_b16 v[60:61], v113 offset:49408
    ds_read_b64_tr_b16 v[62:63], v113 offset:51456
    s_waitcnt lgkmcnt(14)
    v_mfma_f32_32x32x16_bf16 v[72:87], v[64:67], v[108:111], v[72:87]
    ds_read_b64_tr_b16 v[64:65], v114 offset:49408
    ds_read_b64_tr_b16 v[66:67], v114 offset:51456
    v_mfma_f32_32x32x16_bf16 v[88:103], v[68:71], v[108:111], v[88:103]
    ds_read_b64_tr_b16 v[68:69], v115 offset:49408
    ds_read_b64_tr_b16 v[70:71], v115 offset:51456
    s_waitcnt vmcnt(24)
    s_barrier
    s_add_u32 s43, s32, 32768
    s_mov_b32 m0, s43
    s_add_u32 s44, s36, 0
    buffer_load_dwordx4 v26, s[16:19], s44 offen offset:0 lds
    buffer_load_dwordx4 v27, s[16:19], s44 offen offset:1024 lds
    buffer_load_dwordx4 v26, s[16:19], s44 offen offset:2048 lds
    buffer_load_dwordx4 v27, s[16:19], s44 offen offset:3072 lds
    s_mul_i32 s45, s7, 28672
    s_add_u32 s45, s45, s35
    s_add_u32 s45, s45, 768
    s_add_u32 s43, s32, 131072
    s_mov_b32 m0, s43
    s_add_u32 s44, s45, 0
    buffer_load_dwordx4 v126, s[8:11], s44 offen lds
    s_add_u32 s43, s32, 132096
    s_mov_b32 m0, s43
    s_add_u32 s44, s45, 7168
    buffer_load_dwordx4 v127, s[8:11], s44 offen lds
    s_add_u32 s43, s32, 133120
    s_mov_b32 m0, s43
    s_add_u32 s44, s45, 14336
    buffer_load_dwordx4 v126, s[8:11], s44 offen lds
    s_add_u32 s43, s32, 134144
    s_mov_b32 m0, s43
    s_add_u32 s44, s45, 21504
    buffer_load_dwordx4 v127, s[8:11], s44 offen lds
    s_waitcnt lgkmcnt(12)
    v_mfma_f32_32x32x16_bf16 v[128:143], v[40:43], a[0:3], v[128:143]
    ds_read_b64_tr_b16 v[40:41], v120 offset:49152
    ds_read_b64_tr_b16 v[42:43], v120 offset:51200
    v_mfma_f32_32x32x16_bf16 v[144:159], v[44:47], a[0:3], v[144:159]
    ds_read_b64_tr_b16 v[44:45], v121 offset:49152
    ds_read_b64_tr_b16 v[46:47], v121 offset:51200
    s_waitcnt lgkmcnt(12)
    v_mfma_f32_32x32x16_bf16 v[160:175], v[48:51], a[0:3], v[160:175]
    v_xor_b32 v2, 160, v124
    ds_read_b128 v[108:111], v2 offset:512
    v_xor_b32 v3, 32, v125
    v_add_u32 v3, 147456, v3
    ds_read_b128 a[4:7], v3
    ds_read_b64_tr_b16 v[48:49], v112 offset:57344
    ds_read_b64_tr_b16 v[50:51], v112 offset:59392
    v_mfma_f32_32x32x16_bf16 v[176:191], v[52:55], a[0:3], v[176:191]
    ds_read_b64_tr_b16 v[52:53], v113 offset:57344
    ds_read_b64_tr_b16 v[54:55], v113 offset:59392
    s_waitcnt lgkmcnt(14)
    v_mfma_f32_32x32x16_bf16 v[192:207], v[56:59], a[0:3], v[192:207]
    ds_read_b64_tr_b16 v[56:57], v114 offset:57344
    ds_read_b64_tr_b16 v[58:59], v114 offset:59392
    v_mfma_f32_32x32x16_bf16 v[208:223], v[60:63], a[0:3], v[208:223]
    ds_read_b64_tr_b16 v[60:61], v115 offset:57344
    ds_read_b64_tr_b16 v[62:63], v115 offset:59392
    s_waitcnt lgkmcnt(14)
    v_mfma_f32_32x32x16_bf16 v[224:239], v[64:67], a[0:3], v[224:239]
    ds_read_b64_tr_b16 v[64:65], v112 offset:57600
    ds_read_b64_tr_b16 v[66:67], v112 offset:59648
    v_mfma_f32_32x32x16_bf16 v[240:255], v[68:71], a[0:3], v[240:255]
    ds_read_b64_tr_b16 v[68:69], v113 offset:57600
    ds_read_b64_tr_b16 v[70:71], v113 offset:59648
    s_waitcnt lgkmcnt(14)
    v_mfma_f32_32x32x16_bf16 v[72:87], v[40:43], v[104:107], v[72:87]
    ds_read_b64_tr_b16 v[40:41], v114 offset:57600
    ds_read_b64_tr_b16 v[42:43], v114 offset:59648
    v_mfma_f32_32x32x16_bf16 v[88:103], v[44:47], v[104:107], v[88:103]
    ds_read_b64_tr_b16 v[44:45], v115 offset:57600
    ds_read_b64_tr_b16 v[46:47], v115 offset:59648
    s_waitcnt lgkmcnt(12)
    v_mfma_f32_32x32x16_bf16 v[128:143], v[48:51], a[4:7], v[128:143]
    ds_read_b64_tr_b16 v[48:49], v120 offset:57344
    ds_read_b64_tr_b16 v[50:51], v120 offset:59392
    v_mfma_f32_32x32x16_bf16 v[144:159], v[52:55], a[4:7], v[144:159]
    ds_read_b64_tr_b16 v[52:53], v121 offset:57344
    ds_read_b64_tr_b16 v[54:55], v121 offset:59392
    s_waitcnt lgkmcnt(12)
    v_mfma_f32_32x32x16_bf16 v[160:175], v[56:59], a[4:7], v[160:175]
    v_xor_b32 v2, 192, v124
    ds_read_b128 v[104:107], v2 offset:512
    v_xor_b32 v3, 64, v125
    v_add_u32 v3, 147456, v3
    ds_read_b128 a[0:3], v3
    ds_read_b64_tr_b16 v[56:57], v116 offset:0
    ds_read_b64_tr_b16 v[58:59], v116 offset:2048
    v_mfma_f32_32x32x16_bf16 v[176:191], v[60:63], a[4:7], v[176:191]
    ds_read_b64_tr_b16 v[60:61], v117 offset:0
    ds_read_b64_tr_b16 v[62:63], v117 offset:2048
    s_waitcnt lgkmcnt(14)
    v_mfma_f32_32x32x16_bf16 v[192:207], v[64:67], a[4:7], v[192:207]
    ds_read_b64_tr_b16 v[64:65], v118 offset:0
    ds_read_b64_tr_b16 v[66:67], v118 offset:2048
    v_mfma_f32_32x32x16_bf16 v[208:223], v[68:71], a[4:7], v[208:223]
    ds_read_b64_tr_b16 v[68:69], v119 offset:0
    ds_read_b64_tr_b16 v[70:71], v119 offset:2048
    s_waitcnt lgkmcnt(14)
    v_mfma_f32_32x32x16_bf16 v[224:239], v[40:43], a[4:7], v[224:239]
    ds_read_b64_tr_b16 v[40:41], v116 offset:256
    ds_read_b64_tr_b16 v[42:43], v116 offset:2304
    v_mfma_f32_32x32x16_bf16 v[240:255], v[44:47], a[4:7], v[240:255]
    ds_read_b64_tr_b16 v[44:45], v117 offset:256
    ds_read_b64_tr_b16 v[46:47], v117 offset:2304
    s_waitcnt lgkmcnt(14)
    v_mfma_f32_32x32x16_bf16 v[72:87], v[48:51], v[108:111], v[72:87]
    ds_read_b64_tr_b16 v[48:49], v118 offset:256
    ds_read_b64_tr_b16 v[50:51], v118 offset:2304
    v_mfma_f32_32x32x16_bf16 v[88:103], v[52:55], v[108:111], v[88:103]
    ds_read_b64_tr_b16 v[52:53], v119 offset:256
    ds_read_b64_tr_b16 v[54:55], v119 offset:2304
    s_waitcnt vmcnt(0)
    s_barrier
    s_add_u32 s43, s32, 49152
    s_mov_b32 m0, s43
    s_add_u32 s44, s36, 32768
    buffer_load_dwordx4 v22, s[12:15], s44 offen offset:0 lds
    buffer_load_dwordx4 v23, s[12:15], s44 offen offset:1024 lds
    buffer_load_dwordx4 v24, s[12:15], s44 offen offset:2048 lds
    buffer_load_dwordx4 v25, s[12:15], s44 offen offset:3072 lds
    s_waitcnt lgkmcnt(12)
    v_mfma_f32_32x32x16_bf16 v[128:143], v[56:59], a[0:3], v[128:143]
    ds_read_b64_tr_b16 v[56:57], v122 offset:0
    ds_read_b64_tr_b16 v[58:59], v122 offset:2048
    v_mfma_f32_32x32x16_bf16 v[144:159], v[60:63], a[0:3], v[144:159]
    ds_read_b64_tr_b16 v[60:61], v123 offset:0
    ds_read_b64_tr_b16 v[62:63], v123 offset:2048
    s_waitcnt lgkmcnt(12)
    v_mfma_f32_32x32x16_bf16 v[160:175], v[64:67], a[0:3], v[160:175]
    v_xor_b32 v2, 224, v124
    ds_read_b128 v[108:111], v2 offset:512
    v_xor_b32 v3, 96, v125
    v_add_u32 v3, 147456, v3
    ds_read_b128 a[4:7], v3
    ds_read_b64_tr_b16 v[64:65], v116 offset:8192
    ds_read_b64_tr_b16 v[66:67], v116 offset:10240
    v_mfma_f32_32x32x16_bf16 v[176:191], v[68:71], a[0:3], v[176:191]
    ds_read_b64_tr_b16 v[68:69], v117 offset:8192
    ds_read_b64_tr_b16 v[70:71], v117 offset:10240
    s_waitcnt lgkmcnt(14)
    v_mfma_f32_32x32x16_bf16 v[192:207], v[40:43], a[0:3], v[192:207]
    ds_read_b64_tr_b16 v[40:41], v118 offset:8192
    ds_read_b64_tr_b16 v[42:43], v118 offset:10240
    v_mfma_f32_32x32x16_bf16 v[208:223], v[44:47], a[0:3], v[208:223]
    ds_read_b64_tr_b16 v[44:45], v119 offset:8192
    ds_read_b64_tr_b16 v[46:47], v119 offset:10240
    s_waitcnt lgkmcnt(14)
    v_mfma_f32_32x32x16_bf16 v[224:239], v[48:51], a[0:3], v[224:239]
    ds_read_b64_tr_b16 v[48:49], v116 offset:8448
    ds_read_b64_tr_b16 v[50:51], v116 offset:10496
    v_mfma_f32_32x32x16_bf16 v[240:255], v[52:55], a[0:3], v[240:255]
    ds_read_b64_tr_b16 v[52:53], v117 offset:8448
    ds_read_b64_tr_b16 v[54:55], v117 offset:10496
    s_waitcnt lgkmcnt(14)
    v_mfma_f32_32x32x16_bf16 v[72:87], v[56:59], v[104:107], v[72:87]
    ds_read_b64_tr_b16 v[56:57], v118 offset:8448
    ds_read_b64_tr_b16 v[58:59], v118 offset:10496
    v_mfma_f32_32x32x16_bf16 v[88:103], v[60:63], v[104:107], v[88:103]
    ds_read_b64_tr_b16 v[60:61], v119 offset:8448
    ds_read_b64_tr_b16 v[62:63], v119 offset:10496
    s_waitcnt lgkmcnt(12)
    v_mfma_f32_32x32x16_bf16 v[128:143], v[64:67], a[4:7], v[128:143]
    ds_read_b64_tr_b16 v[64:65], v122 offset:8192
    ds_read_b64_tr_b16 v[66:67], v122 offset:10240
    v_mfma_f32_32x32x16_bf16 v[144:159], v[68:71], a[4:7], v[144:159]
    ds_read_b64_tr_b16 v[68:69], v123 offset:8192
    ds_read_b64_tr_b16 v[70:71], v123 offset:10240
    s_waitcnt lgkmcnt(12)
    v_mfma_f32_32x32x16_bf16 v[160:175], v[40:43], a[4:7], v[160:175]
    v_xor_b32 v2, 0, v124
    ds_read_b128 v[104:107], v2 offset:768
    v_xor_b32 v3, 0, v125
    v_add_u32 v3, 131072, v3
    ds_read_b128 a[0:3], v3
    ds_read_b64_tr_b16 v[40:41], v116 offset:16384
    ds_read_b64_tr_b16 v[42:43], v116 offset:18432
    v_mfma_f32_32x32x16_bf16 v[176:191], v[44:47], a[4:7], v[176:191]
    ds_read_b64_tr_b16 v[44:45], v117 offset:16384
    ds_read_b64_tr_b16 v[46:47], v117 offset:18432
    s_waitcnt lgkmcnt(14)
    v_mfma_f32_32x32x16_bf16 v[192:207], v[48:51], a[4:7], v[192:207]
    ds_read_b64_tr_b16 v[48:49], v118 offset:16384
    ds_read_b64_tr_b16 v[50:51], v118 offset:18432
    v_mfma_f32_32x32x16_bf16 v[208:223], v[52:55], a[4:7], v[208:223]
    ds_read_b64_tr_b16 v[52:53], v119 offset:16384
    ds_read_b64_tr_b16 v[54:55], v119 offset:18432
    s_waitcnt lgkmcnt(14)
    v_mfma_f32_32x32x16_bf16 v[224:239], v[56:59], a[4:7], v[224:239]
    ds_read_b64_tr_b16 v[56:57], v116 offset:16640
    ds_read_b64_tr_b16 v[58:59], v116 offset:18688
    v_mfma_f32_32x32x16_bf16 v[240:255], v[60:63], a[4:7], v[240:255]
    ds_read_b64_tr_b16 v[60:61], v117 offset:16640
    ds_read_b64_tr_b16 v[62:63], v117 offset:18688
    s_waitcnt lgkmcnt(14)
    v_mfma_f32_32x32x16_bf16 v[72:87], v[64:67], v[108:111], v[72:87]
    ds_read_b64_tr_b16 v[64:65], v118 offset:16640
    ds_read_b64_tr_b16 v[66:67], v118 offset:18688
    v_mfma_f32_32x32x16_bf16 v[88:103], v[68:71], v[108:111], v[88:103]
    ds_read_b64_tr_b16 v[68:69], v119 offset:16640
    ds_read_b64_tr_b16 v[70:71], v119 offset:18688
    s_waitcnt vmcnt(24)
    s_barrier
    s_add_u32 s43, s32, 65536
    s_mov_b32 m0, s43
    s_add_u32 s44, s36, 16384
    buffer_load_dwordx4 v26, s[16:19], s44 offen offset:0 lds
    buffer_load_dwordx4 v27, s[16:19], s44 offen offset:1024 lds
    buffer_load_dwordx4 v26, s[16:19], s44 offen offset:2048 lds
    buffer_load_dwordx4 v27, s[16:19], s44 offen offset:3072 lds
    s_waitcnt lgkmcnt(12)
    v_mfma_f32_32x32x16_bf16 v[128:143], v[40:43], a[0:3], v[128:143]
    ds_read_b64_tr_b16 v[40:41], v122 offset:16384
    ds_read_b64_tr_b16 v[42:43], v122 offset:18432
    v_mfma_f32_32x32x16_bf16 v[144:159], v[44:47], a[0:3], v[144:159]
    ds_read_b64_tr_b16 v[44:45], v123 offset:16384
    ds_read_b64_tr_b16 v[46:47], v123 offset:18432
    s_waitcnt lgkmcnt(12)
    v_mfma_f32_32x32x16_bf16 v[160:175], v[48:51], a[0:3], v[160:175]
    v_xor_b32 v2, 32, v124
    ds_read_b128 v[108:111], v2 offset:768
    v_xor_b32 v3, 32, v125
    v_add_u32 v3, 131072, v3
    ds_read_b128 a[4:7], v3
    ds_read_b64_tr_b16 v[48:49], v116 offset:24576
    ds_read_b64_tr_b16 v[50:51], v116 offset:26624
    v_mfma_f32_32x32x16_bf16 v[176:191], v[52:55], a[0:3], v[176:191]
    ds_read_b64_tr_b16 v[52:53], v117 offset:24576
    ds_read_b64_tr_b16 v[54:55], v117 offset:26624
    s_waitcnt lgkmcnt(14)
    v_mfma_f32_32x32x16_bf16 v[192:207], v[56:59], a[0:3], v[192:207]
    ds_read_b64_tr_b16 v[56:57], v118 offset:24576
    ds_read_b64_tr_b16 v[58:59], v118 offset:26624
    v_mfma_f32_32x32x16_bf16 v[208:223], v[60:63], a[0:3], v[208:223]
    ds_read_b64_tr_b16 v[60:61], v119 offset:24576
    ds_read_b64_tr_b16 v[62:63], v119 offset:26624
    s_waitcnt lgkmcnt(14)
    v_mfma_f32_32x32x16_bf16 v[224:239], v[64:67], a[0:3], v[224:239]
    ds_read_b64_tr_b16 v[64:65], v116 offset:24832
    ds_read_b64_tr_b16 v[66:67], v116 offset:26880
    v_mfma_f32_32x32x16_bf16 v[240:255], v[68:71], a[0:3], v[240:255]
    ds_read_b64_tr_b16 v[68:69], v117 offset:24832
    ds_read_b64_tr_b16 v[70:71], v117 offset:26880
    s_waitcnt lgkmcnt(14)
    v_mfma_f32_32x32x16_bf16 v[72:87], v[40:43], v[104:107], v[72:87]
    ds_read_b64_tr_b16 v[40:41], v118 offset:24832
    ds_read_b64_tr_b16 v[42:43], v118 offset:26880
    v_mfma_f32_32x32x16_bf16 v[88:103], v[44:47], v[104:107], v[88:103]
    ds_read_b64_tr_b16 v[44:45], v119 offset:24832
    ds_read_b64_tr_b16 v[46:47], v119 offset:26880
    s_waitcnt lgkmcnt(12)
    v_mfma_f32_32x32x16_bf16 v[128:143], v[48:51], a[4:7], v[128:143]
    ds_read_b64_tr_b16 v[48:49], v122 offset:24576
    ds_read_b64_tr_b16 v[50:51], v122 offset:26624
    v_mfma_f32_32x32x16_bf16 v[144:159], v[52:55], a[4:7], v[144:159]
    ds_read_b64_tr_b16 v[52:53], v123 offset:24576
    ds_read_b64_tr_b16 v[54:55], v123 offset:26624
    s_waitcnt lgkmcnt(12)
    v_mfma_f32_32x32x16_bf16 v[160:175], v[56:59], a[4:7], v[160:175]
    v_xor_b32 v2, 64, v124
    ds_read_b128 v[104:107], v2 offset:768
    v_xor_b32 v3, 64, v125
    v_add_u32 v3, 131072, v3
    ds_read_b128 a[0:3], v3
    ds_read_b64_tr_b16 v[56:57], v116 offset:32768
    ds_read_b64_tr_b16 v[58:59], v116 offset:34816
    v_mfma_f32_32x32x16_bf16 v[176:191], v[60:63], a[4:7], v[176:191]
    ds_read_b64_tr_b16 v[60:61], v117 offset:32768
    ds_read_b64_tr_b16 v[62:63], v117 offset:34816
    s_waitcnt lgkmcnt(14)
    v_mfma_f32_32x32x16_bf16 v[192:207], v[64:67], a[4:7], v[192:207]
    ds_read_b64_tr_b16 v[64:65], v118 offset:32768
    ds_read_b64_tr_b16 v[66:67], v118 offset:34816
    v_mfma_f32_32x32x16_bf16 v[208:223], v[68:71], a[4:7], v[208:223]
    ds_read_b64_tr_b16 v[68:69], v119 offset:32768
    ds_read_b64_tr_b16 v[70:71], v119 offset:34816
    s_waitcnt lgkmcnt(14)
    v_mfma_f32_32x32x16_bf16 v[224:239], v[40:43], a[4:7], v[224:239]
    ds_read_b64_tr_b16 v[40:41], v116 offset:33024
    ds_read_b64_tr_b16 v[42:43], v116 offset:35072
    v_mfma_f32_32x32x16_bf16 v[240:255], v[44:47], a[4:7], v[240:255]
    ds_read_b64_tr_b16 v[44:45], v117 offset:33024
    ds_read_b64_tr_b16 v[46:47], v117 offset:35072
    s_waitcnt lgkmcnt(14)
    v_mfma_f32_32x32x16_bf16 v[72:87], v[48:51], v[108:111], v[72:87]
    ds_read_b64_tr_b16 v[48:49], v118 offset:33024
    ds_read_b64_tr_b16 v[50:51], v118 offset:35072
    v_mfma_f32_32x32x16_bf16 v[88:103], v[52:55], v[108:111], v[88:103]
    ds_read_b64_tr_b16 v[52:53], v119 offset:33024
    ds_read_b64_tr_b16 v[54:55], v119 offset:35072
    s_waitcnt vmcnt(24)
    s_barrier
    s_add_u32 s43, s32, 81920
    s_mov_b32 m0, s43
    s_add_u32 s44, s36, 49152
    buffer_load_dwordx4 v22, s[12:15], s44 offen offset:0 lds
    buffer_load_dwordx4 v23, s[12:15], s44 offen offset:1024 lds
    buffer_load_dwordx4 v24, s[12:15], s44 offen offset:2048 lds
    buffer_load_dwordx4 v25, s[12:15], s44 offen offset:3072 lds
    s_waitcnt lgkmcnt(12)
    v_mfma_f32_32x32x16_bf16 v[128:143], v[56:59], a[0:3], v[128:143]
    ds_read_b64_tr_b16 v[56:57], v122 offset:32768
    ds_read_b64_tr_b16 v[58:59], v122 offset:34816
    v_mfma_f32_32x32x16_bf16 v[144:159], v[60:63], a[0:3], v[144:159]
    ds_read_b64_tr_b16 v[60:61], v123 offset:32768
    ds_read_b64_tr_b16 v[62:63], v123 offset:34816
    s_waitcnt lgkmcnt(12)
    v_mfma_f32_32x32x16_bf16 v[160:175], v[64:67], a[0:3], v[160:175]
    v_xor_b32 v2, 96, v124
    ds_read_b128 v[108:111], v2 offset:768
    v_xor_b32 v3, 96, v125
    v_add_u32 v3, 131072, v3
    ds_read_b128 a[4:7], v3
    ds_read_b64_tr_b16 v[64:65], v116 offset:40960
    ds_read_b64_tr_b16 v[66:67], v116 offset:43008
    v_mfma_f32_32x32x16_bf16 v[176:191], v[68:71], a[0:3], v[176:191]
    ds_read_b64_tr_b16 v[68:69], v117 offset:40960
    ds_read_b64_tr_b16 v[70:71], v117 offset:43008
    s_waitcnt lgkmcnt(14)
    v_mfma_f32_32x32x16_bf16 v[192:207], v[40:43], a[0:3], v[192:207]
    ds_read_b64_tr_b16 v[40:41], v118 offset:40960
    ds_read_b64_tr_b16 v[42:43], v118 offset:43008
    v_mfma_f32_32x32x16_bf16 v[208:223], v[44:47], a[0:3], v[208:223]
    ds_read_b64_tr_b16 v[44:45], v119 offset:40960
    ds_read_b64_tr_b16 v[46:47], v119 offset:43008
    s_waitcnt lgkmcnt(14)
    v_mfma_f32_32x32x16_bf16 v[224:239], v[48:51], a[0:3], v[224:239]
    ds_read_b64_tr_b16 v[48:49], v116 offset:41216
    ds_read_b64_tr_b16 v[50:51], v116 offset:43264
    v_mfma_f32_32x32x16_bf16 v[240:255], v[52:55], a[0:3], v[240:255]
    ds_read_b64_tr_b16 v[52:53], v117 offset:41216
    ds_read_b64_tr_b16 v[54:55], v117 offset:43264
    s_waitcnt lgkmcnt(14)
    v_mfma_f32_32x32x16_bf16 v[72:87], v[56:59], v[104:107], v[72:87]
    ds_read_b64_tr_b16 v[56:57], v118 offset:41216
    ds_read_b64_tr_b16 v[58:59], v118 offset:43264
    v_mfma_f32_32x32x16_bf16 v[88:103], v[60:63], v[104:107], v[88:103]
    ds_read_b64_tr_b16 v[60:61], v119 offset:41216
    ds_read_b64_tr_b16 v[62:63], v119 offset:43264
    s_waitcnt lgkmcnt(12)
    v_mfma_f32_32x32x16_bf16 v[128:143], v[64:67], a[4:7], v[128:143]
    ds_read_b64_tr_b16 v[64:65], v122 offset:40960
    ds_read_b64_tr_b16 v[66:67], v122 offset:43008
    v_mfma_f32_32x32x16_bf16 v[144:159], v[68:71], a[4:7], v[144:159]
    ds_read_b64_tr_b16 v[68:69], v123 offset:40960
    ds_read_b64_tr_b16 v[70:71], v123 offset:43008
    s_waitcnt lgkmcnt(12)
    v_mfma_f32_32x32x16_bf16 v[160:175], v[40:43], a[4:7], v[160:175]
    v_mfma_f32_32x32x16_bf16 v[176:191], v[44:47], a[4:7], v[176:191]
    s_waitcnt lgkmcnt(8)
    v_mfma_f32_32x32x16_bf16 v[192:207], v[48:51], a[4:7], v[192:207]
    v_mfma_f32_32x32x16_bf16 v[208:223], v[52:55], a[4:7], v[208:223]
    s_waitcnt lgkmcnt(4)
    v_mfma_f32_32x32x16_bf16 v[224:239], v[56:59], a[4:7], v[224:239]
    v_mfma_f32_32x32x16_bf16 v[240:255], v[60:63], a[4:7], v[240:255]
    s_waitcnt lgkmcnt(0)
    v_mfma_f32_32x32x16_bf16 v[72:87], v[64:67], v[108:111], v[72:87]
    v_mfma_f32_32x32x16_bf16 v[88:103], v[68:71], v[108:111], v[88:103]
    s_nop 15
    s_nop 7
    v_cvt_pk_bf16_f32 v128, v128, v129
    v_cvt_pk_bf16_f32 v129, v130, v131
    v_cvt_pk_bf16_f32 v130, v132, v133
    v_cvt_pk_bf16_f32 v131, v134, v135
    v_cvt_pk_bf16_f32 v132, v136, v137
    v_cvt_pk_bf16_f32 v133, v138, v139
    v_cvt_pk_bf16_f32 v134, v140, v141
    v_cvt_pk_bf16_f32 v135, v142, v143
    v_cvt_pk_bf16_f32 v136, v144, v145
    v_cvt_pk_bf16_f32 v137, v146, v147
    v_cvt_pk_bf16_f32 v138, v148, v149
    v_cvt_pk_bf16_f32 v139, v150, v151
    v_cvt_pk_bf16_f32 v140, v152, v153
    v_cvt_pk_bf16_f32 v141, v154, v155
    v_cvt_pk_bf16_f32 v142, v156, v157
    v_cvt_pk_bf16_f32 v143, v158, v159
    v_cvt_pk_bf16_f32 v144, v160, v161
    v_cvt_pk_bf16_f32 v145, v162, v163
    v_cvt_pk_bf16_f32 v146, v164, v165
    v_cvt_pk_bf16_f32 v147, v166, v167
    v_cvt_pk_bf16_f32 v148, v168, v169
    v_cvt_pk_bf16_f32 v149, v170, v171
    v_cvt_pk_bf16_f32 v150, v172, v173
    v_cvt_pk_bf16_f32 v151, v174, v175
    v_cvt_pk_bf16_f32 v152, v176, v177
    v_cvt_pk_bf16_f32 v153, v178, v179
    v_cvt_pk_bf16_f32 v154, v180, v181
    v_cvt_pk_bf16_f32 v155, v182, v183
    v_cvt_pk_bf16_f32 v156, v184, v185
    v_cvt_pk_bf16_f32 v157, v186, v187
    v_cvt_pk_bf16_f32 v158, v188, v189
    v_cvt_pk_bf16_f32 v159, v190, v191
    v_cvt_pk_bf16_f32 v160, v192, v193
    v_cvt_pk_bf16_f32 v161, v194, v195
    v_cvt_pk_bf16_f32 v162, v196, v197
    v_cvt_pk_bf16_f32 v163, v198, v199
    v_cvt_pk_bf16_f32 v164, v200, v201
    v_cvt_pk_bf16_f32 v165, v202, v203
    v_cvt_pk_bf16_f32 v166, v204, v205
    v_cvt_pk_bf16_f32 v167, v206, v207
    v_cvt_pk_bf16_f32 v168, v208, v209
    v_cvt_pk_bf16_f32 v169, v210, v211
    v_cvt_pk_bf16_f32 v170, v212, v213
    v_cvt_pk_bf16_f32 v171, v214, v215
    v_cvt_pk_bf16_f32 v172, v216, v217
    v_cvt_pk_bf16_f32 v173, v218, v219
    v_cvt_pk_bf16_f32 v174, v220, v221
    v_cvt_pk_bf16_f32 v175, v222, v223
    v_cvt_pk_bf16_f32 v176, v224, v225
    v_cvt_pk_bf16_f32 v177, v226, v227
    v_cvt_pk_bf16_f32 v178, v228, v229
    v_cvt_pk_bf16_f32 v179, v230, v231
    v_cvt_pk_bf16_f32 v180, v232, v233
    v_cvt_pk_bf16_f32 v181, v234, v235
    v_cvt_pk_bf16_f32 v182, v236, v237
    v_cvt_pk_bf16_f32 v183, v238, v239
    v_cvt_pk_bf16_f32 v184, v240, v241
    v_cvt_pk_bf16_f32 v185, v242, v243
    v_cvt_pk_bf16_f32 v186, v244, v245
    v_cvt_pk_bf16_f32 v187, v246, v247
    v_cvt_pk_bf16_f32 v188, v248, v249
    v_cvt_pk_bf16_f32 v189, v250, v251
    v_cvt_pk_bf16_f32 v190, v252, v253
    v_cvt_pk_bf16_f32 v191, v254, v255
    v_cvt_pk_bf16_f32 v72, v72, v73
    v_cvt_pk_bf16_f32 v73, v74, v75
    v_cvt_pk_bf16_f32 v74, v76, v77
    v_cvt_pk_bf16_f32 v75, v78, v79
    v_cvt_pk_bf16_f32 v76, v80, v81
    v_cvt_pk_bf16_f32 v77, v82, v83
    v_cvt_pk_bf16_f32 v78, v84, v85
    v_cvt_pk_bf16_f32 v79, v86, v87
    v_cvt_pk_bf16_f32 v80, v88, v89
    v_cvt_pk_bf16_f32 v81, v90, v91
    v_cvt_pk_bf16_f32 v82, v92, v93
    v_cvt_pk_bf16_f32 v83, v94, v95
    v_cvt_pk_bf16_f32 v84, v96, v97
    v_cvt_pk_bf16_f32 v85, v98, v99
    v_cvt_pk_bf16_f32 v86, v100, v101
    v_cvt_pk_bf16_f32 v87, v102, v103
    v_lshlrev_b32 v2, 4, v1
    v_add_u32 v2, 131072, v2
    v_add_u32 v3, s32, v2
    ds_write_b128 v3, v[72:75] offset:0
    ds_write_b128 v3, v[76:79] offset:1024
    ds_write_b128 v3, v[80:83] offset:2048
    ds_write_b128 v3, v[84:87] offset:3072
    s_waitcnt lgkmcnt(0)
    s_barrier
    ds_read_b128 v[192:195], v2 offset:0
    ds_read_b128 v[196:199], v2 offset:1024
    ds_read_b128 v[200:203], v2 offset:2048
    ds_read_b128 v[204:207], v2 offset:3072
    ds_read_b128 v[208:211], v2 offset:4096
    ds_read_b128 v[212:215], v2 offset:5120
    ds_read_b128 v[216:219], v2 offset:6144
    ds_read_b128 v[220:223], v2 offset:7168
    s_waitcnt lgkmcnt(0)
    ds_read_b128 v[224:227], v2 offset:8192
    ds_read_b128 v[228:231], v2 offset:9216
    ds_read_b128 v[232:235], v2 offset:10240
    ds_read_b128 v[236:239], v2 offset:11264
    ds_read_b128 v[240:243], v2 offset:12288
    ds_read_b128 v[244:247], v2 offset:13312
    ds_read_b128 v[248:251], v2 offset:14336
    ds_read_b128 v[252:255], v2 offset:15360
    s_waitcnt lgkmcnt(0)
    v_mov_b32 v32, 0xf149f2ca
    v_mov_b32 v34, 0xf149f2ca
    v_mov_b32 v33, 0
    v_mov_b32 v35, 0
    v_accvgpr_write_b32 a0, 0
    v_accvgpr_write_b32 a1, 0
    v_accvgpr_write_b32 a2, 0
    v_accvgpr_write_b32 a3, 0
    v_accvgpr_write_b32 a4, 0
    v_accvgpr_write_b32 a5, 0
    v_accvgpr_write_b32 a6, 0
    v_accvgpr_write_b32 a7, 0
    v_accvgpr_write_b32 a8, 0
    v_accvgpr_write_b32 a9, 0
    v_accvgpr_write_b32 a10, 0
    v_accvgpr_write_b32 a11, 0
    v_accvgpr_write_b32 a12, 0
    v_accvgpr_write_b32 a13, 0
    v_accvgpr_write_b32 a14, 0
    v_accvgpr_write_b32 a15, 0
    v_accvgpr_write_b32 a16, 0
    v_accvgpr_write_b32 a17, 0
    v_accvgpr_write_b32 a18, 0
    v_accvgpr_write_b32 a19, 0
    v_accvgpr_write_b32 a20, 0
    v_accvgpr_write_b32 a21, 0
    v_accvgpr_write_b32 a22, 0
    v_accvgpr_write_b32 a23, 0
    v_accvgpr_write_b32 a24, 0
    v_accvgpr_write_b32 a25, 0
    v_accvgpr_write_b32 a26, 0
    v_accvgpr_write_b32 a27, 0
    v_accvgpr_write_b32 a28, 0
    v_accvgpr_write_b32 a29, 0
    v_accvgpr_write_b32 a30, 0
    v_accvgpr_write_b32 a31, 0
    v_accvgpr_write_b32 a32, 0
    v_accvgpr_write_b32 a33, 0
    v_accvgpr_write_b32 a34, 0
    v_accvgpr_write_b32 a35, 0
    v_accvgpr_write_b32 a36, 0
    v_accvgpr_write_b32 a37, 0
    v_accvgpr_write_b32 a38, 0
    v_accvgpr_write_b32 a39, 0
    v_accvgpr_write_b32 a40, 0
    v_accvgpr_write_b32 a41, 0
    v_accvgpr_write_b32 a42, 0
    v_accvgpr_write_b32 a43, 0
    v_accvgpr_write_b32 a44, 0
    v_accvgpr_write_b32 a45, 0
    v_accvgpr_write_b32 a46, 0
    v_accvgpr_write_b32 a47, 0
    v_accvgpr_write_b32 a48, 0
    v_accvgpr_write_b32 a49, 0
    v_accvgpr_write_b32 a50, 0
    v_accvgpr_write_b32 a51, 0
    v_accvgpr_write_b32 a52, 0
    v_accvgpr_write_b32 a53, 0
    v_accvgpr_write_b32 a54, 0
    v_accvgpr_write_b32 a55, 0
    v_accvgpr_write_b32 a56, 0
    v_accvgpr_write_b32 a57, 0
    v_accvgpr_write_b32 a58, 0
    v_accvgpr_write_b32 a59, 0
    v_accvgpr_write_b32 a60, 0
    v_accvgpr_write_b32 a61, 0
    v_accvgpr_write_b32 a62, 0
    v_accvgpr_write_b32 a63, 0
    v_accvgpr_write_b32 a64, 0
    v_accvgpr_write_b32 a65, 0
    v_accvgpr_write_b32 a66, 0
    v_accvgpr_write_b32 a67, 0
    v_accvgpr_write_b32 a68, 0
    v_accvgpr_write_b32 a69, 0
    v_accvgpr_write_b32 a70, 0
    v_accvgpr_write_b32 a71, 0
    v_accvgpr_write_b32 a72, 0
    v_accvgpr_write_b32 a73, 0
    v_accvgpr_write_b32 a74, 0
    v_accvgpr_write_b32 a75, 0
    v_accvgpr_write_b32 a76, 0
    v_accvgpr_write_b32 a77, 0
    v_accvgpr_write_b32 a78, 0
    v_accvgpr_write_b32 a79, 0
    v_accvgpr_write_b32 a80, 0
    v_accvgpr_write_b32 a81, 0
    v_accvgpr_write_b32 a82, 0
    v_accvgpr_write_b32 a83, 0
    v_accvgpr_write_b32 a84, 0
    v_accvgpr_write_b32 a85, 0
    v_accvgpr_write_b32 a86, 0
    v_accvgpr_write_b32 a87, 0
    v_accvgpr_write_b32 a88, 0
    v_accvgpr_write_b32 a89, 0
    v_accvgpr_write_b32 a90, 0
    v_accvgpr_write_b32 a91, 0
    v_accvgpr_write_b32 a92, 0
    v_accvgpr_write_b32 a93, 0
    v_accvgpr_write_b32 a94, 0
    v_accvgpr_write_b32 a95, 0
    v_accvgpr_write_b32 a96, 0
    v_accvgpr_write_b32 a97, 0
    v_accvgpr_write_b32 a98, 0
    v_accvgpr_write_b32 a99, 0
    v_accvgpr_write_b32 a100, 0
    v_accvgpr_write_b32 a101, 0
    v_accvgpr_write_b32 a102, 0
    v_accvgpr_write_b32 a103, 0
    v_accvgpr_write_b32 a104, 0
    v_accvgpr_write_b32 a105, 0
    v_accvgpr_write_b32 a106, 0
    v_accvgpr_write_b32 a107, 0
    v_accvgpr_write_b32 a108, 0
    v_accvgpr_write_b32 a109, 0
    v_accvgpr_write_b32 a110, 0
    v_accvgpr_write_b32 a111, 0
    v_accvgpr_write_b32 a112, 0
    v_accvgpr_write_b32 a113, 0
    v_accvgpr_write_b32 a114, 0
    v_accvgpr_write_b32 a115, 0
    v_accvgpr_write_b32 a116, 0
    v_accvgpr_write_b32 a117, 0
    v_accvgpr_write_b32 a118, 0
    v_accvgpr_write_b32 a119, 0
    v_accvgpr_write_b32 a120, 0
    v_accvgpr_write_b32 a121, 0
    v_accvgpr_write_b32 a122, 0
    v_accvgpr_write_b32 a123, 0
    v_accvgpr_write_b32 a124, 0
    v_accvgpr_write_b32 a125, 0
    v_accvgpr_write_b32 a126, 0
    v_accvgpr_write_b32 a127, 0
    v_accvgpr_write_b32 a128, 0
    v_accvgpr_write_b32 a129, 0
    v_accvgpr_write_b32 a130, 0
    v_accvgpr_write_b32 a131, 0
    v_accvgpr_write_b32 a132, 0
    v_accvgpr_write_b32 a133, 0
    v_accvgpr_write_b32 a134, 0
    v_accvgpr_write_b32 a135, 0
    v_accvgpr_write_b32 a136, 0
    v_accvgpr_write_b32 a137, 0
    v_accvgpr_write_b32 a138, 0
    v_accvgpr_write_b32 a139, 0
    v_accvgpr_write_b32 a140, 0
    v_accvgpr_write_b32 a141, 0
    v_accvgpr_write_b32 a142, 0
    v_accvgpr_write_b32 a143, 0
    v_accvgpr_write_b32 a144, 0
    v_accvgpr_write_b32 a145, 0
    v_accvgpr_write_b32 a146, 0
    v_accvgpr_write_b32 a147, 0
    v_accvgpr_write_b32 a148, 0
    v_accvgpr_write_b32 a149, 0
    v_accvgpr_write_b32 a150, 0
    v_accvgpr_write_b32 a151, 0
    v_accvgpr_write_b32 a152, 0
    v_accvgpr_write_b32 a153, 0
    v_accvgpr_write_b32 a154, 0
    v_accvgpr_write_b32 a155, 0
    v_accvgpr_write_b32 a156, 0
    v_accvgpr_write_b32 a157, 0
    v_accvgpr_write_b32 a158, 0
    v_accvgpr_write_b32 a159, 0
    v_accvgpr_write_b32 a160, 0
    v_accvgpr_write_b32 a161, 0
    v_accvgpr_write_b32 a162, 0
    v_accvgpr_write_b32 a163, 0
    v_accvgpr_write_b32 a164, 0
    v_accvgpr_write_b32 a165, 0
    v_accvgpr_write_b32 a166, 0
    v_accvgpr_write_b32 a167, 0
    v_accvgpr_write_b32 a168, 0
    v_accvgpr_write_b32 a169, 0
    v_accvgpr_write_b32 a170, 0
    v_accvgpr_write_b32 a171, 0
    v_accvgpr_write_b32 a172, 0
    v_accvgpr_write_b32 a173, 0
    v_accvgpr_write_b32 a174, 0
    v_accvgpr_write_b32 a175, 0
    v_accvgpr_write_b32 a176, 0
    v_accvgpr_write_b32 a177, 0
    v_accvgpr_write_b32 a178, 0
    v_accvgpr_write_b32 a179, 0
    v_accvgpr_write_b32 a180, 0
    v_accvgpr_write_b32 a181, 0
    v_accvgpr_write_b32 a182, 0
    v_accvgpr_write_b32 a183, 0
    v_accvgpr_write_b32 a184, 0
    v_accvgpr_write_b32 a185, 0
    v_accvgpr_write_b32 a186, 0
    v_accvgpr_write_b32 a187, 0
    v_accvgpr_write_b32 a188, 0
    v_accvgpr_write_b32 a189, 0
    v_accvgpr_write_b32 a190, 0
    v_accvgpr_write_b32 a191, 0
    v_accvgpr_write_b32 a192, 0
    v_accvgpr_write_b32 a193, 0
    v_accvgpr_write_b32 a194, 0
    v_accvgpr_write_b32 a195, 0
    v_accvgpr_write_b32 a196, 0
    v_accvgpr_write_b32 a197, 0
    v_accvgpr_write_b32 a198, 0
    v_accvgpr_write_b32 a199, 0
    v_accvgpr_write_b32 a200, 0
    v_accvgpr_write_b32 a201, 0
    v_accvgpr_write_b32 a202, 0
    v_accvgpr_write_b32 a203, 0
    v_accvgpr_write_b32 a204, 0
    v_accvgpr_write_b32 a205, 0
    v_accvgpr_write_b32 a206, 0
    v_accvgpr_write_b32 a207, 0
    v_accvgpr_write_b32 a208, 0
    v_accvgpr_write_b32 a209, 0
    v_accvgpr_write_b32 a210, 0
    v_accvgpr_write_b32 a211, 0
    v_accvgpr_write_b32 a212, 0
    v_accvgpr_write_b32 a213, 0
    v_accvgpr_write_b32 a214, 0
    v_accvgpr_write_b32 a215, 0
    v_accvgpr_write_b32 a216, 0
    v_accvgpr_write_b32 a217, 0
    v_accvgpr_write_b32 a218, 0
    v_accvgpr_write_b32 a219, 0
    v_accvgpr_write_b32 a220, 0
    v_accvgpr_write_b32 a221, 0
    v_accvgpr_write_b32 a222, 0
    v_accvgpr_write_b32 a223, 0
    v_accvgpr_write_b32 a224, 0
    v_accvgpr_write_b32 a225, 0
    v_accvgpr_write_b32 a226, 0
    v_accvgpr_write_b32 a227, 0
    v_accvgpr_write_b32 a228, 0
    v_accvgpr_write_b32 a229, 0
    v_accvgpr_write_b32 a230, 0
    v_accvgpr_write_b32 a231, 0
    v_accvgpr_write_b32 a232, 0
    v_accvgpr_write_b32 a233, 0
    v_accvgpr_write_b32 a234, 0
    v_accvgpr_write_b32 a235, 0
    v_accvgpr_write_b32 a236, 0
    v_accvgpr_write_b32 a237, 0
    v_accvgpr_write_b32 a238, 0
    v_accvgpr_write_b32 a239, 0
    v_accvgpr_write_b32 a240, 0
    v_accvgpr_write_b32 a241, 0
    v_accvgpr_write_b32 a242, 0
    v_accvgpr_write_b32 a243, 0
    v_accvgpr_write_b32 a244, 0
    v_accvgpr_write_b32 a245, 0
    v_accvgpr_write_b32 a246, 0
    v_accvgpr_write_b32 a247, 0
    v_accvgpr_write_b32 a248, 0
    v_accvgpr_write_b32 a249, 0
    v_accvgpr_write_b32 a250, 0
    v_accvgpr_write_b32 a251, 0
    v_accvgpr_write_b32 a252, 0
    v_accvgpr_write_b32 a253, 0
    v_accvgpr_write_b32 a254, 0
    v_accvgpr_write_b32 a255, 0
    v_add_u32 v10, 0, v10
    v_add_u32 v11, 0, v11
    v_add_u32 v12, 0, v12
    v_add_u32 v13, 0, v13
    v_add_u32 v14, 0, v14
    v_add_u32 v15, 0, v15
    v_add_u32 v16, 0, v16
    v_add_u32 v17, 0, v17
    v_add_u32 v18, 32768, v18
    v_add_u32 v19, 32768, v19
    v_add_u32 v20, 32768, v20
    v_add_u32 v21, 32768, v21
    s_cmp_eq_u32 s7, 0
    s_cbranch_scc1 LP_1
    ds_read_b128 v[40:43], v10 offset:0
    ds_read_b128 v[44:47], v11 offset:0
    ds_read_b128 v[48:51], v12 offset:0
    ds_read_b128 v[52:55], v13 offset:0
    ds_read_b128 v[56:59], v14 offset:0
    ds_read_b128 v[60:63], v15 offset:0
    ds_read_b128 v[64:67], v16 offset:0
    ds_read_b128 v[68:71], v17 offset:0
    s_waitcnt vmcnt(20)
    s_barrier
    s_add_u32 s43, s32, 98304
    s_mov_b32 m0, s43
    s_add_u32 s44, s36, 32768
    buffer_load_dwordx4 v26, s[16:19], s44 offen offset:0 lds
    buffer_load_dwordx4 v27, s[16:19], s44 offen offset:1024 lds
    buffer_load_dwordx4 v26, s[16:19], s44 offen offset:2048 lds
    buffer_load_dwordx4 v27, s[16:19], s44 offen offset:3072 lds
    s_waitcnt lgkmcnt(6)
    v_mfma_f32_32x32x16_bf16 v[72:87], v[40:43], v[128:131], 0
    ds_read_b128 v[40:43], v10 offset:256
    v_mfma_f32_32x32x16_bf16 v[72:87], v[44:47], v[132:135], v[72:87]
    ds_read_b128 v[44:47], v11 offset:256
    s_waitcnt lgkmcnt(6)
    v_mfma_f32_32x32x16_bf16 v[72:87], v[48:51], v[136:139], v[72:87]
    ds_read_b128 v[48:51], v12 offset:256
    v_mfma_f32_32x32x16_bf16 v[72:87], v[52:55], v[140:143], v[72:87]
    ds_read_b128 v[52:55], v13 offset:256
    s_waitcnt lgkmcnt(6)
    v_mfma_f32_32x32x16_bf16 v[72:87], v[56:59], v[144:147], v[72:87]
    ds_read_b128 v[56:59], v14 offset:256
    v_mfma_f32_32x32x16_bf16 v[72:87], v[60:63], v[148:151], v[72:87]
    ds_read_b128 v[60:63], v15 offset:256
    s_waitcnt lgkmcnt(6)
    v_mfma_f32_32x32x16_bf16 v[72:87], v[64:67], v[152:155], v[72:87]
    ds_read_b128 v[64:67], v16 offset:256
    v_mfma_f32_32x32x16_bf16 v[72:87], v[68:71], v[156:159], v[72:87]
    ds_read_b128 v[68:71], v17 offset:256
    s_waitcnt lgkmcnt(6)
    v_mfma_f32_32x32x16_bf16 v[72:87], v[40:43], v[160:163], v[72:87]
    v_mfma_f32_32x32x16_bf16 v[72:87], v[44:47], v[164:167], v[72:87]
    s_waitcnt lgkmcnt(4)
    v_mfma_f32_32x32x16_bf16 v[72:87], v[48:51], v[168:171], v[72:87]
    v_mfma_f32_32x32x16_bf16 v[72:87], v[52:55], v[172:175], v[72:87]
    s_waitcnt lgkmcnt(2)
    v_mfma_f32_32x32x16_bf16 v[72:87], v[56:59], v[176:179], v[72:87]
    v_mfma_f32_32x32x16_bf16 v[72:87], v[60:63], v[180:183], v[72:87]
    s_waitcnt lgkmcnt(0)
    v_mfma_f32_32x32x16_bf16 v[72:87], v[64:67], v[184:187], v[72:87]
    v_mfma_f32_32x32x16_bf16 v[72:87], v[68:71], v[188:191], v[72:87]
    s_branch LP_2
LP_1:
    ds_read_b128 v[40:43], v10 offset:0
    ds_read_b128 v[44:47], v11 offset:0
    ds_read_b128 v[48:51], v12 offset:0
    ds_read_b128 v[52:55], v13 offset:0
    ds_read_b128 v[56:59], v14 offset:0
    ds_read_b128 v[60:63], v15 offset:0
    ds_read_b128 v[64:67], v16 offset:0
    ds_read_b128 v[68:71], v17 offset:0
    s_waitcnt vmcnt(24)
    s_barrier
    s_add_u32 s43, s32, 98304
    s_mov_b32 m0, s43
    s_add_u32 s44, s36, 32768
    buffer_load_dwordx4 v26, s[16:19], s44 offen offset:0 lds
    buffer_load_dwordx4 v27, s[16:19], s44 offen offset:1024 lds
    buffer_load_dwordx4 v26, s[16:19], s44 offen offset:2048 lds
    buffer_load_dwordx4 v27, s[16:19], s44 offen offset:3072 lds
    s_waitcnt lgkmcnt(6)
    v_mfma_f32_32x32x16_bf16 v[72:87], v[40:43], v[128:131], 0
    v_mfma_f32_32x32x16_bf16 v[104:119], v[40:43], v[192:195], 0
    ds_read_b128 v[40:43], v10 offset:256
    v_mfma_f32_32x32x16_bf16 v[72:87], v[44:47], v[132:135], v[72:87]
    v_mfma_f32_32x32x16_bf16 v[104:119], v[44:47], v[196:199], v[104:119]
    ds_read_b128 v[44:47], v11 offset:256
    s_waitcnt lgkmcnt(6)
    v_mfma_f32_32x32x16_bf16 v[72:87], v[48:51], v[136:139], v[72:87]
    v_mfma_f32_32x32x16_bf16 v[104:119], v[48:51], v[200:203], v[104:119]
    ds_read_b128 v[48:51], v12 offset:256
    v_mfma_f32_32x32x16_bf16 v[72:87], v[52:55], v[140:143], v[72:87]
    v_mfma_f32_32x32x16_bf16 v[104:119], v[52:55], v[204:207], v[104:119]
    ds_read_b128 v[52:55], v13 offset:256
    s_waitcnt lgkmcnt(6)
    v_mfma_f32_32x32x16_bf16 v[72:87], v[56:59], v[144:147], v[72:87]
    v_mfma_f32_32x32x16_bf16 v[104:119], v[56:59], v[208:211], v[104:119]
    ds_read_b128 v[56:59], v14 offset:256
    v_mfma_f32_32x32x16_bf16 v[72:87], v[60:63], v[148:151], v[72:87]
    v_mfma_f32_32x32x16_bf16 v[104:119], v[60:63], v[212:215], v[104:119]
    ds_read_b128 v[60:63], v15 offset:256
    s_waitcnt lgkmcnt(6)
    v_mfma_f32_32x32x16_bf16 v[72:87], v[64:67], v[152:155], v[72:87]
    v_mfma_f32_32x32x16_bf16 v[104:119], v[64:67], v[216:219], v[104:119]
    ds_read_b128 v[64:67], v16 offset:256
    v_mfma_f32_32x32x16_bf16 v[72:87], v[68:71], v[156:159], v[72:87]
    v_mfma_f32_32x32x16_bf16 v[104:119], v[68:71], v[220:223], v[104:119]
    ds_read_b128 v[68:71], v17 offset:256
    s_waitcnt lgkmcnt(6)
    v_mfma_f32_32x32x16_bf16 v[72:87], v[40:43], v[160:163], v[72:87]
    v_mfma_f32_32x32x16_bf16 v[104:119], v[40:43], v[224:227], v[104:119]
    v_mfma_f32_32x32x16_bf16 v[72:87], v[44:47], v[164:167], v[72:87]
    v_mfma_f32_32x32x16_bf16 v[104:119], v[44:47], v[228:231], v[104:119]
    s_waitcnt lgkmcnt(4)
    v_mfma_f32_32x32x16_bf16 v[72:87], v[48:51], v[168:171], v[72:87]
    v_mfma_f32_32x32x16_bf16 v[104:119], v[48:51], v[232:235], v[104:119]
    v_mfma_f32_32x32x16_bf16 v[72:87], v[52:55], v[172:175], v[72:87]
    v_mfma_f32_32x32x16_bf16 v[104:119], v[52:55], v[236:239], v[104:119]
    s_waitcnt lgkmcnt(2)
    v_mfma_f32_32x32x16_bf16 v[72:87], v[56:59], v[176:179], v[72:87]
    v_mfma_f32_32x32x16_bf16 v[104:119], v[56:59], v[240:243], v[104:119]
    v_mfma_f32_32x32x16_bf16 v[72:87], v[60:63], v[180:183], v[72:87]
    v_mfma_f32_32x32x16_bf16 v[104:119], v[60:63], v[244:247], v[104:119]
    s_waitcnt lgkmcnt(0)
    v_mfma_f32_32x32x16_bf16 v[72:87], v[64:67], v[184:187], v[72:87]
    v_mfma_f32_32x32x16_bf16 v[104:119], v[64:67], v[248:251], v[104:119]
    v_mfma_f32_32x32x16_bf16 v[72:87], v[68:71], v[188:191], v[72:87]
    v_mfma_f32_32x32x16_bf16 v[104:119], v[68:71], v[252:255], v[104:119]
LP_2:
    v_add_u32 v10, 16384, v10
    v_add_u32 v11, 16384, v11
    v_add_u32 v12, 16384, v12
    v_add_u32 v13, 16384, v13
    v_add_u32 v14, 16384, v14
    v_add_u32 v15, 16384, v15
    v_add_u32 v16, 16384, v16
    v_add_u32 v17, 16384, v17
    ds_read_b128 v[40:43], v10 offset:0
    ds_read_b128 v[44:47], v11 offset:0
    ds_read_b128 v[48:51], v12 offset:0
    ds_read_b128 v[52:55], v13 offset:0
    ds_read_b128 v[56:59], v14 offset:0
    ds_read_b128 v[60:63], v15 offset:0
    ds_read_b128 v[64:67], v16 offset:0
    s_mov_b32 s40, 0
    s_mov_b32 s41, 16384
    s_mov_b32 s42, 32768
    s_mov_b32 s45, 0
    s_add_u32 s48, s36, 49152
L_attn_loop:
    s_and_b32 s43, s40, 3
    s_cmp_eq_u32 s43, s7
    s_cselect_b32 s49, 1, 0
    s_add_u32 s43, s40, 1
    s_and_b32 s43, s43, 3
    s_cmp_eq_u32 s43, s7
    s_cselect_b32 s50, 1, 0
    s_cmp_eq_u32 s50, 1
    s_cbranch_scc1 LK_3
    s_cmp_eq_u32 s49, 1
    s_cbranch_scc1 LK_4
    ds_read_b128 v[68:71], v17 offset:0
    s_waitcnt vmcnt(16)
    s_barrier
    s_add_u32 s43, s45, s32
    s_mov_b32 m0, s43
    s_add_u32 s44, s48, 16384
    buffer_load_dwordx4 v22, s[12:15], s44 offen offset:0 lds
    buffer_load_dwordx4 v23, s[12:15], s44 offen offset:1024 lds
    buffer_load_dwordx4 v24, s[12:15], s44 offen offset:2048 lds
    buffer_load_dwordx4 v25, s[12:15], s44 offen offset:3072 lds
    s_waitcnt lgkmcnt(6)
    v_mfma_f32_32x32x16_bf16 v[88:103], v[40:43], v[128:131], 0
    v_max3_f32 v2, v72, v73, v74
    v_max3_f32 v2, v2, v75, v76
    v_max3_f32 v2, v2, v77, v78
    v_max3_f32 v2, v2, v79, v80
    v_max3_f32 v2, v2, v81, v82
    ds_read_b128 v[40:43], v10 offset:256
    v_mfma_f32_32x32x16_bf16 v[88:103], v[44:47], v[132:135], v[88:103]
    v_max3_f32 v2, v2, v83, v84
    v_max3_f32 v2, v2, v85, v86
    v_max_f32 v2, v2, v87
    v_mov_b32 v3, v2
    s_nop 1
    ds_read_b128 v[44:47], v11 offset:256
    s_waitcnt lgkmcnt(6)
    v_mfma_f32_32x32x16_bf16 v[88:103], v[48:51], v[136:139], v[88:103]
    v_permlane32_swap_b32 v2, v3
    v_max_f32 v2, v2, v3
    v_mul_f32 v2, s33, v2
    v_sub_f32 v3, v2, v32
    v_cmp_lt_f32 vcc, s34, v3
    ds_read_b128 v[48:51], v12 offset:256
    v_mfma_f32_32x32x16_bf16 v[88:103], v[52:55], v[140:143], v[88:103]
    s_nop 0
    s_cbranch_vccnz LRS_7
LRB_8:
    v_fma_f32 v72, v72, s33, -v32
    v_fma_f32 v73, v73, s33, -v32
    v_fma_f32 v74, v74, s33, -v32
    ds_read_b128 v[52:55], v13 offset:256
    s_waitcnt lgkmcnt(6)
    v_mfma_f32_32x32x16_bf16 v[88:103], v[56:59], v[144:147], v[88:103]
    v_fma_f32 v75, v75, s33, -v32
    v_fma_f32 v76, v76, s33, -v32
    v_fma_f32 v77, v77, s33, -v32
    v_fma_f32 v78, v78, s33, -v32
    v_fma_f32 v79, v79, s33, -v32
    ds_read_b128 v[56:59], v14 offset:256
    v_mfma_f32_32x32x16_bf16 v[88:103], v[60:63], v[148:151], v[88:103]
    v_fma_f32 v80, v80, s33, -v32
    v_fma_f32 v81, v81, s33, -v32
    v_fma_f32 v82, v82, s33, -v32
    v_fma_f32 v83, v83, s33, -v32
    v_fma_f32 v84, v84, s33, -v32
    ds_read_b128 v[60:63], v15 offset:256
    s_waitcnt lgkmcnt(6)
    v_mfma_f32_32x32x16_bf16 v[88:103], v[64:67], v[152:155], v[88:103]
    v_fma_f32 v85, v85, s33, -v32
    v_fma_f32 v86, v86, s33, -v32
    v_fma_f32 v87, v87, s33, -v32
    v_exp_f32 v72, v72
    v_exp_f32 v73, v73
    ds_read_b128 v[64:67], v16 offset:256
    v_mfma_f32_32x32x16_bf16 v[88:103], v[68:71], v[156:159], v[88:103]
    v_exp_f32 v74, v74
    v_exp_f32 v75, v75
    v_exp_f32 v76, v76
    v_exp_f32 v77, v77
    v_exp_f32 v78, v78
    ds_read_b128 v[68:71], v17 offset:256
    s_waitcnt lgkmcnt(6)
    v_mfma_f32_32x32x16_bf16 v[88:103], v[40:43], v[160:163], v[88:103]
    v_exp_f32 v79, v79
    v_exp_f32 v80, v80
    v_exp_f32 v81, v81
    v_exp_f32 v82, v82
    v_exp_f32 v83, v83
    ds_read_b64_tr_b16 v[40:41], v18 offset:0
    ds_read_b64_tr_b16 v[42:43], v18 offset:4096
    v_mfma_f32_32x32x16_bf16 v[88:103], v[44:47], v[164:167], v[88:103]
    v_exp_f32 v84, v84
    v_exp_f32 v85, v85
    v_exp_f32 v86, v86
    v_exp_f32 v87, v87
    s_nop 0
    ds_read_b64_tr_b16 v[44:45], v19 offset:0
    ds_read_b64_tr_b16 v[46:47], v19 offset:4096
    s_waitcnt lgkmcnt(8)
    v_mfma_f32_32x32x16_bf16 v[88:103], v[48:51], v[168:171], v[88:103]
    v_add_f32 v33, v33, v72
    v_add_f32 v33, v33, v73
    v_add_f32 v33, v33, v74
    v_add_f32 v33, v33, v75
    v_add_f32 v33, v33, v76
    ds_read_b64_tr_b16 v[48:49], v20 offset:0
    ds_read_b64_tr_b16 v[50:51], v20 offset:4096
    v_mfma_f32_32x32x16_bf16 v[88:103], v[52:55], v[172:175], v[88:103]
    v_add_f32 v33, v33, v77
    v_add_f32 v33, v33, v78
    v_add_f32 v33, v33, v79
    v_add_f32 v33, v33, v80
    v_add_f32 v33, v33, v81
    ds_read_b64_tr_b16 v[52:53], v21 offset:0
    ds_read_b64_tr_b16 v[54:55], v21 offset:4096
    s_waitcnt lgkmcnt(10)
    v_mfma_f32_32x32x16_bf16 v[88:103], v[56:59], v[176:179], v[88:103]
    v_add_f32 v33, v33, v82
    v_add_f32 v33, v33, v83
    v_add_f32 v33, v33, v84
    v_add_f32 v33, v33, v85
    v_add_f32 v33, v33, v86
    ds_read_b64_tr_b16 v[56:57], v18 offset:256
    ds_read_b64_tr_b16 v[58:59], v18 offset:4352
    v_mfma_f32_32x32x16_bf16 v[88:103], v[60:63], v[180:183], v[88:103]
    v_add_f32 v33, v33, v87
    v_cvt_pk_bf16_f32 v72, v72, v73
    v_cvt_pk_bf16_f32 v73, v74, v75
    v_cvt_pk_bf16_f32 v74, v76, v77
    v_cvt_pk_bf16_f32 v75, v78, v79
    ds_read_b64_tr_b16 v[60:61], v19 offset:256
    ds_read_b64_tr_b16 v[62:63], v19 offset:4352
    s_waitcnt lgkmcnt(12)
    v_mfma_f32_32x32x16_bf16 v[88:103], v[64:67], v[184:187], v[88:103]
    v_cvt_pk_bf16_f32 v76, v80, v81
    v_cvt_pk_bf16_f32 v77, v82, v83
    v_cvt_pk_bf16_f32 v78, v84, v85
    v_cvt_pk_bf16_f32 v79, v86, v87
    ds_read_b64_tr_b16 v[64:65], v20 offset:256
    ds_read_b64_tr_b16 v[66:67], v20 offset:4352
    v_mfma_f32_32x32x16_bf16 v[88:103], v[68:71], v[188:191], v[88:103]
    s_branch LK_5
LK_3:
    ds_read_b128 v[68:71], v17 offset:0
    s_waitcnt vmcnt(16)
    s_barrier
    s_add_u32 s43, s45, s32
    s_mov_b32 m0, s43
    s_add_u32 s44, s48, 16384
    buffer_load_dwordx4 v22, s[12:15], s44 offen offset:0 lds
    buffer_load_dwordx4 v23, s[12:15], s44 offen offset:1024 lds
    buffer_load_dwordx4 v24, s[12:15], s44 offen offset:2048 lds
    buffer_load_dwordx4 v25, s[12:15], s44 offen offset:3072 lds
    s_waitcnt lgkmcnt(6)
    v_mfma_f32_32x32x16_bf16 v[88:103], v[40:43], v[128:131], 0
    v_max3_f32 v2, v72, v73, v74
    v_max3_f32 v2, v2, v75, v76
    v_max3_f32 v2, v2, v77, v78
    v_mfma_f32_32x32x16_bf16 v[104:119], v[40:43], v[192:195], 0
    v_max3_f32 v2, v2, v79, v80
    v_max3_f32 v2, v2, v81, v82
    v_max3_f32 v2, v2, v83, v84
    ds_read_b128 v[40:43], v10 offset:256
    v_mfma_f32_32x32x16_bf16 v[88:103], v[44:47], v[132:135], v[88:103]
    v_max3_f32 v2, v2, v85, v86
    v_max_f32 v2, v2, v87
    v_mov_b32 v3, v2
    v_mfma_f32_32x32x16_bf16 v[104:119], v[44:47], v[196:199], v[104:119]
    s_nop 1
    v_permlane32_swap_b32 v2, v3
    v_max_f32 v2, v2, v3
    ds_read_b128 v[44:47], v11 offset:256
    s_waitcnt lgkmcnt(6)
    v_mfma_f32_32x32x16_bf16 v[88:103], v[48:51], v[136:139], v[88:103]
    v_mul_f32 v2, s33, v2
    v_sub_f32 v3, v2, v32
    v_cmp_lt_f32 vcc, s34, v3
    v_mfma_f32_32x32x16_bf16 v[104:119], v[48:51], v[200:203], v[104:119]
    s_nop 0
    s_cbranch_vccnz LRS_9
LRB_10:
    v_fma_f32 v72, v72, s33, -v32
    ds_read_b128 v[48:51], v12 offset:256
    v_mfma_f32_32x32x16_bf16 v[88:103], v[52:55], v[140:143], v[88:103]
    v_fma_f32 v73, v73, s33, -v32
    v_fma_f32 v74, v74, s33, -v32
    v_fma_f32 v75, v75, s33, -v32
    v_mfma_f32_32x32x16_bf16 v[104:119], v[52:55], v[204:207], v[104:119]
    v_fma_f32 v76, v76, s33, -v32
    v_fma_f32 v77, v77, s33, -v32
    v_fma_f32 v78, v78, s33, -v32
    ds_read_b128 v[52:55], v13 offset:256
    s_waitcnt lgkmcnt(6)
    v_mfma_f32_32x32x16_bf16 v[88:103], v[56:59], v[144:147], v[88:103]
    v_fma_f32 v79, v79, s33, -v32
    v_fma_f32 v80, v80, s33, -v32
    v_fma_f32 v81, v81, s33, -v32
    v_mfma_f32_32x32x16_bf16 v[104:119], v[56:59], v[208:211], v[104:119]
    v_fma_f32 v82, v82, s33, -v32
    v_fma_f32 v83, v83, s33, -v32
    v_fma_f32 v84, v84, s33, -v32
    ds_read_b128 v[56:59], v14 offset:256
    v_mfma_f32_32x32x16_bf16 v[88:103], v[60:63], v[148:151], v[88:103]
    v_fma_f32 v85, v85, s33, -v32
    v_fma_f32 v86, v86, s33, -v32
    v_fma_f32 v87, v87, s33, -v32
    v_mfma_f32_32x32x16_bf16 v[104:119], v[60:63], v[212:215], v[104:119]
    v_exp_f32 v72, v72
    v_exp_f32 v73, v73
    v_exp_f32 v74, v74
    ds_read_b128 v[60:63], v15 offset:256
    s_waitcnt lgkmcnt(6)
    v_mfma_f32_32x32x16_bf16 v[88:103], v[64:67], v[152:155], v[88:103]
    v_exp_f32 v75, v75
    v_exp_f32 v76, v76
    v_exp_f32 v77, v77
    v_mfma_f32_32x32x16_bf16 v[104:119], v[64:67], v[216:219], v[104:119]
    v_exp_f32 v78, v78
    v_exp_f32 v79, v79
    v_exp_f32 v80, v80
    ds_read_b128 v[64:67], v16 offset:256
    v_mfma_f32_32x32x16_bf16 v[88:103], v[68:71], v[156:159], v[88:103]
    v_exp_f32 v81, v81
    v_exp_f32 v82, v82
    v_exp_f32 v83, v83
    v_mfma_f32_32x32x16_bf16 v[104:119], v[68:71], v[220:223], v[104:119]
    v_exp_f32 v84, v84
    v_exp_f32 v85, v85
    v_exp_f32 v86, v86
    ds_read_b128 v[68:71], v17 offset:256
    s_waitcnt lgkmcnt(6)
    v_mfma_f32_32x32x16_bf16 v[88:103], v[40:43], v[160:163], v[88:103]
    v_exp_f32 v87, v87
    s_nop 0
    v_add_f32 v33, v33, v72
    v_mfma_f32_32x32x16_bf16 v[104:119], v[40:43], v[224:227], v[104:119]
    v_add_f32 v33, v33, v73
    v_add_f32 v33, v33, v74
    v_add_f32 v33, v33, v75
    ds_read_b64_tr_b16 v[40:41], v18 offset:0
    ds_read_b64_tr_b16 v[42:43], v18 offset:4096
    v_mfma_f32_32x32x16_bf16 v[88:103], v[44:47], v[164:167], v[88:103]
    v_add_f32 v33, v33, v76
    v_add_f32 v33, v33, v77
    v_add_f32 v33, v33, v78
    v_mfma_f32_32x32x16_bf16 v[104:119], v[44:47], v[228:231], v[104:119]
    v_add_f32 v33, v33, v79
    v_add_f32 v33, v33, v80
    v_add_f32 v33, v33, v81
    ds_read_b64_tr_b16 v[44:45], v19 offset:0
    ds_read_b64_tr_b16 v[46:47], v19 offset:4096
    s_waitcnt lgkmcnt(8)
    v_mfma_f32_32x32x16_bf16 v[88:103], v[48:51], v[168:171], v[88:103]
    v_add_f32 v33, v33, v82
    v_add_f32 v33, v33, v83
    v_add_f32 v33, v33, v84
    v_mfma_f32_32x32x16_bf16 v[104:119], v[48:51], v[232:235], v[104:119]
    v_add_f32 v33, v33, v85
    v_add_f32 v33, v33, v86
    v_add_f32 v33, v33, v87
    ds_read_b64_tr_b16 v[48:49], v20 offset:0
    ds_read_b64_tr_b16 v[50:51], v20 offset:4096
    v_mfma_f32_32x32x16_bf16 v[88:103], v[52:55], v[172:175], v[88:103]
    v_cvt_pk_bf16_f32 v72, v72, v73
    v_cvt_pk_bf16_f32 v73, v74, v75
    v_cvt_pk_bf16_f32 v74, v76, v77
    v_mfma_f32_32x32x16_bf16 v[104:119], v[52:55], v[236:239], v[104:119]
    v_cvt_pk_bf16_f32 v75, v78, v79
    v_cvt_pk_bf16_f32 v76, v80, v81
    v_cvt_pk_bf16_f32 v77, v82, v83
    ds_read_b64_tr_b16 v[52:53], v21 offset:0
    ds_read_b64_tr_b16 v[54:55], v21 offset:4096
    s_waitcnt lgkmcnt(10)
    v_mfma_f32_32x32x16_bf16 v[88:103], v[56:59], v[176:179], v[88:103]
    v_cvt_pk_bf16_f32 v78, v84, v85
    v_cvt_pk_bf16_f32 v79, v86, v87
    v_mfma_f32_32x32x16_bf16 v[104:119], v[56:59], v[240:243], v[104:119]
    ds_read_b64_tr_b16 v[56:57], v18 offset:256
    ds_read_b64_tr_b16 v[58:59], v18 offset:4352
    v_mfma_f32_32x32x16_bf16 v[88:103], v[60:63], v[180:183], v[88:103]
    v_mfma_f32_32x32x16_bf16 v[104:119], v[60:63], v[244:247], v[104:119]
    ds_read_b64_tr_b16 v[60:61], v19 offset:256
    ds_read_b64_tr_b16 v[62:63], v19 offset:4352
    s_waitcnt lgkmcnt(12)
    v_mfma_f32_32x32x16_bf16 v[88:103], v[64:67], v[184:187], v[88:103]
    v_mfma_f32_32x32x16_bf16 v[104:119], v[64:67], v[248:251], v[104:119]
    ds_read_b64_tr_b16 v[64:65], v20 offset:256
    ds_read_b64_tr_b16 v[66:67], v20 offset:4352
    v_mfma_f32_32x32x16_bf16 v[88:103], v[68:71], v[188:191], v[88:103]
    v_mfma_f32_32x32x16_bf16 v[104:119], v[68:71], v[252:255], v[104:119]
    s_branch LK_5
LK_4:
    ds_read_b128 v[68:71], v17 offset:0
    s_waitcnt vmcnt(16)
    s_barrier
    s_add_u32 s43, s45, s32
    s_mov_b32 m0, s43
    s_add_u32 s44, s48, 16384
    buffer_load_dwordx4 v22, s[12:15], s44 offen offset:0 lds
    buffer_load_dwordx4 v23, s[12:15], s44 offen offset:1024 lds
    buffer_load_dwordx4 v24, s[12:15], s44 offen offset:2048 lds
    buffer_load_dwordx4 v25, s[12:15], s44 offen offset:3072 lds
    s_waitcnt lgkmcnt(6)
    v_mfma_f32_32x32x16_bf16 v[88:103], v[40:43], v[128:131], 0
    v_max3_f32 v2, v72, v73, v74
    v_max3_f32 v2, v2, v75, v76
    v_max3_f32 v2, v2, v77, v78
    v_max3_f32 v2, v2, v79, v80
    v_max3_f32 v2, v2, v81, v82
    v_max3_f32 v2, v2, v83, v84
    v_max3_f32 v2, v2, v85, v86
    v_max_f32 v2, v2, v87
    v_mov_b32 v3, v2
    s_nop 1
    ds_read_b128 v[40:43], v10 offset:256
    v_mfma_f32_32x32x16_bf16 v[88:103], v[44:47], v[132:135], v[88:103]
    v_permlane32_swap_b32 v2, v3
    v_max_f32 v2, v2, v3
    v_mul_f32 v2, s33, v2
    v_sub_f32 v3, v2, v32
    v_cmp_lt_f32 vcc, s34, v3
    s_nop 0
    s_cbranch_vccnz LRS_11
LRB_12:
    v_fma_f32 v72, v72, s33, -v32
    v_fma_f32 v73, v73, s33, -v32
    v_fma_f32 v74, v74, s33, -v32
    ds_read_b128 v[44:47], v11 offset:256
    s_waitcnt lgkmcnt(6)
    v_mfma_f32_32x32x16_bf16 v[88:103], v[48:51], v[136:139], v[88:103]
    v_fma_f32 v75, v75, s33, -v32
    v_fma_f32 v76, v76, s33, -v32
    v_fma_f32 v77, v77, s33, -v32
    v_fma_f32 v78, v78, s33, -v32
    v_fma_f32 v79, v79, s33, -v32
    v_fma_f32 v80, v80, s33, -v32
    v_fma_f32 v81, v81, s33, -v32
    v_fma_f32 v82, v82, s33, -v32
    v_fma_f32 v83, v83, s33, -v32
    v_fma_f32 v84, v84, s33, -v32
    ds_read_b128 v[48:51], v12 offset:256
    v_mfma_f32_32x32x16_bf16 v[88:103], v[52:55], v[140:143], v[88:103]
    v_fma_f32 v85, v85, s33, -v32
    v_fma_f32 v86, v86, s33, -v32
    v_fma_f32 v87, v87, s33, -v32
    v_exp_f32 v72, v72
    v_exp_f32 v73, v73
    v_exp_f32 v74, v74
    v_exp_f32 v75, v75
    v_exp_f32 v76, v76
    v_exp_f32 v77, v77
    v_exp_f32 v78, v78
    ds_read_b128 v[52:55], v13 offset:256
    s_waitcnt lgkmcnt(6)
    v_mfma_f32_32x32x16_bf16 v[88:103], v[56:59], v[144:147], v[88:103]
    v_exp_f32 v79, v79
    v_exp_f32 v80, v80
    v_exp_f32 v81, v81
    v_exp_f32 v82, v82
    v_exp_f32 v83, v83
    v_exp_f32 v84, v84
    v_exp_f32 v85, v85
    v_exp_f32 v86, v86
    v_exp_f32 v87, v87
    s_nop 0
    ds_read_b128 v[56:59], v14 offset:256
    v_mfma_f32_32x32x16_bf16 v[88:103], v[60:63], v[148:151], v[88:103]
    v_add_f32 v33, v33, v72
    v_add_f32 v33, v33, v73
    v_add_f32 v33, v33, v74
    v_add_f32 v33, v33, v75
    v_add_f32 v33, v33, v76
    v_add_f32 v33, v33, v77
    v_add_f32 v33, v33, v78
    v_add_f32 v33, v33, v79
    v_add_f32 v33, v33, v80
    v_add_f32 v33, v33, v81
    ds_read_b128 v[60:63], v15 offset:256
    s_waitcnt lgkmcnt(6)
    v_mfma_f32_32x32x16_bf16 v[88:103], v[64:67], v[152:155], v[88:103]
    v_add_f32 v33, v33, v82
    v_add_f32 v33, v33, v83
    v_add_f32 v33, v33, v84
    v_add_f32 v33, v33, v85
    v_add_f32 v33, v33, v86
    v_add_f32 v33, v33, v87
    v_cvt_pk_bf16_f32 v72, v72, v73
    v_cvt_pk_bf16_f32 v73, v74, v75
    v_cvt_pk_bf16_f32 v74, v76, v77
    v_cvt_pk_bf16_f32 v75, v78, v79
    ds_read_b128 v[64:67], v16 offset:256
    v_mfma_f32_32x32x16_bf16 v[88:103], v[68:71], v[156:159], v[88:103]
    v_cvt_pk_bf16_f32 v76, v80, v81
    v_cvt_pk_bf16_f32 v77, v82, v83
    v_cvt_pk_bf16_f32 v78, v84, v85
    v_cvt_pk_bf16_f32 v79, v86, v87
    v_max3_f32 v2, v104, v105, v106
    v_max3_f32 v2, v2, v107, v108
    v_max3_f32 v2, v2, v109, v110
    v_max3_f32 v2, v2, v111, v112
    v_max3_f32 v2, v2, v113, v114
    v_max3_f32 v2, v2, v115, v116
    ds_read_b128 v[68:71], v17 offset:256
    s_waitcnt lgkmcnt(6)
    v_mfma_f32_32x32x16_bf16 v[88:103], v[40:43], v[160:163], v[88:103]
    v_max3_f32 v2, v2, v117, v118
    v_max_f32 v2, v2, v119
    v_mov_b32 v3, v2
    s_nop 1
    v_permlane32_swap_b32 v2, v3
    v_max_f32 v2, v2, v3
    v_mul_f32 v2, s33, v2
    v_sub_f32 v3, v2, v34
    v_cmp_lt_f32 vcc, s34, v3
    s_nop 0
    ds_read_b64_tr_b16 v[40:41], v18 offset:0
    ds_read_b64_tr_b16 v[42:43], v18 offset:4096
    v_mfma_f32_32x32x16_bf16 v[88:103], v[44:47], v[164:167], v[88:103]
    s_cbranch_vccnz LRS_13
LRB_14:
    v_fma_f32 v104, v104, s33, -v34
    v_fma_f32 v105, v105, s33, -v34
    v_fma_f32 v106, v106, s33, -v34
    v_fma_f32 v107, v107, s33, -v34
    v_fma_f32 v108, v108, s33, -v34
    v_fma_f32 v109, v109, s33, -v34
    v_fma_f32 v110, v110, s33, -v34
    v_fma_f32 v111, v111, s33, -v34
    v_fma_f32 v112, v112, s33, -v34
    ds_read_b64_tr_b16 v[44:45], v19 offset:0
    ds_read_b64_tr_b16 v[46:47], v19 offset:4096
    s_waitcnt lgkmcnt(8)
    v_mfma_f32_32x32x16_bf16 v[88:103], v[48:51], v[168:171], v[88:103]
    v_fma_f32 v113, v113, s33, -v34
    v_fma_f32 v114, v114, s33, -v34
    v_fma_f32 v115, v115, s33, -v34
    v_fma_f32 v116, v116, s33, -v34
    v_fma_f32 v117, v117, s33, -v34
    v_fma_f32 v118, v118, s33, -v34
    v_fma_f32 v119, v119, s33, -v34
    v_exp_f32 v104, v104
    v_exp_f32 v105, v105
    v_exp_f32 v106, v106
    ds_read_b64_tr_b16 v[48:49], v20 offset:0
    ds_read_b64_tr_b16 v[50:51], v20 offset:4096
    v_mfma_f32_32x32x16_bf16 v[88:103], v[52:55], v[172:175], v[88:103]
    v_exp_f32 v107, v107
    v_exp_f32 v108, v108
    v_exp_f32 v109, v109
    v_exp_f32 v110, v110
    v_exp_f32 v111, v111
    v_exp_f32 v112, v112
    v_exp_f32 v113, v113
    v_exp_f32 v114, v114
    v_exp_f32 v115, v115
    v_exp_f32 v116, v116
    ds_read_b64_tr_b16 v[52:53], v21 offset:0
    ds_read_b64_tr_b16 v[54:55], v21 offset:4096
    s_waitcnt lgkmcnt(10)
    v_mfma_f32_32x32x16_bf16 v[88:103], v[56:59], v[176:179], v[88:103]
    v_exp_f32 v117, v117
    v_exp_f32 v118, v118
    v_exp_f32 v119, v119
    s_nop 0
    v_add_f32 v35, v35, v104
    v_add_f32 v35, v35, v105
    v_add_f32 v35, v35, v106
    v_add_f32 v35, v35, v107
    v_add_f32 v35, v35, v108
    v_add_f32 v35, v35, v109
    ds_read_b64_tr_b16 v[56:57], v18 offset:256
    ds_read_b64_tr_b16 v[58:59], v18 offset:4352
    v_mfma_f32_32x32x16_bf16 v[88:103], v[60:63], v[180:183], v[88:103]
    v_add_f32 v35, v35, v110
    v_add_f32 v35, v35, v111
    v_add_f32 v35, v35, v112
    v_add_f32 v35, v35, v113
    v_add_f32 v35, v35, v114
    v_add_f32 v35, v35, v115
    v_add_f32 v35, v35, v116
    v_add_f32 v35, v35, v117
    v_add_f32 v35, v35, v118
    v_add_f32 v35, v35, v119
    ds_read_b64_tr_b16 v[60:61], v19 offset:256
    ds_read_b64_tr_b16 v[62:63], v19 offset:4352
    s_waitcnt lgkmcnt(12)
    v_mfma_f32_32x32x16_bf16 v[88:103], v[64:67], v[184:187], v[88:103]
    v_cvt_pk_bf16_f32 v104, v104, v105
    v_cvt_pk_bf16_f32 v105, v106, v107
    v_cvt_pk_bf16_f32 v106, v108, v109
    v_cvt_pk_bf16_f32 v107, v110, v111
    v_cvt_pk_bf16_f32 v108, v112, v113
    v_cvt_pk_bf16_f32 v109, v114, v115
    v_cvt_pk_bf16_f32 v110, v116, v117
    v_cvt_pk_bf16_f32 v111, v118, v119
    ds_read_b64_tr_b16 v[64:65], v20 offset:256
    ds_read_b64_tr_b16 v[66:67], v20 offset:4352
    v_mfma_f32_32x32x16_bf16 v[88:103], v[68:71], v[188:191], v[88:103]
LK_5:
    s_add_u32 s43, s42, 16384
    s_cmp_ge_u32 s43, 114688
    s_cselect_b32 s43, 0, s43
    s_sub_u32 s46, s43, s41
    v_add_u32 v10, s46, v10
    v_add_u32 v11, s46, v11
    v_add_u32 v12, s46, v12
    v_add_u32 v13, s46, v13
    v_add_u32 v14, s46, v14
    v_add_u32 v15, s46, v15
    v_add_u32 v16, s46, v16
    v_add_u32 v17, s46, v17
    s_mov_b32 s46, s43
    s_cmp_eq_u32 s49, 1
    s_cbranch_scc1 LV_15
    ds_read_b64_tr_b16 v[68:69], v21 offset:256
    ds_read_b64_tr_b16 v[70:71], v21 offset:4352
    s_waitcnt vmcnt(16)
    s_barrier
    s_add_u32 s43, s41, s32
    s_mov_b32 m0, s43
    s_nop 0
    buffer_load_dwordx4 v26, s[16:19], s48 offen offset:0 lds
    buffer_load_dwordx4 v27, s[16:19], s48 offen offset:1024 lds
    buffer_load_dwordx4 v26, s[16:19], s48 offen offset:2048 lds
    buffer_load_dwordx4 v27, s[16:19], s48 offen offset:3072 lds
    s_waitcnt lgkmcnt(12)
    v_mfma_f32_32x32x16_bf16 a[0:15], v[40:43], v[72:75], a[0:15]
    ds_read_b64_tr_b16 v[40:41], v18 offset:8192
    ds_read_b64_tr_b16 v[42:43], v18 offset:12288
    v_mfma_f32_32x32x16_bf16 a[16:31], v[44:47], v[72:75], a[16:31]
    ds_read_b64_tr_b16 v[44:45], v19 offset:8192
    ds_read_b64_tr_b16 v[46:47], v19 offset:12288
    s_waitcnt lgkmcnt(12)
    v_mfma_f32_32x32x16_bf16 a[32:47], v[48:51], v[72:75], a[32:47]
    ds_read_b64_tr_b16 v[48:49], v20 offset:8192
    ds_read_b64_tr_b16 v[50:51], v20 offset:12288
    v_mfma_f32_32x32x16_bf16 a[48:63], v[52:55], v[72:75], a[48:63]
    ds_read_b64_tr_b16 v[52:53], v21 offset:8192
    ds_read_b64_tr_b16 v[54:55], v21 offset:12288
    s_waitcnt lgkmcnt(12)
    v_mfma_f32_32x32x16_bf16 a[64:79], v[56:59], v[72:75], a[64:79]
    ds_read_b64_tr_b16 v[56:57], v18 offset:8448
    ds_read_b64_tr_b16 v[58:59], v18 offset:12544
    v_mfma_f32_32x32x16_bf16 a[80:95], v[60:63], v[72:75], a[80:95]
    ds_read_b64_tr_b16 v[60:61], v19 offset:8448
    ds_read_b64_tr_b16 v[62:63], v19 offset:12544
    s_waitcnt lgkmcnt(12)
    v_mfma_f32_32x32x16_bf16 a[96:111], v[64:67], v[72:75], a[96:111]
    ds_read_b64_tr_b16 v[64:65], v20 offset:8448
    ds_read_b64_tr_b16 v[66:67], v20 offset:12544
    v_mfma_f32_32x32x16_bf16 a[112:127], v[68:71], v[72:75], a[112:127]
    ds_read_b64_tr_b16 v[68:69], v21 offset:8448
    ds_read_b64_tr_b16 v[70:71], v21 offset:12544
    s_waitcnt lgkmcnt(12)
    v_mfma_f32_32x32x16_bf16 a[0:15], v[40:43], v[76:79], a[0:15]
    ds_read_b128 v[40:43], v10 offset:0
    v_mfma_f32_32x32x16_bf16 a[16:31], v[44:47], v[76:79], a[16:31]
    ds_read_b128 v[44:47], v11 offset:0
    s_waitcnt lgkmcnt(10)
    v_mfma_f32_32x32x16_bf16 a[32:47], v[48:51], v[76:79], a[32:47]
    ds_read_b128 v[48:51], v12 offset:0
    v_mfma_f32_32x32x16_bf16 a[48:63], v[52:55], v[76:79], a[48:63]
    ds_read_b128 v[52:55], v13 offset:0
    s_waitcnt lgkmcnt(8)
    v_mfma_f32_32x32x16_bf16 a[64:79], v[56:59], v[76:79], a[64:79]
    ds_read_b128 v[56:59], v14 offset:0
    v_mfma_f32_32x32x16_bf16 a[80:95], v[60:63], v[76:79], a[80:95]
    ds_read_b128 v[60:63], v15 offset:0
    s_waitcnt lgkmcnt(6)
    v_mfma_f32_32x32x16_bf16 a[96:111], v[64:67], v[76:79], a[96:111]
    ds_read_b128 v[64:67], v16 offset:0
    v_mfma_f32_32x32x16_bf16 a[112:127], v[68:71], v[76:79], a[112:127]
    s_branch LV_16
LV_15:
    ds_read_b64_tr_b16 v[68:69], v21 offset:256
    ds_read_b64_tr_b16 v[70:71], v21 offset:4352
    s_waitcnt vmcnt(16)
    s_barrier
    s_add_u32 s43, s41, s32
    s_mov_b32 m0, s43
    s_nop 0
    buffer_load_dwordx4 v26, s[16:19], s48 offen offset:0 lds
    buffer_load_dwordx4 v27, s[16:19], s48 offen offset:1024 lds
    buffer_load_dwordx4 v26, s[16:19], s48 offen offset:2048 lds
    buffer_load_dwordx4 v27, s[16:19], s48 offen offset:3072 lds
    s_waitcnt lgkmcnt(12)
    v_mfma_f32_32x32x16_bf16 a[0:15], v[40:43], v[72:75], a[0:15]
    v_mfma_f32_32x32x16_bf16 a[128:143], v[40:43], v[104:107], a[128:143]
    ds_read_b64_tr_b16 v[40:41], v18 offset:8192
    ds_read_b64_tr_b16 v[42:43], v18 offset:12288
    v_mfma_f32_32x32x16_bf16 a[16:31], v[44:47], v[72:75], a[16:31]
    v_mfma_f32_32x32x16_bf16 a[144:159], v[44:47], v[104:107], a[144:159]
    ds_read_b64_tr_b16 v[44:45], v19 offset:8192
    ds_read_b64_tr_b16 v[46:47], v19 offset:12288
    s_waitcnt lgkmcnt(12)
    v_mfma_f32_32x32x16_bf16 a[32:47], v[48:51], v[72:75], a[32:47]
    v_mfma_f32_32x32x16_bf16 a[160:175], v[48:51], v[104:107], a[160:175]
    ds_read_b64_tr_b16 v[48:49], v20 offset:8192
    ds_read_b64_tr_b16 v[50:51], v20 offset:12288
    v_mfma_f32_32x32x16_bf16 a[48:63], v[52:55], v[72:75], a[48:63]
    v_mfma_f32_32x32x16_bf16 a[176:191], v[52:55], v[104:107], a[176:191]
    ds_read_b64_tr_b16 v[52:53], v21 offset:8192
    ds_read_b64_tr_b16 v[54:55], v21 offset:12288
    s_waitcnt lgkmcnt(12)
    v_mfma_f32_32x32x16_bf16 a[64:79], v[56:59], v[72:75], a[64:79]
    v_mfma_f32_32x32x16_bf16 a[192:207], v[56:59], v[104:107], a[192:207]
    ds_read_b64_tr_b16 v[56:57], v18 offset:8448
    ds_read_b64_tr_b16 v[58:59], v18 offset:12544
    v_mfma_f32_32x32x16_bf16 a[80:95], v[60:63], v[72:75], a[80:95]
    v_mfma_f32_32x32x16_bf16 a[208:223], v[60:63], v[104:107], a[208:223]
    ds_read_b64_tr_b16 v[60:61], v19 offset:8448
    ds_read_b64_tr_b16 v[62:63], v19 offset:12544
    s_waitcnt lgkmcnt(12)
    v_mfma_f32_32x32x16_bf16 a[96:111], v[64:67], v[72:75], a[96:111]
    v_mfma_f32_32x32x16_bf16 a[224:239], v[64:67], v[104:107], a[224:239]
    ds_read_b64_tr_b16 v[64:65], v20 offset:8448
    ds_read_b64_tr_b16 v[66:67], v20 offset:12544
    v_mfma_f32_32x32x16_bf16 a[112:127], v[68:71], v[72:75], a[112:127]
    v_mfma_f32_32x32x16_bf16 a[240:255], v[68:71], v[104:107], a[240:255]
    ds_read_b64_tr_b16 v[68:69], v21 offset:8448
    ds_read_b64_tr_b16 v[70:71], v21 offset:12544
    s_waitcnt lgkmcnt(12)
    v_mfma_f32_32x32x16_bf16 a[0:15], v[40:43], v[76:79], a[0:15]
    v_mfma_f32_32x32x16_bf16 a[128:143], v[40:43], v[108:111], a[128:143]
    ds_read_b128 v[40:43], v10 offset:0
    v_mfma_f32_32x32x16_bf16 a[16:31], v[44:47], v[76:79], a[16:31]
    v_mfma_f32_32x32x16_bf16 a[144:159], v[44:47], v[108:111], a[144:159]
    ds_read_b128 v[44:47], v11 offset:0
    s_waitcnt lgkmcnt(10)
    v_mfma_f32_32x32x16_bf16 a[32:47], v[48:51], v[76:79], a[32:47]
    v_mfma_f32_32x32x16_bf16 a[160:175], v[48:51], v[108:111], a[160:175]
    ds_read_b128 v[48:51], v12 offset:0
    v_mfma_f32_32x32x16_bf16 a[48:63], v[52:55], v[76:79], a[48:63]
    v_mfma_f32_32x32x16_bf16 a[176:191], v[52:55], v[108:111], a[176:191]
    ds_read_b128 v[52:55], v13 offset:0
    s_waitcnt lgkmcnt(8)
    v_mfma_f32_32x32x16_bf16 a[64:79], v[56:59], v[76:79], a[64:79]
    v_mfma_f32_32x32x16_bf16 a[192:207], v[56:59], v[108:111], a[192:207]
    ds_read_b128 v[56:59], v14 offset:0
    v_mfma_f32_32x32x16_bf16 a[80:95], v[60:63], v[76:79], a[80:95]
    v_mfma_f32_32x32x16_bf16 a[208:223], v[60:63], v[108:111], a[208:223]
    ds_read_b128 v[60:63], v15 offset:0
    s_waitcnt lgkmcnt(6)
    v_mfma_f32_32x32x16_bf16 a[96:111], v[64:67], v[76:79], a[96:111]
    v_mfma_f32_32x32x16_bf16 a[224:239], v[64:67], v[108:111], a[224:239]
    ds_read_b128 v[64:67], v16 offset:0
    v_mfma_f32_32x32x16_bf16 a[112:127], v[68:71], v[76:79], a[112:127]
    v_mfma_f32_32x32x16_bf16 a[240:255], v[68:71], v[108:111], a[240:255]
LV_16:
    s_mov_b32 s45, s42
    s_add_u32 s43, s46, 16384
    s_cmp_ge_u32 s43, 114688
    s_cselect_b32 s43, 0, s43
    s_sub_u32 s47, s43, s42
    v_add_u32 v18, s47, v18
    v_add_u32 v19, s47, v19
    v_add_u32 v20, s47, v20
    v_add_u32 v21, s47, v21
    s_mov_b32 s42, s43
    s_mov_b32 s41, s46
    s_add_u32 s48, s48, 16384
    s_add_u32 s40, s40, 1
    s_and_b32 s43, s40, 3
    s_cmp_eq_u32 s43, s7
    s_cselect_b32 s49, 1, 0
    s_add_u32 s43, s40, 1
    s_and_b32 s43, s43, 3
    s_cmp_eq_u32 s43, s7
    s_cselect_b32 s50, 1, 0
    s_cmp_eq_u32 s50, 1
    s_cbranch_scc1 LK_17
    s_cmp_eq_u32 s49, 1
    s_cbranch_scc1 LK_18
    ds_read_b128 v[68:71], v17 offset:0
    s_waitcnt vmcnt(16)
    s_barrier
    s_add_u32 s43, s45, s32
    s_mov_b32 m0, s43
    s_add_u32 s44, s48, 16384
    buffer_load_dwordx4 v22, s[12:15], s44 offen offset:0 lds
    buffer_load_dwordx4 v23, s[12:15], s44 offen offset:1024 lds
    buffer_load_dwordx4 v24, s[12:15], s44 offen offset:2048 lds
    buffer_load_dwordx4 v25, s[12:15], s44 offen offset:3072 lds
    s_waitcnt lgkmcnt(6)
    v_mfma_f32_32x32x16_bf16 v[72:87], v[40:43], v[128:131], 0
    v_max3_f32 v2, v88, v89, v90
    v_max3_f32 v2, v2, v91, v92
    v_max3_f32 v2, v2, v93, v94
    v_max3_f32 v2, v2, v95, v96
    v_max3_f32 v2, v2, v97, v98
    ds_read_b128 v[40:43], v10 offset:256
    v_mfma_f32_32x32x16_bf16 v[72:87], v[44:47], v[132:135], v[72:87]
    v_max3_f32 v2, v2, v99, v100
    v_max3_f32 v2, v2, v101, v102
    v_max_f32 v2, v2, v103
    v_mov_b32 v3, v2
    s_nop 1
    ds_read_b128 v[44:47], v11 offset:256
    s_waitcnt lgkmcnt(6)
    v_mfma_f32_32x32x16_bf16 v[72:87], v[48:51], v[136:139], v[72:87]
    v_permlane32_swap_b32 v2, v3
    v_max_f32 v2, v2, v3
    v_mul_f32 v2, s33, v2
    v_sub_f32 v3, v2, v32
    v_cmp_lt_f32 vcc, s34, v3
    ds_read_b128 v[48:51], v12 offset:256
    v_mfma_f32_32x32x16_bf16 v[72:87], v[52:55], v[140:143], v[72:87]
    s_nop 0
    s_cbranch_vccnz LRS_21
LRB_22:
    v_fma_f32 v88, v88, s33, -v32
    v_fma_f32 v89, v89, s33, -v32
    v_fma_f32 v90, v90, s33, -v32
    ds_read_b128 v[52:55], v13 offset:256
    s_waitcnt lgkmcnt(6)
    v_mfma_f32_32x32x16_bf16 v[72:87], v[56:59], v[144:147], v[72:87]
    v_fma_f32 v91, v91, s33, -v32
    v_fma_f32 v92, v92, s33, -v32
    v_fma_f32 v93, v93, s33, -v32
    v_fma_f32 v94, v94, s33, -v32
    v_fma_f32 v95, v95, s33, -v32
    ds_read_b128 v[56:59], v14 offset:256
    v_mfma_f32_32x32x16_bf16 v[72:87], v[60:63], v[148:151], v[72:87]
    v_fma_f32 v96, v96, s33, -v32
    v_fma_f32 v97, v97, s33, -v32
    v_fma_f32 v98, v98, s33, -v32
    v_fma_f32 v99, v99, s33, -v32
    v_fma_f32 v100, v100, s33, -v32
    ds_read_b128 v[60:63], v15 offset:256
    s_waitcnt lgkmcnt(6)
    v_mfma_f32_32x32x16_bf16 v[72:87], v[64:67], v[152:155], v[72:87]
    v_fma_f32 v101, v101, s33, -v32
    v_fma_f32 v102, v102, s33, -v32
    v_fma_f32 v103, v103, s33, -v32
    v_exp_f32 v88, v88
    v_exp_f32 v89, v89
    ds_read_b128 v[64:67], v16 offset:256
    v_mfma_f32_32x32x16_bf16 v[72:87], v[68:71], v[156:159], v[72:87]
    v_exp_f32 v90, v90
    v_exp_f32 v91, v91
    v_exp_f32 v92, v92
    v_exp_f32 v93, v93
    v_exp_f32 v94, v94
    ds_read_b128 v[68:71], v17 offset:256
    s_waitcnt lgkmcnt(6)
    v_mfma_f32_32x32x16_bf16 v[72:87], v[40:43], v[160:163], v[72:87]
    v_exp_f32 v95, v95
    v_exp_f32 v96, v96
    v_exp_f32 v97, v97
    v_exp_f32 v98, v98
    v_exp_f32 v99, v99
    ds_read_b64_tr_b16 v[40:41], v18 offset:0
    ds_read_b64_tr_b16 v[42:43], v18 offset:4096
    v_mfma_f32_32x32x16_bf16 v[72:87], v[44:47], v[164:167], v[72:87]
    v_exp_f32 v100, v100
    v_exp_f32 v101, v101
    v_exp_f32 v102, v102
    v_exp_f32 v103, v103
    s_nop 0
    ds_read_b64_tr_b16 v[44:45], v19 offset:0
    ds_read_b64_tr_b16 v[46:47], v19 offset:4096
    s_waitcnt lgkmcnt(8)
    v_mfma_f32_32x32x16_bf16 v[72:87], v[48:51], v[168:171], v[72:87]
    v_add_f32 v33, v33, v88
    v_add_f32 v33, v33, v89
    v_add_f32 v33, v33, v90
    v_add_f32 v33, v33, v91
    v_add_f32 v33, v33, v92
    ds_read_b64_tr_b16 v[48:49], v20 offset:0
    ds_read_b64_tr_b16 v[50:51], v20 offset:4096
    v_mfma_f32_32x32x16_bf16 v[72:87], v[52:55], v[172:175], v[72:87]
    v_add_f32 v33, v33, v93
    v_add_f32 v33, v33, v94
    v_add_f32 v33, v33, v95
    v_add_f32 v33, v33, v96
    v_add_f32 v33, v33, v97
    ds_read_b64_tr_b16 v[52:53], v21 offset:0
    ds_read_b64_tr_b16 v[54:55], v21 offset:4096
    s_waitcnt lgkmcnt(10)
    v_mfma_f32_32x32x16_bf16 v[72:87], v[56:59], v[176:179], v[72:87]
    v_add_f32 v33, v33, v98
    v_add_f32 v33, v33, v99
    v_add_f32 v33, v33, v100
    v_add_f32 v33, v33, v101
    v_add_f32 v33, v33, v102
    ds_read_b64_tr_b16 v[56:57], v18 offset:256
    ds_read_b64_tr_b16 v[58:59], v18 offset:4352
    v_mfma_f32_32x32x16_bf16 v[72:87], v[60:63], v[180:183], v[72:87]
    v_add_f32 v33, v33, v103
    v_cvt_pk_bf16_f32 v88, v88, v89
    v_cvt_pk_bf16_f32 v89, v90, v91
    v_cvt_pk_bf16_f32 v90, v92, v93
    v_cvt_pk_bf16_f32 v91, v94, v95
    ds_read_b64_tr_b16 v[60:61], v19 offset:256
    ds_read_b64_tr_b16 v[62:63], v19 offset:4352
    s_waitcnt lgkmcnt(12)
    v_mfma_f32_32x32x16_bf16 v[72:87], v[64:67], v[184:187], v[72:87]
    v_cvt_pk_bf16_f32 v92, v96, v97
    v_cvt_pk_bf16_f32 v93, v98, v99
    v_cvt_pk_bf16_f32 v94, v100, v101
    v_cvt_pk_bf16_f32 v95, v102, v103
    ds_read_b64_tr_b16 v[64:65], v20 offset:256
    ds_read_b64_tr_b16 v[66:67], v20 offset:4352
    v_mfma_f32_32x32x16_bf16 v[72:87], v[68:71], v[188:191], v[72:87]
    s_branch LK_19
LK_17:
    ds_read_b128 v[68:71], v17 offset:0
    s_waitcnt vmcnt(16)
    s_barrier
    s_add_u32 s43, s45, s32
    s_mov_b32 m0, s43
    s_add_u32 s44, s48, 16384
    buffer_load_dwordx4 v22, s[12:15], s44 offen offset:0 lds
    buffer_load_dwordx4 v23, s[12:15], s44 offen offset:1024 lds
    buffer_load_dwordx4 v24, s[12:15], s44 offen offset:2048 lds
    buffer_load_dwordx4 v25, s[12:15], s44 offen offset:3072 lds
    s_waitcnt lgkmcnt(6)
    v_mfma_f32_32x32x16_bf16 v[72:87], v[40:43], v[128:131], 0
    v_max3_f32 v2, v88, v89, v90
    v_max3_f32 v2, v2, v91, v92
    v_max3_f32 v2, v2, v93, v94
    v_mfma_f32_32x32x16_bf16 v[104:119], v[40:43], v[192:195], 0
    v_max3_f32 v2, v2, v95, v96
    v_max3_f32 v2, v2, v97, v98
    v_max3_f32 v2, v2, v99, v100
    ds_read_b128 v[40:43], v10 offset:256
    v_mfma_f32_32x32x16_bf16 v[72:87], v[44:47], v[132:135], v[72:87]
    v_max3_f32 v2, v2, v101, v102
    v_max_f32 v2, v2, v103
    v_mov_b32 v3, v2
    v_mfma_f32_32x32x16_bf16 v[104:119], v[44:47], v[196:199], v[104:119]
    s_nop 1
    v_permlane32_swap_b32 v2, v3
    v_max_f32 v2, v2, v3
    ds_read_b128 v[44:47], v11 offset:256
    s_waitcnt lgkmcnt(6)
    v_mfma_f32_32x32x16_bf16 v[72:87], v[48:51], v[136:139], v[72:87]
    v_mul_f32 v2, s33, v2
    v_sub_f32 v3, v2, v32
    v_cmp_lt_f32 vcc, s34, v3
    v_mfma_f32_32x32x16_bf16 v[104:119], v[48:51], v[200:203], v[104:119]
    s_nop 0
    s_cbranch_vccnz LRS_23
LRB_24:
    v_fma_f32 v88, v88, s33, -v32
    ds_read_b128 v[48:51], v12 offset:256
    v_mfma_f32_32x32x16_bf16 v[72:87], v[52:55], v[140:143], v[72:87]
    v_fma_f32 v89, v89, s33, -v32
    v_fma_f32 v90, v90, s33, -v32
    v_fma_f32 v91, v91, s33, -v32
    v_mfma_f32_32x32x16_bf16 v[104:119], v[52:55], v[204:207], v[104:119]
    v_fma_f32 v92, v92, s33, -v32
    v_fma_f32 v93, v93, s33, -v32
    v_fma_f32 v94, v94, s33, -v32
    ds_read_b128 v[52:55], v13 offset:256
    s_waitcnt lgkmcnt(6)
    v_mfma_f32_32x32x16_bf16 v[72:87], v[56:59], v[144:147], v[72:87]
    v_fma_f32 v95, v95, s33, -v32
    v_fma_f32 v96, v96, s33, -v32
    v_fma_f32 v97, v97, s33, -v32
    v_mfma_f32_32x32x16_bf16 v[104:119], v[56:59], v[208:211], v[104:119]
    v_fma_f32 v98, v98, s33, -v32
    v_fma_f32 v99, v99, s33, -v32
    v_fma_f32 v100, v100, s33, -v32
    ds_read_b128 v[56:59], v14 offset:256
    v_mfma_f32_32x32x16_bf16 v[72:87], v[60:63], v[148:151], v[72:87]
    v_fma_f32 v101, v101, s33, -v32
    v_fma_f32 v102, v102, s33, -v32
    v_fma_f32 v103, v103, s33, -v32
    v_mfma_f32_32x32x16_bf16 v[104:119], v[60:63], v[212:215], v[104:119]
    v_exp_f32 v88, v88
    v_exp_f32 v89, v89
    v_exp_f32 v90, v90
    ds_read_b128 v[60:63], v15 offset:256
    s_waitcnt lgkmcnt(6)
    v_mfma_f32_32x32x16_bf16 v[72:87], v[64:67], v[152:155], v[72:87]
    v_exp_f32 v91, v91
    v_exp_f32 v92, v92
    v_exp_f32 v93, v93
    v_mfma_f32_32x32x16_bf16 v[104:119], v[64:67], v[216:219], v[104:119]
    v_exp_f32 v94, v94
    v_exp_f32 v95, v95
    v_exp_f32 v96, v96
    ds_read_b128 v[64:67], v16 offset:256
    v_mfma_f32_32x32x16_bf16 v[72:87], v[68:71], v[156:159], v[72:87]
    v_exp_f32 v97, v97
    v_exp_f32 v98, v98
    v_exp_f32 v99, v99
    v_mfma_f32_32x32x16_bf16 v[104:119], v[68:71], v[220:223], v[104:119]
    v_exp_f32 v100, v100
    v_exp_f32 v101, v101
    v_exp_f32 v102, v102
    ds_read_b128 v[68:71], v17 offset:256
    s_waitcnt lgkmcnt(6)
    v_mfma_f32_32x32x16_bf16 v[72:87], v[40:43], v[160:163], v[72:87]
    v_exp_f32 v103, v103
    s_nop 0
    v_add_f32 v33, v33, v88
    v_mfma_f32_32x32x16_bf16 v[104:119], v[40:43], v[224:227], v[104:119]
    v_add_f32 v33, v33, v89
    v_add_f32 v33, v33, v90
    v_add_f32 v33, v33, v91
    ds_read_b64_tr_b16 v[40:41], v18 offset:0
    ds_read_b64_tr_b16 v[42:43], v18 offset:4096
    v_mfma_f32_32x32x16_bf16 v[72:87], v[44:47], v[164:167], v[72:87]
    v_add_f32 v33, v33, v92
    v_add_f32 v33, v33, v93
    v_add_f32 v33, v33, v94
    v_mfma_f32_32x32x16_bf16 v[104:119], v[44:47], v[228:231], v[104:119]
    v_add_f32 v33, v33, v95
    v_add_f32 v33, v33, v96
    v_add_f32 v33, v33, v97
    ds_read_b64_tr_b16 v[44:45], v19 offset:0
    ds_read_b64_tr_b16 v[46:47], v19 offset:4096
    s_waitcnt lgkmcnt(8)
    v_mfma_f32_32x32x16_bf16 v[72:87], v[48:51], v[168:171], v[72:87]
    v_add_f32 v33, v33, v98
    v_add_f32 v33, v33, v99
    v_add_f32 v33, v33, v100
    v_mfma_f32_32x32x16_bf16 v[104:119], v[48:51], v[232:235], v[104:119]
    v_add_f32 v33, v33, v101
    v_add_f32 v33, v33, v102
    v_add_f32 v33, v33, v103
    ds_read_b64_tr_b16 v[48:49], v20 offset:0
    ds_read_b64_tr_b16 v[50:51], v20 offset:4096
    v_mfma_f32_32x32x16_bf16 v[72:87], v[52:55], v[172:175], v[72:87]
    v_cvt_pk_bf16_f32 v88, v88, v89
    v_cvt_pk_bf16_f32 v89, v90, v91
    v_cvt_pk_bf16_f32 v90, v92, v93
    v_mfma_f32_32x32x16_bf16 v[104:119], v[52:55], v[236:239], v[104:119]
    v_cvt_pk_bf16_f32 v91, v94, v95
    v_cvt_pk_bf16_f32 v92, v96, v97
    v_cvt_pk_bf16_f32 v93, v98, v99
    ds_read_b64_tr_b16 v[52:53], v21 offset:0
    ds_read_b64_tr_b16 v[54:55], v21 offset:4096
    s_waitcnt lgkmcnt(10)
    v_mfma_f32_32x32x16_bf16 v[72:87], v[56:59], v[176:179], v[72:87]
    v_cvt_pk_bf16_f32 v94, v100, v101
    v_cvt_pk_bf16_f32 v95, v102, v103
    v_mfma_f32_32x32x16_bf16 v[104:119], v[56:59], v[240:243], v[104:119]
    ds_read_b64_tr_b16 v[56:57], v18 offset:256
    ds_read_b64_tr_b16 v[58:59], v18 offset:4352
    v_mfma_f32_32x32x16_bf16 v[72:87], v[60:63], v[180:183], v[72:87]
    v_mfma_f32_32x32x16_bf16 v[104:119], v[60:63], v[244:247], v[104:119]
    ds_read_b64_tr_b16 v[60:61], v19 offset:256
    ds_read_b64_tr_b16 v[62:63], v19 offset:4352
    s_waitcnt lgkmcnt(12)
    v_mfma_f32_32x32x16_bf16 v[72:87], v[64:67], v[184:187], v[72:87]
    v_mfma_f32_32x32x16_bf16 v[104:119], v[64:67], v[248:251], v[104:119]
    ds_read_b64_tr_b16 v[64:65], v20 offset:256
    ds_read_b64_tr_b16 v[66:67], v20 offset:4352
    v_mfma_f32_32x32x16_bf16 v[72:87], v[68:71], v[188:191], v[72:87]
    v_mfma_f32_32x32x16_bf16 v[104:119], v[68:71], v[252:255], v[104:119]
    s_branch LK_19
LK_18:
    ds_read_b128 v[68:71], v17 offset:0
    s_waitcnt vmcnt(16)
    s_barrier
    s_add_u32 s43, s45, s32
    s_mov_b32 m0, s43
    s_add_u32 s44, s48, 16384
    buffer_load_dwordx4 v22, s[12:15], s44 offen offset:0 lds
    buffer_load_dwordx4 v23, s[12:15], s44 offen offset:1024 lds
    buffer_load_dwordx4 v24, s[12:15], s44 offen offset:2048 lds
    buffer_load_dwordx4 v25, s[12:15], s44 offen offset:3072 lds
    s_waitcnt lgkmcnt(6)
    v_mfma_f32_32x32x16_bf16 v[72:87], v[40:43], v[128:131], 0
    v_max3_f32 v2, v88, v89, v90
    v_max3_f32 v2, v2, v91, v92
    v_max3_f32 v2, v2, v93, v94
    v_max3_f32 v2, v2, v95, v96
    v_max3_f32 v2, v2, v97, v98
    v_max3_f32 v2, v2, v99, v100
    v_max3_f32 v2, v2, v101, v102
    v_max_f32 v2, v2, v103
    v_mov_b32 v3, v2
    s_nop 1
    ds_read_b128 v[40:43], v10 offset:256
    v_mfma_f32_32x32x16_bf16 v[72:87], v[44:47], v[132:135], v[72:87]
    v_permlane32_swap_b32 v2, v3
    v_max_f32 v2, v2, v3
    v_mul_f32 v2, s33, v2
    v_sub_f32 v3, v2, v32
    v_cmp_lt_f32 vcc, s34, v3
    s_nop 0
    s_cbranch_vccnz LRS_25
LRB_26:
    v_fma_f32 v88, v88, s33, -v32
    v_fma_f32 v89, v89, s33, -v32
    v_fma_f32 v90, v90, s33, -v32
    ds_read_b128 v[44:47], v11 offset:256
    s_waitcnt lgkmcnt(6)
    v_mfma_f32_32x32x16_bf16 v[72:87], v[48:51], v[136:139], v[72:87]
    v_fma_f32 v91, v91, s33, -v32
    v_fma_f32 v92, v92, s33, -v32
    v_fma_f32 v93, v93, s33, -v32
    v_fma_f32 v94, v94, s33, -v32
    v_fma_f32 v95, v95, s33, -v32
    v_fma_f32 v96, v96, s33, -v32
    v_fma_f32 v97, v97, s33, -v32
    v_fma_f32 v98, v98, s33, -v32
    v_fma_f32 v99, v99, s33, -v32
    v_fma_f32 v100, v100, s33, -v32
    ds_read_b128 v[48:51], v12 offset:256
    v_mfma_f32_32x32x16_bf16 v[72:87], v[52:55], v[140:143], v[72:87]
    v_fma_f32 v101, v101, s33, -v32
    v_fma_f32 v102, v102, s33, -v32
    v_fma_f32 v103, v103, s33, -v32
    v_exp_f32 v88, v88
    v_exp_f32 v89, v89
    v_exp_f32 v90, v90
    v_exp_f32 v91, v91
    v_exp_f32 v92, v92
    v_exp_f32 v93, v93
    v_exp_f32 v94, v94
    ds_read_b128 v[52:55], v13 offset:256
    s_waitcnt lgkmcnt(6)
    v_mfma_f32_32x32x16_bf16 v[72:87], v[56:59], v[144:147], v[72:87]
    v_exp_f32 v95, v95
    v_exp_f32 v96, v96
    v_exp_f32 v97, v97
    v_exp_f32 v98, v98
    v_exp_f32 v99, v99
    v_exp_f32 v100, v100
    v_exp_f32 v101, v101
    v_exp_f32 v102, v102
    v_exp_f32 v103, v103
    s_nop 0
    ds_read_b128 v[56:59], v14 offset:256
    v_mfma_f32_32x32x16_bf16 v[72:87], v[60:63], v[148:151], v[72:87]
    v_add_f32 v33, v33, v88
    v_add_f32 v33, v33, v89
    v_add_f32 v33, v33, v90
    v_add_f32 v33, v33, v91
    v_add_f32 v33, v33, v92
    v_add_f32 v33, v33, v93
    v_add_f32 v33, v33, v94
    v_add_f32 v33, v33, v95
    v_add_f32 v33, v33, v96
    v_add_f32 v33, v33, v97
    ds_read_b128 v[60:63], v15 offset:256
    s_waitcnt lgkmcnt(6)
    v_mfma_f32_32x32x16_bf16 v[72:87], v[64:67], v[152:155], v[72:87]
    v_add_f32 v33, v33, v98
    v_add_f32 v33, v33, v99
    v_add_f32 v33, v33, v100
    v_add_f32 v33, v33, v101
    v_add_f32 v33, v33, v102
    v_add_f32 v33, v33, v103
    v_cvt_pk_bf16_f32 v88, v88, v89
    v_cvt_pk_bf16_f32 v89, v90, v91
    v_cvt_pk_bf16_f32 v90, v92, v93
    v_cvt_pk_bf16_f32 v91, v94, v95
    ds_read_b128 v[64:67], v16 offset:256
    v_mfma_f32_32x32x16_bf16 v[72:87], v[68:71], v[156:159], v[72:87]
    v_cvt_pk_bf16_f32 v92, v96, v97
    v_cvt_pk_bf16_f32 v93, v98, v99
    v_cvt_pk_bf16_f32 v94, v100, v101
    v_cvt_pk_bf16_f32 v95, v102, v103
    v_max3_f32 v2, v104, v105, v106
    v_max3_f32 v2, v2, v107, v108
    v_max3_f32 v2, v2, v109, v110
    v_max3_f32 v2, v2, v111, v112
    v_max3_f32 v2, v2, v113, v114
    v_max3_f32 v2, v2, v115, v116
    ds_read_b128 v[68:71], v17 offset:256
    s_waitcnt lgkmcnt(6)
    v_mfma_f32_32x32x16_bf16 v[72:87], v[40:43], v[160:163], v[72:87]
    v_max3_f32 v2, v2, v117, v118
    v_max_f32 v2, v2, v119
    v_mov_b32 v3, v2
    s_nop 1
    v_permlane32_swap_b32 v2, v3
    v_max_f32 v2, v2, v3
    v_mul_f32 v2, s33, v2
    v_sub_f32 v3, v2, v34
    v_cmp_lt_f32 vcc, s34, v3
    s_nop 0
    ds_read_b64_tr_b16 v[40:41], v18 offset:0
    ds_read_b64_tr_b16 v[42:43], v18 offset:4096
    v_mfma_f32_32x32x16_bf16 v[72:87], v[44:47], v[164:167], v[72:87]
    s_cbranch_vccnz LRS_27
LRB_28:
    v_fma_f32 v104, v104, s33, -v34
    v_fma_f32 v105, v105, s33, -v34
    v_fma_f32 v106, v106, s33, -v34
    v_fma_f32 v107, v107, s33, -v34
    v_fma_f32 v108, v108, s33, -v34
    v_fma_f32 v109, v109, s33, -v34
    v_fma_f32 v110, v110, s33, -v34
    v_fma_f32 v111, v111, s33, -v34
    v_fma_f32 v112, v112, s33, -v34
    ds_read_b64_tr_b16 v[44:45], v19 offset:0
    ds_read_b64_tr_b16 v[46:47], v19 offset:4096
    s_waitcnt lgkmcnt(8)
    v_mfma_f32_32x32x16_bf16 v[72:87], v[48:51], v[168:171], v[72:87]
    v_fma_f32 v113, v113, s33, -v34
    v_fma_f32 v114, v114, s33, -v34
    v_fma_f32 v115, v115, s33, -v34
    v_fma_f32 v116, v116, s33, -v34
    v_fma_f32 v117, v117, s33, -v34
    v_fma_f32 v118, v118, s33, -v34
    v_fma_f32 v119, v119, s33, -v34
    v_exp_f32 v104, v104
    v_exp_f32 v105, v105
    v_exp_f32 v106, v106
    ds_read_b64_tr_b16 v[48:49], v20 offset:0
    ds_read_b64_tr_b16 v[50:51], v20 offset:4096
    v_mfma_f32_32x32x16_bf16 v[72:87], v[52:55], v[172:175], v[72:87]
    v_exp_f32 v107, v107
    v_exp_f32 v108, v108
    v_exp_f32 v109, v109
    v_exp_f32 v110, v110
    v_exp_f32 v111, v111
    v_exp_f32 v112, v112
    v_exp_f32 v113, v113
    v_exp_f32 v114, v114
    v_exp_f32 v115, v115
    v_exp_f32 v116, v116
    ds_read_b64_tr_b16 v[52:53], v21 offset:0
    ds_read_b64_tr_b16 v[54:55], v21 offset:4096
    s_waitcnt lgkmcnt(10)
    v_mfma_f32_32x32x16_bf16 v[72:87], v[56:59], v[176:179], v[72:87]
    v_exp_f32 v117, v117
    v_exp_f32 v118, v118
    v_exp_f32 v119, v119
    s_nop 0
    v_add_f32 v35, v35, v104
    v_add_f32 v35, v35, v105
    v_add_f32 v35, v35, v106
    v_add_f32 v35, v35, v107
    v_add_f32 v35, v35, v108
    v_add_f32 v35, v35, v109
    ds_read_b64_tr_b16 v[56:57], v18 offset:256
    ds_read_b64_tr_b16 v[58:59], v18 offset:4352
    v_mfma_f32_32x32x16_bf16 v[72:87], v[60:63], v[180:183], v[72:87]
    v_add_f32 v35, v35, v110
    v_add_f32 v35, v35, v111
    v_add_f32 v35, v35, v112
    v_add_f32 v35, v35, v113
    v_add_f32 v35, v35, v114
    v_add_f32 v35, v35, v115
    v_add_f32 v35, v35, v116
    v_add_f32 v35, v35, v117
    v_add_f32 v35, v35, v118
    v_add_f32 v35, v35, v119
    ds_read_b64_tr_b16 v[60:61], v19 offset:256
    ds_read_b64_tr_b16 v[62:63], v19 offset:4352
    s_waitcnt lgkmcnt(12)
    v_mfma_f32_32x32x16_bf16 v[72:87], v[64:67], v[184:187], v[72:87]
    v_cvt_pk_bf16_f32 v104, v104, v105
    v_cvt_pk_bf16_f32 v105, v106, v107
    v_cvt_pk_bf16_f32 v106, v108, v109
    v_cvt_pk_bf16_f32 v107, v110, v111
    v_cvt_pk_bf16_f32 v108, v112, v113
    v_cvt_pk_bf16_f32 v109, v114, v115
    v_cvt_pk_bf16_f32 v110, v116, v117
    v_cvt_pk_bf16_f32 v111, v118, v119
    ds_read_b64_tr_b16 v[64:65], v20 offset:256
    ds_read_b64_tr_b16 v[66:67], v20 offset:4352
    v_mfma_f32_32x32x16_bf16 v[72:87], v[68:71], v[188:191], v[72:87]
LK_19:
    s_add_u32 s43, s42, 16384
    s_cmp_ge_u32 s43, 114688
    s_cselect_b32 s43, 0, s43
    s_sub_u32 s46, s43, s41
    v_add_u32 v10, s46, v10
    v_add_u32 v11, s46, v11
    v_add_u32 v12, s46, v12
    v_add_u32 v13, s46, v13
    v_add_u32 v14, s46, v14
    v_add_u32 v15, s46, v15
    v_add_u32 v16, s46, v16
    v_add_u32 v17, s46, v17
    s_mov_b32 s46, s43
    s_cmp_eq_u32 s49, 1
    s_cbranch_scc1 LV_29
    ds_read_b64_tr_b16 v[68:69], v21 offset:256
    ds_read_b64_tr_b16 v[70:71], v21 offset:4352
    s_waitcnt vmcnt(16)
    s_barrier
    s_add_u32 s43, s41, s32
    s_mov_b32 m0, s43
    s_nop 0
    buffer_load_dwordx4 v26, s[16:19], s48 offen offset:0 lds
    buffer_load_dwordx4 v27, s[16:19], s48 offen offset:1024 lds
    buffer_load_dwordx4 v26, s[16:19], s48 offen offset:2048 lds
    buffer_load_dwordx4 v27, s[16:19], s48 offen offset:3072 lds
    s_waitcnt lgkmcnt(12)
    v_mfma_f32_32x32x16_bf16 a[0:15], v[40:43], v[88:91], a[0:15]
    ds_read_b64_tr_b16 v[40:41], v18 offset:8192
    ds_read_b64_tr_b16 v[42:43], v18 offset:12288
    v_mfma_f32_32x32x16_bf16 a[16:31], v[44:47], v[88:91], a[16:31]
    ds_read_b64_tr_b16 v[44:45], v19 offset:8192
    ds_read_b64_tr_b16 v[46:47], v19 offset:12288
    s_waitcnt lgkmcnt(12)
    v_mfma_f32_32x32x16_bf16 a[32:47], v[48:51], v[88:91], a[32:47]
    ds_read_b64_tr_b16 v[48:49], v20 offset:8192
    ds_read_b64_tr_b16 v[50:51], v20 offset:12288
    v_mfma_f32_32x32x16_bf16 a[48:63], v[52:55], v[88:91], a[48:63]
    ds_read_b64_tr_b16 v[52:53], v21 offset:8192
    ds_read_b64_tr_b16 v[54:55], v21 offset:12288
    s_waitcnt lgkmcnt(12)
    v_mfma_f32_32x32x16_bf16 a[64:79], v[56:59], v[88:91], a[64:79]
    ds_read_b64_tr_b16 v[56:57], v18 offset:8448
    ds_read_b64_tr_b16 v[58:59], v18 offset:12544
    v_mfma_f32_32x32x16_bf16 a[80:95], v[60:63], v[88:91], a[80:95]
    ds_read_b64_tr_b16 v[60:61], v19 offset:8448
    ds_read_b64_tr_b16 v[62:63], v19 offset:12544
    s_waitcnt lgkmcnt(12)
    v_mfma_f32_32x32x16_bf16 a[96:111], v[64:67], v[88:91], a[96:111]
    ds_read_b64_tr_b16 v[64:65], v20 offset:8448
    ds_read_b64_tr_b16 v[66:67], v20 offset:12544
    v_mfma_f32_32x32x16_bf16 a[112:127], v[68:71], v[88:91], a[112:127]
    ds_read_b64_tr_b16 v[68:69], v21 offset:8448
    ds_read_b64_tr_b16 v[70:71], v21 offset:12544
    s_waitcnt lgkmcnt(12)
    v_mfma_f32_32x32x16_bf16 a[0:15], v[40:43], v[92:95], a[0:15]
    ds_read_b128 v[40:43], v10 offset:0
    v_mfma_f32_32x32x16_bf16 a[16:31], v[44:47], v[92:95], a[16:31]
    ds_read_b128 v[44:47], v11 offset:0
    s_waitcnt lgkmcnt(10)
    v_mfma_f32_32x32x16_bf16 a[32:47], v[48:51], v[92:95], a[32:47]
    ds_read_b128 v[48:51], v12 offset:0
    v_mfma_f32_32x32x16_bf16 a[48:63], v[52:55], v[92:95], a[48:63]
    ds_read_b128 v[52:55], v13 offset:0
    s_waitcnt lgkmcnt(8)
    v_mfma_f32_32x32x16_bf16 a[64:79], v[56:59], v[92:95], a[64:79]
    ds_read_b128 v[56:59], v14 offset:0
    v_mfma_f32_32x32x16_bf16 a[80:95], v[60:63], v[92:95], a[80:95]
    ds_read_b128 v[60:63], v15 offset:0
    s_waitcnt lgkmcnt(6)
    v_mfma_f32_32x32x16_bf16 a[96:111], v[64:67], v[92:95], a[96:111]
    ds_read_b128 v[64:67], v16 offset:0
    v_mfma_f32_32x32x16_bf16 a[112:127], v[68:71], v[92:95], a[112:127]
    s_branch LV_30
LV_29:
    ds_read_b64_tr_b16 v[68:69], v21 offset:256
    ds_read_b64_tr_b16 v[70:71], v21 offset:4352
    s_waitcnt vmcnt(16)
    s_barrier
    s_add_u32 s43, s41, s32
    s_mov_b32 m0, s43
    s_nop 0
    buffer_load_dwordx4 v26, s[16:19], s48 offen offset:0 lds
    buffer_load_dwordx4 v27, s[16:19], s48 offen offset:1024 lds
    buffer_load_dwordx4 v26, s[16:19], s48 offen offset:2048 lds
    buffer_load_dwordx4 v27, s[16:19], s48 offen offset:3072 lds
    s_waitcnt lgkmcnt(12)
    v_mfma_f32_32x32x16_bf16 a[0:15], v[40:43], v[88:91], a[0:15]
    v_mfma_f32_32x32x16_bf16 a[128:143], v[40:43], v[104:107], a[128:143]
    ds_read_b64_tr_b16 v[40:41], v18 offset:8192
    ds_read_b64_tr_b16 v[42:43], v18 offset:12288
    v_mfma_f32_32x32x16_bf16 a[16:31], v[44:47], v[88:91], a[16:31]
    v_mfma_f32_32x32x16_bf16 a[144:159], v[44:47], v[104:107], a[144:159]
    ds_read_b64_tr_b16 v[44:45], v19 offset:8192
    ds_read_b64_tr_b16 v[46:47], v19 offset:12288
    s_waitcnt lgkmcnt(12)
    v_mfma_f32_32x32x16_bf16 a[32:47], v[48:51], v[88:91], a[32:47]
    v_mfma_f32_32x32x16_bf16 a[160:175], v[48:51], v[104:107], a[160:175]
    ds_read_b64_tr_b16 v[48:49], v20 offset:8192
    ds_read_b64_tr_b16 v[50:51], v20 offset:12288
    v_mfma_f32_32x32x16_bf16 a[48:63], v[52:55], v[88:91], a[48:63]
    v_mfma_f32_32x32x16_bf16 a[176:191], v[52:55], v[104:107], a[176:191]
    ds_read_b64_tr_b16 v[52:53], v21 offset:8192
    ds_read_b64_tr_b16 v[54:55], v21 offset:12288
    s_waitcnt lgkmcnt(12)
    v_mfma_f32_32x32x16_bf16 a[64:79], v[56:59], v[88:91], a[64:79]
    v_mfma_f32_32x32x16_bf16 a[192:207], v[56:59], v[104:107], a[192:207]
    ds_read_b64_tr_b16 v[56:57], v18 offset:8448
    ds_read_b64_tr_b16 v[58:59], v18 offset:12544
    v_mfma_f32_32x32x16_bf16 a[80:95], v[60:63], v[88:91], a[80:95]
    v_mfma_f32_32x32x16_bf16 a[208:223], v[60:63], v[104:107], a[208:223]
    ds_read_b64_tr_b16 v[60:61], v19 offset:8448
    ds_read_b64_tr_b16 v[62:63], v19 offset:12544
    s_waitcnt lgkmcnt(12)
    v_mfma_f32_32x32x16_bf16 a[96:111], v[64:67], v[88:91], a[96:111]
    v_mfma_f32_32x32x16_bf16 a[224:239], v[64:67], v[104:107], a[224:239]
    ds_read_b64_tr_b16 v[64:65], v20 offset:8448
    ds_read_b64_tr_b16 v[66:67], v20 offset:12544
    v_mfma_f32_32x32x16_bf16 a[112:127], v[68:71], v[88:91], a[112:127]
    v_mfma_f32_32x32x16_bf16 a[240:255], v[68:71], v[104:107], a[240:255]
    ds_read_b64_tr_b16 v[68:69], v21 offset:8448
    ds_read_b64_tr_b16 v[70:71], v21 offset:12544
    s_waitcnt lgkmcnt(12)
    v_mfma_f32_32x32x16_bf16 a[0:15], v[40:43], v[92:95], a[0:15]
    v_mfma_f32_32x32x16_bf16 a[128:143], v[40:43], v[108:111], a[128:143]
    ds_read_b128 v[40:43], v10 offset:0
    v_mfma_f32_32x32x16_bf16 a[16:31], v[44:47], v[92:95], a[16:31]
    v_mfma_f32_32x32x16_bf16 a[144:159], v[44:47], v[108:111], a[144:159]
    ds_read_b128 v[44:47], v11 offset:0
    s_waitcnt lgkmcnt(10)
    v_mfma_f32_32x32x16_bf16 a[32:47], v[48:51], v[92:95], a[32:47]
    v_mfma_f32_32x32x16_bf16 a[160:175], v[48:51], v[108:111], a[160:175]
    ds_read_b128 v[48:51], v12 offset:0
    v_mfma_f32_32x32x16_bf16 a[48:63], v[52:55], v[92:95], a[48:63]
    v_mfma_f32_32x32x16_bf16 a[176:191], v[52:55], v[108:111], a[176:191]
    ds_read_b128 v[52:55], v13 offset:0
    s_waitcnt lgkmcnt(8)
    v_mfma_f32_32x32x16_bf16 a[64:79], v[56:59], v[92:95], a[64:79]
    v_mfma_f32_32x32x16_bf16 a[192:207], v[56:59], v[108:111], a[192:207]
    ds_read_b128 v[56:59], v14 offset:0
    v_mfma_f32_32x32x16_bf16 a[80:95], v[60:63], v[92:95], a[80:95]
    v_mfma_f32_32x32x16_bf16 a[208:223], v[60:63], v[108:111], a[208:223]
    ds_read_b128 v[60:63], v15 offset:0
    s_waitcnt lgkmcnt(6)
    v_mfma_f32_32x32x16_bf16 a[96:111], v[64:67], v[92:95], a[96:111]
    v_mfma_f32_32x32x16_bf16 a[224:239], v[64:67], v[108:111], a[224:239]
    ds_read_b128 v[64:67], v16 offset:0
    v_mfma_f32_32x32x16_bf16 a[112:127], v[68:71], v[92:95], a[112:127]
    v_mfma_f32_32x32x16_bf16 a[240:255], v[68:71], v[108:111], a[240:255]
LV_30:
    s_mov_b32 s45, s42
    s_add_u32 s43, s46, 16384
    s_cmp_ge_u32 s43, 114688
    s_cselect_b32 s43, 0, s43
    s_sub_u32 s47, s43, s42
    v_add_u32 v18, s47, v18
    v_add_u32 v19, s47, v19
    v_add_u32 v20, s47, v20
    v_add_u32 v21, s47, v21
    s_mov_b32 s42, s43
    s_mov_b32 s41, s46
    s_add_u32 s48, s48, 16384
    s_add_u32 s40, s40, 1
    s_cmp_lt_u32 s40, 10
    s_cbranch_scc1 L_attn_loop
    s_cmp_eq_u32 s7, 2
    s_cselect_b32 s49, 1, 0
    s_cmp_eq_u32 s7, 3
    s_cselect_b32 s50, 1, 0
    s_cmp_eq_u32 s50, 1
    s_cbranch_scc1 LK_31
    s_cmp_eq_u32 s49, 1
    s_cbranch_scc1 LK_32
    ds_read_b128 v[68:71], v17 offset:0
    s_waitcnt vmcnt(16)
    s_barrier
    s_add_u32 s43, s32, 98304
    s_mov_b32 m0, s43
    s_add_u32 s44, s36, 229376
    buffer_load_dwordx4 v22, s[12:15], s44 offen offset:0 lds
    buffer_load_dwordx4 v23, s[12:15], s44 offen offset:1024 lds
    buffer_load_dwordx4 v24, s[12:15], s44 offen offset:2048 lds
    buffer_load_dwordx4 v25, s[12:15], s44 offen offset:3072 lds
    s_waitcnt lgkmcnt(6)
    v_mfma_f32_32x32x16_bf16 v[88:103], v[40:43], v[128:131], 0
    v_max3_f32 v2, v72, v73, v74
    v_max3_f32 v2, v2, v75, v76
    v_max3_f32 v2, v2, v77, v78
    v_max3_f32 v2, v2, v79, v80
    v_max3_f32 v2, v2, v81, v82
    ds_read_b128 v[40:43], v10 offset:256
    v_mfma_f32_32x32x16_bf16 v[88:103], v[44:47], v[132:135], v[88:103]
    v_max3_f32 v2, v2, v83, v84
    v_max3_f32 v2, v2, v85, v86
    v_max_f32 v2, v2, v87
    v_mov_b32 v3, v2
    s_nop 1
    ds_read_b128 v[44:47], v11 offset:256
    s_waitcnt lgkmcnt(6)
    v_mfma_f32_32x32x16_bf16 v[88:103], v[48:51], v[136:139], v[88:103]
    v_permlane32_swap_b32 v2, v3
    v_max_f32 v2, v2, v3
    v_mul_f32 v2, s33, v2
    v_sub_f32 v3, v2, v32
    v_cmp_lt_f32 vcc, s34, v3
    ds_read_b128 v[48:51], v12 offset:256
    v_mfma_f32_32x32x16_bf16 v[88:103], v[52:55], v[140:143], v[88:103]
    s_nop 0
    s_cbranch_vccnz LRS_35
LRB_36:
    v_fma_f32 v72, v72, s33, -v32
    v_fma_f32 v73, v73, s33, -v32
    v_fma_f32 v74, v74, s33, -v32
    ds_read_b128 v[52:55], v13 offset:256
    s_waitcnt lgkmcnt(6)
    v_mfma_f32_32x32x16_bf16 v[88:103], v[56:59], v[144:147], v[88:103]
    v_fma_f32 v75, v75, s33, -v32
    v_fma_f32 v76, v76, s33, -v32
    v_fma_f32 v77, v77, s33, -v32
    v_fma_f32 v78, v78, s33, -v32
    v_fma_f32 v79, v79, s33, -v32
    ds_read_b128 v[56:59], v14 offset:256
    v_mfma_f32_32x32x16_bf16 v[88:103], v[60:63], v[148:151], v[88:103]
    v_fma_f32 v80, v80, s33, -v32
    v_fma_f32 v81, v81, s33, -v32
    v_fma_f32 v82, v82, s33, -v32
    v_fma_f32 v83, v83, s33, -v32
    v_fma_f32 v84, v84, s33, -v32
    ds_read_b128 v[60:63], v15 offset:256
    s_waitcnt lgkmcnt(6)
    v_mfma_f32_32x32x16_bf16 v[88:103], v[64:67], v[152:155], v[88:103]
    v_fma_f32 v85, v85, s33, -v32
    v_fma_f32 v86, v86, s33, -v32
    v_fma_f32 v87, v87, s33, -v32
    v_exp_f32 v72, v72
    v_exp_f32 v73, v73
    ds_read_b128 v[64:67], v16 offset:256
    v_mfma_f32_32x32x16_bf16 v[88:103], v[68:71], v[156:159], v[88:103]
    v_exp_f32 v74, v74
    v_exp_f32 v75, v75
    v_exp_f32 v76, v76
    v_exp_f32 v77, v77
    v_exp_f32 v78, v78
    ds_read_b128 v[68:71], v17 offset:256
    s_waitcnt lgkmcnt(6)
    v_mfma_f32_32x32x16_bf16 v[88:103], v[40:43], v[160:163], v[88:103]
    v_exp_f32 v79, v79
    v_exp_f32 v80, v80
    v_exp_f32 v81, v81
    v_exp_f32 v82, v82
    v_exp_f32 v83, v83
    ds_read_b64_tr_b16 v[40:41], v18 offset:0
    ds_read_b64_tr_b16 v[42:43], v18 offset:4096
    v_mfma_f32_32x32x16_bf16 v[88:103], v[44:47], v[164:167], v[88:103]
    v_exp_f32 v84, v84
    v_exp_f32 v85, v85
    v_exp_f32 v86, v86
    v_exp_f32 v87, v87
    s_nop 0
    ds_read_b64_tr_b16 v[44:45], v19 offset:0
    ds_read_b64_tr_b16 v[46:47], v19 offset:4096
    s_waitcnt lgkmcnt(8)
    v_mfma_f32_32x32x16_bf16 v[88:103], v[48:51], v[168:171], v[88:103]
    v_add_f32 v33, v33, v72
    v_add_f32 v33, v33, v73
    v_add_f32 v33, v33, v74
    v_add_f32 v33, v33, v75
    v_add_f32 v33, v33, v76
    ds_read_b64_tr_b16 v[48:49], v20 offset:0
    ds_read_b64_tr_b16 v[50:51], v20 offset:4096
    v_mfma_f32_32x32x16_bf16 v[88:103], v[52:55], v[172:175], v[88:103]
    v_add_f32 v33, v33, v77
    v_add_f32 v33, v33, v78
    v_add_f32 v33, v33, v79
    v_add_f32 v33, v33, v80
    v_add_f32 v33, v33, v81
    ds_read_b64_tr_b16 v[52:53], v21 offset:0
    ds_read_b64_tr_b16 v[54:55], v21 offset:4096
    s_waitcnt lgkmcnt(10)
    v_mfma_f32_32x32x16_bf16 v[88:103], v[56:59], v[176:179], v[88:103]
    v_add_f32 v33, v33, v82
    v_add_f32 v33, v33, v83
    v_add_f32 v33, v33, v84
    v_add_f32 v33, v33, v85
    v_add_f32 v33, v33, v86
    ds_read_b64_tr_b16 v[56:57], v18 offset:256
    ds_read_b64_tr_b16 v[58:59], v18 offset:4352
    v_mfma_f32_32x32x16_bf16 v[88:103], v[60:63], v[180:183], v[88:103]
    v_add_f32 v33, v33, v87
    v_cvt_pk_bf16_f32 v72, v72, v73
    v_cvt_pk_bf16_f32 v73, v74, v75
    v_cvt_pk_bf16_f32 v74, v76, v77
    v_cvt_pk_bf16_f32 v75, v78, v79
    ds_read_b64_tr_b16 v[60:61], v19 offset:256
    ds_read_b64_tr_b16 v[62:63], v19 offset:4352
    s_waitcnt lgkmcnt(12)
    v_mfma_f32_32x32x16_bf16 v[88:103], v[64:67], v[184:187], v[88:103]
    v_cvt_pk_bf16_f32 v76, v80, v81
    v_cvt_pk_bf16_f32 v77, v82, v83
    v_cvt_pk_bf16_f32 v78, v84, v85
    v_cvt_pk_bf16_f32 v79, v86, v87
    ds_read_b64_tr_b16 v[64:65], v20 offset:256
    ds_read_b64_tr_b16 v[66:67], v20 offset:4352
    v_mfma_f32_32x32x16_bf16 v[88:103], v[68:71], v[188:191], v[88:103]
    s_branch LK_33
LK_31:
    ds_read_b128 v[68:71], v17 offset:0
    s_waitcnt vmcnt(20)
    s_barrier
    s_add_u32 s43, s32, 98304
    s_mov_b32 m0, s43
    s_add_u32 s44, s36, 229376
    buffer_load_dwordx4 v22, s[12:15], s44 offen offset:0 lds
    buffer_load_dwordx4 v23, s[12:15], s44 offen offset:1024 lds
    buffer_load_dwordx4 v24, s[12:15], s44 offen offset:2048 lds
    buffer_load_dwordx4 v25, s[12:15], s44 offen offset:3072 lds
    s_waitcnt lgkmcnt(6)
    v_mfma_f32_32x32x16_bf16 v[88:103], v[40:43], v[128:131], 0
    v_max3_f32 v2, v72, v73, v74
    v_max3_f32 v2, v2, v75, v76
    v_max3_f32 v2, v2, v77, v78
    v_mfma_f32_32x32x16_bf16 v[104:119], v[40:43], v[192:195], 0
    v_max3_f32 v2, v2, v79, v80
    v_max3_f32 v2, v2, v81, v82
    v_max3_f32 v2, v2, v83, v84
    ds_read_b128 v[40:43], v10 offset:256
    v_mfma_f32_32x32x16_bf16 v[88:103], v[44:47], v[132:135], v[88:103]
    v_max3_f32 v2, v2, v85, v86
    v_max_f32 v2, v2, v87
    v_mov_b32 v3, v2
    v_mfma_f32_32x32x16_bf16 v[104:119], v[44:47], v[196:199], v[104:119]
    s_nop 1
    v_permlane32_swap_b32 v2, v3
    v_max_f32 v2, v2, v3
    ds_read_b128 v[44:47], v11 offset:256
    s_waitcnt lgkmcnt(6)
    v_mfma_f32_32x32x16_bf16 v[88:103], v[48:51], v[136:139], v[88:103]
    v_mul_f32 v2, s33, v2
    v_sub_f32 v3, v2, v32
    v_cmp_lt_f32 vcc, s34, v3
    v_mfma_f32_32x32x16_bf16 v[104:119], v[48:51], v[200:203], v[104:119]
    s_nop 0
    s_cbranch_vccnz LRS_37
LRB_38:
    v_fma_f32 v72, v72, s33, -v32
    ds_read_b128 v[48:51], v12 offset:256
    v_mfma_f32_32x32x16_bf16 v[88:103], v[52:55], v[140:143], v[88:103]
    v_fma_f32 v73, v73, s33, -v32
    v_fma_f32 v74, v74, s33, -v32
    v_fma_f32 v75, v75, s33, -v32
    v_mfma_f32_32x32x16_bf16 v[104:119], v[52:55], v[204:207], v[104:119]
    v_fma_f32 v76, v76, s33, -v32
    v_fma_f32 v77, v77, s33, -v32
    v_fma_f32 v78, v78, s33, -v32
    ds_read_b128 v[52:55], v13 offset:256
    s_waitcnt lgkmcnt(6)
    v_mfma_f32_32x32x16_bf16 v[88:103], v[56:59], v[144:147], v[88:103]
    v_fma_f32 v79, v79, s33, -v32
    v_fma_f32 v80, v80, s33, -v32
    v_fma_f32 v81, v81, s33, -v32
    v_mfma_f32_32x32x16_bf16 v[104:119], v[56:59], v[208:211], v[104:119]
    v_fma_f32 v82, v82, s33, -v32
    v_fma_f32 v83, v83, s33, -v32
    v_fma_f32 v84, v84, s33, -v32
    ds_read_b128 v[56:59], v14 offset:256
    v_mfma_f32_32x32x16_bf16 v[88:103], v[60:63], v[148:151], v[88:103]
    v_fma_f32 v85, v85, s33, -v32
    v_fma_f32 v86, v86, s33, -v32
    v_fma_f32 v87, v87, s33, -v32
    v_mfma_f32_32x32x16_bf16 v[104:119], v[60:63], v[212:215], v[104:119]
    v_exp_f32 v72, v72
    v_exp_f32 v73, v73
    v_exp_f32 v74, v74
    ds_read_b128 v[60:63], v15 offset:256
    s_waitcnt lgkmcnt(6)
    v_mfma_f32_32x32x16_bf16 v[88:103], v[64:67], v[152:155], v[88:103]
    v_exp_f32 v75, v75
    v_exp_f32 v76, v76
    v_exp_f32 v77, v77
    v_mfma_f32_32x32x16_bf16 v[104:119], v[64:67], v[216:219], v[104:119]
    v_exp_f32 v78, v78
    v_exp_f32 v79, v79
    v_exp_f32 v80, v80
    ds_read_b128 v[64:67], v16 offset:256
    v_mfma_f32_32x32x16_bf16 v[88:103], v[68:71], v[156:159], v[88:103]
    v_exp_f32 v81, v81
    v_exp_f32 v82, v82
    v_exp_f32 v83, v83
    v_mfma_f32_32x32x16_bf16 v[104:119], v[68:71], v[220:223], v[104:119]
    v_exp_f32 v84, v84
    v_exp_f32 v85, v85
    v_exp_f32 v86, v86
    ds_read_b128 v[68:71], v17 offset:256
    s_waitcnt lgkmcnt(6)
    v_mfma_f32_32x32x16_bf16 v[88:103], v[40:43], v[160:163], v[88:103]
    v_exp_f32 v87, v87
    s_nop 0
    v_add_f32 v33, v33, v72
    v_mfma_f32_32x32x16_bf16 v[104:119], v[40:43], v[224:227], v[104:119]
    v_add_f32 v33, v33, v73
    v_add_f32 v33, v33, v74
    v_add_f32 v33, v33, v75
    ds_read_b64_tr_b16 v[40:41], v18 offset:0
    ds_read_b64_tr_b16 v[42:43], v18 offset:4096
    v_mfma_f32_32x32x16_bf16 v[88:103], v[44:47], v[164:167], v[88:103]
    v_add_f32 v33, v33, v76
    v_add_f32 v33, v33, v77
    v_add_f32 v33, v33, v78
    v_mfma_f32_32x32x16_bf16 v[104:119], v[44:47], v[228:231], v[104:119]
    v_add_f32 v33, v33, v79
    v_add_f32 v33, v33, v80
    v_add_f32 v33, v33, v81
    ds_read_b64_tr_b16 v[44:45], v19 offset:0
    ds_read_b64_tr_b16 v[46:47], v19 offset:4096
    s_waitcnt lgkmcnt(8)
    v_mfma_f32_32x32x16_bf16 v[88:103], v[48:51], v[168:171], v[88:103]
    v_add_f32 v33, v33, v82
    v_add_f32 v33, v33, v83
    v_add_f32 v33, v33, v84
    v_mfma_f32_32x32x16_bf16 v[104:119], v[48:51], v[232:235], v[104:119]
    v_add_f32 v33, v33, v85
    v_add_f32 v33, v33, v86
    v_add_f32 v33, v33, v87
    ds_read_b64_tr_b16 v[48:49], v20 offset:0
    ds_read_b64_tr_b16 v[50:51], v20 offset:4096
    v_mfma_f32_32x32x16_bf16 v[88:103], v[52:55], v[172:175], v[88:103]
    v_cvt_pk_bf16_f32 v72, v72, v73
    v_cvt_pk_bf16_f32 v73, v74, v75
    v_cvt_pk_bf16_f32 v74, v76, v77
    v_mfma_f32_32x32x16_bf16 v[104:119], v[52:55], v[236:239], v[104:119]
    v_cvt_pk_bf16_f32 v75, v78, v79
    v_cvt_pk_bf16_f32 v76, v80, v81
    v_cvt_pk_bf16_f32 v77, v82, v83
    ds_read_b64_tr_b16 v[52:53], v21 offset:0
    ds_read_b64_tr_b16 v[54:55], v21 offset:4096
    s_waitcnt lgkmcnt(10)
    v_mfma_f32_32x32x16_bf16 v[88:103], v[56:59], v[176:179], v[88:103]
    v_cvt_pk_bf16_f32 v78, v84, v85
    v_cvt_pk_bf16_f32 v79, v86, v87
    v_mfma_f32_32x32x16_bf16 v[104:119], v[56:59], v[240:243], v[104:119]
    ds_read_b64_tr_b16 v[56:57], v18 offset:256
    ds_read_b64_tr_b16 v[58:59], v18 offset:4352
    v_mfma_f32_32x32x16_bf16 v[88:103], v[60:63], v[180:183], v[88:103]
    v_mfma_f32_32x32x16_bf16 v[104:119], v[60:63], v[244:247], v[104:119]
    ds_read_b64_tr_b16 v[60:61], v19 offset:256
    ds_read_b64_tr_b16 v[62:63], v19 offset:4352
    s_waitcnt lgkmcnt(12)
    v_mfma_f32_32x32x16_bf16 v[88:103], v[64:67], v[184:187], v[88:103]
    v_mfma_f32_32x32x16_bf16 v[104:119], v[64:67], v[248:251], v[104:119]
    ds_read_b64_tr_b16 v[64:65], v20 offset:256
    ds_read_b64_tr_b16 v[66:67], v20 offset:4352
    v_mfma_f32_32x32x16_bf16 v[88:103], v[68:71], v[188:191], v[88:103]
    v_mfma_f32_32x32x16_bf16 v[104:119], v[68:71], v[252:255], v[104:119]
    s_branch LK_33
LK_32:
    ds_read_b128 v[68:71], v17 offset:0
    s_waitcnt vmcnt(24)
    s_barrier
    s_add_u32 s43, s32, 98304
    s_mov_b32 m0, s43
    s_add_u32 s44, s36, 229376
    buffer_load_dwordx4 v22, s[12:15], s44 offen offset:0 lds
    buffer_load_dwordx4 v23, s[12:15], s44 offen offset:1024 lds
    buffer_load_dwordx4 v24, s[12:15], s44 offen offset:2048 lds
    buffer_load_dwordx4 v25, s[12:15], s44 offen offset:3072 lds
    s_waitcnt lgkmcnt(6)
    v_mfma_f32_32x32x16_bf16 v[88:103], v[40:43], v[128:131], 0
    v_max3_f32 v2, v72, v73, v74
    v_max3_f32 v2, v2, v75, v76
    v_max3_f32 v2, v2, v77, v78
    v_max3_f32 v2, v2, v79, v80
    v_max3_f32 v2, v2, v81, v82
    v_max3_f32 v2, v2, v83, v84
    v_max3_f32 v2, v2, v85, v86
    v_max_f32 v2, v2, v87
    v_mov_b32 v3, v2
    s_nop 1
    ds_read_b128 v[40:43], v10 offset:256
    v_mfma_f32_32x32x16_bf16 v[88:103], v[44:47], v[132:135], v[88:103]
    v_permlane32_swap_b32 v2, v3
    v_max_f32 v2, v2, v3
    v_mul_f32 v2, s33, v2
    v_sub_f32 v3, v2, v32
    v_cmp_lt_f32 vcc, s34, v3
    s_nop 0
    s_cbranch_vccnz LRS_39
LRB_40:
    v_fma_f32 v72, v72, s33, -v32
    v_fma_f32 v73, v73, s33, -v32
    v_fma_f32 v74, v74, s33, -v32
    ds_read_b128 v[44:47], v11 offset:256
    s_waitcnt lgkmcnt(6)
    v_mfma_f32_32x32x16_bf16 v[88:103], v[48:51], v[136:139], v[88:103]
    v_fma_f32 v75, v75, s33, -v32
    v_fma_f32 v76, v76, s33, -v32
    v_fma_f32 v77, v77, s33, -v32
    v_fma_f32 v78, v78, s33, -v32
    v_fma_f32 v79, v79, s33, -v32
    v_fma_f32 v80, v80, s33, -v32
    v_fma_f32 v81, v81, s33, -v32
    v_fma_f32 v82, v82, s33, -v32
    v_fma_f32 v83, v83, s33, -v32
    v_fma_f32 v84, v84, s33, -v32
    ds_read_b128 v[48:51], v12 offset:256
    v_mfma_f32_32x32x16_bf16 v[88:103], v[52:55], v[140:143], v[88:103]
    v_fma_f32 v85, v85, s33, -v32
    v_fma_f32 v86, v86, s33, -v32
    v_fma_f32 v87, v87, s33, -v32
    v_exp_f32 v72, v72
    v_exp_f32 v73, v73
    v_exp_f32 v74, v74
    v_exp_f32 v75, v75
    v_exp_f32 v76, v76
    v_exp_f32 v77, v77
    v_exp_f32 v78, v78
    ds_read_b128 v[52:55], v13 offset:256
    s_waitcnt lgkmcnt(6)
    v_mfma_f32_32x32x16_bf16 v[88:103], v[56:59], v[144:147], v[88:103]
    v_exp_f32 v79, v79
    v_exp_f32 v80, v80
    v_exp_f32 v81, v81
    v_exp_f32 v82, v82
    v_exp_f32 v83, v83
    v_exp_f32 v84, v84
    v_exp_f32 v85, v85
    v_exp_f32 v86, v86
    v_exp_f32 v87, v87
    s_nop 0
    ds_read_b128 v[56:59], v14 offset:256
    v_mfma_f32_32x32x16_bf16 v[88:103], v[60:63], v[148:151], v[88:103]
    v_add_f32 v33, v33, v72
    v_add_f32 v33, v33, v73
    v_add_f32 v33, v33, v74
    v_add_f32 v33, v33, v75
    v_add_f32 v33, v33, v76
    v_add_f32 v33, v33, v77
    v_add_f32 v33, v33, v78
    v_add_f32 v33, v33, v79
    v_add_f32 v33, v33, v80
    v_add_f32 v33, v33, v81
    ds_read_b128 v[60:63], v15 offset:256
    s_waitcnt lgkmcnt(6)
    v_mfma_f32_32x32x16_bf16 v[88:103], v[64:67], v[152:155], v[88:103]
    v_add_f32 v33, v33, v82
    v_add_f32 v33, v33, v83
    v_add_f32 v33, v33, v84
    v_add_f32 v33, v33, v85
    v_add_f32 v33, v33, v86
    v_add_f32 v33, v33, v87
    v_cvt_pk_bf16_f32 v72, v72, v73
    v_cvt_pk_bf16_f32 v73, v74, v75
    v_cvt_pk_bf16_f32 v74, v76, v77
    v_cvt_pk_bf16_f32 v75, v78, v79
    ds_read_b128 v[64:67], v16 offset:256
    v_mfma_f32_32x32x16_bf16 v[88:103], v[68:71], v[156:159], v[88:103]
    v_cvt_pk_bf16_f32 v76, v80, v81
    v_cvt_pk_bf16_f32 v77, v82, v83
    v_cvt_pk_bf16_f32 v78, v84, v85
    v_cvt_pk_bf16_f32 v79, v86, v87
    v_max3_f32 v2, v104, v105, v106
    v_max3_f32 v2, v2, v107, v108
    v_max3_f32 v2, v2, v109, v110
    v_max3_f32 v2, v2, v111, v112
    v_max3_f32 v2, v2, v113, v114
    v_max3_f32 v2, v2, v115, v116
    ds_read_b128 v[68:71], v17 offset:256
    s_waitcnt lgkmcnt(6)
    v_mfma_f32_32x32x16_bf16 v[88:103], v[40:43], v[160:163], v[88:103]
    v_max3_f32 v2, v2, v117, v118
    v_max_f32 v2, v2, v119
    v_mov_b32 v3, v2
    s_nop 1
    v_permlane32_swap_b32 v2, v3
    v_max_f32 v2, v2, v3
    v_mul_f32 v2, s33, v2
    v_sub_f32 v3, v2, v34
    v_cmp_lt_f32 vcc, s34, v3
    s_nop 0
    ds_read_b64_tr_b16 v[40:41], v18 offset:0
    ds_read_b64_tr_b16 v[42:43], v18 offset:4096
    v_mfma_f32_32x32x16_bf16 v[88:103], v[44:47], v[164:167], v[88:103]
    s_cbranch_vccnz LRS_41
LRB_42:
    v_fma_f32 v104, v104, s33, -v34
    v_fma_f32 v105, v105, s33, -v34
    v_fma_f32 v106, v106, s33, -v34
    v_fma_f32 v107, v107, s33, -v34
    v_fma_f32 v108, v108, s33, -v34
    v_fma_f32 v109, v109, s33, -v34
    v_fma_f32 v110, v110, s33, -v34
    v_fma_f32 v111, v111, s33, -v34
    v_fma_f32 v112, v112, s33, -v34
    ds_read_b64_tr_b16 v[44:45], v19 offset:0
    ds_read_b64_tr_b16 v[46:47], v19 offset:4096
    s_waitcnt lgkmcnt(8)
    v_mfma_f32_32x32x16_bf16 v[88:103], v[48:51], v[168:171], v[88:103]
    v_fma_f32 v113, v113, s33, -v34
    v_fma_f32 v114, v114, s33, -v34
    v_fma_f32 v115, v115, s33, -v34
    v_fma_f32 v116, v116, s33, -v34
    v_fma_f32 v117, v117, s33, -v34
    v_fma_f32 v118, v118, s33, -v34
    v_fma_f32 v119, v119, s33, -v34
    v_exp_f32 v104, v104
    v_exp_f32 v105, v105
    v_exp_f32 v106, v106
    ds_read_b64_tr_b16 v[48:49], v20 offset:0
    ds_read_b64_tr_b16 v[50:51], v20 offset:4096
    v_mfma_f32_32x32x16_bf16 v[88:103], v[52:55], v[172:175], v[88:103]
    v_exp_f32 v107, v107
    v_exp_f32 v108, v108
    v_exp_f32 v109, v109
    v_exp_f32 v110, v110
    v_exp_f32 v111, v111
    v_exp_f32 v112, v112
    v_exp_f32 v113, v113
    v_exp_f32 v114, v114
    v_exp_f32 v115, v115
    v_exp_f32 v116, v116
    ds_read_b64_tr_b16 v[52:53], v21 offset:0
    ds_read_b64_tr_b16 v[54:55], v21 offset:4096
    s_waitcnt lgkmcnt(10)
    v_mfma_f32_32x32x16_bf16 v[88:103], v[56:59], v[176:179], v[88:103]
    v_exp_f32 v117, v117
    v_exp_f32 v118, v118
    v_exp_f32 v119, v119
    s_nop 0
    v_add_f32 v35, v35, v104
    v_add_f32 v35, v35, v105
    v_add_f32 v35, v35, v106
    v_add_f32 v35, v35, v107
    v_add_f32 v35, v35, v108
    v_add_f32 v35, v35, v109
    ds_read_b64_tr_b16 v[56:57], v18 offset:256
    ds_read_b64_tr_b16 v[58:59], v18 offset:4352
    v_mfma_f32_32x32x16_bf16 v[88:103], v[60:63], v[180:183], v[88:103]
    v_add_f32 v35, v35, v110
    v_add_f32 v35, v35, v111
    v_add_f32 v35, v35, v112
    v_add_f32 v35, v35, v113
    v_add_f32 v35, v35, v114
    v_add_f32 v35, v35, v115
    v_add_f32 v35, v35, v116
    v_add_f32 v35, v35, v117
    v_add_f32 v35, v35, v118
    v_add_f32 v35, v35, v119
    ds_read_b64_tr_b16 v[60:61], v19 offset:256
    ds_read_b64_tr_b16 v[62:63], v19 offset:4352
    s_waitcnt lgkmcnt(12)
    v_mfma_f32_32x32x16_bf16 v[88:103], v[64:67], v[184:187], v[88:103]
    v_cvt_pk_bf16_f32 v104, v104, v105
    v_cvt_pk_bf16_f32 v105, v106, v107
    v_cvt_pk_bf16_f32 v106, v108, v109
    v_cvt_pk_bf16_f32 v107, v110, v111
    v_cvt_pk_bf16_f32 v108, v112, v113
    v_cvt_pk_bf16_f32 v109, v114, v115
    v_cvt_pk_bf16_f32 v110, v116, v117
    v_cvt_pk_bf16_f32 v111, v118, v119
    ds_read_b64_tr_b16 v[64:65], v20 offset:256
    ds_read_b64_tr_b16 v[66:67], v20 offset:4352
    v_mfma_f32_32x32x16_bf16 v[88:103], v[68:71], v[188:191], v[88:103]
LK_33:
    v_add_u32 v10, 32768, v10
    v_add_u32 v11, 32768, v11
    v_add_u32 v12, 32768, v12
    v_add_u32 v13, 32768, v13
    v_add_u32 v14, 32768, v14
    v_add_u32 v15, 32768, v15
    v_add_u32 v16, 32768, v16
    v_add_u32 v17, 32768, v17
    s_cmp_eq_u32 s49, 1
    s_cbranch_scc1 LV_43
    ds_read_b64_tr_b16 v[68:69], v21 offset:256
    ds_read_b64_tr_b16 v[70:71], v21 offset:4352
    s_waitcnt vmcnt(24)
    s_barrier
    s_add_u32 s43, s32, 0
    s_mov_b32 m0, s43
    s_add_u32 s44, s36, 212992
    buffer_load_dwordx4 v26, s[16:19], s44 offen offset:0 lds
    buffer_load_dwordx4 v27, s[16:19], s44 offen offset:1024 lds
    buffer_load_dwordx4 v26, s[16:19], s44 offen offset:2048 lds
    buffer_load_dwordx4 v27, s[16:19], s44 offen offset:3072 lds
    s_waitcnt lgkmcnt(12)
    v_mfma_f32_32x32x16_bf16 a[0:15], v[40:43], v[72:75], a[0:15]
    ds_read_b64_tr_b16 v[40:41], v18 offset:8192
    ds_read_b64_tr_b16 v[42:43], v18 offset:12288
    v_mfma_f32_32x32x16_bf16 a[16:31], v[44:47], v[72:75], a[16:31]
    ds_read_b64_tr_b16 v[44:45], v19 offset:8192
    ds_read_b64_tr_b16 v[46:47], v19 offset:12288
    s_waitcnt lgkmcnt(12)
    v_mfma_f32_32x32x16_bf16 a[32:47], v[48:51], v[72:75], a[32:47]
    ds_read_b64_tr_b16 v[48:49], v20 offset:8192
    ds_read_b64_tr_b16 v[50:51], v20 offset:12288
    v_mfma_f32_32x32x16_bf16 a[48:63], v[52:55], v[72:75], a[48:63]
    ds_read_b64_tr_b16 v[52:53], v21 offset:8192
    ds_read_b64_tr_b16 v[54:55], v21 offset:12288
    s_waitcnt lgkmcnt(12)
    v_mfma_f32_32x32x16_bf16 a[64:79], v[56:59], v[72:75], a[64:79]
    ds_read_b64_tr_b16 v[56:57], v18 offset:8448
    ds_read_b64_tr_b16 v[58:59], v18 offset:12544
    v_mfma_f32_32x32x16_bf16 a[80:95], v[60:63], v[72:75], a[80:95]
    ds_read_b64_tr_b16 v[60:61], v19 offset:8448
    ds_read_b64_tr_b16 v[62:63], v19 offset:12544
    s_waitcnt lgkmcnt(12)
    v_mfma_f32_32x32x16_bf16 a[96:111], v[64:67], v[72:75], a[96:111]
    ds_read_b64_tr_b16 v[64:65], v20 offset:8448
    ds_read_b64_tr_b16 v[66:67], v20 offset:12544
    v_mfma_f32_32x32x16_bf16 a[112:127], v[68:71], v[72:75], a[112:127]
    ds_read_b64_tr_b16 v[68:69], v21 offset:8448
    ds_read_b64_tr_b16 v[70:71], v21 offset:12544
    s_waitcnt lgkmcnt(12)
    v_mfma_f32_32x32x16_bf16 a[0:15], v[40:43], v[76:79], a[0:15]
    ds_read_b128 v[40:43], v10 offset:0
    v_mfma_f32_32x32x16_bf16 a[16:31], v[44:47], v[76:79], a[16:31]
    ds_read_b128 v[44:47], v11 offset:0
    s_waitcnt lgkmcnt(10)
    v_mfma_f32_32x32x16_bf16 a[32:47], v[48:51], v[76:79], a[32:47]
    ds_read_b128 v[48:51], v12 offset:0
    v_mfma_f32_32x32x16_bf16 a[48:63], v[52:55], v[76:79], a[48:63]
    ds_read_b128 v[52:55], v13 offset:0
    s_waitcnt lgkmcnt(8)
    v_mfma_f32_32x32x16_bf16 a[64:79], v[56:59], v[76:79], a[64:79]
    ds_read_b128 v[56:59], v14 offset:0
    v_mfma_f32_32x32x16_bf16 a[80:95], v[60:63], v[76:79], a[80:95]
    ds_read_b128 v[60:63], v15 offset:0
    s_waitcnt lgkmcnt(6)
    v_mfma_f32_32x32x16_bf16 a[96:111], v[64:67], v[76:79], a[96:111]
    ds_read_b128 v[64:67], v16 offset:0
    v_mfma_f32_32x32x16_bf16 a[112:127], v[68:71], v[76:79], a[112:127]
    s_branch LV_44
LV_43:
    ds_read_b64_tr_b16 v[68:69], v21 offset:256
    ds_read_b64_tr_b16 v[70:71], v21 offset:4352
    s_waitcnt vmcnt(28)
    s_barrier
    s_add_u32 s43, s32, 0
    s_mov_b32 m0, s43
    s_add_u32 s44, s36, 212992
    buffer_load_dwordx4 v26, s[16:19], s44 offen offset:0 lds
    buffer_load_dwordx4 v27, s[16:19], s44 offen offset:1024 lds
    buffer_load_dwordx4 v26, s[16:19], s44 offen offset:2048 lds
    buffer_load_dwordx4 v27, s[16:19], s44 offen offset:3072 lds
    s_waitcnt lgkmcnt(12)
    v_mfma_f32_32x32x16_bf16 a[0:15], v[40:43], v[72:75], a[0:15]
    v_mfma_f32_32x32x16_bf16 a[128:143], v[40:43], v[104:107], a[128:143]
    ds_read_b64_tr_b16 v[40:41], v18 offset:8192
    ds_read_b64_tr_b16 v[42:43], v18 offset:12288
    v_mfma_f32_32x32x16_bf16 a[16:31], v[44:47], v[72:75], a[16:31]
    v_mfma_f32_32x32x16_bf16 a[144:159], v[44:47], v[104:107], a[144:159]
    ds_read_b64_tr_b16 v[44:45], v19 offset:8192
    ds_read_b64_tr_b16 v[46:47], v19 offset:12288
    s_waitcnt lgkmcnt(12)
    v_mfma_f32_32x32x16_bf16 a[32:47], v[48:51], v[72:75], a[32:47]
    v_mfma_f32_32x32x16_bf16 a[160:175], v[48:51], v[104:107], a[160:175]
    ds_read_b64_tr_b16 v[48:49], v20 offset:8192
    ds_read_b64_tr_b16 v[50:51], v20 offset:12288
    v_mfma_f32_32x32x16_bf16 a[48:63], v[52:55], v[72:75], a[48:63]
    v_mfma_f32_32x32x16_bf16 a[176:191], v[52:55], v[104:107], a[176:191]
    ds_read_b64_tr_b16 v[52:53], v21 offset:8192
    ds_read_b64_tr_b16 v[54:55], v21 offset:12288
    s_waitcnt lgkmcnt(12)
    v_mfma_f32_32x32x16_bf16 a[64:79], v[56:59], v[72:75], a[64:79]
    v_mfma_f32_32x32x16_bf16 a[192:207], v[56:59], v[104:107], a[192:207]
    ds_read_b64_tr_b16 v[56:57], v18 offset:8448
    ds_read_b64_tr_b16 v[58:59], v18 offset:12544
    v_mfma_f32_32x32x16_bf16 a[80:95], v[60:63], v[72:75], a[80:95]
    v_mfma_f32_32x32x16_bf16 a[208:223], v[60:63], v[104:107], a[208:223]
    ds_read_b64_tr_b16 v[60:61], v19 offset:8448
    ds_read_b64_tr_b16 v[62:63], v19 offset:12544
    s_waitcnt lgkmcnt(12)
    v_mfma_f32_32x32x16_bf16 a[96:111], v[64:67], v[72:75], a[96:111]
    v_mfma_f32_32x32x16_bf16 a[224:239], v[64:67], v[104:107], a[224:239]
    ds_read_b64_tr_b16 v[64:65], v20 offset:8448
    ds_read_b64_tr_b16 v[66:67], v20 offset:12544
    v_mfma_f32_32x32x16_bf16 a[112:127], v[68:71], v[72:75], a[112:127]
    v_mfma_f32_32x32x16_bf16 a[240:255], v[68:71], v[104:107], a[240:255]
    ds_read_b64_tr_b16 v[68:69], v21 offset:8448
    ds_read_b64_tr_b16 v[70:71], v21 offset:12544
    s_waitcnt lgkmcnt(12)
    v_mfma_f32_32x32x16_bf16 a[0:15], v[40:43], v[76:79], a[0:15]
    v_mfma_f32_32x32x16_bf16 a[128:143], v[40:43], v[108:111], a[128:143]
    ds_read_b128 v[40:43], v10 offset:0
    v_mfma_f32_32x32x16_bf16 a[16:31], v[44:47], v[76:79], a[16:31]
    v_mfma_f32_32x32x16_bf16 a[144:159], v[44:47], v[108:111], a[144:159]
    ds_read_b128 v[44:47], v11 offset:0
    s_waitcnt lgkmcnt(10)
    v_mfma_f32_32x32x16_bf16 a[32:47], v[48:51], v[76:79], a[32:47]
    v_mfma_f32_32x32x16_bf16 a[160:175], v[48:51], v[108:111], a[160:175]
    ds_read_b128 v[48:51], v12 offset:0
    v_mfma_f32_32x32x16_bf16 a[48:63], v[52:55], v[76:79], a[48:63]
    v_mfma_f32_32x32x16_bf16 a[176:191], v[52:55], v[108:111], a[176:191]
    ds_read_b128 v[52:55], v13 offset:0
    s_waitcnt lgkmcnt(8)
    v_mfma_f32_32x32x16_bf16 a[64:79], v[56:59], v[76:79], a[64:79]
    v_mfma_f32_32x32x16_bf16 a[192:207], v[56:59], v[108:111], a[192:207]
    ds_read_b128 v[56:59], v14 offset:0
    v_mfma_f32_32x32x16_bf16 a[80:95], v[60:63], v[76:79], a[80:95]
    v_mfma_f32_32x32x16_bf16 a[208:223], v[60:63], v[108:111], a[208:223]
    ds_read_b128 v[60:63], v15 offset:0
    s_waitcnt lgkmcnt(6)
    v_mfma_f32_32x32x16_bf16 a[96:111], v[64:67], v[76:79], a[96:111]
    v_mfma_f32_32x32x16_bf16 a[224:239], v[64:67], v[108:111], a[224:239]
    ds_read_b128 v[64:67], v16 offset:0
    v_mfma_f32_32x32x16_bf16 a[112:127], v[68:71], v[76:79], a[112:127]
    v_mfma_f32_32x32x16_bf16 a[240:255], v[68:71], v[108:111], a[240:255]
LV_44:
    v_add_u32 v18, 32768, v18
    v_add_u32 v19, 32768, v19
    v_add_u32 v20, 32768, v20
    v_add_u32 v21, 32768, v21
    s_cmp_eq_u32 s7, 3
    s_cselect_b32 s49, 1, 0
    s_cmp_eq_u32 s7, 0
    s_cselect_b32 s50, 1, 0
    s_cmp_eq_u32 s50, 1
    s_cbranch_scc1 LK_45
    s_cmp_eq_u32 s49, 1
    s_cbranch_scc1 LK_46
    ds_read_b128 v[68:71], v17 offset:0
    s_waitcnt vmcnt(28)
    s_barrier
    s_add_u32 s43, s32, 16384
    s_mov_b32 m0, s43
    s_add_u32 s44, s36, 245760
    buffer_load_dwordx4 v22, s[12:15], s44 offen offset:0 lds
    buffer_load_dwordx4 v23, s[12:15], s44 offen offset:1024 lds
    buffer_load_dwordx4 v24, s[12:15], s44 offen offset:2048 lds
    buffer_load_dwordx4 v25, s[12:15], s44 offen offset:3072 lds
    s_waitcnt lgkmcnt(6)
    v_mfma_f32_32x32x16_bf16 v[72:87], v[40:43], v[128:131], 0
    v_max3_f32 v2, v88, v89, v90
    v_max3_f32 v2, v2, v91, v92
    v_max3_f32 v2, v2, v93, v94
    v_max3_f32 v2, v2, v95, v96
    v_max3_f32 v2, v2, v97, v98
    ds_read_b128 v[40:43], v10 offset:256
    v_mfma_f32_32x32x16_bf16 v[72:87], v[44:47], v[132:135], v[72:87]
    v_max3_f32 v2, v2, v99, v100
    v_max3_f32 v2, v2, v101, v102
    v_max_f32 v2, v2, v103
    v_mov_b32 v3, v2
    s_nop 1
    ds_read_b128 v[44:47], v11 offset:256
    s_waitcnt lgkmcnt(6)
    v_mfma_f32_32x32x16_bf16 v[72:87], v[48:51], v[136:139], v[72:87]
    v_permlane32_swap_b32 v2, v3
    v_max_f32 v2, v2, v3
    v_mul_f32 v2, s33, v2
    v_sub_f32 v3, v2, v32
    v_cmp_lt_f32 vcc, s34, v3
    ds_read_b128 v[48:51], v12 offset:256
    v_mfma_f32_32x32x16_bf16 v[72:87], v[52:55], v[140:143], v[72:87]
    s_nop 0
    s_cbranch_vccnz LRS_49
LRB_50:
    v_fma_f32 v88, v88, s33, -v32
    v_fma_f32 v89, v89, s33, -v32
    v_fma_f32 v90, v90, s33, -v32
    ds_read_b128 v[52:55], v13 offset:256
    s_waitcnt lgkmcnt(6)
    v_mfma_f32_32x32x16_bf16 v[72:87], v[56:59], v[144:147], v[72:87]
    v_fma_f32 v91, v91, s33, -v32
    v_fma_f32 v92, v92, s33, -v32
    v_fma_f32 v93, v93, s33, -v32
    v_fma_f32 v94, v94, s33, -v32
    v_fma_f32 v95, v95, s33, -v32
    ds_read_b128 v[56:59], v14 offset:256
    v_mfma_f32_32x32x16_bf16 v[72:87], v[60:63], v[148:151], v[72:87]
    v_fma_f32 v96, v96, s33, -v32
    v_fma_f32 v97, v97, s33, -v32
    v_fma_f32 v98, v98, s33, -v32
    v_fma_f32 v99, v99, s33, -v32
    v_fma_f32 v100, v100, s33, -v32
    ds_read_b128 v[60:63], v15 offset:256
    s_waitcnt lgkmcnt(6)
    v_mfma_f32_32x32x16_bf16 v[72:87], v[64:67], v[152:155], v[72:87]
    v_fma_f32 v101, v101, s33, -v32
    v_fma_f32 v102, v102, s33, -v32
    v_fma_f32 v103, v103, s33, -v32
    v_exp_f32 v88, v88
    v_exp_f32 v89, v89
    ds_read_b128 v[64:67], v16 offset:256
    v_mfma_f32_32x32x16_bf16 v[72:87], v[68:71], v[156:159], v[72:87]
    v_exp_f32 v90, v90
    v_exp_f32 v91, v91
    v_exp_f32 v92, v92
    v_exp_f32 v93, v93
    v_exp_f32 v94, v94
    ds_read_b128 v[68:71], v17 offset:256
    s_waitcnt lgkmcnt(6)
    v_mfma_f32_32x32x16_bf16 v[72:87], v[40:43], v[160:163], v[72:87]
    v_exp_f32 v95, v95
    v_exp_f32 v96, v96
    v_exp_f32 v97, v97
    v_exp_f32 v98, v98
    v_exp_f32 v99, v99
    ds_read_b64_tr_b16 v[40:41], v18 offset:0
    ds_read_b64_tr_b16 v[42:43], v18 offset:4096
    v_mfma_f32_32x32x16_bf16 v[72:87], v[44:47], v[164:167], v[72:87]
    v_exp_f32 v100, v100
    v_exp_f32 v101, v101
    v_exp_f32 v102, v102
    v_exp_f32 v103, v103
    s_nop 0
    ds_read_b64_tr_b16 v[44:45], v19 offset:0
    ds_read_b64_tr_b16 v[46:47], v19 offset:4096
    s_waitcnt lgkmcnt(8)
    v_mfma_f32_32x32x16_bf16 v[72:87], v[48:51], v[168:171], v[72:87]
    v_add_f32 v33, v33, v88
    v_add_f32 v33, v33, v89
    v_add_f32 v33, v33, v90
    v_add_f32 v33, v33, v91
    v_add_f32 v33, v33, v92
    ds_read_b64_tr_b16 v[48:49], v20 offset:0
    ds_read_b64_tr_b16 v[50:51], v20 offset:4096
    v_mfma_f32_32x32x16_bf16 v[72:87], v[52:55], v[172:175], v[72:87]
    v_add_f32 v33, v33, v93
    v_add_f32 v33, v33, v94
    v_add_f32 v33, v33, v95
    v_add_f32 v33, v33, v96
    v_add_f32 v33, v33, v97
    ds_read_b64_tr_b16 v[52:53], v21 offset:0
    ds_read_b64_tr_b16 v[54:55], v21 offset:4096
    s_waitcnt lgkmcnt(10)
    v_mfma_f32_32x32x16_bf16 v[72:87], v[56:59], v[176:179], v[72:87]
    v_add_f32 v33, v33, v98
    v_add_f32 v33, v33, v99
    v_add_f32 v33, v33, v100
    v_add_f32 v33, v33, v101
    v_add_f32 v33, v33, v102
    ds_read_b64_tr_b16 v[56:57], v18 offset:256
    ds_read_b64_tr_b16 v[58:59], v18 offset:4352
    v_mfma_f32_32x32x16_bf16 v[72:87], v[60:63], v[180:183], v[72:87]
    v_add_f32 v33, v33, v103
    v_cvt_pk_bf16_f32 v88, v88, v89
    v_cvt_pk_bf16_f32 v89, v90, v91
    v_cvt_pk_bf16_f32 v90, v92, v93
    v_cvt_pk_bf16_f32 v91, v94, v95
    ds_read_b64_tr_b16 v[60:61], v19 offset:256
    ds_read_b64_tr_b16 v[62:63], v19 offset:4352
    s_waitcnt lgkmcnt(12)
    v_mfma_f32_32x32x16_bf16 v[72:87], v[64:67], v[184:187], v[72:87]
    v_cvt_pk_bf16_f32 v92, v96, v97
    v_cvt_pk_bf16_f32 v93, v98, v99
    v_cvt_pk_bf16_f32 v94, v100, v101
    v_cvt_pk_bf16_f32 v95, v102, v103
    ds_read_b64_tr_b16 v[64:65], v20 offset:256
    ds_read_b64_tr_b16 v[66:67], v20 offset:4352
    v_mfma_f32_32x32x16_bf16 v[72:87], v[68:71], v[188:191], v[72:87]
    s_branch LK_47
LK_45:
    ds_read_b128 v[68:71], v17 offset:0
    s_waitcnt vmcnt(32)
    s_barrier
    s_add_u32 s43, s32, 16384
    s_mov_b32 m0, s43
    s_add_u32 s44, s36, 245760
    buffer_load_dwordx4 v22, s[12:15], s44 offen offset:0 lds
    buffer_load_dwordx4 v23, s[12:15], s44 offen offset:1024 lds
    buffer_load_dwordx4 v24, s[12:15], s44 offen offset:2048 lds
    buffer_load_dwordx4 v25, s[12:15], s44 offen offset:3072 lds
    s_waitcnt lgkmcnt(6)
    v_mfma_f32_32x32x16_bf16 v[72:87], v[40:43], v[128:131], 0
    v_max3_f32 v2, v88, v89, v90
    v_max3_f32 v2, v2, v91, v92
    v_max3_f32 v2, v2, v93, v94
    v_mfma_f32_32x32x16_bf16 v[104:119], v[40:43], v[192:195], 0
    v_max3_f32 v2, v2, v95, v96
    v_max3_f32 v2, v2, v97, v98
    v_max3_f32 v2, v2, v99, v100
    ds_read_b128 v[40:43], v10 offset:256
    v_mfma_f32_32x32x16_bf16 v[72:87], v[44:47], v[132:135], v[72:87]
    v_max3_f32 v2, v2, v101, v102
    v_max_f32 v2, v2, v103
    v_mov_b32 v3, v2
    v_mfma_f32_32x32x16_bf16 v[104:119], v[44:47], v[196:199], v[104:119]
    s_nop 1
    v_permlane32_swap_b32 v2, v3
    v_max_f32 v2, v2, v3
    ds_read_b128 v[44:47], v11 offset:256
    s_waitcnt lgkmcnt(6)
    v_mfma_f32_32x32x16_bf16 v[72:87], v[48:51], v[136:139], v[72:87]
    v_mul_f32 v2, s33, v2
    v_sub_f32 v3, v2, v32
    v_cmp_lt_f32 vcc, s34, v3
    v_mfma_f32_32x32x16_bf16 v[104:119], v[48:51], v[200:203], v[104:119]
    s_nop 0
    s_cbranch_vccnz LRS_51
LRB_52:
    v_fma_f32 v88, v88, s33, -v32
    ds_read_b128 v[48:51], v12 offset:256
    v_mfma_f32_32x32x16_bf16 v[72:87], v[52:55], v[140:143], v[72:87]
    v_fma_f32 v89, v89, s33, -v32
    v_fma_f32 v90, v90, s33, -v32
    v_fma_f32 v91, v91, s33, -v32
    v_mfma_f32_32x32x16_bf16 v[104:119], v[52:55], v[204:207], v[104:119]
    v_fma_f32 v92, v92, s33, -v32
    v_fma_f32 v93, v93, s33, -v32
    v_fma_f32 v94, v94, s33, -v32
    ds_read_b128 v[52:55], v13 offset:256
    s_waitcnt lgkmcnt(6)
    v_mfma_f32_32x32x16_bf16 v[72:87], v[56:59], v[144:147], v[72:87]
    v_fma_f32 v95, v95, s33, -v32
    v_fma_f32 v96, v96, s33, -v32
    v_fma_f32 v97, v97, s33, -v32
    v_mfma_f32_32x32x16_bf16 v[104:119], v[56:59], v[208:211], v[104:119]
    v_fma_f32 v98, v98, s33, -v32
    v_fma_f32 v99, v99, s33, -v32
    v_fma_f32 v100, v100, s33, -v32
    ds_read_b128 v[56:59], v14 offset:256
    v_mfma_f32_32x32x16_bf16 v[72:87], v[60:63], v[148:151], v[72:87]
    v_fma_f32 v101, v101, s33, -v32
    v_fma_f32 v102, v102, s33, -v32
    v_fma_f32 v103, v103, s33, -v32
    v_mfma_f32_32x32x16_bf16 v[104:119], v[60:63], v[212:215], v[104:119]
    v_exp_f32 v88, v88
    v_exp_f32 v89, v89
    v_exp_f32 v90, v90
    ds_read_b128 v[60:63], v15 offset:256
    s_waitcnt lgkmcnt(6)
    v_mfma_f32_32x32x16_bf16 v[72:87], v[64:67], v[152:155], v[72:87]
    v_exp_f32 v91, v91
    v_exp_f32 v92, v92
    v_exp_f32 v93, v93
    v_mfma_f32_32x32x16_bf16 v[104:119], v[64:67], v[216:219], v[104:119]
    v_exp_f32 v94, v94
    v_exp_f32 v95, v95
    v_exp_f32 v96, v96
    ds_read_b128 v[64:67], v16 offset:256
    v_mfma_f32_32x32x16_bf16 v[72:87], v[68:71], v[156:159], v[72:87]
    v_exp_f32 v97, v97
    v_exp_f32 v98, v98
    v_exp_f32 v99, v99
    v_mfma_f32_32x32x16_bf16 v[104:119], v[68:71], v[220:223], v[104:119]
    v_exp_f32 v100, v100
    v_exp_f32 v101, v101
    v_exp_f32 v102, v102
    ds_read_b128 v[68:71], v17 offset:256
    s_waitcnt lgkmcnt(6)
    v_mfma_f32_32x32x16_bf16 v[72:87], v[40:43], v[160:163], v[72:87]
    v_exp_f32 v103, v103
    s_nop 0
    v_add_f32 v33, v33, v88
    v_mfma_f32_32x32x16_bf16 v[104:119], v[40:43], v[224:227], v[104:119]
    v_add_f32 v33, v33, v89
    v_add_f32 v33, v33, v90
    v_add_f32 v33, v33, v91
    ds_read_b64_tr_b16 v[40:41], v18 offset:0
    ds_read_b64_tr_b16 v[42:43], v18 offset:4096
    v_mfma_f32_32x32x16_bf16 v[72:87], v[44:47], v[164:167], v[72:87]
    v_add_f32 v33, v33, v92
    v_add_f32 v33, v33, v93
    v_add_f32 v33, v33, v94
    v_mfma_f32_32x32x16_bf16 v[104:119], v[44:47], v[228:231], v[104:119]
    v_add_f32 v33, v33, v95
    v_add_f32 v33, v33, v96
    v_add_f32 v33, v33, v97
    ds_read_b64_tr_b16 v[44:45], v19 offset:0
    ds_read_b64_tr_b16 v[46:47], v19 offset:4096
    s_waitcnt lgkmcnt(8)
    v_mfma_f32_32x32x16_bf16 v[72:87], v[48:51], v[168:171], v[72:87]
    v_add_f32 v33, v33, v98
    v_add_f32 v33, v33, v99
    v_add_f32 v33, v33, v100
    v_mfma_f32_32x32x16_bf16 v[104:119], v[48:51], v[232:235], v[104:119]
    v_add_f32 v33, v33, v101
    v_add_f32 v33, v33, v102
    v_add_f32 v33, v33, v103
    ds_read_b64_tr_b16 v[48:49], v20 offset:0
    ds_read_b64_tr_b16 v[50:51], v20 offset:4096
    v_mfma_f32_32x32x16_bf16 v[72:87], v[52:55], v[172:175], v[72:87]
    v_cvt_pk_bf16_f32 v88, v88, v89
    v_cvt_pk_bf16_f32 v89, v90, v91
    v_cvt_pk_bf16_f32 v90, v92, v93
    v_mfma_f32_32x32x16_bf16 v[104:119], v[52:55], v[236:239], v[104:119]
    v_cvt_pk_bf16_f32 v91, v94, v95
    v_cvt_pk_bf16_f32 v92, v96, v97
    v_cvt_pk_bf16_f32 v93, v98, v99
    ds_read_b64_tr_b16 v[52:53], v21 offset:0
    ds_read_b64_tr_b16 v[54:55], v21 offset:4096
    s_waitcnt lgkmcnt(10)
    v_mfma_f32_32x32x16_bf16 v[72:87], v[56:59], v[176:179], v[72:87]
    v_cvt_pk_bf16_f32 v94, v100, v101
    v_cvt_pk_bf16_f32 v95, v102, v103
    v_mfma_f32_32x32x16_bf16 v[104:119], v[56:59], v[240:243], v[104:119]
    ds_read_b64_tr_b16 v[56:57], v18 offset:256
    ds_read_b64_tr_b16 v[58:59], v18 offset:4352
    v_mfma_f32_32x32x16_bf16 v[72:87], v[60:63], v[180:183], v[72:87]
    v_mfma_f32_32x32x16_bf16 v[104:119], v[60:63], v[244:247], v[104:119]
    ds_read_b64_tr_b16 v[60:61], v19 offset:256
    ds_read_b64_tr_b16 v[62:63], v19 offset:4352
    s_waitcnt lgkmcnt(12)
    v_mfma_f32_32x32x16_bf16 v[72:87], v[64:67], v[184:187], v[72:87]
    v_mfma_f32_32x32x16_bf16 v[104:119], v[64:67], v[248:251], v[104:119]
    ds_read_b64_tr_b16 v[64:65], v20 offset:256
    ds_read_b64_tr_b16 v[66:67], v20 offset:4352
    v_mfma_f32_32x32x16_bf16 v[72:87], v[68:71], v[188:191], v[72:87]
    v_mfma_f32_32x32x16_bf16 v[104:119], v[68:71], v[252:255], v[104:119]
    s_branch LK_47
LK_46:
    ds_read_b128 v[68:71], v17 offset:0
    s_waitcnt vmcnt(36)
    s_barrier
    s_add_u32 s43, s32, 16384
    s_mov_b32 m0, s43
    s_add_u32 s44, s36, 245760
    buffer_load_dwordx4 v22, s[12:15], s44 offen offset:0 lds
    buffer_load_dwordx4 v23, s[12:15], s44 offen offset:1024 lds
    buffer_load_dwordx4 v24, s[12:15], s44 offen offset:2048 lds
    buffer_load_dwordx4 v25, s[12:15], s44 offen offset:3072 lds
    s_waitcnt lgkmcnt(6)
    v_mfma_f32_32x32x16_bf16 v[72:87], v[40:43], v[128:131], 0
    v_max3_f32 v2, v88, v89, v90
    v_max3_f32 v2, v2, v91, v92
    v_max3_f32 v2, v2, v93, v94
    v_max3_f32 v2, v2, v95, v96
    v_max3_f32 v2, v2, v97, v98
    v_max3_f32 v2, v2, v99, v100
    v_max3_f32 v2, v2, v101, v102
    v_max_f32 v2, v2, v103
    v_mov_b32 v3, v2
    s_nop 1
    ds_read_b128 v[40:43], v10 offset:256
    v_mfma_f32_32x32x16_bf16 v[72:87], v[44:47], v[132:135], v[72:87]
    v_permlane32_swap_b32 v2, v3
    v_max_f32 v2, v2, v3
    v_mul_f32 v2, s33, v2
    v_sub_f32 v3, v2, v32
    v_cmp_lt_f32 vcc, s34, v3
    s_nop 0
    s_cbranch_vccnz LRS_53
LRB_54:
    v_fma_f32 v88, v88, s33, -v32
    v_fma_f32 v89, v89, s33, -v32
    v_fma_f32 v90, v90, s33, -v32
    ds_read_b128 v[44:47], v11 offset:256
    s_waitcnt lgkmcnt(6)
    v_mfma_f32_32x32x16_bf16 v[72:87], v[48:51], v[136:139], v[72:87]
    v_fma_f32 v91, v91, s33, -v32
    v_fma_f32 v92, v92, s33, -v32
    v_fma_f32 v93, v93, s33, -v32
    v_fma_f32 v94, v94, s33, -v32
    v_fma_f32 v95, v95, s33, -v32
    v_fma_f32 v96, v96, s33, -v32
    v_fma_f32 v97, v97, s33, -v32
    v_fma_f32 v98, v98, s33, -v32
    v_fma_f32 v99, v99, s33, -v32
    v_fma_f32 v100, v100, s33, -v32
    ds_read_b128 v[48:51], v12 offset:256
    v_mfma_f32_32x32x16_bf16 v[72:87], v[52:55], v[140:143], v[72:87]
    v_fma_f32 v101, v101, s33, -v32
    v_fma_f32 v102, v102, s33, -v32
    v_fma_f32 v103, v103, s33, -v32
    v_exp_f32 v88, v88
    v_exp_f32 v89, v89
    v_exp_f32 v90, v90
    v_exp_f32 v91, v91
    v_exp_f32 v92, v92
    v_exp_f32 v93, v93
    v_exp_f32 v94, v94
    ds_read_b128 v[52:55], v13 offset:256
    s_waitcnt lgkmcnt(6)
    v_mfma_f32_32x32x16_bf16 v[72:87], v[56:59], v[144:147], v[72:87]
    v_exp_f32 v95, v95
    v_exp_f32 v96, v96
    v_exp_f32 v97, v97
    v_exp_f32 v98, v98
    v_exp_f32 v99, v99
    v_exp_f32 v100, v100
    v_exp_f32 v101, v101
    v_exp_f32 v102, v102
    v_exp_f32 v103, v103
    s_nop 0
    ds_read_b128 v[56:59], v14 offset:256
    v_mfma_f32_32x32x16_bf16 v[72:87], v[60:63], v[148:151], v[72:87]
    v_add_f32 v33, v33, v88
    v_add_f32 v33, v33, v89
    v_add_f32 v33, v33, v90
    v_add_f32 v33, v33, v91
    v_add_f32 v33, v33, v92
    v_add_f32 v33, v33, v93
    v_add_f32 v33, v33, v94
    v_add_f32 v33, v33, v95
    v_add_f32 v33, v33, v96
    v_add_f32 v33, v33, v97
    ds_read_b128 v[60:63], v15 offset:256
    s_waitcnt lgkmcnt(6)
    v_mfma_f32_32x32x16_bf16 v[72:87], v[64:67], v[152:155], v[72:87]
    v_add_f32 v33, v33, v98
    v_add_f32 v33, v33, v99
    v_add_f32 v33, v33, v100
    v_add_f32 v33, v33, v101
    v_add_f32 v33, v33, v102
    v_add_f32 v33, v33, v103
    v_cvt_pk_bf16_f32 v88, v88, v89
    v_cvt_pk_bf16_f32 v89, v90, v91
    v_cvt_pk_bf16_f32 v90, v92, v93
    v_cvt_pk_bf16_f32 v91, v94, v95
    ds_read_b128 v[64:67], v16 offset:256
    v_mfma_f32_32x32x16_bf16 v[72:87], v[68:71], v[156:159], v[72:87]
    v_cvt_pk_bf16_f32 v92, v96, v97
    v_cvt_pk_bf16_f32 v93, v98, v99
    v_cvt_pk_bf16_f32 v94, v100, v101
    v_cvt_pk_bf16_f32 v95, v102, v103
    v_max3_f32 v2, v104, v105, v106
    v_max3_f32 v2, v2, v107, v108
    v_max3_f32 v2, v2, v109, v110
    v_max3_f32 v2, v2, v111, v112
    v_max3_f32 v2, v2, v113, v114
    v_max3_f32 v2, v2, v115, v116
    ds_read_b128 v[68:71], v17 offset:256
    s_waitcnt lgkmcnt(6)
    v_mfma_f32_32x32x16_bf16 v[72:87], v[40:43], v[160:163], v[72:87]
    v_max3_f32 v2, v2, v117, v118
    v_max_f32 v2, v2, v119
    v_mov_b32 v3, v2
    s_nop 1
    v_permlane32_swap_b32 v2, v3
    v_max_f32 v2, v2, v3
    v_mul_f32 v2, s33, v2
    v_sub_f32 v3, v2, v34
    v_cmp_lt_f32 vcc, s34, v3
    s_nop 0
    ds_read_b64_tr_b16 v[40:41], v18 offset:0
    ds_read_b64_tr_b16 v[42:43], v18 offset:4096
    v_mfma_f32_32x32x16_bf16 v[72:87], v[44:47], v[164:167], v[72:87]
    s_cbranch_vccnz LRS_55
LRB_56:
    v_fma_f32 v104, v104, s33, -v34
    v_fma_f32 v105, v105, s33, -v34
    v_fma_f32 v106, v106, s33, -v34
    v_fma_f32 v107, v107, s33, -v34
    v_fma_f32 v108, v108, s33, -v34
    v_fma_f32 v109, v109, s33, -v34
    v_fma_f32 v110, v110, s33, -v34
    v_fma_f32 v111, v111, s33, -v34
    v_fma_f32 v112, v112, s33, -v34
    ds_read_b64_tr_b16 v[44:45], v19 offset:0
    ds_read_b64_tr_b16 v[46:47], v19 offset:4096
    s_waitcnt lgkmcnt(8)
    v_mfma_f32_32x32x16_bf16 v[72:87], v[48:51], v[168:171], v[72:87]
    v_fma_f32 v113, v113, s33, -v34
    v_fma_f32 v114, v114, s33, -v34
    v_fma_f32 v115, v115, s33, -v34
    v_fma_f32 v116, v116, s33, -v34
    v_fma_f32 v117, v117, s33, -v34
    v_fma_f32 v118, v118, s33, -v34
    v_fma_f32 v119, v119, s33, -v34
    v_exp_f32 v104, v104
    v_exp_f32 v105, v105
    v_exp_f32 v106, v106
    ds_read_b64_tr_b16 v[48:49], v20 offset:0
    ds_read_b64_tr_b16 v[50:51], v20 offset:4096
    v_mfma_f32_32x32x16_bf16 v[72:87], v[52:55], v[172:175], v[72:87]
    v_exp_f32 v107, v107
    v_exp_f32 v108, v108
    v_exp_f32 v109, v109
    v_exp_f32 v110, v110
    v_exp_f32 v111, v111
    v_exp_f32 v112, v112
    v_exp_f32 v113, v113
    v_exp_f32 v114, v114
    v_exp_f32 v115, v115
    v_exp_f32 v116, v116
    ds_read_b64_tr_b16 v[52:53], v21 offset:0
    ds_read_b64_tr_b16 v[54:55], v21 offset:4096
    s_waitcnt lgkmcnt(10)
    v_mfma_f32_32x32x16_bf16 v[72:87], v[56:59], v[176:179], v[72:87]
    v_exp_f32 v117, v117
    v_exp_f32 v118, v118
    v_exp_f32 v119, v119
    s_nop 0
    v_add_f32 v35, v35, v104
    v_add_f32 v35, v35, v105
    v_add_f32 v35, v35, v106
    v_add_f32 v35, v35, v107
    v_add_f32 v35, v35, v108
    v_add_f32 v35, v35, v109
    ds_read_b64_tr_b16 v[56:57], v18 offset:256
    ds_read_b64_tr_b16 v[58:59], v18 offset:4352
    v_mfma_f32_32x32x16_bf16 v[72:87], v[60:63], v[180:183], v[72:87]
    v_add_f32 v35, v35, v110
    v_add_f32 v35, v35, v111
    v_add_f32 v35, v35, v112
    v_add_f32 v35, v35, v113
    v_add_f32 v35, v35, v114
    v_add_f32 v35, v35, v115
    v_add_f32 v35, v35, v116
    v_add_f32 v35, v35, v117
    v_add_f32 v35, v35, v118
    v_add_f32 v35, v35, v119
    ds_read_b64_tr_b16 v[60:61], v19 offset:256
    ds_read_b64_tr_b16 v[62:63], v19 offset:4352
    s_waitcnt lgkmcnt(12)
    v_mfma_f32_32x32x16_bf16 v[72:87], v[64:67], v[184:187], v[72:87]
    v_cvt_pk_bf16_f32 v104, v104, v105
    v_cvt_pk_bf16_f32 v105, v106, v107
    v_cvt_pk_bf16_f32 v106, v108, v109
    v_cvt_pk_bf16_f32 v107, v110, v111
    v_cvt_pk_bf16_f32 v108, v112, v113
    v_cvt_pk_bf16_f32 v109, v114, v115
    v_cvt_pk_bf16_f32 v110, v116, v117
    v_cvt_pk_bf16_f32 v111, v118, v119
    ds_read_b64_tr_b16 v[64:65], v20 offset:256
    ds_read_b64_tr_b16 v[66:67], v20 offset:4352
    v_mfma_f32_32x32x16_bf16 v[72:87], v[68:71], v[188:191], v[72:87]
LK_47:
    v_add_u32 v10, 32768, v10
    v_add_u32 v11, 32768, v11
    v_add_u32 v12, 32768, v12
    v_add_u32 v13, 32768, v13
    v_add_u32 v14, 32768, v14
    v_add_u32 v15, 32768, v15
    v_add_u32 v16, 32768, v16
    v_add_u32 v17, 32768, v17
    s_cmp_eq_u32 s49, 1
    s_cbranch_scc1 LV_57
    ds_read_b64_tr_b16 v[68:69], v21 offset:256
    ds_read_b64_tr_b16 v[70:71], v21 offset:4352
    s_waitcnt vmcnt(36)
    s_barrier
    s_add_u32 s43, s32, 32768
    s_mov_b32 m0, s43
    s_add_u32 s44, s36, 229376
    buffer_load_dwordx4 v26, s[16:19], s44 offen offset:0 lds
    buffer_load_dwordx4 v27, s[16:19], s44 offen offset:1024 lds
    buffer_load_dwordx4 v26, s[16:19], s44 offen offset:2048 lds
    buffer_load_dwordx4 v27, s[16:19], s44 offen offset:3072 lds
    s_waitcnt lgkmcnt(12)
    v_mfma_f32_32x32x16_bf16 a[0:15], v[40:43], v[88:91], a[0:15]
    ds_read_b64_tr_b16 v[40:41], v18 offset:8192
    ds_read_b64_tr_b16 v[42:43], v18 offset:12288
    v_mfma_f32_32x32x16_bf16 a[16:31], v[44:47], v[88:91], a[16:31]
    ds_read_b64_tr_b16 v[44:45], v19 offset:8192
    ds_read_b64_tr_b16 v[46:47], v19 offset:12288
    s_waitcnt lgkmcnt(12)
    v_mfma_f32_32x32x16_bf16 a[32:47], v[48:51], v[88:91], a[32:47]
    ds_read_b64_tr_b16 v[48:49], v20 offset:8192
    ds_read_b64_tr_b16 v[50:51], v20 offset:12288
    v_mfma_f32_32x32x16_bf16 a[48:63], v[52:55], v[88:91], a[48:63]
    ds_read_b64_tr_b16 v[52:53], v21 offset:8192
    ds_read_b64_tr_b16 v[54:55], v21 offset:12288
    s_waitcnt lgkmcnt(12)
    v_mfma_f32_32x32x16_bf16 a[64:79], v[56:59], v[88:91], a[64:79]
    ds_read_b64_tr_b16 v[56:57], v18 offset:8448
    ds_read_b64_tr_b16 v[58:59], v18 offset:12544
    v_mfma_f32_32x32x16_bf16 a[80:95], v[60:63], v[88:91], a[80:95]
    ds_read_b64_tr_b16 v[60:61], v19 offset:8448
    ds_read_b64_tr_b16 v[62:63], v19 offset:12544
    s_waitcnt lgkmcnt(12)
    v_mfma_f32_32x32x16_bf16 a[96:111], v[64:67], v[88:91], a[96:111]
    ds_read_b64_tr_b16 v[64:65], v20 offset:8448
    ds_read_b64_tr_b16 v[66:67], v20 offset:12544
    v_mfma_f32_32x32x16_bf16 a[112:127], v[68:71], v[88:91], a[112:127]
    ds_read_b64_tr_b16 v[68:69], v21 offset:8448
    ds_read_b64_tr_b16 v[70:71], v21 offset:12544
    s_waitcnt lgkmcnt(12)
    v_mfma_f32_32x32x16_bf16 a[0:15], v[40:43], v[92:95], a[0:15]
    ds_read_b128 v[40:43], v10 offset:0
    v_mfma_f32_32x32x16_bf16 a[16:31], v[44:47], v[92:95], a[16:31]
    ds_read_b128 v[44:47], v11 offset:0
    s_waitcnt lgkmcnt(10)
    v_mfma_f32_32x32x16_bf16 a[32:47], v[48:51], v[92:95], a[32:47]
    ds_read_b128 v[48:51], v12 offset:0
    v_mfma_f32_32x32x16_bf16 a[48:63], v[52:55], v[92:95], a[48:63]
    ds_read_b128 v[52:55], v13 offset:0
    s_waitcnt lgkmcnt(8)
    v_mfma_f32_32x32x16_bf16 a[64:79], v[56:59], v[92:95], a[64:79]
    ds_read_b128 v[56:59], v14 offset:0
    v_mfma_f32_32x32x16_bf16 a[80:95], v[60:63], v[92:95], a[80:95]
    ds_read_b128 v[60:63], v15 offset:0
    s_waitcnt lgkmcnt(6)
    v_mfma_f32_32x32x16_bf16 a[96:111], v[64:67], v[92:95], a[96:111]
    ds_read_b128 v[64:67], v16 offset:0
    v_mfma_f32_32x32x16_bf16 a[112:127], v[68:71], v[92:95], a[112:127]
    s_branch LV_58
LV_57:
    ds_read_b64_tr_b16 v[68:69], v21 offset:256
    ds_read_b64_tr_b16 v[70:71], v21 offset:4352
    s_waitcnt vmcnt(40)
    s_barrier
    s_add_u32 s43, s32, 32768
    s_mov_b32 m0, s43
    s_add_u32 s44, s36, 229376
    buffer_load_dwordx4 v26, s[16:19], s44 offen offset:0 lds
    buffer_load_dwordx4 v27, s[16:19], s44 offen offset:1024 lds
    buffer_load_dwordx4 v26, s[16:19], s44 offen offset:2048 lds
    buffer_load_dwordx4 v27, s[16:19], s44 offen offset:3072 lds
    s_waitcnt lgkmcnt(12)
    v_mfma_f32_32x32x16_bf16 a[0:15], v[40:43], v[88:91], a[0:15]
    v_mfma_f32_32x32x16_bf16 a[128:143], v[40:43], v[104:107], a[128:143]
    ds_read_b64_tr_b16 v[40:41], v18 offset:8192
    ds_read_b64_tr_b16 v[42:43], v18 offset:12288
    v_mfma_f32_32x32x16_bf16 a[16:31], v[44:47], v[88:91], a[16:31]
    v_mfma_f32_32x32x16_bf16 a[144:159], v[44:47], v[104:107], a[144:159]
    ds_read_b64_tr_b16 v[44:45], v19 offset:8192
    ds_read_b64_tr_b16 v[46:47], v19 offset:12288
    s_waitcnt lgkmcnt(12)
    v_mfma_f32_32x32x16_bf16 a[32:47], v[48:51], v[88:91], a[32:47]
    v_mfma_f32_32x32x16_bf16 a[160:175], v[48:51], v[104:107], a[160:175]
    ds_read_b64_tr_b16 v[48:49], v20 offset:8192
    ds_read_b64_tr_b16 v[50:51], v20 offset:12288
    v_mfma_f32_32x32x16_bf16 a[48:63], v[52:55], v[88:91], a[48:63]
    v_mfma_f32_32x32x16_bf16 a[176:191], v[52:55], v[104:107], a[176:191]
    ds_read_b64_tr_b16 v[52:53], v21 offset:8192
    ds_read_b64_tr_b16 v[54:55], v21 offset:12288
    s_waitcnt lgkmcnt(12)
    v_mfma_f32_32x32x16_bf16 a[64:79], v[56:59], v[88:91], a[64:79]
    v_mfma_f32_32x32x16_bf16 a[192:207], v[56:59], v[104:107], a[192:207]
    ds_read_b64_tr_b16 v[56:57], v18 offset:8448
    ds_read_b64_tr_b16 v[58:59], v18 offset:12544
    v_mfma_f32_32x32x16_bf16 a[80:95], v[60:63], v[88:91], a[80:95]
    v_mfma_f32_32x32x16_bf16 a[208:223], v[60:63], v[104:107], a[208:223]
    ds_read_b64_tr_b16 v[60:61], v19 offset:8448
    ds_read_b64_tr_b16 v[62:63], v19 offset:12544
    s_waitcnt lgkmcnt(12)
    v_mfma_f32_32x32x16_bf16 a[96:111], v[64:67], v[88:91], a[96:111]
    v_mfma_f32_32x32x16_bf16 a[224:239], v[64:67], v[104:107], a[224:239]
    ds_read_b64_tr_b16 v[64:65], v20 offset:8448
    ds_read_b64_tr_b16 v[66:67], v20 offset:12544
    v_mfma_f32_32x32x16_bf16 a[112:127], v[68:71], v[88:91], a[112:127]
    v_mfma_f32_32x32x16_bf16 a[240:255], v[68:71], v[104:107], a[240:255]
    ds_read_b64_tr_b16 v[68:69], v21 offset:8448
    ds_read_b64_tr_b16 v[70:71], v21 offset:12544
    s_waitcnt lgkmcnt(12)
    v_mfma_f32_32x32x16_bf16 a[0:15], v[40:43], v[92:95], a[0:15]
    v_mfma_f32_32x32x16_bf16 a[128:143], v[40:43], v[108:111], a[128:143]
    ds_read_b128 v[40:43], v10 offset:0
    v_mfma_f32_32x32x16_bf16 a[16:31], v[44:47], v[92:95], a[16:31]
    v_mfma_f32_32x32x16_bf16 a[144:159], v[44:47], v[108:111], a[144:159]
    ds_read_b128 v[44:47], v11 offset:0
    s_waitcnt lgkmcnt(10)
    v_mfma_f32_32x32x16_bf16 a[32:47], v[48:51], v[92:95], a[32:47]
    v_mfma_f32_32x32x16_bf16 a[160:175], v[48:51], v[108:111], a[160:175]
    ds_read_b128 v[48:51], v12 offset:0
    v_mfma_f32_32x32x16_bf16 a[48:63], v[52:55], v[92:95], a[48:63]
    v_mfma_f32_32x32x16_bf16 a[176:191], v[52:55], v[108:111], a[176:191]
    ds_read_b128 v[52:55], v13 offset:0
    s_waitcnt lgkmcnt(8)
    v_mfma_f32_32x32x16_bf16 a[64:79], v[56:59], v[92:95], a[64:79]
    v_mfma_f32_32x32x16_bf16 a[192:207], v[56:59], v[108:111], a[192:207]
    ds_read_b128 v[56:59], v14 offset:0
    v_mfma_f32_32x32x16_bf16 a[80:95], v[60:63], v[92:95], a[80:95]
    v_mfma_f32_32x32x16_bf16 a[208:223], v[60:63], v[108:111], a[208:223]
    ds_read_b128 v[60:63], v15 offset:0
    s_waitcnt lgkmcnt(6)
    v_mfma_f32_32x32x16_bf16 a[96:111], v[64:67], v[92:95], a[96:111]
    v_mfma_f32_32x32x16_bf16 a[224:239], v[64:67], v[108:111], a[224:239]
    ds_read_b128 v[64:67], v16 offset:0
    v_mfma_f32_32x32x16_bf16 a[112:127], v[68:71], v[92:95], a[112:127]
    v_mfma_f32_32x32x16_bf16 a[240:255], v[68:71], v[108:111], a[240:255]
LV_58:
    v_add_u32 v18, 32768, v18
    v_add_u32 v19, 32768, v19
    v_add_u32 v20, 32768, v20
    v_add_u32 v21, 32768, v21
    s_cmp_eq_u32 s7, 0
    s_cselect_b32 s49, 1, 0
    s_cmp_eq_u32 s7, 1
    s_cselect_b32 s50, 1, 0
    s_cmp_eq_u32 s50, 1
    s_cbranch_scc1 LK_59
    s_cmp_eq_u32 s49, 1
    s_cbranch_scc1 LK_60
    ds_read_b128 v[68:71], v17 offset:0
    s_waitcnt vmcnt(40)
    s_barrier
    s_add_u32 s43, s32, 49152
    s_mov_b32 m0, s43
    s_add_u32 s44, s36, 245760
    buffer_load_dwordx4 v26, s[16:19], s44 offen offset:0 lds
    buffer_load_dwordx4 v27, s[16:19], s44 offen offset:1024 lds
    buffer_load_dwordx4 v26, s[16:19], s44 offen offset:2048 lds
    buffer_load_dwordx4 v27, s[16:19], s44 offen offset:3072 lds
    s_waitcnt lgkmcnt(6)
    v_mfma_f32_32x32x16_bf16 v[88:103], v[40:43], v[128:131], 0
    v_max3_f32 v2, v72, v73, v74
    v_max3_f32 v2, v2, v75, v76
    v_max3_f32 v2, v2, v77, v78
    v_max3_f32 v2, v2, v79, v80
    v_max3_f32 v2, v2, v81, v82
    ds_read_b128 v[40:43], v10 offset:256
    v_mfma_f32_32x32x16_bf16 v[88:103], v[44:47], v[132:135], v[88:103]
    v_max3_f32 v2, v2, v83, v84
    v_max3_f32 v2, v2, v85, v86
    v_max_f32 v2, v2, v87
    v_mov_b32 v3, v2
    s_nop 1
    ds_read_b128 v[44:47], v11 offset:256
    s_waitcnt lgkmcnt(6)
    v_mfma_f32_32x32x16_bf16 v[88:103], v[48:51], v[136:139], v[88:103]
    v_permlane32_swap_b32 v2, v3
    v_max_f32 v2, v2, v3
    v_mul_f32 v2, s33, v2
    v_sub_f32 v3, v2, v32
    v_cmp_lt_f32 vcc, s34, v3
    ds_read_b128 v[48:51], v12 offset:256
    v_mfma_f32_32x32x16_bf16 v[88:103], v[52:55], v[140:143], v[88:103]
    s_nop 0
    s_cbranch_vccnz LRS_63
LRB_64:
    v_fma_f32 v72, v72, s33, -v32
    v_fma_f32 v73, v73, s33, -v32
    v_fma_f32 v74, v74, s33, -v32
    ds_read_b128 v[52:55], v13 offset:256
    s_waitcnt lgkmcnt(6)
    v_mfma_f32_32x32x16_bf16 v[88:103], v[56:59], v[144:147], v[88:103]
    v_fma_f32 v75, v75, s33, -v32
    v_fma_f32 v76, v76, s33, -v32
    v_fma_f32 v77, v77, s33, -v32
    v_fma_f32 v78, v78, s33, -v32
    v_fma_f32 v79, v79, s33, -v32
    ds_read_b128 v[56:59], v14 offset:256
    v_mfma_f32_32x32x16_bf16 v[88:103], v[60:63], v[148:151], v[88:103]
    v_fma_f32 v80, v80, s33, -v32
    v_fma_f32 v81, v81, s33, -v32
    v_fma_f32 v82, v82, s33, -v32
    v_fma_f32 v83, v83, s33, -v32
    v_fma_f32 v84, v84, s33, -v32
    ds_read_b128 v[60:63], v15 offset:256
    s_waitcnt lgkmcnt(6)
    v_mfma_f32_32x32x16_bf16 v[88:103], v[64:67], v[152:155], v[88:103]
    v_fma_f32 v85, v85, s33, -v32
    v_fma_f32 v86, v86, s33, -v32
    v_fma_f32 v87, v87, s33, -v32
    v_exp_f32 v72, v72
    v_exp_f32 v73, v73
    ds_read_b128 v[64:67], v16 offset:256
    v_mfma_f32_32x32x16_bf16 v[88:103], v[68:71], v[156:159], v[88:103]
    v_exp_f32 v74, v74
    v_exp_f32 v75, v75
    v_exp_f32 v76, v76
    v_exp_f32 v77, v77
    v_exp_f32 v78, v78
    ds_read_b128 v[68:71], v17 offset:256
    s_waitcnt lgkmcnt(6)
    v_mfma_f32_32x32x16_bf16 v[88:103], v[40:43], v[160:163], v[88:103]
    v_exp_f32 v79, v79
    v_exp_f32 v80, v80
    v_exp_f32 v81, v81
    v_exp_f32 v82, v82
    v_exp_f32 v83, v83
    ds_read_b64_tr_b16 v[40:41], v18 offset:0
    ds_read_b64_tr_b16 v[42:43], v18 offset:4096
    v_mfma_f32_32x32x16_bf16 v[88:103], v[44:47], v[164:167], v[88:103]
    v_exp_f32 v84, v84
    v_exp_f32 v85, v85
    v_exp_f32 v86, v86
    v_exp_f32 v87, v87
    s_nop 0
    ds_read_b64_tr_b16 v[44:45], v19 offset:0
    ds_read_b64_tr_b16 v[46:47], v19 offset:4096
    s_waitcnt lgkmcnt(8)
    v_mfma_f32_32x32x16_bf16 v[88:103], v[48:51], v[168:171], v[88:103]
    v_add_f32 v33, v33, v72
    v_add_f32 v33, v33, v73
    v_add_f32 v33, v33, v74
    v_add_f32 v33, v33, v75
    v_add_f32 v33, v33, v76
    ds_read_b64_tr_b16 v[48:49], v20 offset:0
    ds_read_b64_tr_b16 v[50:51], v20 offset:4096
    v_mfma_f32_32x32x16_bf16 v[88:103], v[52:55], v[172:175], v[88:103]
    v_add_f32 v33, v33, v77
    v_add_f32 v33, v33, v78
    v_add_f32 v33, v33, v79
    v_add_f32 v33, v33, v80
    v_add_f32 v33, v33, v81
    ds_read_b64_tr_b16 v[52:53], v21 offset:0
    ds_read_b64_tr_b16 v[54:55], v21 offset:4096
    s_waitcnt lgkmcnt(10)
    v_mfma_f32_32x32x16_bf16 v[88:103], v[56:59], v[176:179], v[88:103]
    v_add_f32 v33, v33, v82
    v_add_f32 v33, v33, v83
    v_add_f32 v33, v33, v84
    v_add_f32 v33, v33, v85
    v_add_f32 v33, v33, v86
    ds_read_b64_tr_b16 v[56:57], v18 offset:256
    ds_read_b64_tr_b16 v[58:59], v18 offset:4352
    v_mfma_f32_32x32x16_bf16 v[88:103], v[60:63], v[180:183], v[88:103]
    v_add_f32 v33, v33, v87
    v_cvt_pk_bf16_f32 v72, v72, v73
    v_cvt_pk_bf16_f32 v73, v74, v75
    v_cvt_pk_bf16_f32 v74, v76, v77
    v_cvt_pk_bf16_f32 v75, v78, v79
    ds_read_b64_tr_b16 v[60:61], v19 offset:256
    ds_read_b64_tr_b16 v[62:63], v19 offset:4352
    s_waitcnt lgkmcnt(12)
    v_mfma_f32_32x32x16_bf16 v[88:103], v[64:67], v[184:187], v[88:103]
    v_cvt_pk_bf16_f32 v76, v80, v81
    v_cvt_pk_bf16_f32 v77, v82, v83
    v_cvt_pk_bf16_f32 v78, v84, v85
    v_cvt_pk_bf16_f32 v79, v86, v87
    ds_read_b64_tr_b16 v[64:65], v20 offset:256
    ds_read_b64_tr_b16 v[66:67], v20 offset:4352
    v_mfma_f32_32x32x16_bf16 v[88:103], v[68:71], v[188:191], v[88:103]
    s_branch LK_61
LK_59:
    ds_read_b128 v[68:71], v17 offset:0
    s_waitcnt vmcnt(44)
    s_barrier
    s_add_u32 s43, s32, 49152
    s_mov_b32 m0, s43
    s_add_u32 s44, s36, 245760
    buffer_load_dwordx4 v26, s[16:19], s44 offen offset:0 lds
    buffer_load_dwordx4 v27, s[16:19], s44 offen offset:1024 lds
    buffer_load_dwordx4 v26, s[16:19], s44 offen offset:2048 lds
    buffer_load_dwordx4 v27, s[16:19], s44 offen offset:3072 lds
    s_waitcnt lgkmcnt(6)
    v_mfma_f32_32x32x16_bf16 v[88:103], v[40:43], v[128:131], 0
    v_max3_f32 v2, v72, v73, v74
    v_max3_f32 v2, v2, v75, v76
    v_max3_f32 v2, v2, v77, v78
    v_mfma_f32_32x32x16_bf16 v[104:119], v[40:43], v[192:195], 0
    v_max3_f32 v2, v2, v79, v80
    v_max3_f32 v2, v2, v81, v82
    v_max3_f32 v2, v2, v83, v84
    ds_read_b128 v[40:43], v10 offset:256
    v_mfma_f32_32x32x16_bf16 v[88:103], v[44:47], v[132:135], v[88:103]
    v_max3_f32 v2, v2, v85, v86
    v_max_f32 v2, v2, v87
    v_mov_b32 v3, v2
    v_mfma_f32_32x32x16_bf16 v[104:119], v[44:47], v[196:199], v[104:119]
    s_nop 1
    v_permlane32_swap_b32 v2, v3
    v_max_f32 v2, v2, v3
    ds_read_b128 v[44:47], v11 offset:256
    s_waitcnt lgkmcnt(6)
    v_mfma_f32_32x32x16_bf16 v[88:103], v[48:51], v[136:139], v[88:103]
    v_mul_f32 v2, s33, v2
    v_sub_f32 v3, v2, v32
    v_cmp_lt_f32 vcc, s34, v3
    v_mfma_f32_32x32x16_bf16 v[104:119], v[48:51], v[200:203], v[104:119]
    s_nop 0
    s_cbranch_vccnz LRS_65
LRB_66:
    v_fma_f32 v72, v72, s33, -v32
    ds_read_b128 v[48:51], v12 offset:256
    v_mfma_f32_32x32x16_bf16 v[88:103], v[52:55], v[140:143], v[88:103]
    v_fma_f32 v73, v73, s33, -v32
    v_fma_f32 v74, v74, s33, -v32
    v_fma_f32 v75, v75, s33, -v32
    v_mfma_f32_32x32x16_bf16 v[104:119], v[52:55], v[204:207], v[104:119]
    v_fma_f32 v76, v76, s33, -v32
    v_fma_f32 v77, v77, s33, -v32
    v_fma_f32 v78, v78, s33, -v32
    ds_read_b128 v[52:55], v13 offset:256
    s_waitcnt lgkmcnt(6)
    v_mfma_f32_32x32x16_bf16 v[88:103], v[56:59], v[144:147], v[88:103]
    v_fma_f32 v79, v79, s33, -v32
    v_fma_f32 v80, v80, s33, -v32
    v_fma_f32 v81, v81, s33, -v32
    v_mfma_f32_32x32x16_bf16 v[104:119], v[56:59], v[208:211], v[104:119]
    v_fma_f32 v82, v82, s33, -v32
    v_fma_f32 v83, v83, s33, -v32
    v_fma_f32 v84, v84, s33, -v32
    ds_read_b128 v[56:59], v14 offset:256
    v_mfma_f32_32x32x16_bf16 v[88:103], v[60:63], v[148:151], v[88:103]
    v_fma_f32 v85, v85, s33, -v32
    v_fma_f32 v86, v86, s33, -v32
    v_fma_f32 v87, v87, s33, -v32
    v_mfma_f32_32x32x16_bf16 v[104:119], v[60:63], v[212:215], v[104:119]
    v_exp_f32 v72, v72
    v_exp_f32 v73, v73
    v_exp_f32 v74, v74
    ds_read_b128 v[60:63], v15 offset:256
    s_waitcnt lgkmcnt(6)
    v_mfma_f32_32x32x16_bf16 v[88:103], v[64:67], v[152:155], v[88:103]
    v_exp_f32 v75, v75
    v_exp_f32 v76, v76
    v_exp_f32 v77, v77
    v_mfma_f32_32x32x16_bf16 v[104:119], v[64:67], v[216:219], v[104:119]
    v_exp_f32 v78, v78
    v_exp_f32 v79, v79
    v_exp_f32 v80, v80
    ds_read_b128 v[64:67], v16 offset:256
    v_mfma_f32_32x32x16_bf16 v[88:103], v[68:71], v[156:159], v[88:103]
    v_exp_f32 v81, v81
    v_exp_f32 v82, v82
    v_exp_f32 v83, v83
    v_mfma_f32_32x32x16_bf16 v[104:119], v[68:71], v[220:223], v[104:119]
    v_exp_f32 v84, v84
    v_exp_f32 v85, v85
    v_exp_f32 v86, v86
    ds_read_b128 v[68:71], v17 offset:256
    s_waitcnt lgkmcnt(6)
    v_mfma_f32_32x32x16_bf16 v[88:103], v[40:43], v[160:163], v[88:103]
    v_exp_f32 v87, v87
    s_nop 0
    v_add_f32 v33, v33, v72
    v_mfma_f32_32x32x16_bf16 v[104:119], v[40:43], v[224:227], v[104:119]
    v_add_f32 v33, v33, v73
    v_add_f32 v33, v33, v74
    v_add_f32 v33, v33, v75
    ds_read_b64_tr_b16 v[40:41], v18 offset:0
    ds_read_b64_tr_b16 v[42:43], v18 offset:4096
    v_mfma_f32_32x32x16_bf16 v[88:103], v[44:47], v[164:167], v[88:103]
    v_add_f32 v33, v33, v76
    v_add_f32 v33, v33, v77
    v_add_f32 v33, v33, v78
    v_mfma_f32_32x32x16_bf16 v[104:119], v[44:47], v[228:231], v[104:119]
    v_add_f32 v33, v33, v79
    v_add_f32 v33, v33, v80
    v_add_f32 v33, v33, v81
    ds_read_b64_tr_b16 v[44:45], v19 offset:0
    ds_read_b64_tr_b16 v[46:47], v19 offset:4096
    s_waitcnt lgkmcnt(8)
    v_mfma_f32_32x32x16_bf16 v[88:103], v[48:51], v[168:171], v[88:103]
    v_add_f32 v33, v33, v82
    v_add_f32 v33, v33, v83
    v_add_f32 v33, v33, v84
    v_mfma_f32_32x32x16_bf16 v[104:119], v[48:51], v[232:235], v[104:119]
    v_add_f32 v33, v33, v85
    v_add_f32 v33, v33, v86
    v_add_f32 v33, v33, v87
    ds_read_b64_tr_b16 v[48:49], v20 offset:0
    ds_read_b64_tr_b16 v[50:51], v20 offset:4096
    v_mfma_f32_32x32x16_bf16 v[88:103], v[52:55], v[172:175], v[88:103]
    v_cvt_pk_bf16_f32 v72, v72, v73
    v_cvt_pk_bf16_f32 v73, v74, v75
    v_cvt_pk_bf16_f32 v74, v76, v77
    v_mfma_f32_32x32x16_bf16 v[104:119], v[52:55], v[236:239], v[104:119]
    v_cvt_pk_bf16_f32 v75, v78, v79
    v_cvt_pk_bf16_f32 v76, v80, v81
    v_cvt_pk_bf16_f32 v77, v82, v83
    ds_read_b64_tr_b16 v[52:53], v21 offset:0
    ds_read_b64_tr_b16 v[54:55], v21 offset:4096
    s_waitcnt lgkmcnt(10)
    v_mfma_f32_32x32x16_bf16 v[88:103], v[56:59], v[176:179], v[88:103]
    v_cvt_pk_bf16_f32 v78, v84, v85
    v_cvt_pk_bf16_f32 v79, v86, v87
    v_mfma_f32_32x32x16_bf16 v[104:119], v[56:59], v[240:243], v[104:119]
    ds_read_b64_tr_b16 v[56:57], v18 offset:256
    ds_read_b64_tr_b16 v[58:59], v18 offset:4352
    v_mfma_f32_32x32x16_bf16 v[88:103], v[60:63], v[180:183], v[88:103]
    v_mfma_f32_32x32x16_bf16 v[104:119], v[60:63], v[244:247], v[104:119]
    ds_read_b64_tr_b16 v[60:61], v19 offset:256
    ds_read_b64_tr_b16 v[62:63], v19 offset:4352
    s_waitcnt lgkmcnt(12)
    v_mfma_f32_32x32x16_bf16 v[88:103], v[64:67], v[184:187], v[88:103]
    v_mfma_f32_32x32x16_bf16 v[104:119], v[64:67], v[248:251], v[104:119]
    ds_read_b64_tr_b16 v[64:65], v20 offset:256
    ds_read_b64_tr_b16 v[66:67], v20 offset:4352
    v_mfma_f32_32x32x16_bf16 v[88:103], v[68:71], v[188:191], v[88:103]
    v_mfma_f32_32x32x16_bf16 v[104:119], v[68:71], v[252:255], v[104:119]
    s_branch LK_61
LK_60:
    ds_read_b128 v[68:71], v17 offset:0
    s_waitcnt vmcnt(48)
    s_barrier
    s_add_u32 s43, s32, 49152
    s_mov_b32 m0, s43
    s_add_u32 s44, s36, 245760
    buffer_load_dwordx4 v26, s[16:19], s44 offen offset:0 lds
    buffer_load_dwordx4 v27, s[16:19], s44 offen offset:1024 lds
    buffer_load_dwordx4 v26, s[16:19], s44 offen offset:2048 lds
    buffer_load_dwordx4 v27, s[16:19], s44 offen offset:3072 lds
    s_waitcnt lgkmcnt(6)
    v_mfma_f32_32x32x16_bf16 v[88:103], v[40:43], v[128:131], 0
    v_max3_f32 v2, v72, v73, v74
    v_max3_f32 v2, v2, v75, v76
    v_max3_f32 v2, v2, v77, v78
    v_max3_f32 v2, v2, v79, v80
    v_max3_f32 v2, v2, v81, v82
    v_max3_f32 v2, v2, v83, v84
    v_max3_f32 v2, v2, v85, v86
    v_max_f32 v2, v2, v87
    v_mov_b32 v3, v2
    s_nop 1
    ds_read_b128 v[40:43], v10 offset:256
    v_mfma_f32_32x32x16_bf16 v[88:103], v[44:47], v[132:135], v[88:103]
    v_permlane32_swap_b32 v2, v3
    v_max_f32 v2, v2, v3
    v_mul_f32 v2, s33, v2
    v_sub_f32 v3, v2, v32
    v_cmp_lt_f32 vcc, s34, v3
    s_nop 0
    s_cbranch_vccnz LRS_67
LRB_68:
    v_fma_f32 v72, v72, s33, -v32
    v_fma_f32 v73, v73, s33, -v32
    v_fma_f32 v74, v74, s33, -v32
    ds_read_b128 v[44:47], v11 offset:256
    s_waitcnt lgkmcnt(6)
    v_mfma_f32_32x32x16_bf16 v[88:103], v[48:51], v[136:139], v[88:103]
    v_fma_f32 v75, v75, s33, -v32
    v_fma_f32 v76, v76, s33, -v32
    v_fma_f32 v77, v77, s33, -v32
    v_fma_f32 v78, v78, s33, -v32
    v_fma_f32 v79, v79, s33, -v32
    v_fma_f32 v80, v80, s33, -v32
    v_fma_f32 v81, v81, s33, -v32
    v_fma_f32 v82, v82, s33, -v32
    v_fma_f32 v83, v83, s33, -v32
    v_fma_f32 v84, v84, s33, -v32
    ds_read_b128 v[48:51], v12 offset:256
    v_mfma_f32_32x32x16_bf16 v[88:103], v[52:55], v[140:143], v[88:103]
    v_fma_f32 v85, v85, s33, -v32
    v_fma_f32 v86, v86, s33, -v32
    v_fma_f32 v87, v87, s33, -v32
    v_exp_f32 v72, v72
    v_exp_f32 v73, v73
    v_exp_f32 v74, v74
    v_exp_f32 v75, v75
    v_exp_f32 v76, v76
    v_exp_f32 v77, v77
    v_exp_f32 v78, v78
    ds_read_b128 v[52:55], v13 offset:256
    s_waitcnt lgkmcnt(6)
    v_mfma_f32_32x32x16_bf16 v[88:103], v[56:59], v[144:147], v[88:103]
    v_exp_f32 v79, v79
    v_exp_f32 v80, v80
    v_exp_f32 v81, v81
    v_exp_f32 v82, v82
    v_exp_f32 v83, v83
    v_exp_f32 v84, v84
    v_exp_f32 v85, v85
    v_exp_f32 v86, v86
    v_exp_f32 v87, v87
    s_nop 0
    ds_read_b128 v[56:59], v14 offset:256
    v_mfma_f32_32x32x16_bf16 v[88:103], v[60:63], v[148:151], v[88:103]
    v_add_f32 v33, v33, v72
    v_add_f32 v33, v33, v73
    v_add_f32 v33, v33, v74
    v_add_f32 v33, v33, v75
    v_add_f32 v33, v33, v76
    v_add_f32 v33, v33, v77
    v_add_f32 v33, v33, v78
    v_add_f32 v33, v33, v79
    v_add_f32 v33, v33, v80
    v_add_f32 v33, v33, v81
    ds_read_b128 v[60:63], v15 offset:256
    s_waitcnt lgkmcnt(6)
    v_mfma_f32_32x32x16_bf16 v[88:103], v[64:67], v[152:155], v[88:103]
    v_add_f32 v33, v33, v82
    v_add_f32 v33, v33, v83
    v_add_f32 v33, v33, v84
    v_add_f32 v33, v33, v85
    v_add_f32 v33, v33, v86
    v_add_f32 v33, v33, v87
    v_cvt_pk_bf16_f32 v72, v72, v73
    v_cvt_pk_bf16_f32 v73, v74, v75
    v_cvt_pk_bf16_f32 v74, v76, v77
    v_cvt_pk_bf16_f32 v75, v78, v79
    ds_read_b128 v[64:67], v16 offset:256
    v_mfma_f32_32x32x16_bf16 v[88:103], v[68:71], v[156:159], v[88:103]
    v_cvt_pk_bf16_f32 v76, v80, v81
    v_cvt_pk_bf16_f32 v77, v82, v83
    v_cvt_pk_bf16_f32 v78, v84, v85
    v_cvt_pk_bf16_f32 v79, v86, v87
    v_max3_f32 v2, v104, v105, v106
    v_max3_f32 v2, v2, v107, v108
    v_max3_f32 v2, v2, v109, v110
    v_max3_f32 v2, v2, v111, v112
    v_max3_f32 v2, v2, v113, v114
    v_max3_f32 v2, v2, v115, v116
    ds_read_b128 v[68:71], v17 offset:256
    s_waitcnt lgkmcnt(6)
    v_mfma_f32_32x32x16_bf16 v[88:103], v[40:43], v[160:163], v[88:103]
    v_max3_f32 v2, v2, v117, v118
    v_max_f32 v2, v2, v119
    v_mov_b32 v3, v2
    s_nop 1
    v_permlane32_swap_b32 v2, v3
    v_max_f32 v2, v2, v3
    v_mul_f32 v2, s33, v2
    v_sub_f32 v3, v2, v34
    v_cmp_lt_f32 vcc, s34, v3
    s_nop 0
    ds_read_b64_tr_b16 v[40:41], v18 offset:0
    ds_read_b64_tr_b16 v[42:43], v18 offset:4096
    v_mfma_f32_32x32x16_bf16 v[88:103], v[44:47], v[164:167], v[88:103]
    s_cbranch_vccnz LRS_69
LRB_70:
    v_fma_f32 v104, v104, s33, -v34
    v_fma_f32 v105, v105, s33, -v34
    v_fma_f32 v106, v106, s33, -v34
    v_fma_f32 v107, v107, s33, -v34
    v_fma_f32 v108, v108, s33, -v34
    v_fma_f32 v109, v109, s33, -v34
    v_fma_f32 v110, v110, s33, -v34
    v_fma_f32 v111, v111, s33, -v34
    v_fma_f32 v112, v112, s33, -v34
    ds_read_b64_tr_b16 v[44:45], v19 offset:0
    ds_read_b64_tr_b16 v[46:47], v19 offset:4096
    s_waitcnt lgkmcnt(8)
    v_mfma_f32_32x32x16_bf16 v[88:103], v[48:51], v[168:171], v[88:103]
    v_fma_f32 v113, v113, s33, -v34
    v_fma_f32 v114, v114, s33, -v34
    v_fma_f32 v115, v115, s33, -v34
    v_fma_f32 v116, v116, s33, -v34
    v_fma_f32 v117, v117, s33, -v34
    v_fma_f32 v118, v118, s33, -v34
    v_fma_f32 v119, v119, s33, -v34
    v_exp_f32 v104, v104
    v_exp_f32 v105, v105
    v_exp_f32 v106, v106
    ds_read_b64_tr_b16 v[48:49], v20 offset:0
    ds_read_b64_tr_b16 v[50:51], v20 offset:4096
    v_mfma_f32_32x32x16_bf16 v[88:103], v[52:55], v[172:175], v[88:103]
    v_exp_f32 v107, v107
    v_exp_f32 v108, v108
    v_exp_f32 v109, v109
    v_exp_f32 v110, v110
    v_exp_f32 v111, v111
    v_exp_f32 v112, v112
    v_exp_f32 v113, v113
    v_exp_f32 v114, v114
    v_exp_f32 v115, v115
    v_exp_f32 v116, v116
    ds_read_b64_tr_b16 v[52:53], v21 offset:0
    ds_read_b64_tr_b16 v[54:55], v21 offset:4096
    s_waitcnt lgkmcnt(10)
    v_mfma_f32_32x32x16_bf16 v[88:103], v[56:59], v[176:179], v[88:103]
    v_exp_f32 v117, v117
    v_exp_f32 v118, v118
    v_exp_f32 v119, v119
    s_nop 0
    v_add_f32 v35, v35, v104
    v_add_f32 v35, v35, v105
    v_add_f32 v35, v35, v106
    v_add_f32 v35, v35, v107
    v_add_f32 v35, v35, v108
    v_add_f32 v35, v35, v109
    ds_read_b64_tr_b16 v[56:57], v18 offset:256
    ds_read_b64_tr_b16 v[58:59], v18 offset:4352
    v_mfma_f32_32x32x16_bf16 v[88:103], v[60:63], v[180:183], v[88:103]
    v_add_f32 v35, v35, v110
    v_add_f32 v35, v35, v111
    v_add_f32 v35, v35, v112
    v_add_f32 v35, v35, v113
    v_add_f32 v35, v35, v114
    v_add_f32 v35, v35, v115
    v_add_f32 v35, v35, v116
    v_add_f32 v35, v35, v117
    v_add_f32 v35, v35, v118
    v_add_f32 v35, v35, v119
    ds_read_b64_tr_b16 v[60:61], v19 offset:256
    ds_read_b64_tr_b16 v[62:63], v19 offset:4352
    s_waitcnt lgkmcnt(12)
    v_mfma_f32_32x32x16_bf16 v[88:103], v[64:67], v[184:187], v[88:103]
    v_cvt_pk_bf16_f32 v104, v104, v105
    v_cvt_pk_bf16_f32 v105, v106, v107
    v_cvt_pk_bf16_f32 v106, v108, v109
    v_cvt_pk_bf16_f32 v107, v110, v111
    v_cvt_pk_bf16_f32 v108, v112, v113
    v_cvt_pk_bf16_f32 v109, v114, v115
    v_cvt_pk_bf16_f32 v110, v116, v117
    v_cvt_pk_bf16_f32 v111, v118, v119
    ds_read_b64_tr_b16 v[64:65], v20 offset:256
    ds_read_b64_tr_b16 v[66:67], v20 offset:4352
    v_mfma_f32_32x32x16_bf16 v[88:103], v[68:71], v[188:191], v[88:103]
LK_61:
    v_add_u32 v10, 32768, v10
    v_add_u32 v11, 32768, v11
    v_add_u32 v12, 32768, v12
    v_add_u32 v13, 32768, v13
    v_add_u32 v14, 32768, v14
    v_add_u32 v15, 32768, v15
    v_add_u32 v16, 32768, v16
    v_add_u32 v17, 32768, v17
    s_cmp_eq_u32 s49, 1
    s_cbranch_scc1 LV_71
    ds_read_b64_tr_b16 v[68:69], v21 offset:256
    ds_read_b64_tr_b16 v[70:71], v21 offset:4352
    s_waitcnt vmcnt(40)
    s_barrier
    s_add_u32 s43, s32, 65536
    s_mov_b32 m0, s43
    s_add_u32 s44, s38, 0
    buffer_load_dwordx4 v28, s[24:27], s44 offen offset:0 lds
    buffer_load_dwordx4 v29, s[24:27], s44 offen offset:1024 lds
    buffer_load_dwordx4 v30, s[24:27], s44 offen offset:2048 lds
    buffer_load_dwordx4 v31, s[24:27], s44 offen offset:3072 lds
    s_waitcnt lgkmcnt(12)
    v_mfma_f32_32x32x16_bf16 a[0:15], v[40:43], v[72:75], a[0:15]
    ds_read_b64_tr_b16 v[40:41], v18 offset:8192
    ds_read_b64_tr_b16 v[42:43], v18 offset:12288
    v_mfma_f32_32x32x16_bf16 a[16:31], v[44:47], v[72:75], a[16:31]
    ds_read_b64_tr_b16 v[44:45], v19 offset:8192
    ds_read_b64_tr_b16 v[46:47], v19 offset:12288
    s_waitcnt lgkmcnt(12)
    v_mfma_f32_32x32x16_bf16 a[32:47], v[48:51], v[72:75], a[32:47]
    ds_read_b64_tr_b16 v[48:49], v20 offset:8192
    ds_read_b64_tr_b16 v[50:51], v20 offset:12288
    v_mfma_f32_32x32x16_bf16 a[48:63], v[52:55], v[72:75], a[48:63]
    ds_read_b64_tr_b16 v[52:53], v21 offset:8192
    ds_read_b64_tr_b16 v[54:55], v21 offset:12288
    s_waitcnt lgkmcnt(12)
    v_mfma_f32_32x32x16_bf16 a[64:79], v[56:59], v[72:75], a[64:79]
    ds_read_b64_tr_b16 v[56:57], v18 offset:8448
    ds_read_b64_tr_b16 v[58:59], v18 offset:12544
    v_mfma_f32_32x32x16_bf16 a[80:95], v[60:63], v[72:75], a[80:95]
    ds_read_b64_tr_b16 v[60:61], v19 offset:8448
    ds_read_b64_tr_b16 v[62:63], v19 offset:12544
    s_waitcnt lgkmcnt(12)
    v_mfma_f32_32x32x16_bf16 a[96:111], v[64:67], v[72:75], a[96:111]
    ds_read_b64_tr_b16 v[64:65], v20 offset:8448
    ds_read_b64_tr_b16 v[66:67], v20 offset:12544
    v_mfma_f32_32x32x16_bf16 a[112:127], v[68:71], v[72:75], a[112:127]
    ds_read_b64_tr_b16 v[68:69], v21 offset:8448
    ds_read_b64_tr_b16 v[70:71], v21 offset:12544
    s_waitcnt lgkmcnt(12)
    v_mfma_f32_32x32x16_bf16 a[0:15], v[40:43], v[76:79], a[0:15]
    ds_read_b128 v[40:43], v10 offset:0
    v_mfma_f32_32x32x16_bf16 a[16:31], v[44:47], v[76:79], a[16:31]
    ds_read_b128 v[44:47], v11 offset:0
    s_waitcnt lgkmcnt(10)
    v_mfma_f32_32x32x16_bf16 a[32:47], v[48:51], v[76:79], a[32:47]
    ds_read_b128 v[48:51], v12 offset:0
    v_mfma_f32_32x32x16_bf16 a[48:63], v[52:55], v[76:79], a[48:63]
    ds_read_b128 v[52:55], v13 offset:0
    s_waitcnt lgkmcnt(8)
    v_mfma_f32_32x32x16_bf16 a[64:79], v[56:59], v[76:79], a[64:79]
    ds_read_b128 v[56:59], v14 offset:0
    v_mfma_f32_32x32x16_bf16 a[80:95], v[60:63], v[76:79], a[80:95]
    ds_read_b128 v[60:63], v15 offset:0
    s_waitcnt lgkmcnt(6)
    v_mfma_f32_32x32x16_bf16 a[96:111], v[64:67], v[76:79], a[96:111]
    ds_read_b128 v[64:67], v16 offset:0
    v_mfma_f32_32x32x16_bf16 a[112:127], v[68:71], v[76:79], a[112:127]
    s_branch LV_72
LV_71:
    ds_read_b64_tr_b16 v[68:69], v21 offset:256
    ds_read_b64_tr_b16 v[70:71], v21 offset:4352
    s_waitcnt vmcnt(44)
    s_barrier
    s_add_u32 s43, s32, 65536
    s_mov_b32 m0, s43
    s_add_u32 s44, s38, 0
    buffer_load_dwordx4 v28, s[24:27], s44 offen offset:0 lds
    buffer_load_dwordx4 v29, s[24:27], s44 offen offset:1024 lds
    buffer_load_dwordx4 v30, s[24:27], s44 offen offset:2048 lds
    buffer_load_dwordx4 v31, s[24:27], s44 offen offset:3072 lds
    s_waitcnt lgkmcnt(12)
    v_mfma_f32_32x32x16_bf16 a[0:15], v[40:43], v[72:75], a[0:15]
    v_mfma_f32_32x32x16_bf16 a[128:143], v[40:43], v[104:107], a[128:143]
    ds_read_b64_tr_b16 v[40:41], v18 offset:8192
    ds_read_b64_tr_b16 v[42:43], v18 offset:12288
    v_mfma_f32_32x32x16_bf16 a[16:31], v[44:47], v[72:75], a[16:31]
    v_mfma_f32_32x32x16_bf16 a[144:159], v[44:47], v[104:107], a[144:159]
    ds_read_b64_tr_b16 v[44:45], v19 offset:8192
    ds_read_b64_tr_b16 v[46:47], v19 offset:12288
    s_waitcnt lgkmcnt(12)
    v_mfma_f32_32x32x16_bf16 a[32:47], v[48:51], v[72:75], a[32:47]
    v_mfma_f32_32x32x16_bf16 a[160:175], v[48:51], v[104:107], a[160:175]
    ds_read_b64_tr_b16 v[48:49], v20 offset:8192
    ds_read_b64_tr_b16 v[50:51], v20 offset:12288
    v_mfma_f32_32x32x16_bf16 a[48:63], v[52:55], v[72:75], a[48:63]
    v_mfma_f32_32x32x16_bf16 a[176:191], v[52:55], v[104:107], a[176:191]
    ds_read_b64_tr_b16 v[52:53], v21 offset:8192
    ds_read_b64_tr_b16 v[54:55], v21 offset:12288
    s_waitcnt lgkmcnt(12)
    v_mfma_f32_32x32x16_bf16 a[64:79], v[56:59], v[72:75], a[64:79]
    v_mfma_f32_32x32x16_bf16 a[192:207], v[56:59], v[104:107], a[192:207]
    ds_read_b64_tr_b16 v[56:57], v18 offset:8448
    ds_read_b64_tr_b16 v[58:59], v18 offset:12544
    v_mfma_f32_32x32x16_bf16 a[80:95], v[60:63], v[72:75], a[80:95]
    v_mfma_f32_32x32x16_bf16 a[208:223], v[60:63], v[104:107], a[208:223]
    ds_read_b64_tr_b16 v[60:61], v19 offset:8448
    ds_read_b64_tr_b16 v[62:63], v19 offset:12544
    s_waitcnt lgkmcnt(12)
    v_mfma_f32_32x32x16_bf16 a[96:111], v[64:67], v[72:75], a[96:111]
    v_mfma_f32_32x32x16_bf16 a[224:239], v[64:67], v[104:107], a[224:239]
    ds_read_b64_tr_b16 v[64:65], v20 offset:8448
    ds_read_b64_tr_b16 v[66:67], v20 offset:12544
    v_mfma_f32_32x32x16_bf16 a[112:127], v[68:71], v[72:75], a[112:127]
    v_mfma_f32_32x32x16_bf16 a[240:255], v[68:71], v[104:107], a[240:255]
    ds_read_b64_tr_b16 v[68:69], v21 offset:8448
    ds_read_b64_tr_b16 v[70:71], v21 offset:12544
    s_waitcnt lgkmcnt(12)
    v_mfma_f32_32x32x16_bf16 a[0:15], v[40:43], v[76:79], a[0:15]
    v_mfma_f32_32x32x16_bf16 a[128:143], v[40:43], v[108:111], a[128:143]
    ds_read_b128 v[40:43], v10 offset:0
    v_mfma_f32_32x32x16_bf16 a[16:31], v[44:47], v[76:79], a[16:31]
    v_mfma_f32_32x32x16_bf16 a[144:159], v[44:47], v[108:111], a[144:159]
    ds_read_b128 v[44:47], v11 offset:0
    s_waitcnt lgkmcnt(10)
    v_mfma_f32_32x32x16_bf16 a[32:47], v[48:51], v[76:79], a[32:47]
    v_mfma_f32_32x32x16_bf16 a[160:175], v[48:51], v[108:111], a[160:175]
    ds_read_b128 v[48:51], v12 offset:0
    v_mfma_f32_32x32x16_bf16 a[48:63], v[52:55], v[76:79], a[48:63]
    v_mfma_f32_32x32x16_bf16 a[176:191], v[52:55], v[108:111], a[176:191]
    ds_read_b128 v[52:55], v13 offset:0
    s_waitcnt lgkmcnt(8)
    v_mfma_f32_32x32x16_bf16 a[64:79], v[56:59], v[76:79], a[64:79]
    v_mfma_f32_32x32x16_bf16 a[192:207], v[56:59], v[108:111], a[192:207]
    ds_read_b128 v[56:59], v14 offset:0
    v_mfma_f32_32x32x16_bf16 a[80:95], v[60:63], v[76:79], a[80:95]
    v_mfma_f32_32x32x16_bf16 a[208:223], v[60:63], v[108:111], a[208:223]
    ds_read_b128 v[60:63], v15 offset:0
    s_waitcnt lgkmcnt(6)
    v_mfma_f32_32x32x16_bf16 a[96:111], v[64:67], v[76:79], a[96:111]
    v_mfma_f32_32x32x16_bf16 a[224:239], v[64:67], v[108:111], a[224:239]
    ds_read_b128 v[64:67], v16 offset:0
    v_mfma_f32_32x32x16_bf16 a[112:127], v[68:71], v[76:79], a[112:127]
    v_mfma_f32_32x32x16_bf16 a[240:255], v[68:71], v[108:111], a[240:255]
LV_72:
    v_add_u32 v18, 4294885376, v18
    v_add_u32 v19, 4294885376, v19
    v_add_u32 v20, 4294885376, v20
    v_add_u32 v21, 4294885376, v21
    s_cmp_eq_u32 s7, 1
    s_cselect_b32 s49, 1, 0
    s_cmp_eq_u32 s7, 2
    s_cselect_b32 s50, 1, 0
    s_cmp_eq_u32 s50, 1
    s_cbranch_scc1 LK_73
    s_cmp_eq_u32 s49, 1
    s_cbranch_scc1 LK_74
    ds_read_b128 v[68:71], v17 offset:0
    s_waitcnt vmcnt(40)
    s_barrier
    s_add_u32 s43, s32, 81920
    s_mov_b32 m0, s43
    s_add_u32 s44, s38, 28672
    buffer_load_dwordx4 v28, s[24:27], s44 offen offset:0 lds
    buffer_load_dwordx4 v29, s[24:27], s44 offen offset:1024 lds
    buffer_load_dwordx4 v30, s[24:27], s44 offen offset:2048 lds
    buffer_load_dwordx4 v31, s[24:27], s44 offen offset:3072 lds
    s_waitcnt lgkmcnt(6)
    v_mfma_f32_32x32x16_bf16 v[72:87], v[40:43], v[128:131], 0
    v_max3_f32 v2, v88, v89, v90
    v_max3_f32 v2, v2, v91, v92
    v_max3_f32 v2, v2, v93, v94
    v_max3_f32 v2, v2, v95, v96
    v_max3_f32 v2, v2, v97, v98
    ds_read_b128 v[40:43], v10 offset:256
    v_mfma_f32_32x32x16_bf16 v[72:87], v[44:47], v[132:135], v[72:87]
    v_max3_f32 v2, v2, v99, v100
    v_max3_f32 v2, v2, v101, v102
    v_max_f32 v2, v2, v103
    v_mov_b32 v3, v2
    s_nop 1
    ds_read_b128 v[44:47], v11 offset:256
    s_waitcnt lgkmcnt(6)
    v_mfma_f32_32x32x16_bf16 v[72:87], v[48:51], v[136:139], v[72:87]
    v_permlane32_swap_b32 v2, v3
    v_max_f32 v2, v2, v3
    v_mul_f32 v2, s33, v2
    v_sub_f32 v3, v2, v32
    v_cmp_lt_f32 vcc, s34, v3
    ds_read_b128 v[48:51], v12 offset:256
    v_mfma_f32_32x32x16_bf16 v[72:87], v[52:55], v[140:143], v[72:87]
    s_nop 0
    s_cbranch_vccnz LRS_77
LRB_78:
    v_fma_f32 v88, v88, s33, -v32
    v_fma_f32 v89, v89, s33, -v32
    v_fma_f32 v90, v90, s33, -v32
    ds_read_b128 v[52:55], v13 offset:256
    s_waitcnt lgkmcnt(6)
    v_mfma_f32_32x32x16_bf16 v[72:87], v[56:59], v[144:147], v[72:87]
    v_fma_f32 v91, v91, s33, -v32
    v_fma_f32 v92, v92, s33, -v32
    v_fma_f32 v93, v93, s33, -v32
    v_fma_f32 v94, v94, s33, -v32
    v_fma_f32 v95, v95, s33, -v32
    ds_read_b128 v[56:59], v14 offset:256
    v_mfma_f32_32x32x16_bf16 v[72:87], v[60:63], v[148:151], v[72:87]
    v_fma_f32 v96, v96, s33, -v32
    v_fma_f32 v97, v97, s33, -v32
    v_fma_f32 v98, v98, s33, -v32
    v_fma_f32 v99, v99, s33, -v32
    v_fma_f32 v100, v100, s33, -v32
    ds_read_b128 v[60:63], v15 offset:256
    s_waitcnt lgkmcnt(6)
    v_mfma_f32_32x32x16_bf16 v[72:87], v[64:67], v[152:155], v[72:87]
    v_fma_f32 v101, v101, s33, -v32
    v_fma_f32 v102, v102, s33, -v32
    v_fma_f32 v103, v103, s33, -v32
    v_exp_f32 v88, v88
    v_exp_f32 v89, v89
    ds_read_b128 v[64:67], v16 offset:256
    v_mfma_f32_32x32x16_bf16 v[72:87], v[68:71], v[156:159], v[72:87]
    v_exp_f32 v90, v90
    v_exp_f32 v91, v91
    v_exp_f32 v92, v92
    v_exp_f32 v93, v93
    v_exp_f32 v94, v94
    ds_read_b128 v[68:71], v17 offset:256
    s_waitcnt lgkmcnt(6)
    v_mfma_f32_32x32x16_bf16 v[72:87], v[40:43], v[160:163], v[72:87]
    v_exp_f32 v95, v95
    v_exp_f32 v96, v96
    v_exp_f32 v97, v97
    v_exp_f32 v98, v98
    v_exp_f32 v99, v99
    ds_read_b64_tr_b16 v[40:41], v18 offset:0
    ds_read_b64_tr_b16 v[42:43], v18 offset:4096
    v_mfma_f32_32x32x16_bf16 v[72:87], v[44:47], v[164:167], v[72:87]
    v_exp_f32 v100, v100
    v_exp_f32 v101, v101
    v_exp_f32 v102, v102
    v_exp_f32 v103, v103
    s_nop 0
    ds_read_b64_tr_b16 v[44:45], v19 offset:0
    ds_read_b64_tr_b16 v[46:47], v19 offset:4096
    s_waitcnt lgkmcnt(8)
    v_mfma_f32_32x32x16_bf16 v[72:87], v[48:51], v[168:171], v[72:87]
    v_add_f32 v33, v33, v88
    v_add_f32 v33, v33, v89
    v_add_f32 v33, v33, v90
    v_add_f32 v33, v33, v91
    v_add_f32 v33, v33, v92
    ds_read_b64_tr_b16 v[48:49], v20 offset:0
    ds_read_b64_tr_b16 v[50:51], v20 offset:4096
    v_mfma_f32_32x32x16_bf16 v[72:87], v[52:55], v[172:175], v[72:87]
    v_add_f32 v33, v33, v93
    v_add_f32 v33, v33, v94
    v_add_f32 v33, v33, v95
    v_add_f32 v33, v33, v96
    v_add_f32 v33, v33, v97
    ds_read_b64_tr_b16 v[52:53], v21 offset:0
    ds_read_b64_tr_b16 v[54:55], v21 offset:4096
    s_waitcnt lgkmcnt(10)
    v_mfma_f32_32x32x16_bf16 v[72:87], v[56:59], v[176:179], v[72:87]
    v_add_f32 v33, v33, v98
    v_add_f32 v33, v33, v99
    v_add_f32 v33, v33, v100
    v_add_f32 v33, v33, v101
    v_add_f32 v33, v33, v102
    ds_read_b64_tr_b16 v[56:57], v18 offset:256
    ds_read_b64_tr_b16 v[58:59], v18 offset:4352
    v_mfma_f32_32x32x16_bf16 v[72:87], v[60:63], v[180:183], v[72:87]
    v_add_f32 v33, v33, v103
    v_cvt_pk_bf16_f32 v88, v88, v89
    v_cvt_pk_bf16_f32 v89, v90, v91
    v_cvt_pk_bf16_f32 v90, v92, v93
    v_cvt_pk_bf16_f32 v91, v94, v95
    ds_read_b64_tr_b16 v[60:61], v19 offset:256
    ds_read_b64_tr_b16 v[62:63], v19 offset:4352
    s_waitcnt lgkmcnt(12)
    v_mfma_f32_32x32x16_bf16 v[72:87], v[64:67], v[184:187], v[72:87]
    v_cvt_pk_bf16_f32 v92, v96, v97
    v_cvt_pk_bf16_f32 v93, v98, v99
    v_cvt_pk_bf16_f32 v94, v100, v101
    v_cvt_pk_bf16_f32 v95, v102, v103
    ds_read_b64_tr_b16 v[64:65], v20 offset:256
    ds_read_b64_tr_b16 v[66:67], v20 offset:4352
    v_mfma_f32_32x32x16_bf16 v[72:87], v[68:71], v[188:191], v[72:87]
    s_branch LK_75
LK_73:
    ds_read_b128 v[68:71], v17 offset:0
    s_waitcnt vmcnt(44)
    s_barrier
    s_add_u32 s43, s32, 81920
    s_mov_b32 m0, s43
    s_add_u32 s44, s38, 28672
    buffer_load_dwordx4 v28, s[24:27], s44 offen offset:0 lds
    buffer_load_dwordx4 v29, s[24:27], s44 offen offset:1024 lds
    buffer_load_dwordx4 v30, s[24:27], s44 offen offset:2048 lds
    buffer_load_dwordx4 v31, s[24:27], s44 offen offset:3072 lds
    s_waitcnt lgkmcnt(6)
    v_mfma_f32_32x32x16_bf16 v[72:87], v[40:43], v[128:131], 0
    v_max3_f32 v2, v88, v89, v90
    v_max3_f32 v2, v2, v91, v92
    v_max3_f32 v2, v2, v93, v94
    v_mfma_f32_32x32x16_bf16 v[104:119], v[40:43], v[192:195], 0
    v_max3_f32 v2, v2, v95, v96
    v_max3_f32 v2, v2, v97, v98
    v_max3_f32 v2, v2, v99, v100
    ds_read_b128 v[40:43], v10 offset:256
    v_mfma_f32_32x32x16_bf16 v[72:87], v[44:47], v[132:135], v[72:87]
    v_max3_f32 v2, v2, v101, v102
    v_max_f32 v2, v2, v103
    v_mov_b32 v3, v2
    v_mfma_f32_32x32x16_bf16 v[104:119], v[44:47], v[196:199], v[104:119]
    s_nop 1
    v_permlane32_swap_b32 v2, v3
    v_max_f32 v2, v2, v3
    ds_read_b128 v[44:47], v11 offset:256
    s_waitcnt lgkmcnt(6)
    v_mfma_f32_32x32x16_bf16 v[72:87], v[48:51], v[136:139], v[72:87]
    v_mul_f32 v2, s33, v2
    v_sub_f32 v3, v2, v32
    v_cmp_lt_f32 vcc, s34, v3
    v_mfma_f32_32x32x16_bf16 v[104:119], v[48:51], v[200:203], v[104:119]
    s_nop 0
    s_cbranch_vccnz LRS_79
LRB_80:
    v_fma_f32 v88, v88, s33, -v32
    ds_read_b128 v[48:51], v12 offset:256
    v_mfma_f32_32x32x16_bf16 v[72:87], v[52:55], v[140:143], v[72:87]
    v_fma_f32 v89, v89, s33, -v32
    v_fma_f32 v90, v90, s33, -v32
    v_fma_f32 v91, v91, s33, -v32
    v_mfma_f32_32x32x16_bf16 v[104:119], v[52:55], v[204:207], v[104:119]
    v_fma_f32 v92, v92, s33, -v32
    v_fma_f32 v93, v93, s33, -v32
    v_fma_f32 v94, v94, s33, -v32
    ds_read_b128 v[52:55], v13 offset:256
    s_waitcnt lgkmcnt(6)
    v_mfma_f32_32x32x16_bf16 v[72:87], v[56:59], v[144:147], v[72:87]
    v_fma_f32 v95, v95, s33, -v32
    v_fma_f32 v96, v96, s33, -v32
    v_fma_f32 v97, v97, s33, -v32
    v_mfma_f32_32x32x16_bf16 v[104:119], v[56:59], v[208:211], v[104:119]
    v_fma_f32 v98, v98, s33, -v32
    v_fma_f32 v99, v99, s33, -v32
    v_fma_f32 v100, v100, s33, -v32
    ds_read_b128 v[56:59], v14 offset:256
    v_mfma_f32_32x32x16_bf16 v[72:87], v[60:63], v[148:151], v[72:87]
    v_fma_f32 v101, v101, s33, -v32
    v_fma_f32 v102, v102, s33, -v32
    v_fma_f32 v103, v103, s33, -v32
    v_mfma_f32_32x32x16_bf16 v[104:119], v[60:63], v[212:215], v[104:119]
    v_exp_f32 v88, v88
    v_exp_f32 v89, v89
    v_exp_f32 v90, v90
    ds_read_b128 v[60:63], v15 offset:256
    s_waitcnt lgkmcnt(6)
    v_mfma_f32_32x32x16_bf16 v[72:87], v[64:67], v[152:155], v[72:87]
    v_exp_f32 v91, v91
    v_exp_f32 v92, v92
    v_exp_f32 v93, v93
    v_mfma_f32_32x32x16_bf16 v[104:119], v[64:67], v[216:219], v[104:119]
    v_exp_f32 v94, v94
    v_exp_f32 v95, v95
    v_exp_f32 v96, v96
    ds_read_b128 v[64:67], v16 offset:256
    v_mfma_f32_32x32x16_bf16 v[72:87], v[68:71], v[156:159], v[72:87]
    v_exp_f32 v97, v97
    v_exp_f32 v98, v98
    v_exp_f32 v99, v99
    v_mfma_f32_32x32x16_bf16 v[104:119], v[68:71], v[220:223], v[104:119]
    v_exp_f32 v100, v100
    v_exp_f32 v101, v101
    v_exp_f32 v102, v102
    ds_read_b128 v[68:71], v17 offset:256
    s_waitcnt lgkmcnt(6)
    v_mfma_f32_32x32x16_bf16 v[72:87], v[40:43], v[160:163], v[72:87]
    v_exp_f32 v103, v103
    s_nop 0
    v_add_f32 v33, v33, v88
    v_mfma_f32_32x32x16_bf16 v[104:119], v[40:43], v[224:227], v[104:119]
    v_add_f32 v33, v33, v89
    v_add_f32 v33, v33, v90
    v_add_f32 v33, v33, v91
    ds_read_b64_tr_b16 v[40:41], v18 offset:0
    ds_read_b64_tr_b16 v[42:43], v18 offset:4096
    v_mfma_f32_32x32x16_bf16 v[72:87], v[44:47], v[164:167], v[72:87]
    v_add_f32 v33, v33, v92
    v_add_f32 v33, v33, v93
    v_add_f32 v33, v33, v94
    v_mfma_f32_32x32x16_bf16 v[104:119], v[44:47], v[228:231], v[104:119]
    v_add_f32 v33, v33, v95
    v_add_f32 v33, v33, v96
    v_add_f32 v33, v33, v97
    ds_read_b64_tr_b16 v[44:45], v19 offset:0
    ds_read_b64_tr_b16 v[46:47], v19 offset:4096
    s_waitcnt lgkmcnt(8)
    v_mfma_f32_32x32x16_bf16 v[72:87], v[48:51], v[168:171], v[72:87]
    v_add_f32 v33, v33, v98
    v_add_f32 v33, v33, v99
    v_add_f32 v33, v33, v100
    v_mfma_f32_32x32x16_bf16 v[104:119], v[48:51], v[232:235], v[104:119]
    v_add_f32 v33, v33, v101
    v_add_f32 v33, v33, v102
    v_add_f32 v33, v33, v103
    ds_read_b64_tr_b16 v[48:49], v20 offset:0
    ds_read_b64_tr_b16 v[50:51], v20 offset:4096
    v_mfma_f32_32x32x16_bf16 v[72:87], v[52:55], v[172:175], v[72:87]
    v_cvt_pk_bf16_f32 v88, v88, v89
    v_cvt_pk_bf16_f32 v89, v90, v91
    v_cvt_pk_bf16_f32 v90, v92, v93
    v_mfma_f32_32x32x16_bf16 v[104:119], v[52:55], v[236:239], v[104:119]
    v_cvt_pk_bf16_f32 v91, v94, v95
    v_cvt_pk_bf16_f32 v92, v96, v97
    v_cvt_pk_bf16_f32 v93, v98, v99
    ds_read_b64_tr_b16 v[52:53], v21 offset:0
    ds_read_b64_tr_b16 v[54:55], v21 offset:4096
    s_waitcnt lgkmcnt(10)
    v_mfma_f32_32x32x16_bf16 v[72:87], v[56:59], v[176:179], v[72:87]
    v_cvt_pk_bf16_f32 v94, v100, v101
    v_cvt_pk_bf16_f32 v95, v102, v103
    v_mfma_f32_32x32x16_bf16 v[104:119], v[56:59], v[240:243], v[104:119]
    ds_read_b64_tr_b16 v[56:57], v18 offset:256
    ds_read_b64_tr_b16 v[58:59], v18 offset:4352
    v_mfma_f32_32x32x16_bf16 v[72:87], v[60:63], v[180:183], v[72:87]
    v_mfma_f32_32x32x16_bf16 v[104:119], v[60:63], v[244:247], v[104:119]
    ds_read_b64_tr_b16 v[60:61], v19 offset:256
    ds_read_b64_tr_b16 v[62:63], v19 offset:4352
    s_waitcnt lgkmcnt(12)
    v_mfma_f32_32x32x16_bf16 v[72:87], v[64:67], v[184:187], v[72:87]
    v_mfma_f32_32x32x16_bf16 v[104:119], v[64:67], v[248:251], v[104:119]
    ds_read_b64_tr_b16 v[64:65], v20 offset:256
    ds_read_b64_tr_b16 v[66:67], v20 offset:4352
    v_mfma_f32_32x32x16_bf16 v[72:87], v[68:71], v[188:191], v[72:87]
    v_mfma_f32_32x32x16_bf16 v[104:119], v[68:71], v[252:255], v[104:119]
    s_branch LK_75
LK_74:
    ds_read_b128 v[68:71], v17 offset:0
    s_waitcnt vmcnt(48)
    s_barrier
    s_add_u32 s43, s32, 81920
    s_mov_b32 m0, s43
    s_add_u32 s44, s38, 28672
    buffer_load_dwordx4 v28, s[24:27], s44 offen offset:0 lds
    buffer_load_dwordx4 v29, s[24:27], s44 offen offset:1024 lds
    buffer_load_dwordx4 v30, s[24:27], s44 offen offset:2048 lds
    buffer_load_dwordx4 v31, s[24:27], s44 offen offset:3072 lds
    s_waitcnt lgkmcnt(6)
    v_mfma_f32_32x32x16_bf16 v[72:87], v[40:43], v[128:131], 0
    v_max3_f32 v2, v88, v89, v90
    v_max3_f32 v2, v2, v91, v92
    v_max3_f32 v2, v2, v93, v94
    v_max3_f32 v2, v2, v95, v96
    v_max3_f32 v2, v2, v97, v98
    v_max3_f32 v2, v2, v99, v100
    v_max3_f32 v2, v2, v101, v102
    v_max_f32 v2, v2, v103
    v_mov_b32 v3, v2
    s_nop 1
    ds_read_b128 v[40:43], v10 offset:256
    v_mfma_f32_32x32x16_bf16 v[72:87], v[44:47], v[132:135], v[72:87]
    v_permlane32_swap_b32 v2, v3
    v_max_f32 v2, v2, v3
    v_mul_f32 v2, s33, v2
    v_sub_f32 v3, v2, v32
    v_cmp_lt_f32 vcc, s34, v3
    s_nop 0
    s_cbranch_vccnz LRS_81
LRB_82:
    v_fma_f32 v88, v88, s33, -v32
    v_fma_f32 v89, v89, s33, -v32
    v_fma_f32 v90, v90, s33, -v32
    ds_read_b128 v[44:47], v11 offset:256
    s_waitcnt lgkmcnt(6)
    v_mfma_f32_32x32x16_bf16 v[72:87], v[48:51], v[136:139], v[72:87]
    v_fma_f32 v91, v91, s33, -v32
    v_fma_f32 v92, v92, s33, -v32
    v_fma_f32 v93, v93, s33, -v32
    v_fma_f32 v94, v94, s33, -v32
    v_fma_f32 v95, v95, s33, -v32
    v_fma_f32 v96, v96, s33, -v32
    v_fma_f32 v97, v97, s33, -v32
    v_fma_f32 v98, v98, s33, -v32
    v_fma_f32 v99, v99, s33, -v32
    v_fma_f32 v100, v100, s33, -v32
    ds_read_b128 v[48:51], v12 offset:256
    v_mfma_f32_32x32x16_bf16 v[72:87], v[52:55], v[140:143], v[72:87]
    v_fma_f32 v101, v101, s33, -v32
    v_fma_f32 v102, v102, s33, -v32
    v_fma_f32 v103, v103, s33, -v32
    v_exp_f32 v88, v88
    v_exp_f32 v89, v89
    v_exp_f32 v90, v90
    v_exp_f32 v91, v91
    v_exp_f32 v92, v92
    v_exp_f32 v93, v93
    v_exp_f32 v94, v94
    ds_read_b128 v[52:55], v13 offset:256
    s_waitcnt lgkmcnt(6)
    v_mfma_f32_32x32x16_bf16 v[72:87], v[56:59], v[144:147], v[72:87]
    v_exp_f32 v95, v95
    v_exp_f32 v96, v96
    v_exp_f32 v97, v97
    v_exp_f32 v98, v98
    v_exp_f32 v99, v99
    v_exp_f32 v100, v100
    v_exp_f32 v101, v101
    v_exp_f32 v102, v102
    v_exp_f32 v103, v103
    s_nop 0
    ds_read_b128 v[56:59], v14 offset:256
    v_mfma_f32_32x32x16_bf16 v[72:87], v[60:63], v[148:151], v[72:87]
    v_add_f32 v33, v33, v88
    v_add_f32 v33, v33, v89
    v_add_f32 v33, v33, v90
    v_add_f32 v33, v33, v91
    v_add_f32 v33, v33, v92
    v_add_f32 v33, v33, v93
    v_add_f32 v33, v33, v94
    v_add_f32 v33, v33, v95
    v_add_f32 v33, v33, v96
    v_add_f32 v33, v33, v97
    ds_read_b128 v[60:63], v15 offset:256
    s_waitcnt lgkmcnt(6)
    v_mfma_f32_32x32x16_bf16 v[72:87], v[64:67], v[152:155], v[72:87]
    v_add_f32 v33, v33, v98
    v_add_f32 v33, v33, v99
    v_add_f32 v33, v33, v100
    v_add_f32 v33, v33, v101
    v_add_f32 v33, v33, v102
    v_add_f32 v33, v33, v103
    v_cvt_pk_bf16_f32 v88, v88, v89
    v_cvt_pk_bf16_f32 v89, v90, v91
    v_cvt_pk_bf16_f32 v90, v92, v93
    v_cvt_pk_bf16_f32 v91, v94, v95
    ds_read_b128 v[64:67], v16 offset:256
    v_mfma_f32_32x32x16_bf16 v[72:87], v[68:71], v[156:159], v[72:87]
    v_cvt_pk_bf16_f32 v92, v96, v97
    v_cvt_pk_bf16_f32 v93, v98, v99
    v_cvt_pk_bf16_f32 v94, v100, v101
    v_cvt_pk_bf16_f32 v95, v102, v103
    v_max3_f32 v2, v104, v105, v106
    v_max3_f32 v2, v2, v107, v108
    v_max3_f32 v2, v2, v109, v110
    v_max3_f32 v2, v2, v111, v112
    v_max3_f32 v2, v2, v113, v114
    v_max3_f32 v2, v2, v115, v116
    ds_read_b128 v[68:71], v17 offset:256
    s_waitcnt lgkmcnt(6)
    v_mfma_f32_32x32x16_bf16 v[72:87], v[40:43], v[160:163], v[72:87]
    v_max3_f32 v2, v2, v117, v118
    v_max_f32 v2, v2, v119
    v_mov_b32 v3, v2
    s_nop 1
    v_permlane32_swap_b32 v2, v3
    v_max_f32 v2, v2, v3
    v_mul_f32 v2, s33, v2
    v_sub_f32 v3, v2, v34
    v_cmp_lt_f32 vcc, s34, v3
    s_nop 0
    ds_read_b64_tr_b16 v[40:41], v18 offset:0
    ds_read_b64_tr_b16 v[42:43], v18 offset:4096
    v_mfma_f32_32x32x16_bf16 v[72:87], v[44:47], v[164:167], v[72:87]
    s_cbranch_vccnz LRS_83
LRB_84:
    v_fma_f32 v104, v104, s33, -v34
    v_fma_f32 v105, v105, s33, -v34
    v_fma_f32 v106, v106, s33, -v34
    v_fma_f32 v107, v107, s33, -v34
    v_fma_f32 v108, v108, s33, -v34
    v_fma_f32 v109, v109, s33, -v34
    v_fma_f32 v110, v110, s33, -v34
    v_fma_f32 v111, v111, s33, -v34
    v_fma_f32 v112, v112, s33, -v34
    ds_read_b64_tr_b16 v[44:45], v19 offset:0
    ds_read_b64_tr_b16 v[46:47], v19 offset:4096
    s_waitcnt lgkmcnt(8)
    v_mfma_f32_32x32x16_bf16 v[72:87], v[48:51], v[168:171], v[72:87]
    v_fma_f32 v113, v113, s33, -v34
    v_fma_f32 v114, v114, s33, -v34
    v_fma_f32 v115, v115, s33, -v34
    v_fma_f32 v116, v116, s33, -v34
    v_fma_f32 v117, v117, s33, -v34
    v_fma_f32 v118, v118, s33, -v34
    v_fma_f32 v119, v119, s33, -v34
    v_exp_f32 v104, v104
    v_exp_f32 v105, v105
    v_exp_f32 v106, v106
    ds_read_b64_tr_b16 v[48:49], v20 offset:0
    ds_read_b64_tr_b16 v[50:51], v20 offset:4096
    v_mfma_f32_32x32x16_bf16 v[72:87], v[52:55], v[172:175], v[72:87]
    v_exp_f32 v107, v107
    v_exp_f32 v108, v108
    v_exp_f32 v109, v109
    v_exp_f32 v110, v110
    v_exp_f32 v111, v111
    v_exp_f32 v112, v112
    v_exp_f32 v113, v113
    v_exp_f32 v114, v114
    v_exp_f32 v115, v115
    v_exp_f32 v116, v116
    ds_read_b64_tr_b16 v[52:53], v21 offset:0
    ds_read_b64_tr_b16 v[54:55], v21 offset:4096
    s_waitcnt lgkmcnt(10)
    v_mfma_f32_32x32x16_bf16 v[72:87], v[56:59], v[176:179], v[72:87]
    v_exp_f32 v117, v117
    v_exp_f32 v118, v118
    v_exp_f32 v119, v119
    s_nop 0
    v_add_f32 v35, v35, v104
    v_add_f32 v35, v35, v105
    v_add_f32 v35, v35, v106
    v_add_f32 v35, v35, v107
    v_add_f32 v35, v35, v108
    v_add_f32 v35, v35, v109
    ds_read_b64_tr_b16 v[56:57], v18 offset:256
    ds_read_b64_tr_b16 v[58:59], v18 offset:4352
    v_mfma_f32_32x32x16_bf16 v[72:87], v[60:63], v[180:183], v[72:87]
    v_add_f32 v35, v35, v110
    v_add_f32 v35, v35, v111
    v_add_f32 v35, v35, v112
    v_add_f32 v35, v35, v113
    v_add_f32 v35, v35, v114
    v_add_f32 v35, v35, v115
    v_add_f32 v35, v35, v116
    v_add_f32 v35, v35, v117
    v_add_f32 v35, v35, v118
    v_add_f32 v35, v35, v119
    ds_read_b64_tr_b16 v[60:61], v19 offset:256
    ds_read_b64_tr_b16 v[62:63], v19 offset:4352
    s_waitcnt lgkmcnt(12)
    v_mfma_f32_32x32x16_bf16 v[72:87], v[64:67], v[184:187], v[72:87]
    v_cvt_pk_bf16_f32 v104, v104, v105
    v_cvt_pk_bf16_f32 v105, v106, v107
    v_cvt_pk_bf16_f32 v106, v108, v109
    v_cvt_pk_bf16_f32 v107, v110, v111
    v_cvt_pk_bf16_f32 v108, v112, v113
    v_cvt_pk_bf16_f32 v109, v114, v115
    v_cvt_pk_bf16_f32 v110, v116, v117
    v_cvt_pk_bf16_f32 v111, v118, v119
    ds_read_b64_tr_b16 v[64:65], v20 offset:256
    ds_read_b64_tr_b16 v[66:67], v20 offset:4352
    v_mfma_f32_32x32x16_bf16 v[72:87], v[68:71], v[188:191], v[72:87]
LK_75:
    v_add_u32 v10, 4294885376, v10
    v_add_u32 v11, 4294885376, v11
    v_add_u32 v12, 4294885376, v12
    v_add_u32 v13, 4294885376, v13
    v_add_u32 v14, 4294885376, v14
    v_add_u32 v15, 4294885376, v15
    v_add_u32 v16, 4294885376, v16
    v_add_u32 v17, 4294885376, v17
    s_cmp_eq_u32 s49, 1
    s_cbranch_scc1 LV_85
    ds_read_b64_tr_b16 v[68:69], v21 offset:256
    ds_read_b64_tr_b16 v[70:71], v21 offset:4352
    s_waitcnt vmcnt(40)
    s_barrier
    s_add_u32 s43, s32, 98304
    s_mov_b32 m0, s43
    s_add_u32 s44, s38, 57344
    buffer_load_dwordx4 v28, s[24:27], s44 offen offset:0 lds
    buffer_load_dwordx4 v29, s[24:27], s44 offen offset:1024 lds
    buffer_load_dwordx4 v30, s[24:27], s44 offen offset:2048 lds
    buffer_load_dwordx4 v31, s[24:27], s44 offen offset:3072 lds
    s_waitcnt lgkmcnt(12)
    v_mfma_f32_32x32x16_bf16 a[0:15], v[40:43], v[88:91], a[0:15]
    ds_read_b64_tr_b16 v[40:41], v18 offset:8192
    ds_read_b64_tr_b16 v[42:43], v18 offset:12288
    v_mfma_f32_32x32x16_bf16 a[16:31], v[44:47], v[88:91], a[16:31]
    ds_read_b64_tr_b16 v[44:45], v19 offset:8192
    ds_read_b64_tr_b16 v[46:47], v19 offset:12288
    s_waitcnt lgkmcnt(12)
    v_mfma_f32_32x32x16_bf16 a[32:47], v[48:51], v[88:91], a[32:47]
    ds_read_b64_tr_b16 v[48:49], v20 offset:8192
    ds_read_b64_tr_b16 v[50:51], v20 offset:12288
    v_mfma_f32_32x32x16_bf16 a[48:63], v[52:55], v[88:91], a[48:63]
    ds_read_b64_tr_b16 v[52:53], v21 offset:8192
    ds_read_b64_tr_b16 v[54:55], v21 offset:12288
    s_waitcnt lgkmcnt(12)
    v_mfma_f32_32x32x16_bf16 a[64:79], v[56:59], v[88:91], a[64:79]
    ds_read_b64_tr_b16 v[56:57], v18 offset:8448
    ds_read_b64_tr_b16 v[58:59], v18 offset:12544
    v_mfma_f32_32x32x16_bf16 a[80:95], v[60:63], v[88:91], a[80:95]
    ds_read_b64_tr_b16 v[60:61], v19 offset:8448
    ds_read_b64_tr_b16 v[62:63], v19 offset:12544
    s_waitcnt lgkmcnt(12)
    v_mfma_f32_32x32x16_bf16 a[96:111], v[64:67], v[88:91], a[96:111]
    ds_read_b64_tr_b16 v[64:65], v20 offset:8448
    ds_read_b64_tr_b16 v[66:67], v20 offset:12544
    v_mfma_f32_32x32x16_bf16 a[112:127], v[68:71], v[88:91], a[112:127]
    ds_read_b64_tr_b16 v[68:69], v21 offset:8448
    ds_read_b64_tr_b16 v[70:71], v21 offset:12544
    s_waitcnt lgkmcnt(12)
    v_mfma_f32_32x32x16_bf16 a[0:15], v[40:43], v[92:95], a[0:15]
    ds_read_b128 v[40:43], v10 offset:0
    v_mfma_f32_32x32x16_bf16 a[16:31], v[44:47], v[92:95], a[16:31]
    ds_read_b128 v[44:47], v11 offset:0
    s_waitcnt lgkmcnt(10)
    v_mfma_f32_32x32x16_bf16 a[32:47], v[48:51], v[92:95], a[32:47]
    ds_read_b128 v[48:51], v12 offset:0
    v_mfma_f32_32x32x16_bf16 a[48:63], v[52:55], v[92:95], a[48:63]
    ds_read_b128 v[52:55], v13 offset:0
    s_waitcnt lgkmcnt(8)
    v_mfma_f32_32x32x16_bf16 a[64:79], v[56:59], v[92:95], a[64:79]
    ds_read_b128 v[56:59], v14 offset:0
    v_mfma_f32_32x32x16_bf16 a[80:95], v[60:63], v[92:95], a[80:95]
    ds_read_b128 v[60:63], v15 offset:0
    s_waitcnt lgkmcnt(6)
    v_mfma_f32_32x32x16_bf16 a[96:111], v[64:67], v[92:95], a[96:111]
    ds_read_b128 v[64:67], v16 offset:0
    v_mfma_f32_32x32x16_bf16 a[112:127], v[68:71], v[92:95], a[112:127]
    s_branch LV_86
LV_85:
    ds_read_b64_tr_b16 v[68:69], v21 offset:256
    ds_read_b64_tr_b16 v[70:71], v21 offset:4352
    s_waitcnt vmcnt(44)
    s_barrier
    s_add_u32 s43, s32, 98304
    s_mov_b32 m0, s43
    s_add_u32 s44, s38, 57344
    buffer_load_dwordx4 v28, s[24:27], s44 offen offset:0 lds
    buffer_load_dwordx4 v29, s[24:27], s44 offen offset:1024 lds
    buffer_load_dwordx4 v30, s[24:27], s44 offen offset:2048 lds
    buffer_load_dwordx4 v31, s[24:27], s44 offen offset:3072 lds
    s_waitcnt lgkmcnt(12)
    v_mfma_f32_32x32x16_bf16 a[0:15], v[40:43], v[88:91], a[0:15]
    v_mfma_f32_32x32x16_bf16 a[128:143], v[40:43], v[104:107], a[128:143]
    ds_read_b64_tr_b16 v[40:41], v18 offset:8192
    ds_read_b64_tr_b16 v[42:43], v18 offset:12288
    v_mfma_f32_32x32x16_bf16 a[16:31], v[44:47], v[88:91], a[16:31]
    v_mfma_f32_32x32x16_bf16 a[144:159], v[44:47], v[104:107], a[144:159]
    ds_read_b64_tr_b16 v[44:45], v19 offset:8192
    ds_read_b64_tr_b16 v[46:47], v19 offset:12288
    s_waitcnt lgkmcnt(12)
    v_mfma_f32_32x32x16_bf16 a[32:47], v[48:51], v[88:91], a[32:47]
    v_mfma_f32_32x32x16_bf16 a[160:175], v[48:51], v[104:107], a[160:175]
    ds_read_b64_tr_b16 v[48:49], v20 offset:8192
    ds_read_b64_tr_b16 v[50:51], v20 offset:12288
    v_mfma_f32_32x32x16_bf16 a[48:63], v[52:55], v[88:91], a[48:63]
    v_mfma_f32_32x32x16_bf16 a[176:191], v[52:55], v[104:107], a[176:191]
    ds_read_b64_tr_b16 v[52:53], v21 offset:8192
    ds_read_b64_tr_b16 v[54:55], v21 offset:12288
    s_waitcnt lgkmcnt(12)
    v_mfma_f32_32x32x16_bf16 a[64:79], v[56:59], v[88:91], a[64:79]
    v_mfma_f32_32x32x16_bf16 a[192:207], v[56:59], v[104:107], a[192:207]
    ds_read_b64_tr_b16 v[56:57], v18 offset:8448
    ds_read_b64_tr_b16 v[58:59], v18 offset:12544
    v_mfma_f32_32x32x16_bf16 a[80:95], v[60:63], v[88:91], a[80:95]
    v_mfma_f32_32x32x16_bf16 a[208:223], v[60:63], v[104:107], a[208:223]
    ds_read_b64_tr_b16 v[60:61], v19 offset:8448
    ds_read_b64_tr_b16 v[62:63], v19 offset:12544
    s_waitcnt lgkmcnt(12)
    v_mfma_f32_32x32x16_bf16 a[96:111], v[64:67], v[88:91], a[96:111]
    v_mfma_f32_32x32x16_bf16 a[224:239], v[64:67], v[104:107], a[224:239]
    ds_read_b64_tr_b16 v[64:65], v20 offset:8448
    ds_read_b64_tr_b16 v[66:67], v20 offset:12544
    v_mfma_f32_32x32x16_bf16 a[112:127], v[68:71], v[88:91], a[112:127]
    v_mfma_f32_32x32x16_bf16 a[240:255], v[68:71], v[104:107], a[240:255]
    ds_read_b64_tr_b16 v[68:69], v21 offset:8448
    ds_read_b64_tr_b16 v[70:71], v21 offset:12544
    s_waitcnt lgkmcnt(12)
    v_mfma_f32_32x32x16_bf16 a[0:15], v[40:43], v[92:95], a[0:15]
    v_mfma_f32_32x32x16_bf16 a[128:143], v[40:43], v[108:111], a[128:143]
    ds_read_b128 v[40:43], v10 offset:0
    v_mfma_f32_32x32x16_bf16 a[16:31], v[44:47], v[92:95], a[16:31]
    v_mfma_f32_32x32x16_bf16 a[144:159], v[44:47], v[108:111], a[144:159]
    ds_read_b128 v[44:47], v11 offset:0
    s_waitcnt lgkmcnt(10)
    v_mfma_f32_32x32x16_bf16 a[32:47], v[48:51], v[92:95], a[32:47]
    v_mfma_f32_32x32x16_bf16 a[160:175], v[48:51], v[108:111], a[160:175]
    ds_read_b128 v[48:51], v12 offset:0
    v_mfma_f32_32x32x16_bf16 a[48:63], v[52:55], v[92:95], a[48:63]
    v_mfma_f32_32x32x16_bf16 a[176:191], v[52:55], v[108:111], a[176:191]
    ds_read_b128 v[52:55], v13 offset:0
    s_waitcnt lgkmcnt(8)
    v_mfma_f32_32x32x16_bf16 a[64:79], v[56:59], v[92:95], a[64:79]
    v_mfma_f32_32x32x16_bf16 a[192:207], v[56:59], v[108:111], a[192:207]
    ds_read_b128 v[56:59], v14 offset:0
    v_mfma_f32_32x32x16_bf16 a[80:95], v[60:63], v[92:95], a[80:95]
    v_mfma_f32_32x32x16_bf16 a[208:223], v[60:63], v[108:111], a[208:223]
    ds_read_b128 v[60:63], v15 offset:0
    s_waitcnt lgkmcnt(6)
    v_mfma_f32_32x32x16_bf16 a[96:111], v[64:67], v[92:95], a[96:111]
    v_mfma_f32_32x32x16_bf16 a[224:239], v[64:67], v[108:111], a[224:239]
    ds_read_b128 v[64:67], v16 offset:0
    v_mfma_f32_32x32x16_bf16 a[112:127], v[68:71], v[92:95], a[112:127]
    v_mfma_f32_32x32x16_bf16 a[240:255], v[68:71], v[108:111], a[240:255]
LV_86:
    v_add_u32 v18, 32768, v18
    v_add_u32 v19, 32768, v19
    v_add_u32 v20, 32768, v20
    v_add_u32 v21, 32768, v21
    s_cmp_eq_u32 s7, 2
    s_cselect_b32 s49, 1, 0
    s_cmp_eq_u32 s7, 3
    s_cselect_b32 s50, 1, 0
    s_cmp_eq_u32 s50, 1
    s_cbranch_scc1 LK_87
    s_cmp_eq_u32 s49, 1
    s_cbranch_scc1 LK_88
    ds_read_b128 v[68:71], v17 offset:0
    s_waitcnt vmcnt(40)
    s_barrier
    s_add_u32 s43, s32, 0
    s_mov_b32 m0, s43
    s_add_u32 s44, s38, 86016
    buffer_load_dwordx4 v28, s[24:27], s44 offen offset:0 lds
    buffer_load_dwordx4 v29, s[24:27], s44 offen offset:1024 lds
    buffer_load_dwordx4 v30, s[24:27], s44 offen offset:2048 lds
    buffer_load_dwordx4 v31, s[24:27], s44 offen offset:3072 lds
    s_waitcnt lgkmcnt(6)
    v_mfma_f32_32x32x16_bf16 v[88:103], v[40:43], v[128:131], 0
    v_max3_f32 v2, v72, v73, v74
    v_max3_f32 v2, v2, v75, v76
    v_max3_f32 v2, v2, v77, v78
    v_max3_f32 v2, v2, v79, v80
    v_max3_f32 v2, v2, v81, v82
    ds_read_b128 v[40:43], v10 offset:256
    v_mfma_f32_32x32x16_bf16 v[88:103], v[44:47], v[132:135], v[88:103]
    v_max3_f32 v2, v2, v83, v84
    v_max3_f32 v2, v2, v85, v86
    v_max_f32 v2, v2, v87
    v_mov_b32 v3, v2
    s_nop 1
    ds_read_b128 v[44:47], v11 offset:256
    s_waitcnt lgkmcnt(6)
    v_mfma_f32_32x32x16_bf16 v[88:103], v[48:51], v[136:139], v[88:103]
    v_permlane32_swap_b32 v2, v3
    v_max_f32 v2, v2, v3
    v_mul_f32 v2, s33, v2
    v_sub_f32 v3, v2, v32
    v_cmp_lt_f32 vcc, s34, v3
    ds_read_b128 v[48:51], v12 offset:256
    v_mfma_f32_32x32x16_bf16 v[88:103], v[52:55], v[140:143], v[88:103]
    s_nop 0
    s_cbranch_vccnz LRS_91
LRB_92:
    v_fma_f32 v72, v72, s33, -v32
    v_fma_f32 v73, v73, s33, -v32
    v_fma_f32 v74, v74, s33, -v32
    ds_read_b128 v[52:55], v13 offset:256
    s_waitcnt lgkmcnt(6)
    v_mfma_f32_32x32x16_bf16 v[88:103], v[56:59], v[144:147], v[88:103]
    v_fma_f32 v75, v75, s33, -v32
    v_fma_f32 v76, v76, s33, -v32
    v_fma_f32 v77, v77, s33, -v32
    v_fma_f32 v78, v78, s33, -v32
    v_fma_f32 v79, v79, s33, -v32
    ds_read_b128 v[56:59], v14 offset:256
    v_mfma_f32_32x32x16_bf16 v[88:103], v[60:63], v[148:151], v[88:103]
    v_fma_f32 v80, v80, s33, -v32
    v_fma_f32 v81, v81, s33, -v32
    v_fma_f32 v82, v82, s33, -v32
    v_fma_f32 v83, v83, s33, -v32
    v_fma_f32 v84, v84, s33, -v32
    ds_read_b128 v[60:63], v15 offset:256
    s_waitcnt lgkmcnt(6)
    v_mfma_f32_32x32x16_bf16 v[88:103], v[64:67], v[152:155], v[88:103]
    v_fma_f32 v85, v85, s33, -v32
    v_fma_f32 v86, v86, s33, -v32
    v_fma_f32 v87, v87, s33, -v32
    v_exp_f32 v72, v72
    v_exp_f32 v73, v73
    ds_read_b128 v[64:67], v16 offset:256
    v_mfma_f32_32x32x16_bf16 v[88:103], v[68:71], v[156:159], v[88:103]
    v_exp_f32 v74, v74
    v_exp_f32 v75, v75
    v_exp_f32 v76, v76
    v_exp_f32 v77, v77
    v_exp_f32 v78, v78
    ds_read_b128 v[68:71], v17 offset:256
    s_waitcnt lgkmcnt(6)
    v_mfma_f32_32x32x16_bf16 v[88:103], v[40:43], v[160:163], v[88:103]
    v_exp_f32 v79, v79
    v_exp_f32 v80, v80
    v_exp_f32 v81, v81
    v_exp_f32 v82, v82
    v_exp_f32 v83, v83
    ds_read_b64_tr_b16 v[40:41], v18 offset:0
    ds_read_b64_tr_b16 v[42:43], v18 offset:4096
    v_mfma_f32_32x32x16_bf16 v[88:103], v[44:47], v[164:167], v[88:103]
    v_exp_f32 v84, v84
    v_exp_f32 v85, v85
    v_exp_f32 v86, v86
    v_exp_f32 v87, v87
    s_nop 0
    ds_read_b64_tr_b16 v[44:45], v19 offset:0
    ds_read_b64_tr_b16 v[46:47], v19 offset:4096
    s_waitcnt lgkmcnt(8)
    v_mfma_f32_32x32x16_bf16 v[88:103], v[48:51], v[168:171], v[88:103]
    v_add_f32 v33, v33, v72
    v_add_f32 v33, v33, v73
    v_add_f32 v33, v33, v74
    v_add_f32 v33, v33, v75
    v_add_f32 v33, v33, v76
    ds_read_b64_tr_b16 v[48:49], v20 offset:0
    ds_read_b64_tr_b16 v[50:51], v20 offset:4096
    v_mfma_f32_32x32x16_bf16 v[88:103], v[52:55], v[172:175], v[88:103]
    v_add_f32 v33, v33, v77
    v_add_f32 v33, v33, v78
    v_add_f32 v33, v33, v79
    v_add_f32 v33, v33, v80
    v_add_f32 v33, v33, v81
    ds_read_b64_tr_b16 v[52:53], v21 offset:0
    ds_read_b64_tr_b16 v[54:55], v21 offset:4096
    s_waitcnt lgkmcnt(10)
    v_mfma_f32_32x32x16_bf16 v[88:103], v[56:59], v[176:179], v[88:103]
    v_add_f32 v33, v33, v82
    v_add_f32 v33, v33, v83
    v_add_f32 v33, v33, v84
    v_add_f32 v33, v33, v85
    v_add_f32 v33, v33, v86
    ds_read_b64_tr_b16 v[56:57], v18 offset:256
    ds_read_b64_tr_b16 v[58:59], v18 offset:4352
    v_mfma_f32_32x32x16_bf16 v[88:103], v[60:63], v[180:183], v[88:103]
    v_add_f32 v33, v33, v87
    v_cvt_pk_bf16_f32 v72, v72, v73
    v_cvt_pk_bf16_f32 v73, v74, v75
    v_cvt_pk_bf16_f32 v74, v76, v77
    v_cvt_pk_bf16_f32 v75, v78, v79
    ds_read_b64_tr_b16 v[60:61], v19 offset:256
    ds_read_b64_tr_b16 v[62:63], v19 offset:4352
    s_waitcnt lgkmcnt(12)
    v_mfma_f32_32x32x16_bf16 v[88:103], v[64:67], v[184:187], v[88:103]
    v_cvt_pk_bf16_f32 v76, v80, v81
    v_cvt_pk_bf16_f32 v77, v82, v83
    v_cvt_pk_bf16_f32 v78, v84, v85
    v_cvt_pk_bf16_f32 v79, v86, v87
    ds_read_b64_tr_b16 v[64:65], v20 offset:256
    ds_read_b64_tr_b16 v[66:67], v20 offset:4352
    v_mfma_f32_32x32x16_bf16 v[88:103], v[68:71], v[188:191], v[88:103]
    s_branch LK_89
LK_87:
    ds_read_b128 v[68:71], v17 offset:0
    s_waitcnt vmcnt(44)
    s_barrier
    s_add_u32 s43, s32, 0
    s_mov_b32 m0, s43
    s_add_u32 s44, s38, 86016
    buffer_load_dwordx4 v28, s[24:27], s44 offen offset:0 lds
    buffer_load_dwordx4 v29, s[24:27], s44 offen offset:1024 lds
    buffer_load_dwordx4 v30, s[24:27], s44 offen offset:2048 lds
    buffer_load_dwordx4 v31, s[24:27], s44 offen offset:3072 lds
    s_waitcnt lgkmcnt(6)
    v_mfma_f32_32x32x16_bf16 v[88:103], v[40:43], v[128:131], 0
    v_max3_f32 v2, v72, v73, v74
    v_max3_f32 v2, v2, v75, v76
    v_max3_f32 v2, v2, v77, v78
    v_mfma_f32_32x32x16_bf16 v[104:119], v[40:43], v[192:195], 0
    v_max3_f32 v2, v2, v79, v80
    v_max3_f32 v2, v2, v81, v82
    v_max3_f32 v2, v2, v83, v84
    ds_read_b128 v[40:43], v10 offset:256
    v_mfma_f32_32x32x16_bf16 v[88:103], v[44:47], v[132:135], v[88:103]
    v_max3_f32 v2, v2, v85, v86
    v_max_f32 v2, v2, v87
    v_mov_b32 v3, v2
    v_mfma_f32_32x32x16_bf16 v[104:119], v[44:47], v[196:199], v[104:119]
    s_nop 1
    v_permlane32_swap_b32 v2, v3
    v_max_f32 v2, v2, v3
    ds_read_b128 v[44:47], v11 offset:256
    s_waitcnt lgkmcnt(6)
    v_mfma_f32_32x32x16_bf16 v[88:103], v[48:51], v[136:139], v[88:103]
    v_mul_f32 v2, s33, v2
    v_sub_f32 v3, v2, v32
    v_cmp_lt_f32 vcc, s34, v3
    v_mfma_f32_32x32x16_bf16 v[104:119], v[48:51], v[200:203], v[104:119]
    s_nop 0
    s_cbranch_vccnz LRS_93
LRB_94:
    v_fma_f32 v72, v72, s33, -v32
    ds_read_b128 v[48:51], v12 offset:256
    v_mfma_f32_32x32x16_bf16 v[88:103], v[52:55], v[140:143], v[88:103]
    v_fma_f32 v73, v73, s33, -v32
    v_fma_f32 v74, v74, s33, -v32
    v_fma_f32 v75, v75, s33, -v32
    v_mfma_f32_32x32x16_bf16 v[104:119], v[52:55], v[204:207], v[104:119]
    v_fma_f32 v76, v76, s33, -v32
    v_fma_f32 v77, v77, s33, -v32
    v_fma_f32 v78, v78, s33, -v32
    ds_read_b128 v[52:55], v13 offset:256
    s_waitcnt lgkmcnt(6)
    v_mfma_f32_32x32x16_bf16 v[88:103], v[56:59], v[144:147], v[88:103]
    v_fma_f32 v79, v79, s33, -v32
    v_fma_f32 v80, v80, s33, -v32
    v_fma_f32 v81, v81, s33, -v32
    v_mfma_f32_32x32x16_bf16 v[104:119], v[56:59], v[208:211], v[104:119]
    v_fma_f32 v82, v82, s33, -v32
    v_fma_f32 v83, v83, s33, -v32
    v_fma_f32 v84, v84, s33, -v32
    ds_read_b128 v[56:59], v14 offset:256
    v_mfma_f32_32x32x16_bf16 v[88:103], v[60:63], v[148:151], v[88:103]
    v_fma_f32 v85, v85, s33, -v32
    v_fma_f32 v86, v86, s33, -v32
    v_fma_f32 v87, v87, s33, -v32
    v_mfma_f32_32x32x16_bf16 v[104:119], v[60:63], v[212:215], v[104:119]
    v_exp_f32 v72, v72
    v_exp_f32 v73, v73
    v_exp_f32 v74, v74
    ds_read_b128 v[60:63], v15 offset:256
    s_waitcnt lgkmcnt(6)
    v_mfma_f32_32x32x16_bf16 v[88:103], v[64:67], v[152:155], v[88:103]
    v_exp_f32 v75, v75
    v_exp_f32 v76, v76
    v_exp_f32 v77, v77
    v_mfma_f32_32x32x16_bf16 v[104:119], v[64:67], v[216:219], v[104:119]
    v_exp_f32 v78, v78
    v_exp_f32 v79, v79
    v_exp_f32 v80, v80
    ds_read_b128 v[64:67], v16 offset:256
    v_mfma_f32_32x32x16_bf16 v[88:103], v[68:71], v[156:159], v[88:103]
    v_exp_f32 v81, v81
    v_exp_f32 v82, v82
    v_exp_f32 v83, v83
    v_mfma_f32_32x32x16_bf16 v[104:119], v[68:71], v[220:223], v[104:119]
    v_exp_f32 v84, v84
    v_exp_f32 v85, v85
    v_exp_f32 v86, v86
    ds_read_b128 v[68:71], v17 offset:256
    s_waitcnt lgkmcnt(6)
    v_mfma_f32_32x32x16_bf16 v[88:103], v[40:43], v[160:163], v[88:103]
    v_exp_f32 v87, v87
    s_nop 0
    v_add_f32 v33, v33, v72
    v_mfma_f32_32x32x16_bf16 v[104:119], v[40:43], v[224:227], v[104:119]
    v_add_f32 v33, v33, v73
    v_add_f32 v33, v33, v74
    v_add_f32 v33, v33, v75
    ds_read_b64_tr_b16 v[40:41], v18 offset:0
    ds_read_b64_tr_b16 v[42:43], v18 offset:4096
    v_mfma_f32_32x32x16_bf16 v[88:103], v[44:47], v[164:167], v[88:103]
    v_add_f32 v33, v33, v76
    v_add_f32 v33, v33, v77
    v_add_f32 v33, v33, v78
    v_mfma_f32_32x32x16_bf16 v[104:119], v[44:47], v[228:231], v[104:119]
    v_add_f32 v33, v33, v79
    v_add_f32 v33, v33, v80
    v_add_f32 v33, v33, v81
    ds_read_b64_tr_b16 v[44:45], v19 offset:0
    ds_read_b64_tr_b16 v[46:47], v19 offset:4096
    s_waitcnt lgkmcnt(8)
    v_mfma_f32_32x32x16_bf16 v[88:103], v[48:51], v[168:171], v[88:103]
    v_add_f32 v33, v33, v82
    v_add_f32 v33, v33, v83
    v_add_f32 v33, v33, v84
    v_mfma_f32_32x32x16_bf16 v[104:119], v[48:51], v[232:235], v[104:119]
    v_add_f32 v33, v33, v85
    v_add_f32 v33, v33, v86
    v_add_f32 v33, v33, v87
    ds_read_b64_tr_b16 v[48:49], v20 offset:0
    ds_read_b64_tr_b16 v[50:51], v20 offset:4096
    v_mfma_f32_32x32x16_bf16 v[88:103], v[52:55], v[172:175], v[88:103]
    v_cvt_pk_bf16_f32 v72, v72, v73
    v_cvt_pk_bf16_f32 v73, v74, v75
    v_cvt_pk_bf16_f32 v74, v76, v77
    v_mfma_f32_32x32x16_bf16 v[104:119], v[52:55], v[236:239], v[104:119]
    v_cvt_pk_bf16_f32 v75, v78, v79
    v_cvt_pk_bf16_f32 v76, v80, v81
    v_cvt_pk_bf16_f32 v77, v82, v83
    ds_read_b64_tr_b16 v[52:53], v21 offset:0
    ds_read_b64_tr_b16 v[54:55], v21 offset:4096
    s_waitcnt lgkmcnt(10)
    v_mfma_f32_32x32x16_bf16 v[88:103], v[56:59], v[176:179], v[88:103]
    v_cvt_pk_bf16_f32 v78, v84, v85
    v_cvt_pk_bf16_f32 v79, v86, v87
    v_mfma_f32_32x32x16_bf16 v[104:119], v[56:59], v[240:243], v[104:119]
    ds_read_b64_tr_b16 v[56:57], v18 offset:256
    ds_read_b64_tr_b16 v[58:59], v18 offset:4352
    v_mfma_f32_32x32x16_bf16 v[88:103], v[60:63], v[180:183], v[88:103]
    v_mfma_f32_32x32x16_bf16 v[104:119], v[60:63], v[244:247], v[104:119]
    ds_read_b64_tr_b16 v[60:61], v19 offset:256
    ds_read_b64_tr_b16 v[62:63], v19 offset:4352
    s_waitcnt lgkmcnt(12)
    v_mfma_f32_32x32x16_bf16 v[88:103], v[64:67], v[184:187], v[88:103]
    v_mfma_f32_32x32x16_bf16 v[104:119], v[64:67], v[248:251], v[104:119]
    ds_read_b64_tr_b16 v[64:65], v20 offset:256
    ds_read_b64_tr_b16 v[66:67], v20 offset:4352
    v_mfma_f32_32x32x16_bf16 v[88:103], v[68:71], v[188:191], v[88:103]
    v_mfma_f32_32x32x16_bf16 v[104:119], v[68:71], v[252:255], v[104:119]
    s_branch LK_89
LK_88:
    ds_read_b128 v[68:71], v17 offset:0
    s_waitcnt vmcnt(48)
    s_barrier
    s_add_u32 s43, s32, 0
    s_mov_b32 m0, s43
    s_add_u32 s44, s38, 86016
    buffer_load_dwordx4 v28, s[24:27], s44 offen offset:0 lds
    buffer_load_dwordx4 v29, s[24:27], s44 offen offset:1024 lds
    buffer_load_dwordx4 v30, s[24:27], s44 offen offset:2048 lds
    buffer_load_dwordx4 v31, s[24:27], s44 offen offset:3072 lds
    s_waitcnt lgkmcnt(6)
    v_mfma_f32_32x32x16_bf16 v[88:103], v[40:43], v[128:131], 0
    v_max3_f32 v2, v72, v73, v74
    v_max3_f32 v2, v2, v75, v76
    v_max3_f32 v2, v2, v77, v78
    v_max3_f32 v2, v2, v79, v80
    v_max3_f32 v2, v2, v81, v82
    v_max3_f32 v2, v2, v83, v84
    v_max3_f32 v2, v2, v85, v86
    v_max_f32 v2, v2, v87
    v_mov_b32 v3, v2
    s_nop 1
    ds_read_b128 v[40:43], v10 offset:256
    v_mfma_f32_32x32x16_bf16 v[88:103], v[44:47], v[132:135], v[88:103]
    v_permlane32_swap_b32 v2, v3
    v_max_f32 v2, v2, v3
    v_mul_f32 v2, s33, v2
    v_sub_f32 v3, v2, v32
    v_cmp_lt_f32 vcc, s34, v3
    s_nop 0
    s_cbranch_vccnz LRS_95
LRB_96:
    v_fma_f32 v72, v72, s33, -v32
    v_fma_f32 v73, v73, s33, -v32
    v_fma_f32 v74, v74, s33, -v32
    ds_read_b128 v[44:47], v11 offset:256
    s_waitcnt lgkmcnt(6)
    v_mfma_f32_32x32x16_bf16 v[88:103], v[48:51], v[136:139], v[88:103]
    v_fma_f32 v75, v75, s33, -v32
    v_fma_f32 v76, v76, s33, -v32
    v_fma_f32 v77, v77, s33, -v32
    v_fma_f32 v78, v78, s33, -v32
    v_fma_f32 v79, v79, s33, -v32
    v_fma_f32 v80, v80, s33, -v32
    v_fma_f32 v81, v81, s33, -v32
    v_fma_f32 v82, v82, s33, -v32
    v_fma_f32 v83, v83, s33, -v32
    v_fma_f32 v84, v84, s33, -v32
    ds_read_b128 v[48:51], v12 offset:256
    v_mfma_f32_32x32x16_bf16 v[88:103], v[52:55], v[140:143], v[88:103]
    v_fma_f32 v85, v85, s33, -v32
    v_fma_f32 v86, v86, s33, -v32
    v_fma_f32 v87, v87, s33, -v32
    v_exp_f32 v72, v72
    v_exp_f32 v73, v73
    v_exp_f32 v74, v74
    v_exp_f32 v75, v75
    v_exp_f32 v76, v76
    v_exp_f32 v77, v77
    v_exp_f32 v78, v78
    ds_read_b128 v[52:55], v13 offset:256
    s_waitcnt lgkmcnt(6)
    v_mfma_f32_32x32x16_bf16 v[88:103], v[56:59], v[144:147], v[88:103]
    v_exp_f32 v79, v79
    v_exp_f32 v80, v80
    v_exp_f32 v81, v81
    v_exp_f32 v82, v82
    v_exp_f32 v83, v83
    v_exp_f32 v84, v84
    v_exp_f32 v85, v85
    v_exp_f32 v86, v86
    v_exp_f32 v87, v87
    s_nop 0
    ds_read_b128 v[56:59], v14 offset:256
    v_mfma_f32_32x32x16_bf16 v[88:103], v[60:63], v[148:151], v[88:103]
    v_add_f32 v33, v33, v72
    v_add_f32 v33, v33, v73
    v_add_f32 v33, v33, v74
    v_add_f32 v33, v33, v75
    v_add_f32 v33, v33, v76
    v_add_f32 v33, v33, v77
    v_add_f32 v33, v33, v78
    v_add_f32 v33, v33, v79
    v_add_f32 v33, v33, v80
    v_add_f32 v33, v33, v81
    ds_read_b128 v[60:63], v15 offset:256
    s_waitcnt lgkmcnt(6)
    v_mfma_f32_32x32x16_bf16 v[88:103], v[64:67], v[152:155], v[88:103]
    v_add_f32 v33, v33, v82
    v_add_f32 v33, v33, v83
    v_add_f32 v33, v33, v84
    v_add_f32 v33, v33, v85
    v_add_f32 v33, v33, v86
    v_add_f32 v33, v33, v87
    v_cvt_pk_bf16_f32 v72, v72, v73
    v_cvt_pk_bf16_f32 v73, v74, v75
    v_cvt_pk_bf16_f32 v74, v76, v77
    v_cvt_pk_bf16_f32 v75, v78, v79
    ds_read_b128 v[64:67], v16 offset:256
    v_mfma_f32_32x32x16_bf16 v[88:103], v[68:71], v[156:159], v[88:103]
    v_cvt_pk_bf16_f32 v76, v80, v81
    v_cvt_pk_bf16_f32 v77, v82, v83
    v_cvt_pk_bf16_f32 v78, v84, v85
    v_cvt_pk_bf16_f32 v79, v86, v87
    v_max3_f32 v2, v104, v105, v106
    v_max3_f32 v2, v2, v107, v108
    v_max3_f32 v2, v2, v109, v110
    v_max3_f32 v2, v2, v111, v112
    v_max3_f32 v2, v2, v113, v114
    v_max3_f32 v2, v2, v115, v116
    ds_read_b128 v[68:71], v17 offset:256
    s_waitcnt lgkmcnt(6)
    v_mfma_f32_32x32x16_bf16 v[88:103], v[40:43], v[160:163], v[88:103]
    v_max3_f32 v2, v2, v117, v118
    v_max_f32 v2, v2, v119
    v_mov_b32 v3, v2
    s_nop 1
    v_permlane32_swap_b32 v2, v3
    v_max_f32 v2, v2, v3
    v_mul_f32 v2, s33, v2
    v_sub_f32 v3, v2, v34
    v_cmp_lt_f32 vcc, s34, v3
    s_nop 0
    ds_read_b64_tr_b16 v[40:41], v18 offset:0
    ds_read_b64_tr_b16 v[42:43], v18 offset:4096
    v_mfma_f32_32x32x16_bf16 v[88:103], v[44:47], v[164:167], v[88:103]
    s_cbranch_vccnz LRS_97
LRB_98:
    v_fma_f32 v104, v104, s33, -v34
    v_fma_f32 v105, v105, s33, -v34
    v_fma_f32 v106, v106, s33, -v34
    v_fma_f32 v107, v107, s33, -v34
    v_fma_f32 v108, v108, s33, -v34
    v_fma_f32 v109, v109, s33, -v34
    v_fma_f32 v110, v110, s33, -v34
    v_fma_f32 v111, v111, s33, -v34
    v_fma_f32 v112, v112, s33, -v34
    ds_read_b64_tr_b16 v[44:45], v19 offset:0
    ds_read_b64_tr_b16 v[46:47], v19 offset:4096
    s_waitcnt lgkmcnt(8)
    v_mfma_f32_32x32x16_bf16 v[88:103], v[48:51], v[168:171], v[88:103]
    v_fma_f32 v113, v113, s33, -v34
    v_fma_f32 v114, v114, s33, -v34
    v_fma_f32 v115, v115, s33, -v34
    v_fma_f32 v116, v116, s33, -v34
    v_fma_f32 v117, v117, s33, -v34
    v_fma_f32 v118, v118, s33, -v34
    v_fma_f32 v119, v119, s33, -v34
    v_exp_f32 v104, v104
    v_exp_f32 v105, v105
    v_exp_f32 v106, v106
    ds_read_b64_tr_b16 v[48:49], v20 offset:0
    ds_read_b64_tr_b16 v[50:51], v20 offset:4096
    v_mfma_f32_32x32x16_bf16 v[88:103], v[52:55], v[172:175], v[88:103]
    v_exp_f32 v107, v107
    v_exp_f32 v108, v108
    v_exp_f32 v109, v109
    v_exp_f32 v110, v110
    v_exp_f32 v111, v111
    v_exp_f32 v112, v112
    v_exp_f32 v113, v113
    v_exp_f32 v114, v114
    v_exp_f32 v115, v115
    v_exp_f32 v116, v116
    ds_read_b64_tr_b16 v[52:53], v21 offset:0
    ds_read_b64_tr_b16 v[54:55], v21 offset:4096
    s_waitcnt lgkmcnt(10)
    v_mfma_f32_32x32x16_bf16 v[88:103], v[56:59], v[176:179], v[88:103]
    v_exp_f32 v117, v117
    v_exp_f32 v118, v118
    v_exp_f32 v119, v119
    s_nop 0
    v_add_f32 v35, v35, v104
    v_add_f32 v35, v35, v105
    v_add_f32 v35, v35, v106
    v_add_f32 v35, v35, v107
    v_add_f32 v35, v35, v108
    v_add_f32 v35, v35, v109
    ds_read_b64_tr_b16 v[56:57], v18 offset:256
    ds_read_b64_tr_b16 v[58:59], v18 offset:4352
    v_mfma_f32_32x32x16_bf16 v[88:103], v[60:63], v[180:183], v[88:103]
    v_add_f32 v35, v35, v110
    v_add_f32 v35, v35, v111
    v_add_f32 v35, v35, v112
    v_add_f32 v35, v35, v113
    v_add_f32 v35, v35, v114
    v_add_f32 v35, v35, v115
    v_add_f32 v35, v35, v116
    v_add_f32 v35, v35, v117
    v_add_f32 v35, v35, v118
    v_add_f32 v35, v35, v119
    ds_read_b64_tr_b16 v[60:61], v19 offset:256
    ds_read_b64_tr_b16 v[62:63], v19 offset:4352
    s_waitcnt lgkmcnt(12)
    v_mfma_f32_32x32x16_bf16 v[88:103], v[64:67], v[184:187], v[88:103]
    v_cvt_pk_bf16_f32 v104, v104, v105
    v_cvt_pk_bf16_f32 v105, v106, v107
    v_cvt_pk_bf16_f32 v106, v108, v109
    v_cvt_pk_bf16_f32 v107, v110, v111
    v_cvt_pk_bf16_f32 v108, v112, v113
    v_cvt_pk_bf16_f32 v109, v114, v115
    v_cvt_pk_bf16_f32 v110, v116, v117
    v_cvt_pk_bf16_f32 v111, v118, v119
    ds_read_b64_tr_b16 v[64:65], v20 offset:256
    ds_read_b64_tr_b16 v[66:67], v20 offset:4352
    v_mfma_f32_32x32x16_bf16 v[88:103], v[68:71], v[188:191], v[88:103]
LK_89:
    s_cmp_eq_u32 s49, 1
    s_cbranch_scc1 LV_99
    ds_read_b64_tr_b16 v[68:69], v21 offset:256
    ds_read_b64_tr_b16 v[70:71], v21 offset:4352
    s_waitcnt vmcnt(40)
    s_barrier
    s_add_u32 s43, s32, 16384
    s_mov_b32 m0, s43
    s_add_u32 s44, s38, 114688
    buffer_load_dwordx4 v28, s[24:27], s44 offen offset:0 lds
    buffer_load_dwordx4 v29, s[24:27], s44 offen offset:1024 lds
    buffer_load_dwordx4 v30, s[24:27], s44 offen offset:2048 lds
    buffer_load_dwordx4 v31, s[24:27], s44 offen offset:3072 lds
    s_waitcnt lgkmcnt(12)
    v_mfma_f32_32x32x16_bf16 a[0:15], v[40:43], v[72:75], a[0:15]
    ds_read_b64_tr_b16 v[40:41], v18 offset:8192
    ds_read_b64_tr_b16 v[42:43], v18 offset:12288
    v_mfma_f32_32x32x16_bf16 a[16:31], v[44:47], v[72:75], a[16:31]
    ds_read_b64_tr_b16 v[44:45], v19 offset:8192
    ds_read_b64_tr_b16 v[46:47], v19 offset:12288
    s_waitcnt lgkmcnt(12)
    v_mfma_f32_32x32x16_bf16 a[32:47], v[48:51], v[72:75], a[32:47]
    ds_read_b64_tr_b16 v[48:49], v20 offset:8192
    ds_read_b64_tr_b16 v[50:51], v20 offset:12288
    v_mfma_f32_32x32x16_bf16 a[48:63], v[52:55], v[72:75], a[48:63]
    ds_read_b64_tr_b16 v[52:53], v21 offset:8192
    ds_read_b64_tr_b16 v[54:55], v21 offset:12288
    s_waitcnt lgkmcnt(12)
    v_mfma_f32_32x32x16_bf16 a[64:79], v[56:59], v[72:75], a[64:79]
    ds_read_b64_tr_b16 v[56:57], v18 offset:8448
    ds_read_b64_tr_b16 v[58:59], v18 offset:12544
    v_mfma_f32_32x32x16_bf16 a[80:95], v[60:63], v[72:75], a[80:95]
    ds_read_b64_tr_b16 v[60:61], v19 offset:8448
    ds_read_b64_tr_b16 v[62:63], v19 offset:12544
    s_waitcnt lgkmcnt(12)
    v_mfma_f32_32x32x16_bf16 a[96:111], v[64:67], v[72:75], a[96:111]
    ds_read_b64_tr_b16 v[64:65], v20 offset:8448
    ds_read_b64_tr_b16 v[66:67], v20 offset:12544
    v_mfma_f32_32x32x16_bf16 a[112:127], v[68:71], v[72:75], a[112:127]
    ds_read_b64_tr_b16 v[68:69], v21 offset:8448
    ds_read_b64_tr_b16 v[70:71], v21 offset:12544
    s_waitcnt lgkmcnt(12)
    v_mfma_f32_32x32x16_bf16 a[0:15], v[40:43], v[76:79], a[0:15]
    v_mfma_f32_32x32x16_bf16 a[16:31], v[44:47], v[76:79], a[16:31]
    s_waitcnt lgkmcnt(8)
    v_mfma_f32_32x32x16_bf16 a[32:47], v[48:51], v[76:79], a[32:47]
    v_mfma_f32_32x32x16_bf16 a[48:63], v[52:55], v[76:79], a[48:63]
    s_waitcnt lgkmcnt(4)
    v_mfma_f32_32x32x16_bf16 a[64:79], v[56:59], v[76:79], a[64:79]
    v_mfma_f32_32x32x16_bf16 a[80:95], v[60:63], v[76:79], a[80:95]
    s_waitcnt lgkmcnt(0)
    v_mfma_f32_32x32x16_bf16 a[96:111], v[64:67], v[76:79], a[96:111]
    v_mfma_f32_32x32x16_bf16 a[112:127], v[68:71], v[76:79], a[112:127]
    s_branch LV_100
LV_99:
    ds_read_b64_tr_b16 v[68:69], v21 offset:256
    ds_read_b64_tr_b16 v[70:71], v21 offset:4352
    s_waitcnt vmcnt(44)
    s_barrier
    s_add_u32 s43, s32, 16384
    s_mov_b32 m0, s43
    s_add_u32 s44, s38, 114688
    buffer_load_dwordx4 v28, s[24:27], s44 offen offset:0 lds
    buffer_load_dwordx4 v29, s[24:27], s44 offen offset:1024 lds
    buffer_load_dwordx4 v30, s[24:27], s44 offen offset:2048 lds
    buffer_load_dwordx4 v31, s[24:27], s44 offen offset:3072 lds
    s_waitcnt lgkmcnt(12)
    v_mfma_f32_32x32x16_bf16 a[0:15], v[40:43], v[72:75], a[0:15]
    v_mfma_f32_32x32x16_bf16 a[128:143], v[40:43], v[104:107], a[128:143]
    ds_read_b64_tr_b16 v[40:41], v18 offset:8192
    ds_read_b64_tr_b16 v[42:43], v18 offset:12288
    v_mfma_f32_32x32x16_bf16 a[16:31], v[44:47], v[72:75], a[16:31]
    v_mfma_f32_32x32x16_bf16 a[144:159], v[44:47], v[104:107], a[144:159]
    ds_read_b64_tr_b16 v[44:45], v19 offset:8192
    ds_read_b64_tr_b16 v[46:47], v19 offset:12288
    s_waitcnt lgkmcnt(12)
    v_mfma_f32_32x32x16_bf16 a[32:47], v[48:51], v[72:75], a[32:47]
    v_mfma_f32_32x32x16_bf16 a[160:175], v[48:51], v[104:107], a[160:175]
    ds_read_b64_tr_b16 v[48:49], v20 offset:8192
    ds_read_b64_tr_b16 v[50:51], v20 offset:12288
    v_mfma_f32_32x32x16_bf16 a[48:63], v[52:55], v[72:75], a[48:63]
    v_mfma_f32_32x32x16_bf16 a[176:191], v[52:55], v[104:107], a[176:191]
    ds_read_b64_tr_b16 v[52:53], v21 offset:8192
    ds_read_b64_tr_b16 v[54:55], v21 offset:12288
    s_waitcnt lgkmcnt(12)
    v_mfma_f32_32x32x16_bf16 a[64:79], v[56:59], v[72:75], a[64:79]
    v_mfma_f32_32x32x16_bf16 a[192:207], v[56:59], v[104:107], a[192:207]
    ds_read_b64_tr_b16 v[56:57], v18 offset:8448
    ds_read_b64_tr_b16 v[58:59], v18 offset:12544
    v_mfma_f32_32x32x16_bf16 a[80:95], v[60:63], v[72:75], a[80:95]
    v_mfma_f32_32x32x16_bf16 a[208:223], v[60:63], v[104:107], a[208:223]
    ds_read_b64_tr_b16 v[60:61], v19 offset:8448
    ds_read_b64_tr_b16 v[62:63], v19 offset:12544
    s_waitcnt lgkmcnt(12)
    v_mfma_f32_32x32x16_bf16 a[96:111], v[64:67], v[72:75], a[96:111]
    v_mfma_f32_32x32x16_bf16 a[224:239], v[64:67], v[104:107], a[224:239]
    ds_read_b64_tr_b16 v[64:65], v20 offset:8448
    ds_read_b64_tr_b16 v[66:67], v20 offset:12544
    v_mfma_f32_32x32x16_bf16 a[112:127], v[68:71], v[72:75], a[112:127]
    v_mfma_f32_32x32x16_bf16 a[240:255], v[68:71], v[104:107], a[240:255]
    ds_read_b64_tr_b16 v[68:69], v21 offset:8448
    ds_read_b64_tr_b16 v[70:71], v21 offset:12544
    s_waitcnt lgkmcnt(12)
    v_mfma_f32_32x32x16_bf16 a[0:15], v[40:43], v[76:79], a[0:15]
    v_mfma_f32_32x32x16_bf16 a[128:143], v[40:43], v[108:111], a[128:143]
    v_mfma_f32_32x32x16_bf16 a[16:31], v[44:47], v[76:79], a[16:31]
    v_mfma_f32_32x32x16_bf16 a[144:159], v[44:47], v[108:111], a[144:159]
    s_waitcnt lgkmcnt(8)
    v_mfma_f32_32x32x16_bf16 a[32:47], v[48:51], v[76:79], a[32:47]
    v_mfma_f32_32x32x16_bf16 a[160:175], v[48:51], v[108:111], a[160:175]
    v_mfma_f32_32x32x16_bf16 a[48:63], v[52:55], v[76:79], a[48:63]
    v_mfma_f32_32x32x16_bf16 a[176:191], v[52:55], v[108:111], a[176:191]
    s_waitcnt lgkmcnt(4)
    v_mfma_f32_32x32x16_bf16 a[64:79], v[56:59], v[76:79], a[64:79]
    v_mfma_f32_32x32x16_bf16 a[192:207], v[56:59], v[108:111], a[192:207]
    v_mfma_f32_32x32x16_bf16 a[80:95], v[60:63], v[76:79], a[80:95]
    v_mfma_f32_32x32x16_bf16 a[208:223], v[60:63], v[108:111], a[208:223]
    s_waitcnt lgkmcnt(0)
    v_mfma_f32_32x32x16_bf16 a[96:111], v[64:67], v[76:79], a[96:111]
    v_mfma_f32_32x32x16_bf16 a[224:239], v[64:67], v[108:111], a[224:239]
    v_mfma_f32_32x32x16_bf16 a[112:127], v[68:71], v[76:79], a[112:127]
    v_mfma_f32_32x32x16_bf16 a[240:255], v[68:71], v[108:111], a[240:255]
LV_100:
    v_add_u32 v18, 16384, v18
    v_add_u32 v19, 16384, v19
    v_add_u32 v20, 16384, v20
    v_add_u32 v21, 16384, v21
    s_cmp_eq_u32 s7, 3
    s_cselect_b32 s49, 1, 0
    s_cmp_eq_u32 s7, 0
    s_cselect_b32 s50, 1, 0
    s_cmp_eq_u32 s49, 1
    s_cbranch_scc1 LK_102
    v_max3_f32 v2, v88, v89, v90
    v_max3_f32 v2, v2, v91, v92
    v_max3_f32 v2, v2, v93, v94
    v_max3_f32 v2, v2, v95, v96
    v_max3_f32 v2, v2, v97, v98
    v_max3_f32 v2, v2, v99, v100
    v_max3_f32 v2, v2, v101, v102
    v_max_f32 v2, v2, v103
    v_mov_b32 v3, v2
    s_nop 1
    v_permlane32_swap_b32 v2, v3
    v_max_f32 v2, v2, v3
    v_mul_f32 v2, s33, v2
    v_sub_f32 v3, v2, v32
    v_cmp_lt_f32 vcc, s34, v3
    s_nop 0
    s_cbranch_vccnz LRS_105
LRB_106:
    v_fma_f32 v88, v88, s33, -v32
    v_fma_f32 v89, v89, s33, -v32
    v_fma_f32 v90, v90, s33, -v32
    v_fma_f32 v91, v91, s33, -v32
    v_fma_f32 v92, v92, s33, -v32
    v_fma_f32 v93, v93, s33, -v32
    v_fma_f32 v94, v94, s33, -v32
    v_fma_f32 v95, v95, s33, -v32
    v_fma_f32 v96, v96, s33, -v32
    v_fma_f32 v97, v97, s33, -v32
    v_fma_f32 v98, v98, s33, -v32
    v_fma_f32 v99, v99, s33, -v32
    v_fma_f32 v100, v100, s33, -v32
    v_fma_f32 v101, v101, s33, -v32
    v_fma_f32 v102, v102, s33, -v32
    v_fma_f32 v103, v103, s33, -v32
    v_exp_f32 v88, v88
    v_exp_f32 v89, v89
    v_exp_f32 v90, v90
    v_exp_f32 v91, v91
    v_exp_f32 v92, v92
    v_exp_f32 v93, v93
    v_exp_f32 v94, v94
    v_exp_f32 v95, v95
    v_exp_f32 v96, v96
    v_exp_f32 v97, v97
    v_exp_f32 v98, v98
    v_exp_f32 v99, v99
    v_exp_f32 v100, v100
    v_exp_f32 v101, v101
    v_exp_f32 v102, v102
    v_exp_f32 v103, v103
    s_nop 0
    v_add_f32 v33, v33, v88
    v_add_f32 v33, v33, v89
    v_add_f32 v33, v33, v90
    v_add_f32 v33, v33, v91
    v_add_f32 v33, v33, v92
    v_add_f32 v33, v33, v93
    v_add_f32 v33, v33, v94
    v_add_f32 v33, v33, v95
    v_add_f32 v33, v33, v96
    v_add_f32 v33, v33, v97
    v_add_f32 v33, v33, v98
    v_add_f32 v33, v33, v99
    v_add_f32 v33, v33, v100
    v_add_f32 v33, v33, v101
    v_add_f32 v33, v33, v102
    v_add_f32 v33, v33, v103
    v_cvt_pk_bf16_f32 v88, v88, v89
    v_cvt_pk_bf16_f32 v89, v90, v91
    v_cvt_pk_bf16_f32 v90, v92, v93
    v_cvt_pk_bf16_f32 v91, v94, v95
    v_cvt_pk_bf16_f32 v92, v96, v97
    v_cvt_pk_bf16_f32 v93, v98, v99
    v_cvt_pk_bf16_f32 v94, v100, v101
    v_cvt_pk_bf16_f32 v95, v102, v103
    s_branch LK_103
LK_102:
    v_max3_f32 v2, v88, v89, v90
    v_max3_f32 v2, v2, v91, v92
    v_max3_f32 v2, v2, v93, v94
    v_max3_f32 v2, v2, v95, v96
    v_max3_f32 v2, v2, v97, v98
    v_max3_f32 v2, v2, v99, v100
    v_max3_f32 v2, v2, v101, v102
    v_max_f32 v2, v2, v103
    v_mov_b32 v3, v2
    s_nop 1
    v_permlane32_swap_b32 v2, v3
    v_max_f32 v2, v2, v3
    v_mul_f32 v2, s33, v2
    v_sub_f32 v3, v2, v32
    v_cmp_lt_f32 vcc, s34, v3
    s_nop 0
    s_cbranch_vccnz LRS_107
LRB_108:
    v_fma_f32 v88, v88, s33, -v32
    v_fma_f32 v89, v89, s33, -v32
    v_fma_f32 v90, v90, s33, -v32
    v_fma_f32 v91, v91, s33, -v32
    v_fma_f32 v92, v92, s33, -v32
    v_fma_f32 v93, v93, s33, -v32
    v_fma_f32 v94, v94, s33, -v32
    v_fma_f32 v95, v95, s33, -v32
    v_fma_f32 v96, v96, s33, -v32
    v_fma_f32 v97, v97, s33, -v32
    v_fma_f32 v98, v98, s33, -v32
    v_fma_f32 v99, v99, s33, -v32
    v_fma_f32 v100, v100, s33, -v32
    v_fma_f32 v101, v101, s33, -v32
    v_fma_f32 v102, v102, s33, -v32
    v_fma_f32 v103, v103, s33, -v32
    v_exp_f32 v88, v88
    v_exp_f32 v89, v89
    v_exp_f32 v90, v90
    v_exp_f32 v91, v91
    v_exp_f32 v92, v92
    v_exp_f32 v93, v93
    v_exp_f32 v94, v94
    v_exp_f32 v95, v95
    v_exp_f32 v96, v96
    v_exp_f32 v97, v97
    v_exp_f32 v98, v98
    v_exp_f32 v99, v99
    v_exp_f32 v100, v100
    v_exp_f32 v101, v101
    v_exp_f32 v102, v102
    v_exp_f32 v103, v103
    s_nop 0
    v_add_f32 v33, v33, v88
    v_add_f32 v33, v33, v89
    v_add_f32 v33, v33, v90
    v_add_f32 v33, v33, v91
    v_add_f32 v33, v33, v92
    v_add_f32 v33, v33, v93
    v_add_f32 v33, v33, v94
    v_add_f32 v33, v33, v95
    v_add_f32 v33, v33, v96
    v_add_f32 v33, v33, v97
    v_add_f32 v33, v33, v98
    v_add_f32 v33, v33, v99
    v_add_f32 v33, v33, v100
    v_add_f32 v33, v33, v101
    v_add_f32 v33, v33, v102
    v_add_f32 v33, v33, v103
    v_cvt_pk_bf16_f32 v88, v88, v89
    v_cvt_pk_bf16_f32 v89, v90, v91
    v_cvt_pk_bf16_f32 v90, v92, v93
    v_cvt_pk_bf16_f32 v91, v94, v95
    v_cvt_pk_bf16_f32 v92, v96, v97
    v_cvt_pk_bf16_f32 v93, v98, v99
    v_cvt_pk_bf16_f32 v94, v100, v101
    v_cvt_pk_bf16_f32 v95, v102, v103
    v_max3_f32 v2, v104, v105, v106
    v_max3_f32 v2, v2, v107, v108
    v_max3_f32 v2, v2, v109, v110
    v_max3_f32 v2, v2, v111, v112
    v_max3_f32 v2, v2, v113, v114
    v_max3_f32 v2, v2, v115, v116
    v_max3_f32 v2, v2, v117, v118
    v_max_f32 v2, v2, v119
    v_mov_b32 v3, v2
    s_nop 1
    v_permlane32_swap_b32 v2, v3
    v_max_f32 v2, v2, v3
    v_mul_f32 v2, s33, v2
    v_sub_f32 v3, v2, v34
    v_cmp_lt_f32 vcc, s34, v3
    s_nop 0
    s_cbranch_vccnz LRS_109
LRB_110:
    v_fma_f32 v104, v104, s33, -v34
    v_fma_f32 v105, v105, s33, -v34
    v_fma_f32 v106, v106, s33, -v34
    v_fma_f32 v107, v107, s33, -v34
    v_fma_f32 v108, v108, s33, -v34
    v_fma_f32 v109, v109, s33, -v34
    v_fma_f32 v110, v110, s33, -v34
    v_fma_f32 v111, v111, s33, -v34
    v_fma_f32 v112, v112, s33, -v34
    v_fma_f32 v113, v113, s33, -v34
    v_fma_f32 v114, v114, s33, -v34
    v_fma_f32 v115, v115, s33, -v34
    v_fma_f32 v116, v116, s33, -v34
    v_fma_f32 v117, v117, s33, -v34
    v_fma_f32 v118, v118, s33, -v34
    v_fma_f32 v119, v119, s33, -v34
    v_exp_f32 v104, v104
    v_exp_f32 v105, v105
    v_exp_f32 v106, v106
    v_exp_f32 v107, v107
    v_exp_f32 v108, v108
    v_exp_f32 v109, v109
    v_exp_f32 v110, v110
    v_exp_f32 v111, v111
    v_exp_f32 v112, v112
    v_exp_f32 v113, v113
    v_exp_f32 v114, v114
    v_exp_f32 v115, v115
    v_exp_f32 v116, v116
    v_exp_f32 v117, v117
    v_exp_f32 v118, v118
    v_exp_f32 v119, v119
    s_nop 0
    v_add_f32 v35, v35, v104
    v_add_f32 v35, v35, v105
    v_add_f32 v35, v35, v106
    v_add_f32 v35, v35, v107
    v_add_f32 v35, v35, v108
    v_add_f32 v35, v35, v109
    v_add_f32 v35, v35, v110
    v_add_f32 v35, v35, v111
    v_add_f32 v35, v35, v112
    v_add_f32 v35, v35, v113
    v_add_f32 v35, v35, v114
    v_add_f32 v35, v35, v115
    v_add_f32 v35, v35, v116
    v_add_f32 v35, v35, v117
    v_add_f32 v35, v35, v118
    v_add_f32 v35, v35, v119
    v_cvt_pk_bf16_f32 v104, v104, v105
    v_cvt_pk_bf16_f32 v105, v106, v107
    v_cvt_pk_bf16_f32 v106, v108, v109
    v_cvt_pk_bf16_f32 v107, v110, v111
    v_cvt_pk_bf16_f32 v108, v112, v113
    v_cvt_pk_bf16_f32 v109, v114, v115
    v_cvt_pk_bf16_f32 v110, v116, v117
    v_cvt_pk_bf16_f32 v111, v118, v119
LK_103:
    ds_read_b64_tr_b16 v[40:41], v18 offset:0
    ds_read_b64_tr_b16 v[42:43], v18 offset:4096
    ds_read_b64_tr_b16 v[44:45], v19 offset:0
    ds_read_b64_tr_b16 v[46:47], v19 offset:4096
    ds_read_b64_tr_b16 v[48:49], v20 offset:0
    ds_read_b64_tr_b16 v[50:51], v20 offset:4096
    ds_read_b64_tr_b16 v[52:53], v21 offset:0
    ds_read_b64_tr_b16 v[54:55], v21 offset:4096
    ds_read_b64_tr_b16 v[56:57], v18 offset:256
    ds_read_b64_tr_b16 v[58:59], v18 offset:4352
    ds_read_b64_tr_b16 v[60:61], v19 offset:256
    ds_read_b64_tr_b16 v[62:63], v19 offset:4352
    ds_read_b64_tr_b16 v[64:65], v20 offset:256
    ds_read_b64_tr_b16 v[66:67], v20 offset:4352
    s_cmp_eq_u32 s49, 1
    s_cbranch_scc1 LV_111
    ds_read_b64_tr_b16 v[68:69], v21 offset:256
    ds_read_b64_tr_b16 v[70:71], v21 offset:4352
    s_waitcnt vmcnt(40)
    s_barrier
    s_add_u32 s43, s32, 32768
    s_mov_b32 m0, s43
    s_add_u32 s44, s38, 143360
    buffer_load_dwordx4 v28, s[24:27], s44 offen offset:0 lds
    buffer_load_dwordx4 v29, s[24:27], s44 offen offset:1024 lds
    buffer_load_dwordx4 v30, s[24:27], s44 offen offset:2048 lds
    buffer_load_dwordx4 v31, s[24:27], s44 offen offset:3072 lds
    s_waitcnt lgkmcnt(12)
    v_mfma_f32_32x32x16_bf16 a[0:15], v[40:43], v[88:91], a[0:15]
    ds_read_b64_tr_b16 v[40:41], v18 offset:8192
    ds_read_b64_tr_b16 v[42:43], v18 offset:12288
    v_mfma_f32_32x32x16_bf16 a[16:31], v[44:47], v[88:91], a[16:31]
    ds_read_b64_tr_b16 v[44:45], v19 offset:8192
    ds_read_b64_tr_b16 v[46:47], v19 offset:12288
    s_waitcnt lgkmcnt(12)
    v_mfma_f32_32x32x16_bf16 a[32:47], v[48:51], v[88:91], a[32:47]
    ds_read_b64_tr_b16 v[48:49], v20 offset:8192
    ds_read_b64_tr_b16 v[50:51], v20 offset:12288
    v_mfma_f32_32x32x16_bf16 a[48:63], v[52:55], v[88:91], a[48:63]
    ds_read_b64_tr_b16 v[52:53], v21 offset:8192
    ds_read_b64_tr_b16 v[54:55], v21 offset:12288
    s_waitcnt lgkmcnt(12)
    v_mfma_f32_32x32x16_bf16 a[64:79], v[56:59], v[88:91], a[64:79]
    ds_read_b64_tr_b16 v[56:57], v18 offset:8448
    ds_read_b64_tr_b16 v[58:59], v18 offset:12544
    v_mfma_f32_32x32x16_bf16 a[80:95], v[60:63], v[88:91], a[80:95]
    ds_read_b64_tr_b16 v[60:61], v19 offset:8448
    ds_read_b64_tr_b16 v[62:63], v19 offset:12544
    s_waitcnt lgkmcnt(12)
    v_mfma_f32_32x32x16_bf16 a[96:111], v[64:67], v[88:91], a[96:111]
    ds_read_b64_tr_b16 v[64:65], v20 offset:8448
    ds_read_b64_tr_b16 v[66:67], v20 offset:12544
    v_mfma_f32_32x32x16_bf16 a[112:127], v[68:71], v[88:91], a[112:127]
    ds_read_b64_tr_b16 v[68:69], v21 offset:8448
    ds_read_b64_tr_b16 v[70:71], v21 offset:12544
    s_waitcnt lgkmcnt(12)
    v_mfma_f32_32x32x16_bf16 a[0:15], v[40:43], v[92:95], a[0:15]
    v_mfma_f32_32x32x16_bf16 a[16:31], v[44:47], v[92:95], a[16:31]
    s_waitcnt lgkmcnt(8)
    v_mfma_f32_32x32x16_bf16 a[32:47], v[48:51], v[92:95], a[32:47]
    v_mfma_f32_32x32x16_bf16 a[48:63], v[52:55], v[92:95], a[48:63]
    s_waitcnt lgkmcnt(4)
    v_mfma_f32_32x32x16_bf16 a[64:79], v[56:59], v[92:95], a[64:79]
    v_mfma_f32_32x32x16_bf16 a[80:95], v[60:63], v[92:95], a[80:95]
    s_waitcnt lgkmcnt(0)
    v_mfma_f32_32x32x16_bf16 a[96:111], v[64:67], v[92:95], a[96:111]
    v_mfma_f32_32x32x16_bf16 a[112:127], v[68:71], v[92:95], a[112:127]
    s_branch LV_112
LV_111:
    ds_read_b64_tr_b16 v[68:69], v21 offset:256
    ds_read_b64_tr_b16 v[70:71], v21 offset:4352
    s_waitcnt vmcnt(44)
    s_barrier
    s_add_u32 s43, s32, 32768
    s_mov_b32 m0, s43
    s_add_u32 s44, s38, 143360
    buffer_load_dwordx4 v28, s[24:27], s44 offen offset:0 lds
    buffer_load_dwordx4 v29, s[24:27], s44 offen offset:1024 lds
    buffer_load_dwordx4 v30, s[24:27], s44 offen offset:2048 lds
    buffer_load_dwordx4 v31, s[24:27], s44 offen offset:3072 lds
    s_waitcnt lgkmcnt(12)
    v_mfma_f32_32x32x16_bf16 a[0:15], v[40:43], v[88:91], a[0:15]
    v_mfma_f32_32x32x16_bf16 a[128:143], v[40:43], v[104:107], a[128:143]
    ds_read_b64_tr_b16 v[40:41], v18 offset:8192
    ds_read_b64_tr_b16 v[42:43], v18 offset:12288
    v_mfma_f32_32x32x16_bf16 a[16:31], v[44:47], v[88:91], a[16:31]
    v_mfma_f32_32x32x16_bf16 a[144:159], v[44:47], v[104:107], a[144:159]
    ds_read_b64_tr_b16 v[44:45], v19 offset:8192
    ds_read_b64_tr_b16 v[46:47], v19 offset:12288
    s_waitcnt lgkmcnt(12)
    v_mfma_f32_32x32x16_bf16 a[32:47], v[48:51], v[88:91], a[32:47]
    v_mfma_f32_32x32x16_bf16 a[160:175], v[48:51], v[104:107], a[160:175]
    ds_read_b64_tr_b16 v[48:49], v20 offset:8192
    ds_read_b64_tr_b16 v[50:51], v20 offset:12288
    v_mfma_f32_32x32x16_bf16 a[48:63], v[52:55], v[88:91], a[48:63]
    v_mfma_f32_32x32x16_bf16 a[176:191], v[52:55], v[104:107], a[176:191]
    ds_read_b64_tr_b16 v[52:53], v21 offset:8192
    ds_read_b64_tr_b16 v[54:55], v21 offset:12288
    s_waitcnt lgkmcnt(12)
    v_mfma_f32_32x32x16_bf16 a[64:79], v[56:59], v[88:91], a[64:79]
    v_mfma_f32_32x32x16_bf16 a[192:207], v[56:59], v[104:107], a[192:207]
    ds_read_b64_tr_b16 v[56:57], v18 offset:8448
    ds_read_b64_tr_b16 v[58:59], v18 offset:12544
    v_mfma_f32_32x32x16_bf16 a[80:95], v[60:63], v[88:91], a[80:95]
    v_mfma_f32_32x32x16_bf16 a[208:223], v[60:63], v[104:107], a[208:223]
    ds_read_b64_tr_b16 v[60:61], v19 offset:8448
    ds_read_b64_tr_b16 v[62:63], v19 offset:12544
    s_waitcnt lgkmcnt(12)
    v_mfma_f32_32x32x16_bf16 a[96:111], v[64:67], v[88:91], a[96:111]
    v_mfma_f32_32x32x16_bf16 a[224:239], v[64:67], v[104:107], a[224:239]
    ds_read_b64_tr_b16 v[64:65], v20 offset:8448
    ds_read_b64_tr_b16 v[66:67], v20 offset:12544
    v_mfma_f32_32x32x16_bf16 a[112:127], v[68:71], v[88:91], a[112:127]
    v_mfma_f32_32x32x16_bf16 a[240:255], v[68:71], v[104:107], a[240:255]
    ds_read_b64_tr_b16 v[68:69], v21 offset:8448
    ds_read_b64_tr_b16 v[70:71], v21 offset:12544
    s_waitcnt lgkmcnt(12)
    v_mfma_f32_32x32x16_bf16 a[0:15], v[40:43], v[92:95], a[0:15]
    v_mfma_f32_32x32x16_bf16 a[128:143], v[40:43], v[108:111], a[128:143]
    v_mfma_f32_32x32x16_bf16 a[16:31], v[44:47], v[92:95], a[16:31]
    v_mfma_f32_32x32x16_bf16 a[144:159], v[44:47], v[108:111], a[144:159]
    s_waitcnt lgkmcnt(8)
    v_mfma_f32_32x32x16_bf16 a[32:47], v[48:51], v[92:95], a[32:47]
    v_mfma_f32_32x32x16_bf16 a[160:175], v[48:51], v[108:111], a[160:175]
    v_mfma_f32_32x32x16_bf16 a[48:63], v[52:55], v[92:95], a[48:63]
    v_mfma_f32_32x32x16_bf16 a[176:191], v[52:55], v[108:111], a[176:191]
    s_waitcnt lgkmcnt(4)
    v_mfma_f32_32x32x16_bf16 a[64:79], v[56:59], v[92:95], a[64:79]
    v_mfma_f32_32x32x16_bf16 a[192:207], v[56:59], v[108:111], a[192:207]
    v_mfma_f32_32x32x16_bf16 a[80:95], v[60:63], v[92:95], a[80:95]
    v_mfma_f32_32x32x16_bf16 a[208:223], v[60:63], v[108:111], a[208:223]
    s_waitcnt lgkmcnt(0)
    v_mfma_f32_32x32x16_bf16 a[96:111], v[64:67], v[92:95], a[96:111]
    v_mfma_f32_32x32x16_bf16 a[224:239], v[64:67], v[108:111], a[224:239]
    v_mfma_f32_32x32x16_bf16 a[112:127], v[68:71], v[92:95], a[112:127]
    v_mfma_f32_32x32x16_bf16 a[240:255], v[68:71], v[108:111], a[240:255]
LV_112:
    s_branch LOUT_113
LRS_7:
    v_max_f32 v3, v32, v2
    v_sub_f32 v4, v32, v3
    v_exp_f32 v4, v4
    v_mov_b32 v32, v3
    s_nop 0
    v_mul_f32 v33, v33, v4
    s_nop 15
    v_accvgpr_read_b32 v5, a0
    v_mul_f32 v5, v5, v4
    v_accvgpr_write_b32 a0, v5
    v_accvgpr_read_b32 v6, a1
    v_mul_f32 v6, v6, v4
    v_accvgpr_write_b32 a1, v6
    v_accvgpr_read_b32 v7, a2
    v_mul_f32 v7, v7, v4
    v_accvgpr_write_b32 a2, v7
    v_accvgpr_read_b32 v8, a3
    v_mul_f32 v8, v8, v4
    v_accvgpr_write_b32 a3, v8
    v_accvgpr_read_b32 v5, a4
    v_mul_f32 v5, v5, v4
    v_accvgpr_write_b32 a4, v5
    v_accvgpr_read_b32 v6, a5
    v_mul_f32 v6, v6, v4
    v_accvgpr_write_b32 a5, v6
    v_accvgpr_read_b32 v7, a6
    v_mul_f32 v7, v7, v4
    v_accvgpr_write_b32 a6, v7
    v_accvgpr_read_b32 v8, a7
    v_mul_f32 v8, v8, v4
    v_accvgpr_write_b32 a7, v8
    v_accvgpr_read_b32 v5, a8
    v_mul_f32 v5, v5, v4
    v_accvgpr_write_b32 a8, v5
    v_accvgpr_read_b32 v6, a9
    v_mul_f32 v6, v6, v4
    v_accvgpr_write_b32 a9, v6
    v_accvgpr_read_b32 v7, a10
    v_mul_f32 v7, v7, v4
    v_accvgpr_write_b32 a10, v7
    v_accvgpr_read_b32 v8, a11
    v_mul_f32 v8, v8, v4
    v_accvgpr_write_b32 a11, v8
    v_accvgpr_read_b32 v5, a12
    v_mul_f32 v5, v5, v4
    v_accvgpr_write_b32 a12, v5
    v_accvgpr_read_b32 v6, a13
    v_mul_f32 v6, v6, v4
    v_accvgpr_write_b32 a13, v6
    v_accvgpr_read_b32 v7, a14
    v_mul_f32 v7, v7, v4
    v_accvgpr_write_b32 a14, v7
    v_accvgpr_read_b32 v8, a15
    v_mul_f32 v8, v8, v4
    v_accvgpr_write_b32 a15, v8
    v_accvgpr_read_b32 v5, a16
    v_mul_f32 v5, v5, v4
    v_accvgpr_write_b32 a16, v5
    v_accvgpr_read_b32 v6, a17
    v_mul_f32 v6, v6, v4
    v_accvgpr_write_b32 a17, v6
    v_accvgpr_read_b32 v7, a18
    v_mul_f32 v7, v7, v4
    v_accvgpr_write_b32 a18, v7
    v_accvgpr_read_b32 v8, a19
    v_mul_f32 v8, v8, v4
    v_accvgpr_write_b32 a19, v8
    v_accvgpr_read_b32 v5, a20
    v_mul_f32 v5, v5, v4
    v_accvgpr_write_b32 a20, v5
    v_accvgpr_read_b32 v6, a21
    v_mul_f32 v6, v6, v4
    v_accvgpr_write_b32 a21, v6
    v_accvgpr_read_b32 v7, a22
    v_mul_f32 v7, v7, v4
    v_accvgpr_write_b32 a22, v7
    v_accvgpr_read_b32 v8, a23
    v_mul_f32 v8, v8, v4
    v_accvgpr_write_b32 a23, v8
    v_accvgpr_read_b32 v5, a24
    v_mul_f32 v5, v5, v4
    v_accvgpr_write_b32 a24, v5
    v_accvgpr_read_b32 v6, a25
    v_mul_f32 v6, v6, v4
    v_accvgpr_write_b32 a25, v6
    v_accvgpr_read_b32 v7, a26
    v_mul_f32 v7, v7, v4
    v_accvgpr_write_b32 a26, v7
    v_accvgpr_read_b32 v8, a27
    v_mul_f32 v8, v8, v4
    v_accvgpr_write_b32 a27, v8
    v_accvgpr_read_b32 v5, a28
    v_mul_f32 v5, v5, v4
    v_accvgpr_write_b32 a28, v5
    v_accvgpr_read_b32 v6, a29
    v_mul_f32 v6, v6, v4
    v_accvgpr_write_b32 a29, v6
    v_accvgpr_read_b32 v7, a30
    v_mul_f32 v7, v7, v4
    v_accvgpr_write_b32 a30, v7
    v_accvgpr_read_b32 v8, a31
    v_mul_f32 v8, v8, v4
    v_accvgpr_write_b32 a31, v8
    v_accvgpr_read_b32 v5, a32
    v_mul_f32 v5, v5, v4
    v_accvgpr_write_b32 a32, v5
    v_accvgpr_read_b32 v6, a33
    v_mul_f32 v6, v6, v4
    v_accvgpr_write_b32 a33, v6
    v_accvgpr_read_b32 v7, a34
    v_mul_f32 v7, v7, v4
    v_accvgpr_write_b32 a34, v7
    v_accvgpr_read_b32 v8, a35
    v_mul_f32 v8, v8, v4
    v_accvgpr_write_b32 a35, v8
    v_accvgpr_read_b32 v5, a36
    v_mul_f32 v5, v5, v4
    v_accvgpr_write_b32 a36, v5
    v_accvgpr_read_b32 v6, a37
    v_mul_f32 v6, v6, v4
    v_accvgpr_write_b32 a37, v6
    v_accvgpr_read_b32 v7, a38
    v_mul_f32 v7, v7, v4
    v_accvgpr_write_b32 a38, v7
    v_accvgpr_read_b32 v8, a39
    v_mul_f32 v8, v8, v4
    v_accvgpr_write_b32 a39, v8
    v_accvgpr_read_b32 v5, a40
    v_mul_f32 v5, v5, v4
    v_accvgpr_write_b32 a40, v5
    v_accvgpr_read_b32 v6, a41
    v_mul_f32 v6, v6, v4
    v_accvgpr_write_b32 a41, v6
    v_accvgpr_read_b32 v7, a42
    v_mul_f32 v7, v7, v4
    v_accvgpr_write_b32 a42, v7
    v_accvgpr_read_b32 v8, a43
    v_mul_f32 v8, v8, v4
    v_accvgpr_write_b32 a43, v8
    v_accvgpr_read_b32 v5, a44
    v_mul_f32 v5, v5, v4
    v_accvgpr_write_b32 a44, v5
    v_accvgpr_read_b32 v6, a45
    v_mul_f32 v6, v6, v4
    v_accvgpr_write_b32 a45, v6
    v_accvgpr_read_b32 v7, a46
    v_mul_f32 v7, v7, v4
    v_accvgpr_write_b32 a46, v7
    v_accvgpr_read_b32 v8, a47
    v_mul_f32 v8, v8, v4
    v_accvgpr_write_b32 a47, v8
    v_accvgpr_read_b32 v5, a48
    v_mul_f32 v5, v5, v4
    v_accvgpr_write_b32 a48, v5
    v_accvgpr_read_b32 v6, a49
    v_mul_f32 v6, v6, v4
    v_accvgpr_write_b32 a49, v6
    v_accvgpr_read_b32 v7, a50
    v_mul_f32 v7, v7, v4
    v_accvgpr_write_b32 a50, v7
    v_accvgpr_read_b32 v8, a51
    v_mul_f32 v8, v8, v4
    v_accvgpr_write_b32 a51, v8
    v_accvgpr_read_b32 v5, a52
    v_mul_f32 v5, v5, v4
    v_accvgpr_write_b32 a52, v5
    v_accvgpr_read_b32 v6, a53
    v_mul_f32 v6, v6, v4
    v_accvgpr_write_b32 a53, v6
    v_accvgpr_read_b32 v7, a54
    v_mul_f32 v7, v7, v4
    v_accvgpr_write_b32 a54, v7
    v_accvgpr_read_b32 v8, a55
    v_mul_f32 v8, v8, v4
    v_accvgpr_write_b32 a55, v8
    v_accvgpr_read_b32 v5, a56
    v_mul_f32 v5, v5, v4
    v_accvgpr_write_b32 a56, v5
    v_accvgpr_read_b32 v6, a57
    v_mul_f32 v6, v6, v4
    v_accvgpr_write_b32 a57, v6
    v_accvgpr_read_b32 v7, a58
    v_mul_f32 v7, v7, v4
    v_accvgpr_write_b32 a58, v7
    v_accvgpr_read_b32 v8, a59
    v_mul_f32 v8, v8, v4
    v_accvgpr_write_b32 a59, v8
    v_accvgpr_read_b32 v5, a60
    v_mul_f32 v5, v5, v4
    v_accvgpr_write_b32 a60, v5
    v_accvgpr_read_b32 v6, a61
    v_mul_f32 v6, v6, v4
    v_accvgpr_write_b32 a61, v6
    v_accvgpr_read_b32 v7, a62
    v_mul_f32 v7, v7, v4
    v_accvgpr_write_b32 a62, v7
    v_accvgpr_read_b32 v8, a63
    v_mul_f32 v8, v8, v4
    v_accvgpr_write_b32 a63, v8
    v_accvgpr_read_b32 v5, a64
    v_mul_f32 v5, v5, v4
    v_accvgpr_write_b32 a64, v5
    v_accvgpr_read_b32 v6, a65
    v_mul_f32 v6, v6, v4
    v_accvgpr_write_b32 a65, v6
    v_accvgpr_read_b32 v7, a66
    v_mul_f32 v7, v7, v4
    v_accvgpr_write_b32 a66, v7
    v_accvgpr_read_b32 v8, a67
    v_mul_f32 v8, v8, v4
    v_accvgpr_write_b32 a67, v8
    v_accvgpr_read_b32 v5, a68
    v_mul_f32 v5, v5, v4
    v_accvgpr_write_b32 a68, v5
    v_accvgpr_read_b32 v6, a69
    v_mul_f32 v6, v6, v4
    v_accvgpr_write_b32 a69, v6
    v_accvgpr_read_b32 v7, a70
    v_mul_f32 v7, v7, v4
    v_accvgpr_write_b32 a70, v7
    v_accvgpr_read_b32 v8, a71
    v_mul_f32 v8, v8, v4
    v_accvgpr_write_b32 a71, v8
    v_accvgpr_read_b32 v5, a72
    v_mul_f32 v5, v5, v4
    v_accvgpr_write_b32 a72, v5
    v_accvgpr_read_b32 v6, a73
    v_mul_f32 v6, v6, v4
    v_accvgpr_write_b32 a73, v6
    v_accvgpr_read_b32 v7, a74
    v_mul_f32 v7, v7, v4
    v_accvgpr_write_b32 a74, v7
    v_accvgpr_read_b32 v8, a75
    v_mul_f32 v8, v8, v4
    v_accvgpr_write_b32 a75, v8
    v_accvgpr_read_b32 v5, a76
    v_mul_f32 v5, v5, v4
    v_accvgpr_write_b32 a76, v5
    v_accvgpr_read_b32 v6, a77
    v_mul_f32 v6, v6, v4
    v_accvgpr_write_b32 a77, v6
    v_accvgpr_read_b32 v7, a78
    v_mul_f32 v7, v7, v4
    v_accvgpr_write_b32 a78, v7
    v_accvgpr_read_b32 v8, a79
    v_mul_f32 v8, v8, v4
    v_accvgpr_write_b32 a79, v8
    v_accvgpr_read_b32 v5, a80
    v_mul_f32 v5, v5, v4
    v_accvgpr_write_b32 a80, v5
    v_accvgpr_read_b32 v6, a81
    v_mul_f32 v6, v6, v4
    v_accvgpr_write_b32 a81, v6
    v_accvgpr_read_b32 v7, a82
    v_mul_f32 v7, v7, v4
    v_accvgpr_write_b32 a82, v7
    v_accvgpr_read_b32 v8, a83
    v_mul_f32 v8, v8, v4
    v_accvgpr_write_b32 a83, v8
    v_accvgpr_read_b32 v5, a84
    v_mul_f32 v5, v5, v4
    v_accvgpr_write_b32 a84, v5
    v_accvgpr_read_b32 v6, a85
    v_mul_f32 v6, v6, v4
    v_accvgpr_write_b32 a85, v6
    v_accvgpr_read_b32 v7, a86
    v_mul_f32 v7, v7, v4
    v_accvgpr_write_b32 a86, v7
    v_accvgpr_read_b32 v8, a87
    v_mul_f32 v8, v8, v4
    v_accvgpr_write_b32 a87, v8
    v_accvgpr_read_b32 v5, a88
    v_mul_f32 v5, v5, v4
    v_accvgpr_write_b32 a88, v5
    v_accvgpr_read_b32 v6, a89
    v_mul_f32 v6, v6, v4
    v_accvgpr_write_b32 a89, v6
    v_accvgpr_read_b32 v7, a90
    v_mul_f32 v7, v7, v4
    v_accvgpr_write_b32 a90, v7
    v_accvgpr_read_b32 v8, a91
    v_mul_f32 v8, v8, v4
    v_accvgpr_write_b32 a91, v8
    v_accvgpr_read_b32 v5, a92
    v_mul_f32 v5, v5, v4
    v_accvgpr_write_b32 a92, v5
    v_accvgpr_read_b32 v6, a93
    v_mul_f32 v6, v6, v4
    v_accvgpr_write_b32 a93, v6
    v_accvgpr_read_b32 v7, a94
    v_mul_f32 v7, v7, v4
    v_accvgpr_write_b32 a94, v7
    v_accvgpr_read_b32 v8, a95
    v_mul_f32 v8, v8, v4
    v_accvgpr_write_b32 a95, v8
    v_accvgpr_read_b32 v5, a96
    v_mul_f32 v5, v5, v4
    v_accvgpr_write_b32 a96, v5
    v_accvgpr_read_b32 v6, a97
    v_mul_f32 v6, v6, v4
    v_accvgpr_write_b32 a97, v6
    v_accvgpr_read_b32 v7, a98
    v_mul_f32 v7, v7, v4
    v_accvgpr_write_b32 a98, v7
    v_accvgpr_read_b32 v8, a99
    v_mul_f32 v8, v8, v4
    v_accvgpr_write_b32 a99, v8
    v_accvgpr_read_b32 v5, a100
    v_mul_f32 v5, v5, v4
    v_accvgpr_write_b32 a100, v5
    v_accvgpr_read_b32 v6, a101
    v_mul_f32 v6, v6, v4
    v_accvgpr_write_b32 a101, v6
    v_accvgpr_read_b32 v7, a102
    v_mul_f32 v7, v7, v4
    v_accvgpr_write_b32 a102, v7
    v_accvgpr_read_b32 v8, a103
    v_mul_f32 v8, v8, v4
    v_accvgpr_write_b32 a103, v8
    v_accvgpr_read_b32 v5, a104
    v_mul_f32 v5, v5, v4
    v_accvgpr_write_b32 a104, v5
    v_accvgpr_read_b32 v6, a105
    v_mul_f32 v6, v6, v4
    v_accvgpr_write_b32 a105, v6
    v_accvgpr_read_b32 v7, a106
    v_mul_f32 v7, v7, v4
    v_accvgpr_write_b32 a106, v7
    v_accvgpr_read_b32 v8, a107
    v_mul_f32 v8, v8, v4
    v_accvgpr_write_b32 a107, v8
    v_accvgpr_read_b32 v5, a108
    v_mul_f32 v5, v5, v4
    v_accvgpr_write_b32 a108, v5
    v_accvgpr_read_b32 v6, a109
    v_mul_f32 v6, v6, v4
    v_accvgpr_write_b32 a109, v6
    v_accvgpr_read_b32 v7, a110
    v_mul_f32 v7, v7, v4
    v_accvgpr_write_b32 a110, v7
    v_accvgpr_read_b32 v8, a111
    v_mul_f32 v8, v8, v4
    v_accvgpr_write_b32 a111, v8
    v_accvgpr_read_b32 v5, a112
    v_mul_f32 v5, v5, v4
    v_accvgpr_write_b32 a112, v5
    v_accvgpr_read_b32 v6, a113
    v_mul_f32 v6, v6, v4
    v_accvgpr_write_b32 a113, v6
    v_accvgpr_read_b32 v7, a114
    v_mul_f32 v7, v7, v4
    v_accvgpr_write_b32 a114, v7
    v_accvgpr_read_b32 v8, a115
    v_mul_f32 v8, v8, v4
    v_accvgpr_write_b32 a115, v8
    v_accvgpr_read_b32 v5, a116
    v_mul_f32 v5, v5, v4
    v_accvgpr_write_b32 a116, v5
    v_accvgpr_read_b32 v6, a117
    v_mul_f32 v6, v6, v4
    v_accvgpr_write_b32 a117, v6
    v_accvgpr_read_b32 v7, a118
    v_mul_f32 v7, v7, v4
    v_accvgpr_write_b32 a118, v7
    v_accvgpr_read_b32 v8, a119
    v_mul_f32 v8, v8, v4
    v_accvgpr_write_b32 a119, v8
    v_accvgpr_read_b32 v5, a120
    v_mul_f32 v5, v5, v4
    v_accvgpr_write_b32 a120, v5
    v_accvgpr_read_b32 v6, a121
    v_mul_f32 v6, v6, v4
    v_accvgpr_write_b32 a121, v6
    v_accvgpr_read_b32 v7, a122
    v_mul_f32 v7, v7, v4
    v_accvgpr_write_b32 a122, v7
    v_accvgpr_read_b32 v8, a123
    v_mul_f32 v8, v8, v4
    v_accvgpr_write_b32 a123, v8
    v_accvgpr_read_b32 v5, a124
    v_mul_f32 v5, v5, v4
    v_accvgpr_write_b32 a124, v5
    v_accvgpr_read_b32 v6, a125
    v_mul_f32 v6, v6, v4
    v_accvgpr_write_b32 a125, v6
    v_accvgpr_read_b32 v7, a126
    v_mul_f32 v7, v7, v4
    v_accvgpr_write_b32 a126, v7
    v_accvgpr_read_b32 v8, a127
    v_mul_f32 v8, v8, v4
    v_accvgpr_write_b32 a127, v8
    s_nop 1
    s_branch LRB_8
LRS_9:
    v_max_f32 v3, v32, v2
    v_sub_f32 v4, v32, v3
    v_exp_f32 v4, v4
    v_mov_b32 v32, v3
    s_nop 0
    v_mul_f32 v33, v33, v4
    s_nop 15
    v_accvgpr_read_b32 v5, a0
    v_mul_f32 v5, v5, v4
    v_accvgpr_write_b32 a0, v5
    v_accvgpr_read_b32 v6, a1
    v_mul_f32 v6, v6, v4
    v_accvgpr_write_b32 a1, v6
    v_accvgpr_read_b32 v7, a2
    v_mul_f32 v7, v7, v4
    v_accvgpr_write_b32 a2, v7
    v_accvgpr_read_b32 v8, a3
    v_mul_f32 v8, v8, v4
    v_accvgpr_write_b32 a3, v8
    v_accvgpr_read_b32 v5, a4
    v_mul_f32 v5, v5, v4
    v_accvgpr_write_b32 a4, v5
    v_accvgpr_read_b32 v6, a5
    v_mul_f32 v6, v6, v4
    v_accvgpr_write_b32 a5, v6
    v_accvgpr_read_b32 v7, a6
    v_mul_f32 v7, v7, v4
    v_accvgpr_write_b32 a6, v7
    v_accvgpr_read_b32 v8, a7
    v_mul_f32 v8, v8, v4
    v_accvgpr_write_b32 a7, v8
    v_accvgpr_read_b32 v5, a8
    v_mul_f32 v5, v5, v4
    v_accvgpr_write_b32 a8, v5
    v_accvgpr_read_b32 v6, a9
    v_mul_f32 v6, v6, v4
    v_accvgpr_write_b32 a9, v6
    v_accvgpr_read_b32 v7, a10
    v_mul_f32 v7, v7, v4
    v_accvgpr_write_b32 a10, v7
    v_accvgpr_read_b32 v8, a11
    v_mul_f32 v8, v8, v4
    v_accvgpr_write_b32 a11, v8
    v_accvgpr_read_b32 v5, a12
    v_mul_f32 v5, v5, v4
    v_accvgpr_write_b32 a12, v5
    v_accvgpr_read_b32 v6, a13
    v_mul_f32 v6, v6, v4
    v_accvgpr_write_b32 a13, v6
    v_accvgpr_read_b32 v7, a14
    v_mul_f32 v7, v7, v4
    v_accvgpr_write_b32 a14, v7
    v_accvgpr_read_b32 v8, a15
    v_mul_f32 v8, v8, v4
    v_accvgpr_write_b32 a15, v8
    v_accvgpr_read_b32 v5, a16
    v_mul_f32 v5, v5, v4
    v_accvgpr_write_b32 a16, v5
    v_accvgpr_read_b32 v6, a17
    v_mul_f32 v6, v6, v4
    v_accvgpr_write_b32 a17, v6
    v_accvgpr_read_b32 v7, a18
    v_mul_f32 v7, v7, v4
    v_accvgpr_write_b32 a18, v7
    v_accvgpr_read_b32 v8, a19
    v_mul_f32 v8, v8, v4
    v_accvgpr_write_b32 a19, v8
    v_accvgpr_read_b32 v5, a20
    v_mul_f32 v5, v5, v4
    v_accvgpr_write_b32 a20, v5
    v_accvgpr_read_b32 v6, a21
    v_mul_f32 v6, v6, v4
    v_accvgpr_write_b32 a21, v6
    v_accvgpr_read_b32 v7, a22
    v_mul_f32 v7, v7, v4
    v_accvgpr_write_b32 a22, v7
    v_accvgpr_read_b32 v8, a23
    v_mul_f32 v8, v8, v4
    v_accvgpr_write_b32 a23, v8
    v_accvgpr_read_b32 v5, a24
    v_mul_f32 v5, v5, v4
    v_accvgpr_write_b32 a24, v5
    v_accvgpr_read_b32 v6, a25
    v_mul_f32 v6, v6, v4
    v_accvgpr_write_b32 a25, v6
    v_accvgpr_read_b32 v7, a26
    v_mul_f32 v7, v7, v4
    v_accvgpr_write_b32 a26, v7
    v_accvgpr_read_b32 v8, a27
    v_mul_f32 v8, v8, v4
    v_accvgpr_write_b32 a27, v8
    v_accvgpr_read_b32 v5, a28
    v_mul_f32 v5, v5, v4
    v_accvgpr_write_b32 a28, v5
    v_accvgpr_read_b32 v6, a29
    v_mul_f32 v6, v6, v4
    v_accvgpr_write_b32 a29, v6
    v_accvgpr_read_b32 v7, a30
    v_mul_f32 v7, v7, v4
    v_accvgpr_write_b32 a30, v7
    v_accvgpr_read_b32 v8, a31
    v_mul_f32 v8, v8, v4
    v_accvgpr_write_b32 a31, v8
    v_accvgpr_read_b32 v5, a32
    v_mul_f32 v5, v5, v4
    v_accvgpr_write_b32 a32, v5
    v_accvgpr_read_b32 v6, a33
    v_mul_f32 v6, v6, v4
    v_accvgpr_write_b32 a33, v6
    v_accvgpr_read_b32 v7, a34
    v_mul_f32 v7, v7, v4
    v_accvgpr_write_b32 a34, v7
    v_accvgpr_read_b32 v8, a35
    v_mul_f32 v8, v8, v4
    v_accvgpr_write_b32 a35, v8
    v_accvgpr_read_b32 v5, a36
    v_mul_f32 v5, v5, v4
    v_accvgpr_write_b32 a36, v5
    v_accvgpr_read_b32 v6, a37
    v_mul_f32 v6, v6, v4
    v_accvgpr_write_b32 a37, v6
    v_accvgpr_read_b32 v7, a38
    v_mul_f32 v7, v7, v4
    v_accvgpr_write_b32 a38, v7
    v_accvgpr_read_b32 v8, a39
    v_mul_f32 v8, v8, v4
    v_accvgpr_write_b32 a39, v8
    v_accvgpr_read_b32 v5, a40
    v_mul_f32 v5, v5, v4
    v_accvgpr_write_b32 a40, v5
    v_accvgpr_read_b32 v6, a41
    v_mul_f32 v6, v6, v4
    v_accvgpr_write_b32 a41, v6
    v_accvgpr_read_b32 v7, a42
    v_mul_f32 v7, v7, v4
    v_accvgpr_write_b32 a42, v7
    v_accvgpr_read_b32 v8, a43
    v_mul_f32 v8, v8, v4
    v_accvgpr_write_b32 a43, v8
    v_accvgpr_read_b32 v5, a44
    v_mul_f32 v5, v5, v4
    v_accvgpr_write_b32 a44, v5
    v_accvgpr_read_b32 v6, a45
    v_mul_f32 v6, v6, v4
    v_accvgpr_write_b32 a45, v6
    v_accvgpr_read_b32 v7, a46
    v_mul_f32 v7, v7, v4
    v_accvgpr_write_b32 a46, v7
    v_accvgpr_read_b32 v8, a47
    v_mul_f32 v8, v8, v4
    v_accvgpr_write_b32 a47, v8
    v_accvgpr_read_b32 v5, a48
    v_mul_f32 v5, v5, v4
    v_accvgpr_write_b32 a48, v5
    v_accvgpr_read_b32 v6, a49
    v_mul_f32 v6, v6, v4
    v_accvgpr_write_b32 a49, v6
    v_accvgpr_read_b32 v7, a50
    v_mul_f32 v7, v7, v4
    v_accvgpr_write_b32 a50, v7
    v_accvgpr_read_b32 v8, a51
    v_mul_f32 v8, v8, v4
    v_accvgpr_write_b32 a51, v8
    v_accvgpr_read_b32 v5, a52
    v_mul_f32 v5, v5, v4
    v_accvgpr_write_b32 a52, v5
    v_accvgpr_read_b32 v6, a53
    v_mul_f32 v6, v6, v4
    v_accvgpr_write_b32 a53, v6
    v_accvgpr_read_b32 v7, a54
    v_mul_f32 v7, v7, v4
    v_accvgpr_write_b32 a54, v7
    v_accvgpr_read_b32 v8, a55
    v_mul_f32 v8, v8, v4
    v_accvgpr_write_b32 a55, v8
    v_accvgpr_read_b32 v5, a56
    v_mul_f32 v5, v5, v4
    v_accvgpr_write_b32 a56, v5
    v_accvgpr_read_b32 v6, a57
    v_mul_f32 v6, v6, v4
    v_accvgpr_write_b32 a57, v6
    v_accvgpr_read_b32 v7, a58
    v_mul_f32 v7, v7, v4
    v_accvgpr_write_b32 a58, v7
    v_accvgpr_read_b32 v8, a59
    v_mul_f32 v8, v8, v4
    v_accvgpr_write_b32 a59, v8
    v_accvgpr_read_b32 v5, a60
    v_mul_f32 v5, v5, v4
    v_accvgpr_write_b32 a60, v5
    v_accvgpr_read_b32 v6, a61
    v_mul_f32 v6, v6, v4
    v_accvgpr_write_b32 a61, v6
    v_accvgpr_read_b32 v7, a62
    v_mul_f32 v7, v7, v4
    v_accvgpr_write_b32 a62, v7
    v_accvgpr_read_b32 v8, a63
    v_mul_f32 v8, v8, v4
    v_accvgpr_write_b32 a63, v8
    v_accvgpr_read_b32 v5, a64
    v_mul_f32 v5, v5, v4
    v_accvgpr_write_b32 a64, v5
    v_accvgpr_read_b32 v6, a65
    v_mul_f32 v6, v6, v4
    v_accvgpr_write_b32 a65, v6
    v_accvgpr_read_b32 v7, a66
    v_mul_f32 v7, v7, v4
    v_accvgpr_write_b32 a66, v7
    v_accvgpr_read_b32 v8, a67
    v_mul_f32 v8, v8, v4
    v_accvgpr_write_b32 a67, v8
    v_accvgpr_read_b32 v5, a68
    v_mul_f32 v5, v5, v4
    v_accvgpr_write_b32 a68, v5
    v_accvgpr_read_b32 v6, a69
    v_mul_f32 v6, v6, v4
    v_accvgpr_write_b32 a69, v6
    v_accvgpr_read_b32 v7, a70
    v_mul_f32 v7, v7, v4
    v_accvgpr_write_b32 a70, v7
    v_accvgpr_read_b32 v8, a71
    v_mul_f32 v8, v8, v4
    v_accvgpr_write_b32 a71, v8
    v_accvgpr_read_b32 v5, a72
    v_mul_f32 v5, v5, v4
    v_accvgpr_write_b32 a72, v5
    v_accvgpr_read_b32 v6, a73
    v_mul_f32 v6, v6, v4
    v_accvgpr_write_b32 a73, v6
    v_accvgpr_read_b32 v7, a74
    v_mul_f32 v7, v7, v4
    v_accvgpr_write_b32 a74, v7
    v_accvgpr_read_b32 v8, a75
    v_mul_f32 v8, v8, v4
    v_accvgpr_write_b32 a75, v8
    v_accvgpr_read_b32 v5, a76
    v_mul_f32 v5, v5, v4
    v_accvgpr_write_b32 a76, v5
    v_accvgpr_read_b32 v6, a77
    v_mul_f32 v6, v6, v4
    v_accvgpr_write_b32 a77, v6
    v_accvgpr_read_b32 v7, a78
    v_mul_f32 v7, v7, v4
    v_accvgpr_write_b32 a78, v7
    v_accvgpr_read_b32 v8, a79
    v_mul_f32 v8, v8, v4
    v_accvgpr_write_b32 a79, v8
    v_accvgpr_read_b32 v5, a80
    v_mul_f32 v5, v5, v4
    v_accvgpr_write_b32 a80, v5
    v_accvgpr_read_b32 v6, a81
    v_mul_f32 v6, v6, v4
    v_accvgpr_write_b32 a81, v6
    v_accvgpr_read_b32 v7, a82
    v_mul_f32 v7, v7, v4
    v_accvgpr_write_b32 a82, v7
    v_accvgpr_read_b32 v8, a83
    v_mul_f32 v8, v8, v4
    v_accvgpr_write_b32 a83, v8
    v_accvgpr_read_b32 v5, a84
    v_mul_f32 v5, v5, v4
    v_accvgpr_write_b32 a84, v5
    v_accvgpr_read_b32 v6, a85
    v_mul_f32 v6, v6, v4
    v_accvgpr_write_b32 a85, v6
    v_accvgpr_read_b32 v7, a86
    v_mul_f32 v7, v7, v4
    v_accvgpr_write_b32 a86, v7
    v_accvgpr_read_b32 v8, a87
    v_mul_f32 v8, v8, v4
    v_accvgpr_write_b32 a87, v8
    v_accvgpr_read_b32 v5, a88
    v_mul_f32 v5, v5, v4
    v_accvgpr_write_b32 a88, v5
    v_accvgpr_read_b32 v6, a89
    v_mul_f32 v6, v6, v4
    v_accvgpr_write_b32 a89, v6
    v_accvgpr_read_b32 v7, a90
    v_mul_f32 v7, v7, v4
    v_accvgpr_write_b32 a90, v7
    v_accvgpr_read_b32 v8, a91
    v_mul_f32 v8, v8, v4
    v_accvgpr_write_b32 a91, v8
    v_accvgpr_read_b32 v5, a92
    v_mul_f32 v5, v5, v4
    v_accvgpr_write_b32 a92, v5
    v_accvgpr_read_b32 v6, a93
    v_mul_f32 v6, v6, v4
    v_accvgpr_write_b32 a93, v6
    v_accvgpr_read_b32 v7, a94
    v_mul_f32 v7, v7, v4
    v_accvgpr_write_b32 a94, v7
    v_accvgpr_read_b32 v8, a95
    v_mul_f32 v8, v8, v4
    v_accvgpr_write_b32 a95, v8
    v_accvgpr_read_b32 v5, a96
    v_mul_f32 v5, v5, v4
    v_accvgpr_write_b32 a96, v5
    v_accvgpr_read_b32 v6, a97
    v_mul_f32 v6, v6, v4
    v_accvgpr_write_b32 a97, v6
    v_accvgpr_read_b32 v7, a98
    v_mul_f32 v7, v7, v4
    v_accvgpr_write_b32 a98, v7
    v_accvgpr_read_b32 v8, a99
    v_mul_f32 v8, v8, v4
    v_accvgpr_write_b32 a99, v8
    v_accvgpr_read_b32 v5, a100
    v_mul_f32 v5, v5, v4
    v_accvgpr_write_b32 a100, v5
    v_accvgpr_read_b32 v6, a101
    v_mul_f32 v6, v6, v4
    v_accvgpr_write_b32 a101, v6
    v_accvgpr_read_b32 v7, a102
    v_mul_f32 v7, v7, v4
    v_accvgpr_write_b32 a102, v7
    v_accvgpr_read_b32 v8, a103
    v_mul_f32 v8, v8, v4
    v_accvgpr_write_b32 a103, v8
    v_accvgpr_read_b32 v5, a104
    v_mul_f32 v5, v5, v4
    v_accvgpr_write_b32 a104, v5
    v_accvgpr_read_b32 v6, a105
    v_mul_f32 v6, v6, v4
    v_accvgpr_write_b32 a105, v6
    v_accvgpr_read_b32 v7, a106
    v_mul_f32 v7, v7, v4
    v_accvgpr_write_b32 a106, v7
    v_accvgpr_read_b32 v8, a107
    v_mul_f32 v8, v8, v4
    v_accvgpr_write_b32 a107, v8
    v_accvgpr_read_b32 v5, a108
    v_mul_f32 v5, v5, v4
    v_accvgpr_write_b32 a108, v5
    v_accvgpr_read_b32 v6, a109
    v_mul_f32 v6, v6, v4
    v_accvgpr_write_b32 a109, v6
    v_accvgpr_read_b32 v7, a110
    v_mul_f32 v7, v7, v4
    v_accvgpr_write_b32 a110, v7
    v_accvgpr_read_b32 v8, a111
    v_mul_f32 v8, v8, v4
    v_accvgpr_write_b32 a111, v8
    v_accvgpr_read_b32 v5, a112
    v_mul_f32 v5, v5, v4
    v_accvgpr_write_b32 a112, v5
    v_accvgpr_read_b32 v6, a113
    v_mul_f32 v6, v6, v4
    v_accvgpr_write_b32 a113, v6
    v_accvgpr_read_b32 v7, a114
    v_mul_f32 v7, v7, v4
    v_accvgpr_write_b32 a114, v7
    v_accvgpr_read_b32 v8, a115
    v_mul_f32 v8, v8, v4
    v_accvgpr_write_b32 a115, v8
    v_accvgpr_read_b32 v5, a116
    v_mul_f32 v5, v5, v4
    v_accvgpr_write_b32 a116, v5
    v_accvgpr_read_b32 v6, a117
    v_mul_f32 v6, v6, v4
    v_accvgpr_write_b32 a117, v6
    v_accvgpr_read_b32 v7, a118
    v_mul_f32 v7, v7, v4
    v_accvgpr_write_b32 a118, v7
    v_accvgpr_read_b32 v8, a119
    v_mul_f32 v8, v8, v4
    v_accvgpr_write_b32 a119, v8
    v_accvgpr_read_b32 v5, a120
    v_mul_f32 v5, v5, v4
    v_accvgpr_write_b32 a120, v5
    v_accvgpr_read_b32 v6, a121
    v_mul_f32 v6, v6, v4
    v_accvgpr_write_b32 a121, v6
    v_accvgpr_read_b32 v7, a122
    v_mul_f32 v7, v7, v4
    v_accvgpr_write_b32 a122, v7
    v_accvgpr_read_b32 v8, a123
    v_mul_f32 v8, v8, v4
    v_accvgpr_write_b32 a123, v8
    v_accvgpr_read_b32 v5, a124
    v_mul_f32 v5, v5, v4
    v_accvgpr_write_b32 a124, v5
    v_accvgpr_read_b32 v6, a125
    v_mul_f32 v6, v6, v4
    v_accvgpr_write_b32 a125, v6
    v_accvgpr_read_b32 v7, a126
    v_mul_f32 v7, v7, v4
    v_accvgpr_write_b32 a126, v7
    v_accvgpr_read_b32 v8, a127
    v_mul_f32 v8, v8, v4
    v_accvgpr_write_b32 a127, v8
    s_nop 1
    s_branch LRB_10
LRS_11:
    v_max_f32 v3, v32, v2
    v_sub_f32 v4, v32, v3
    v_exp_f32 v4, v4
    v_mov_b32 v32, v3
    s_nop 0
    v_mul_f32 v33, v33, v4
    s_nop 15
    v_accvgpr_read_b32 v5, a0
    v_mul_f32 v5, v5, v4
    v_accvgpr_write_b32 a0, v5
    v_accvgpr_read_b32 v6, a1
    v_mul_f32 v6, v6, v4
    v_accvgpr_write_b32 a1, v6
    v_accvgpr_read_b32 v7, a2
    v_mul_f32 v7, v7, v4
    v_accvgpr_write_b32 a2, v7
    v_accvgpr_read_b32 v8, a3
    v_mul_f32 v8, v8, v4
    v_accvgpr_write_b32 a3, v8
    v_accvgpr_read_b32 v5, a4
    v_mul_f32 v5, v5, v4
    v_accvgpr_write_b32 a4, v5
    v_accvgpr_read_b32 v6, a5
    v_mul_f32 v6, v6, v4
    v_accvgpr_write_b32 a5, v6
    v_accvgpr_read_b32 v7, a6
    v_mul_f32 v7, v7, v4
    v_accvgpr_write_b32 a6, v7
    v_accvgpr_read_b32 v8, a7
    v_mul_f32 v8, v8, v4
    v_accvgpr_write_b32 a7, v8
    v_accvgpr_read_b32 v5, a8
    v_mul_f32 v5, v5, v4
    v_accvgpr_write_b32 a8, v5
    v_accvgpr_read_b32 v6, a9
    v_mul_f32 v6, v6, v4
    v_accvgpr_write_b32 a9, v6
    v_accvgpr_read_b32 v7, a10
    v_mul_f32 v7, v7, v4
    v_accvgpr_write_b32 a10, v7
    v_accvgpr_read_b32 v8, a11
    v_mul_f32 v8, v8, v4
    v_accvgpr_write_b32 a11, v8
    v_accvgpr_read_b32 v5, a12
    v_mul_f32 v5, v5, v4
    v_accvgpr_write_b32 a12, v5
    v_accvgpr_read_b32 v6, a13
    v_mul_f32 v6, v6, v4
    v_accvgpr_write_b32 a13, v6
    v_accvgpr_read_b32 v7, a14
    v_mul_f32 v7, v7, v4
    v_accvgpr_write_b32 a14, v7
    v_accvgpr_read_b32 v8, a15
    v_mul_f32 v8, v8, v4
    v_accvgpr_write_b32 a15, v8
    v_accvgpr_read_b32 v5, a16
    v_mul_f32 v5, v5, v4
    v_accvgpr_write_b32 a16, v5
    v_accvgpr_read_b32 v6, a17
    v_mul_f32 v6, v6, v4
    v_accvgpr_write_b32 a17, v6
    v_accvgpr_read_b32 v7, a18
    v_mul_f32 v7, v7, v4
    v_accvgpr_write_b32 a18, v7
    v_accvgpr_read_b32 v8, a19
    v_mul_f32 v8, v8, v4
    v_accvgpr_write_b32 a19, v8
    v_accvgpr_read_b32 v5, a20
    v_mul_f32 v5, v5, v4
    v_accvgpr_write_b32 a20, v5
    v_accvgpr_read_b32 v6, a21
    v_mul_f32 v6, v6, v4
    v_accvgpr_write_b32 a21, v6
    v_accvgpr_read_b32 v7, a22
    v_mul_f32 v7, v7, v4
    v_accvgpr_write_b32 a22, v7
    v_accvgpr_read_b32 v8, a23
    v_mul_f32 v8, v8, v4
    v_accvgpr_write_b32 a23, v8
    v_accvgpr_read_b32 v5, a24
    v_mul_f32 v5, v5, v4
    v_accvgpr_write_b32 a24, v5
    v_accvgpr_read_b32 v6, a25
    v_mul_f32 v6, v6, v4
    v_accvgpr_write_b32 a25, v6
    v_accvgpr_read_b32 v7, a26
    v_mul_f32 v7, v7, v4
    v_accvgpr_write_b32 a26, v7
    v_accvgpr_read_b32 v8, a27
    v_mul_f32 v8, v8, v4
    v_accvgpr_write_b32 a27, v8
    v_accvgpr_read_b32 v5, a28
    v_mul_f32 v5, v5, v4
    v_accvgpr_write_b32 a28, v5
    v_accvgpr_read_b32 v6, a29
    v_mul_f32 v6, v6, v4
    v_accvgpr_write_b32 a29, v6
    v_accvgpr_read_b32 v7, a30
    v_mul_f32 v7, v7, v4
    v_accvgpr_write_b32 a30, v7
    v_accvgpr_read_b32 v8, a31
    v_mul_f32 v8, v8, v4
    v_accvgpr_write_b32 a31, v8
    v_accvgpr_read_b32 v5, a32
    v_mul_f32 v5, v5, v4
    v_accvgpr_write_b32 a32, v5
    v_accvgpr_read_b32 v6, a33
    v_mul_f32 v6, v6, v4
    v_accvgpr_write_b32 a33, v6
    v_accvgpr_read_b32 v7, a34
    v_mul_f32 v7, v7, v4
    v_accvgpr_write_b32 a34, v7
    v_accvgpr_read_b32 v8, a35
    v_mul_f32 v8, v8, v4
    v_accvgpr_write_b32 a35, v8
    v_accvgpr_read_b32 v5, a36
    v_mul_f32 v5, v5, v4
    v_accvgpr_write_b32 a36, v5
    v_accvgpr_read_b32 v6, a37
    v_mul_f32 v6, v6, v4
    v_accvgpr_write_b32 a37, v6
    v_accvgpr_read_b32 v7, a38
    v_mul_f32 v7, v7, v4
    v_accvgpr_write_b32 a38, v7
    v_accvgpr_read_b32 v8, a39
    v_mul_f32 v8, v8, v4
    v_accvgpr_write_b32 a39, v8
    v_accvgpr_read_b32 v5, a40
    v_mul_f32 v5, v5, v4
    v_accvgpr_write_b32 a40, v5
    v_accvgpr_read_b32 v6, a41
    v_mul_f32 v6, v6, v4
    v_accvgpr_write_b32 a41, v6
    v_accvgpr_read_b32 v7, a42
    v_mul_f32 v7, v7, v4
    v_accvgpr_write_b32 a42, v7
    v_accvgpr_read_b32 v8, a43
    v_mul_f32 v8, v8, v4
    v_accvgpr_write_b32 a43, v8
    v_accvgpr_read_b32 v5, a44
    v_mul_f32 v5, v5, v4
    v_accvgpr_write_b32 a44, v5
    v_accvgpr_read_b32 v6, a45
    v_mul_f32 v6, v6, v4
    v_accvgpr_write_b32 a45, v6
    v_accvgpr_read_b32 v7, a46
    v_mul_f32 v7, v7, v4
    v_accvgpr_write_b32 a46, v7
    v_accvgpr_read_b32 v8, a47
    v_mul_f32 v8, v8, v4
    v_accvgpr_write_b32 a47, v8
    v_accvgpr_read_b32 v5, a48
    v_mul_f32 v5, v5, v4
    v_accvgpr_write_b32 a48, v5
    v_accvgpr_read_b32 v6, a49
    v_mul_f32 v6, v6, v4
    v_accvgpr_write_b32 a49, v6
    v_accvgpr_read_b32 v7, a50
    v_mul_f32 v7, v7, v4
    v_accvgpr_write_b32 a50, v7
    v_accvgpr_read_b32 v8, a51
    v_mul_f32 v8, v8, v4
    v_accvgpr_write_b32 a51, v8
    v_accvgpr_read_b32 v5, a52
    v_mul_f32 v5, v5, v4
    v_accvgpr_write_b32 a52, v5
    v_accvgpr_read_b32 v6, a53
    v_mul_f32 v6, v6, v4
    v_accvgpr_write_b32 a53, v6
    v_accvgpr_read_b32 v7, a54
    v_mul_f32 v7, v7, v4
    v_accvgpr_write_b32 a54, v7
    v_accvgpr_read_b32 v8, a55
    v_mul_f32 v8, v8, v4
    v_accvgpr_write_b32 a55, v8
    v_accvgpr_read_b32 v5, a56
    v_mul_f32 v5, v5, v4
    v_accvgpr_write_b32 a56, v5
    v_accvgpr_read_b32 v6, a57
    v_mul_f32 v6, v6, v4
    v_accvgpr_write_b32 a57, v6
    v_accvgpr_read_b32 v7, a58
    v_mul_f32 v7, v7, v4
    v_accvgpr_write_b32 a58, v7
    v_accvgpr_read_b32 v8, a59
    v_mul_f32 v8, v8, v4
    v_accvgpr_write_b32 a59, v8
    v_accvgpr_read_b32 v5, a60
    v_mul_f32 v5, v5, v4
    v_accvgpr_write_b32 a60, v5
    v_accvgpr_read_b32 v6, a61
    v_mul_f32 v6, v6, v4
    v_accvgpr_write_b32 a61, v6
    v_accvgpr_read_b32 v7, a62
    v_mul_f32 v7, v7, v4
    v_accvgpr_write_b32 a62, v7
    v_accvgpr_read_b32 v8, a63
    v_mul_f32 v8, v8, v4
    v_accvgpr_write_b32 a63, v8
    v_accvgpr_read_b32 v5, a64
    v_mul_f32 v5, v5, v4
    v_accvgpr_write_b32 a64, v5
    v_accvgpr_read_b32 v6, a65
    v_mul_f32 v6, v6, v4
    v_accvgpr_write_b32 a65, v6
    v_accvgpr_read_b32 v7, a66
    v_mul_f32 v7, v7, v4
    v_accvgpr_write_b32 a66, v7
    v_accvgpr_read_b32 v8, a67
    v_mul_f32 v8, v8, v4
    v_accvgpr_write_b32 a67, v8
    v_accvgpr_read_b32 v5, a68
    v_mul_f32 v5, v5, v4
    v_accvgpr_write_b32 a68, v5
    v_accvgpr_read_b32 v6, a69
    v_mul_f32 v6, v6, v4
    v_accvgpr_write_b32 a69, v6
    v_accvgpr_read_b32 v7, a70
    v_mul_f32 v7, v7, v4
    v_accvgpr_write_b32 a70, v7
    v_accvgpr_read_b32 v8, a71
    v_mul_f32 v8, v8, v4
    v_accvgpr_write_b32 a71, v8
    v_accvgpr_read_b32 v5, a72
    v_mul_f32 v5, v5, v4
    v_accvgpr_write_b32 a72, v5
    v_accvgpr_read_b32 v6, a73
    v_mul_f32 v6, v6, v4
    v_accvgpr_write_b32 a73, v6
    v_accvgpr_read_b32 v7, a74
    v_mul_f32 v7, v7, v4
    v_accvgpr_write_b32 a74, v7
    v_accvgpr_read_b32 v8, a75
    v_mul_f32 v8, v8, v4
    v_accvgpr_write_b32 a75, v8
    v_accvgpr_read_b32 v5, a76
    v_mul_f32 v5, v5, v4
    v_accvgpr_write_b32 a76, v5
    v_accvgpr_read_b32 v6, a77
    v_mul_f32 v6, v6, v4
    v_accvgpr_write_b32 a77, v6
    v_accvgpr_read_b32 v7, a78
    v_mul_f32 v7, v7, v4
    v_accvgpr_write_b32 a78, v7
    v_accvgpr_read_b32 v8, a79
    v_mul_f32 v8, v8, v4
    v_accvgpr_write_b32 a79, v8
    v_accvgpr_read_b32 v5, a80
    v_mul_f32 v5, v5, v4
    v_accvgpr_write_b32 a80, v5
    v_accvgpr_read_b32 v6, a81
    v_mul_f32 v6, v6, v4
    v_accvgpr_write_b32 a81, v6
    v_accvgpr_read_b32 v7, a82
    v_mul_f32 v7, v7, v4
    v_accvgpr_write_b32 a82, v7
    v_accvgpr_read_b32 v8, a83
    v_mul_f32 v8, v8, v4
    v_accvgpr_write_b32 a83, v8
    v_accvgpr_read_b32 v5, a84
    v_mul_f32 v5, v5, v4
    v_accvgpr_write_b32 a84, v5
    v_accvgpr_read_b32 v6, a85
    v_mul_f32 v6, v6, v4
    v_accvgpr_write_b32 a85, v6
    v_accvgpr_read_b32 v7, a86
    v_mul_f32 v7, v7, v4
    v_accvgpr_write_b32 a86, v7
    v_accvgpr_read_b32 v8, a87
    v_mul_f32 v8, v8, v4
    v_accvgpr_write_b32 a87, v8
    v_accvgpr_read_b32 v5, a88
    v_mul_f32 v5, v5, v4
    v_accvgpr_write_b32 a88, v5
    v_accvgpr_read_b32 v6, a89
    v_mul_f32 v6, v6, v4
    v_accvgpr_write_b32 a89, v6
    v_accvgpr_read_b32 v7, a90
    v_mul_f32 v7, v7, v4
    v_accvgpr_write_b32 a90, v7
    v_accvgpr_read_b32 v8, a91
    v_mul_f32 v8, v8, v4
    v_accvgpr_write_b32 a91, v8
    v_accvgpr_read_b32 v5, a92
    v_mul_f32 v5, v5, v4
    v_accvgpr_write_b32 a92, v5
    v_accvgpr_read_b32 v6, a93
    v_mul_f32 v6, v6, v4
    v_accvgpr_write_b32 a93, v6
    v_accvgpr_read_b32 v7, a94
    v_mul_f32 v7, v7, v4
    v_accvgpr_write_b32 a94, v7
    v_accvgpr_read_b32 v8, a95
    v_mul_f32 v8, v8, v4
    v_accvgpr_write_b32 a95, v8
    v_accvgpr_read_b32 v5, a96
    v_mul_f32 v5, v5, v4
    v_accvgpr_write_b32 a96, v5
    v_accvgpr_read_b32 v6, a97
    v_mul_f32 v6, v6, v4
    v_accvgpr_write_b32 a97, v6
    v_accvgpr_read_b32 v7, a98
    v_mul_f32 v7, v7, v4
    v_accvgpr_write_b32 a98, v7
    v_accvgpr_read_b32 v8, a99
    v_mul_f32 v8, v8, v4
    v_accvgpr_write_b32 a99, v8
    v_accvgpr_read_b32 v5, a100
    v_mul_f32 v5, v5, v4
    v_accvgpr_write_b32 a100, v5
    v_accvgpr_read_b32 v6, a101
    v_mul_f32 v6, v6, v4
    v_accvgpr_write_b32 a101, v6
    v_accvgpr_read_b32 v7, a102
    v_mul_f32 v7, v7, v4
    v_accvgpr_write_b32 a102, v7
    v_accvgpr_read_b32 v8, a103
    v_mul_f32 v8, v8, v4
    v_accvgpr_write_b32 a103, v8
    v_accvgpr_read_b32 v5, a104
    v_mul_f32 v5, v5, v4
    v_accvgpr_write_b32 a104, v5
    v_accvgpr_read_b32 v6, a105
    v_mul_f32 v6, v6, v4
    v_accvgpr_write_b32 a105, v6
    v_accvgpr_read_b32 v7, a106
    v_mul_f32 v7, v7, v4
    v_accvgpr_write_b32 a106, v7
    v_accvgpr_read_b32 v8, a107
    v_mul_f32 v8, v8, v4
    v_accvgpr_write_b32 a107, v8
    v_accvgpr_read_b32 v5, a108
    v_mul_f32 v5, v5, v4
    v_accvgpr_write_b32 a108, v5
    v_accvgpr_read_b32 v6, a109
    v_mul_f32 v6, v6, v4
    v_accvgpr_write_b32 a109, v6
    v_accvgpr_read_b32 v7, a110
    v_mul_f32 v7, v7, v4
    v_accvgpr_write_b32 a110, v7
    v_accvgpr_read_b32 v8, a111
    v_mul_f32 v8, v8, v4
    v_accvgpr_write_b32 a111, v8
    v_accvgpr_read_b32 v5, a112
    v_mul_f32 v5, v5, v4
    v_accvgpr_write_b32 a112, v5
    v_accvgpr_read_b32 v6, a113
    v_mul_f32 v6, v6, v4
    v_accvgpr_write_b32 a113, v6
    v_accvgpr_read_b32 v7, a114
    v_mul_f32 v7, v7, v4
    v_accvgpr_write_b32 a114, v7
    v_accvgpr_read_b32 v8, a115
    v_mul_f32 v8, v8, v4
    v_accvgpr_write_b32 a115, v8
    v_accvgpr_read_b32 v5, a116
    v_mul_f32 v5, v5, v4
    v_accvgpr_write_b32 a116, v5
    v_accvgpr_read_b32 v6, a117
    v_mul_f32 v6, v6, v4
    v_accvgpr_write_b32 a117, v6
    v_accvgpr_read_b32 v7, a118
    v_mul_f32 v7, v7, v4
    v_accvgpr_write_b32 a118, v7
    v_accvgpr_read_b32 v8, a119
    v_mul_f32 v8, v8, v4
    v_accvgpr_write_b32 a119, v8
    v_accvgpr_read_b32 v5, a120
    v_mul_f32 v5, v5, v4
    v_accvgpr_write_b32 a120, v5
    v_accvgpr_read_b32 v6, a121
    v_mul_f32 v6, v6, v4
    v_accvgpr_write_b32 a121, v6
    v_accvgpr_read_b32 v7, a122
    v_mul_f32 v7, v7, v4
    v_accvgpr_write_b32 a122, v7
    v_accvgpr_read_b32 v8, a123
    v_mul_f32 v8, v8, v4
    v_accvgpr_write_b32 a123, v8
    v_accvgpr_read_b32 v5, a124
    v_mul_f32 v5, v5, v4
    v_accvgpr_write_b32 a124, v5
    v_accvgpr_read_b32 v6, a125
    v_mul_f32 v6, v6, v4
    v_accvgpr_write_b32 a125, v6
    v_accvgpr_read_b32 v7, a126
    v_mul_f32 v7, v7, v4
    v_accvgpr_write_b32 a126, v7
    v_accvgpr_read_b32 v8, a127
    v_mul_f32 v8, v8, v4
    v_accvgpr_write_b32 a127, v8
    s_nop 1
    s_branch LRB_12
LRS_13:
    v_max_f32 v3, v34, v2
    v_sub_f32 v4, v34, v3
    v_exp_f32 v4, v4
    v_mov_b32 v34, v3
    s_nop 0
    v_mul_f32 v35, v35, v4
    s_nop 15
    v_accvgpr_read_b32 v5, a128
    v_mul_f32 v5, v5, v4
    v_accvgpr_write_b32 a128, v5
    v_accvgpr_read_b32 v6, a129
    v_mul_f32 v6, v6, v4
    v_accvgpr_write_b32 a129, v6
    v_accvgpr_read_b32 v7, a130
    v_mul_f32 v7, v7, v4
    v_accvgpr_write_b32 a130, v7
    v_accvgpr_read_b32 v8, a131
    v_mul_f32 v8, v8, v4
    v_accvgpr_write_b32 a131, v8
    v_accvgpr_read_b32 v5, a132
    v_mul_f32 v5, v5, v4
    v_accvgpr_write_b32 a132, v5
    v_accvgpr_read_b32 v6, a133
    v_mul_f32 v6, v6, v4
    v_accvgpr_write_b32 a133, v6
    v_accvgpr_read_b32 v7, a134
    v_mul_f32 v7, v7, v4
    v_accvgpr_write_b32 a134, v7
    v_accvgpr_read_b32 v8, a135
    v_mul_f32 v8, v8, v4
    v_accvgpr_write_b32 a135, v8
    v_accvgpr_read_b32 v5, a136
    v_mul_f32 v5, v5, v4
    v_accvgpr_write_b32 a136, v5
    v_accvgpr_read_b32 v6, a137
    v_mul_f32 v6, v6, v4
    v_accvgpr_write_b32 a137, v6
    v_accvgpr_read_b32 v7, a138
    v_mul_f32 v7, v7, v4
    v_accvgpr_write_b32 a138, v7
    v_accvgpr_read_b32 v8, a139
    v_mul_f32 v8, v8, v4
    v_accvgpr_write_b32 a139, v8
    v_accvgpr_read_b32 v5, a140
    v_mul_f32 v5, v5, v4
    v_accvgpr_write_b32 a140, v5
    v_accvgpr_read_b32 v6, a141
    v_mul_f32 v6, v6, v4
    v_accvgpr_write_b32 a141, v6
    v_accvgpr_read_b32 v7, a142
    v_mul_f32 v7, v7, v4
    v_accvgpr_write_b32 a142, v7
    v_accvgpr_read_b32 v8, a143
    v_mul_f32 v8, v8, v4
    v_accvgpr_write_b32 a143, v8
    v_accvgpr_read_b32 v5, a144
    v_mul_f32 v5, v5, v4
    v_accvgpr_write_b32 a144, v5
    v_accvgpr_read_b32 v6, a145
    v_mul_f32 v6, v6, v4
    v_accvgpr_write_b32 a145, v6
    v_accvgpr_read_b32 v7, a146
    v_mul_f32 v7, v7, v4
    v_accvgpr_write_b32 a146, v7
    v_accvgpr_read_b32 v8, a147
    v_mul_f32 v8, v8, v4
    v_accvgpr_write_b32 a147, v8
    v_accvgpr_read_b32 v5, a148
    v_mul_f32 v5, v5, v4
    v_accvgpr_write_b32 a148, v5
    v_accvgpr_read_b32 v6, a149
    v_mul_f32 v6, v6, v4
    v_accvgpr_write_b32 a149, v6
    v_accvgpr_read_b32 v7, a150
    v_mul_f32 v7, v7, v4
    v_accvgpr_write_b32 a150, v7
    v_accvgpr_read_b32 v8, a151
    v_mul_f32 v8, v8, v4
    v_accvgpr_write_b32 a151, v8
    v_accvgpr_read_b32 v5, a152
    v_mul_f32 v5, v5, v4
    v_accvgpr_write_b32 a152, v5
    v_accvgpr_read_b32 v6, a153
    v_mul_f32 v6, v6, v4
    v_accvgpr_write_b32 a153, v6
    v_accvgpr_read_b32 v7, a154
    v_mul_f32 v7, v7, v4
    v_accvgpr_write_b32 a154, v7
    v_accvgpr_read_b32 v8, a155
    v_mul_f32 v8, v8, v4
    v_accvgpr_write_b32 a155, v8
    v_accvgpr_read_b32 v5, a156
    v_mul_f32 v5, v5, v4
    v_accvgpr_write_b32 a156, v5
    v_accvgpr_read_b32 v6, a157
    v_mul_f32 v6, v6, v4
    v_accvgpr_write_b32 a157, v6
    v_accvgpr_read_b32 v7, a158
    v_mul_f32 v7, v7, v4
    v_accvgpr_write_b32 a158, v7
    v_accvgpr_read_b32 v8, a159
    v_mul_f32 v8, v8, v4
    v_accvgpr_write_b32 a159, v8
    v_accvgpr_read_b32 v5, a160
    v_mul_f32 v5, v5, v4
    v_accvgpr_write_b32 a160, v5
    v_accvgpr_read_b32 v6, a161
    v_mul_f32 v6, v6, v4
    v_accvgpr_write_b32 a161, v6
    v_accvgpr_read_b32 v7, a162
    v_mul_f32 v7, v7, v4
    v_accvgpr_write_b32 a162, v7
    v_accvgpr_read_b32 v8, a163
    v_mul_f32 v8, v8, v4
    v_accvgpr_write_b32 a163, v8
    v_accvgpr_read_b32 v5, a164
    v_mul_f32 v5, v5, v4
    v_accvgpr_write_b32 a164, v5
    v_accvgpr_read_b32 v6, a165
    v_mul_f32 v6, v6, v4
    v_accvgpr_write_b32 a165, v6
    v_accvgpr_read_b32 v7, a166
    v_mul_f32 v7, v7, v4
    v_accvgpr_write_b32 a166, v7
    v_accvgpr_read_b32 v8, a167
    v_mul_f32 v8, v8, v4
    v_accvgpr_write_b32 a167, v8
    v_accvgpr_read_b32 v5, a168
    v_mul_f32 v5, v5, v4
    v_accvgpr_write_b32 a168, v5
    v_accvgpr_read_b32 v6, a169
    v_mul_f32 v6, v6, v4
    v_accvgpr_write_b32 a169, v6
    v_accvgpr_read_b32 v7, a170
    v_mul_f32 v7, v7, v4
    v_accvgpr_write_b32 a170, v7
    v_accvgpr_read_b32 v8, a171
    v_mul_f32 v8, v8, v4
    v_accvgpr_write_b32 a171, v8
    v_accvgpr_read_b32 v5, a172
    v_mul_f32 v5, v5, v4
    v_accvgpr_write_b32 a172, v5
    v_accvgpr_read_b32 v6, a173
    v_mul_f32 v6, v6, v4
    v_accvgpr_write_b32 a173, v6
    v_accvgpr_read_b32 v7, a174
    v_mul_f32 v7, v7, v4
    v_accvgpr_write_b32 a174, v7
    v_accvgpr_read_b32 v8, a175
    v_mul_f32 v8, v8, v4
    v_accvgpr_write_b32 a175, v8
    v_accvgpr_read_b32 v5, a176
    v_mul_f32 v5, v5, v4
    v_accvgpr_write_b32 a176, v5
    v_accvgpr_read_b32 v6, a177
    v_mul_f32 v6, v6, v4
    v_accvgpr_write_b32 a177, v6
    v_accvgpr_read_b32 v7, a178
    v_mul_f32 v7, v7, v4
    v_accvgpr_write_b32 a178, v7
    v_accvgpr_read_b32 v8, a179
    v_mul_f32 v8, v8, v4
    v_accvgpr_write_b32 a179, v8
    v_accvgpr_read_b32 v5, a180
    v_mul_f32 v5, v5, v4
    v_accvgpr_write_b32 a180, v5
    v_accvgpr_read_b32 v6, a181
    v_mul_f32 v6, v6, v4
    v_accvgpr_write_b32 a181, v6
    v_accvgpr_read_b32 v7, a182
    v_mul_f32 v7, v7, v4
    v_accvgpr_write_b32 a182, v7
    v_accvgpr_read_b32 v8, a183
    v_mul_f32 v8, v8, v4
    v_accvgpr_write_b32 a183, v8
    v_accvgpr_read_b32 v5, a184
    v_mul_f32 v5, v5, v4
    v_accvgpr_write_b32 a184, v5
    v_accvgpr_read_b32 v6, a185
    v_mul_f32 v6, v6, v4
    v_accvgpr_write_b32 a185, v6
    v_accvgpr_read_b32 v7, a186
    v_mul_f32 v7, v7, v4
    v_accvgpr_write_b32 a186, v7
    v_accvgpr_read_b32 v8, a187
    v_mul_f32 v8, v8, v4
    v_accvgpr_write_b32 a187, v8
    v_accvgpr_read_b32 v5, a188
    v_mul_f32 v5, v5, v4
    v_accvgpr_write_b32 a188, v5
    v_accvgpr_read_b32 v6, a189
    v_mul_f32 v6, v6, v4
    v_accvgpr_write_b32 a189, v6
    v_accvgpr_read_b32 v7, a190
    v_mul_f32 v7, v7, v4
    v_accvgpr_write_b32 a190, v7
    v_accvgpr_read_b32 v8, a191
    v_mul_f32 v8, v8, v4
    v_accvgpr_write_b32 a191, v8
    v_accvgpr_read_b32 v5, a192
    v_mul_f32 v5, v5, v4
    v_accvgpr_write_b32 a192, v5
    v_accvgpr_read_b32 v6, a193
    v_mul_f32 v6, v6, v4
    v_accvgpr_write_b32 a193, v6
    v_accvgpr_read_b32 v7, a194
    v_mul_f32 v7, v7, v4
    v_accvgpr_write_b32 a194, v7
    v_accvgpr_read_b32 v8, a195
    v_mul_f32 v8, v8, v4
    v_accvgpr_write_b32 a195, v8
    v_accvgpr_read_b32 v5, a196
    v_mul_f32 v5, v5, v4
    v_accvgpr_write_b32 a196, v5
    v_accvgpr_read_b32 v6, a197
    v_mul_f32 v6, v6, v4
    v_accvgpr_write_b32 a197, v6
    v_accvgpr_read_b32 v7, a198
    v_mul_f32 v7, v7, v4
    v_accvgpr_write_b32 a198, v7
    v_accvgpr_read_b32 v8, a199
    v_mul_f32 v8, v8, v4
    v_accvgpr_write_b32 a199, v8
    v_accvgpr_read_b32 v5, a200
    v_mul_f32 v5, v5, v4
    v_accvgpr_write_b32 a200, v5
    v_accvgpr_read_b32 v6, a201
    v_mul_f32 v6, v6, v4
    v_accvgpr_write_b32 a201, v6
    v_accvgpr_read_b32 v7, a202
    v_mul_f32 v7, v7, v4
    v_accvgpr_write_b32 a202, v7
    v_accvgpr_read_b32 v8, a203
    v_mul_f32 v8, v8, v4
    v_accvgpr_write_b32 a203, v8
    v_accvgpr_read_b32 v5, a204
    v_mul_f32 v5, v5, v4
    v_accvgpr_write_b32 a204, v5
    v_accvgpr_read_b32 v6, a205
    v_mul_f32 v6, v6, v4
    v_accvgpr_write_b32 a205, v6
    v_accvgpr_read_b32 v7, a206
    v_mul_f32 v7, v7, v4
    v_accvgpr_write_b32 a206, v7
    v_accvgpr_read_b32 v8, a207
    v_mul_f32 v8, v8, v4
    v_accvgpr_write_b32 a207, v8
    v_accvgpr_read_b32 v5, a208
    v_mul_f32 v5, v5, v4
    v_accvgpr_write_b32 a208, v5
    v_accvgpr_read_b32 v6, a209
    v_mul_f32 v6, v6, v4
    v_accvgpr_write_b32 a209, v6
    v_accvgpr_read_b32 v7, a210
    v_mul_f32 v7, v7, v4
    v_accvgpr_write_b32 a210, v7
    v_accvgpr_read_b32 v8, a211
    v_mul_f32 v8, v8, v4
    v_accvgpr_write_b32 a211, v8
    v_accvgpr_read_b32 v5, a212
    v_mul_f32 v5, v5, v4
    v_accvgpr_write_b32 a212, v5
    v_accvgpr_read_b32 v6, a213
    v_mul_f32 v6, v6, v4
    v_accvgpr_write_b32 a213, v6
    v_accvgpr_read_b32 v7, a214
    v_mul_f32 v7, v7, v4
    v_accvgpr_write_b32 a214, v7
    v_accvgpr_read_b32 v8, a215
    v_mul_f32 v8, v8, v4
    v_accvgpr_write_b32 a215, v8
    v_accvgpr_read_b32 v5, a216
    v_mul_f32 v5, v5, v4
    v_accvgpr_write_b32 a216, v5
    v_accvgpr_read_b32 v6, a217
    v_mul_f32 v6, v6, v4
    v_accvgpr_write_b32 a217, v6
    v_accvgpr_read_b32 v7, a218
    v_mul_f32 v7, v7, v4
    v_accvgpr_write_b32 a218, v7
    v_accvgpr_read_b32 v8, a219
    v_mul_f32 v8, v8, v4
    v_accvgpr_write_b32 a219, v8
    v_accvgpr_read_b32 v5, a220
    v_mul_f32 v5, v5, v4
    v_accvgpr_write_b32 a220, v5
    v_accvgpr_read_b32 v6, a221
    v_mul_f32 v6, v6, v4
    v_accvgpr_write_b32 a221, v6
    v_accvgpr_read_b32 v7, a222
    v_mul_f32 v7, v7, v4
    v_accvgpr_write_b32 a222, v7
    v_accvgpr_read_b32 v8, a223
    v_mul_f32 v8, v8, v4
    v_accvgpr_write_b32 a223, v8
    v_accvgpr_read_b32 v5, a224
    v_mul_f32 v5, v5, v4
    v_accvgpr_write_b32 a224, v5
    v_accvgpr_read_b32 v6, a225
    v_mul_f32 v6, v6, v4
    v_accvgpr_write_b32 a225, v6
    v_accvgpr_read_b32 v7, a226
    v_mul_f32 v7, v7, v4
    v_accvgpr_write_b32 a226, v7
    v_accvgpr_read_b32 v8, a227
    v_mul_f32 v8, v8, v4
    v_accvgpr_write_b32 a227, v8
    v_accvgpr_read_b32 v5, a228
    v_mul_f32 v5, v5, v4
    v_accvgpr_write_b32 a228, v5
    v_accvgpr_read_b32 v6, a229
    v_mul_f32 v6, v6, v4
    v_accvgpr_write_b32 a229, v6
    v_accvgpr_read_b32 v7, a230
    v_mul_f32 v7, v7, v4
    v_accvgpr_write_b32 a230, v7
    v_accvgpr_read_b32 v8, a231
    v_mul_f32 v8, v8, v4
    v_accvgpr_write_b32 a231, v8
    v_accvgpr_read_b32 v5, a232
    v_mul_f32 v5, v5, v4
    v_accvgpr_write_b32 a232, v5
    v_accvgpr_read_b32 v6, a233
    v_mul_f32 v6, v6, v4
    v_accvgpr_write_b32 a233, v6
    v_accvgpr_read_b32 v7, a234
    v_mul_f32 v7, v7, v4
    v_accvgpr_write_b32 a234, v7
    v_accvgpr_read_b32 v8, a235
    v_mul_f32 v8, v8, v4
    v_accvgpr_write_b32 a235, v8
    v_accvgpr_read_b32 v5, a236
    v_mul_f32 v5, v5, v4
    v_accvgpr_write_b32 a236, v5
    v_accvgpr_read_b32 v6, a237
    v_mul_f32 v6, v6, v4
    v_accvgpr_write_b32 a237, v6
    v_accvgpr_read_b32 v7, a238
    v_mul_f32 v7, v7, v4
    v_accvgpr_write_b32 a238, v7
    v_accvgpr_read_b32 v8, a239
    v_mul_f32 v8, v8, v4
    v_accvgpr_write_b32 a239, v8
    v_accvgpr_read_b32 v5, a240
    v_mul_f32 v5, v5, v4
    v_accvgpr_write_b32 a240, v5
    v_accvgpr_read_b32 v6, a241
    v_mul_f32 v6, v6, v4
    v_accvgpr_write_b32 a241, v6
    v_accvgpr_read_b32 v7, a242
    v_mul_f32 v7, v7, v4
    v_accvgpr_write_b32 a242, v7
    v_accvgpr_read_b32 v8, a243
    v_mul_f32 v8, v8, v4
    v_accvgpr_write_b32 a243, v8
    v_accvgpr_read_b32 v5, a244
    v_mul_f32 v5, v5, v4
    v_accvgpr_write_b32 a244, v5
    v_accvgpr_read_b32 v6, a245
    v_mul_f32 v6, v6, v4
    v_accvgpr_write_b32 a245, v6
    v_accvgpr_read_b32 v7, a246
    v_mul_f32 v7, v7, v4
    v_accvgpr_write_b32 a246, v7
    v_accvgpr_read_b32 v8, a247
    v_mul_f32 v8, v8, v4
    v_accvgpr_write_b32 a247, v8
    v_accvgpr_read_b32 v5, a248
    v_mul_f32 v5, v5, v4
    v_accvgpr_write_b32 a248, v5
    v_accvgpr_read_b32 v6, a249
    v_mul_f32 v6, v6, v4
    v_accvgpr_write_b32 a249, v6
    v_accvgpr_read_b32 v7, a250
    v_mul_f32 v7, v7, v4
    v_accvgpr_write_b32 a250, v7
    v_accvgpr_read_b32 v8, a251
    v_mul_f32 v8, v8, v4
    v_accvgpr_write_b32 a251, v8
    v_accvgpr_read_b32 v5, a252
    v_mul_f32 v5, v5, v4
    v_accvgpr_write_b32 a252, v5
    v_accvgpr_read_b32 v6, a253
    v_mul_f32 v6, v6, v4
    v_accvgpr_write_b32 a253, v6
    v_accvgpr_read_b32 v7, a254
    v_mul_f32 v7, v7, v4
    v_accvgpr_write_b32 a254, v7
    v_accvgpr_read_b32 v8, a255
    v_mul_f32 v8, v8, v4
    v_accvgpr_write_b32 a255, v8
    s_nop 1
    s_branch LRB_14
LRS_21:
    v_max_f32 v3, v32, v2
    v_sub_f32 v4, v32, v3
    v_exp_f32 v4, v4
    v_mov_b32 v32, v3
    s_nop 0
    v_mul_f32 v33, v33, v4
    s_nop 15
    v_accvgpr_read_b32 v5, a0
    v_mul_f32 v5, v5, v4
    v_accvgpr_write_b32 a0, v5
    v_accvgpr_read_b32 v6, a1
    v_mul_f32 v6, v6, v4
    v_accvgpr_write_b32 a1, v6
    v_accvgpr_read_b32 v7, a2
    v_mul_f32 v7, v7, v4
    v_accvgpr_write_b32 a2, v7
    v_accvgpr_read_b32 v8, a3
    v_mul_f32 v8, v8, v4
    v_accvgpr_write_b32 a3, v8
    v_accvgpr_read_b32 v5, a4
    v_mul_f32 v5, v5, v4
    v_accvgpr_write_b32 a4, v5
    v_accvgpr_read_b32 v6, a5
    v_mul_f32 v6, v6, v4
    v_accvgpr_write_b32 a5, v6
    v_accvgpr_read_b32 v7, a6
    v_mul_f32 v7, v7, v4
    v_accvgpr_write_b32 a6, v7
    v_accvgpr_read_b32 v8, a7
    v_mul_f32 v8, v8, v4
    v_accvgpr_write_b32 a7, v8
    v_accvgpr_read_b32 v5, a8
    v_mul_f32 v5, v5, v4
    v_accvgpr_write_b32 a8, v5
    v_accvgpr_read_b32 v6, a9
    v_mul_f32 v6, v6, v4
    v_accvgpr_write_b32 a9, v6
    v_accvgpr_read_b32 v7, a10
    v_mul_f32 v7, v7, v4
    v_accvgpr_write_b32 a10, v7
    v_accvgpr_read_b32 v8, a11
    v_mul_f32 v8, v8, v4
    v_accvgpr_write_b32 a11, v8
    v_accvgpr_read_b32 v5, a12
    v_mul_f32 v5, v5, v4
    v_accvgpr_write_b32 a12, v5
    v_accvgpr_read_b32 v6, a13
    v_mul_f32 v6, v6, v4
    v_accvgpr_write_b32 a13, v6
    v_accvgpr_read_b32 v7, a14
    v_mul_f32 v7, v7, v4
    v_accvgpr_write_b32 a14, v7
    v_accvgpr_read_b32 v8, a15
    v_mul_f32 v8, v8, v4
    v_accvgpr_write_b32 a15, v8
    v_accvgpr_read_b32 v5, a16
    v_mul_f32 v5, v5, v4
    v_accvgpr_write_b32 a16, v5
    v_accvgpr_read_b32 v6, a17
    v_mul_f32 v6, v6, v4
    v_accvgpr_write_b32 a17, v6
    v_accvgpr_read_b32 v7, a18
    v_mul_f32 v7, v7, v4
    v_accvgpr_write_b32 a18, v7
    v_accvgpr_read_b32 v8, a19
    v_mul_f32 v8, v8, v4
    v_accvgpr_write_b32 a19, v8
    v_accvgpr_read_b32 v5, a20
    v_mul_f32 v5, v5, v4
    v_accvgpr_write_b32 a20, v5
    v_accvgpr_read_b32 v6, a21
    v_mul_f32 v6, v6, v4
    v_accvgpr_write_b32 a21, v6
    v_accvgpr_read_b32 v7, a22
    v_mul_f32 v7, v7, v4
    v_accvgpr_write_b32 a22, v7
    v_accvgpr_read_b32 v8, a23
    v_mul_f32 v8, v8, v4
    v_accvgpr_write_b32 a23, v8
    v_accvgpr_read_b32 v5, a24
    v_mul_f32 v5, v5, v4
    v_accvgpr_write_b32 a24, v5
    v_accvgpr_read_b32 v6, a25
    v_mul_f32 v6, v6, v4
    v_accvgpr_write_b32 a25, v6
    v_accvgpr_read_b32 v7, a26
    v_mul_f32 v7, v7, v4
    v_accvgpr_write_b32 a26, v7
    v_accvgpr_read_b32 v8, a27
    v_mul_f32 v8, v8, v4
    v_accvgpr_write_b32 a27, v8
    v_accvgpr_read_b32 v5, a28
    v_mul_f32 v5, v5, v4
    v_accvgpr_write_b32 a28, v5
    v_accvgpr_read_b32 v6, a29
    v_mul_f32 v6, v6, v4
    v_accvgpr_write_b32 a29, v6
    v_accvgpr_read_b32 v7, a30
    v_mul_f32 v7, v7, v4
    v_accvgpr_write_b32 a30, v7
    v_accvgpr_read_b32 v8, a31
    v_mul_f32 v8, v8, v4
    v_accvgpr_write_b32 a31, v8
    v_accvgpr_read_b32 v5, a32
    v_mul_f32 v5, v5, v4
    v_accvgpr_write_b32 a32, v5
    v_accvgpr_read_b32 v6, a33
    v_mul_f32 v6, v6, v4
    v_accvgpr_write_b32 a33, v6
    v_accvgpr_read_b32 v7, a34
    v_mul_f32 v7, v7, v4
    v_accvgpr_write_b32 a34, v7
    v_accvgpr_read_b32 v8, a35
    v_mul_f32 v8, v8, v4
    v_accvgpr_write_b32 a35, v8
    v_accvgpr_read_b32 v5, a36
    v_mul_f32 v5, v5, v4
    v_accvgpr_write_b32 a36, v5
    v_accvgpr_read_b32 v6, a37
    v_mul_f32 v6, v6, v4
    v_accvgpr_write_b32 a37, v6
    v_accvgpr_read_b32 v7, a38
    v_mul_f32 v7, v7, v4
    v_accvgpr_write_b32 a38, v7
    v_accvgpr_read_b32 v8, a39
    v_mul_f32 v8, v8, v4
    v_accvgpr_write_b32 a39, v8
    v_accvgpr_read_b32 v5, a40
    v_mul_f32 v5, v5, v4
    v_accvgpr_write_b32 a40, v5
    v_accvgpr_read_b32 v6, a41
    v_mul_f32 v6, v6, v4
    v_accvgpr_write_b32 a41, v6
    v_accvgpr_read_b32 v7, a42
    v_mul_f32 v7, v7, v4
    v_accvgpr_write_b32 a42, v7
    v_accvgpr_read_b32 v8, a43
    v_mul_f32 v8, v8, v4
    v_accvgpr_write_b32 a43, v8
    v_accvgpr_read_b32 v5, a44
    v_mul_f32 v5, v5, v4
    v_accvgpr_write_b32 a44, v5
    v_accvgpr_read_b32 v6, a45
    v_mul_f32 v6, v6, v4
    v_accvgpr_write_b32 a45, v6
    v_accvgpr_read_b32 v7, a46
    v_mul_f32 v7, v7, v4
    v_accvgpr_write_b32 a46, v7
    v_accvgpr_read_b32 v8, a47
    v_mul_f32 v8, v8, v4
    v_accvgpr_write_b32 a47, v8
    v_accvgpr_read_b32 v5, a48
    v_mul_f32 v5, v5, v4
    v_accvgpr_write_b32 a48, v5
    v_accvgpr_read_b32 v6, a49
    v_mul_f32 v6, v6, v4
    v_accvgpr_write_b32 a49, v6
    v_accvgpr_read_b32 v7, a50
    v_mul_f32 v7, v7, v4
    v_accvgpr_write_b32 a50, v7
    v_accvgpr_read_b32 v8, a51
    v_mul_f32 v8, v8, v4
    v_accvgpr_write_b32 a51, v8
    v_accvgpr_read_b32 v5, a52
    v_mul_f32 v5, v5, v4
    v_accvgpr_write_b32 a52, v5
    v_accvgpr_read_b32 v6, a53
    v_mul_f32 v6, v6, v4
    v_accvgpr_write_b32 a53, v6
    v_accvgpr_read_b32 v7, a54
    v_mul_f32 v7, v7, v4
    v_accvgpr_write_b32 a54, v7
    v_accvgpr_read_b32 v8, a55
    v_mul_f32 v8, v8, v4
    v_accvgpr_write_b32 a55, v8
    v_accvgpr_read_b32 v5, a56
    v_mul_f32 v5, v5, v4
    v_accvgpr_write_b32 a56, v5
    v_accvgpr_read_b32 v6, a57
    v_mul_f32 v6, v6, v4
    v_accvgpr_write_b32 a57, v6
    v_accvgpr_read_b32 v7, a58
    v_mul_f32 v7, v7, v4
    v_accvgpr_write_b32 a58, v7
    v_accvgpr_read_b32 v8, a59
    v_mul_f32 v8, v8, v4
    v_accvgpr_write_b32 a59, v8
    v_accvgpr_read_b32 v5, a60
    v_mul_f32 v5, v5, v4
    v_accvgpr_write_b32 a60, v5
    v_accvgpr_read_b32 v6, a61
    v_mul_f32 v6, v6, v4
    v_accvgpr_write_b32 a61, v6
    v_accvgpr_read_b32 v7, a62
    v_mul_f32 v7, v7, v4
    v_accvgpr_write_b32 a62, v7
    v_accvgpr_read_b32 v8, a63
    v_mul_f32 v8, v8, v4
    v_accvgpr_write_b32 a63, v8
    v_accvgpr_read_b32 v5, a64
    v_mul_f32 v5, v5, v4
    v_accvgpr_write_b32 a64, v5
    v_accvgpr_read_b32 v6, a65
    v_mul_f32 v6, v6, v4
    v_accvgpr_write_b32 a65, v6
    v_accvgpr_read_b32 v7, a66
    v_mul_f32 v7, v7, v4
    v_accvgpr_write_b32 a66, v7
    v_accvgpr_read_b32 v8, a67
    v_mul_f32 v8, v8, v4
    v_accvgpr_write_b32 a67, v8
    v_accvgpr_read_b32 v5, a68
    v_mul_f32 v5, v5, v4
    v_accvgpr_write_b32 a68, v5
    v_accvgpr_read_b32 v6, a69
    v_mul_f32 v6, v6, v4
    v_accvgpr_write_b32 a69, v6
    v_accvgpr_read_b32 v7, a70
    v_mul_f32 v7, v7, v4
    v_accvgpr_write_b32 a70, v7
    v_accvgpr_read_b32 v8, a71
    v_mul_f32 v8, v8, v4
    v_accvgpr_write_b32 a71, v8
    v_accvgpr_read_b32 v5, a72
    v_mul_f32 v5, v5, v4
    v_accvgpr_write_b32 a72, v5
    v_accvgpr_read_b32 v6, a73
    v_mul_f32 v6, v6, v4
    v_accvgpr_write_b32 a73, v6
    v_accvgpr_read_b32 v7, a74
    v_mul_f32 v7, v7, v4
    v_accvgpr_write_b32 a74, v7
    v_accvgpr_read_b32 v8, a75
    v_mul_f32 v8, v8, v4
    v_accvgpr_write_b32 a75, v8
    v_accvgpr_read_b32 v5, a76
    v_mul_f32 v5, v5, v4
    v_accvgpr_write_b32 a76, v5
    v_accvgpr_read_b32 v6, a77
    v_mul_f32 v6, v6, v4
    v_accvgpr_write_b32 a77, v6
    v_accvgpr_read_b32 v7, a78
    v_mul_f32 v7, v7, v4
    v_accvgpr_write_b32 a78, v7
    v_accvgpr_read_b32 v8, a79
    v_mul_f32 v8, v8, v4
    v_accvgpr_write_b32 a79, v8
    v_accvgpr_read_b32 v5, a80
    v_mul_f32 v5, v5, v4
    v_accvgpr_write_b32 a80, v5
    v_accvgpr_read_b32 v6, a81
    v_mul_f32 v6, v6, v4
    v_accvgpr_write_b32 a81, v6
    v_accvgpr_read_b32 v7, a82
    v_mul_f32 v7, v7, v4
    v_accvgpr_write_b32 a82, v7
    v_accvgpr_read_b32 v8, a83
    v_mul_f32 v8, v8, v4
    v_accvgpr_write_b32 a83, v8
    v_accvgpr_read_b32 v5, a84
    v_mul_f32 v5, v5, v4
    v_accvgpr_write_b32 a84, v5
    v_accvgpr_read_b32 v6, a85
    v_mul_f32 v6, v6, v4
    v_accvgpr_write_b32 a85, v6
    v_accvgpr_read_b32 v7, a86
    v_mul_f32 v7, v7, v4
    v_accvgpr_write_b32 a86, v7
    v_accvgpr_read_b32 v8, a87
    v_mul_f32 v8, v8, v4
    v_accvgpr_write_b32 a87, v8
    v_accvgpr_read_b32 v5, a88
    v_mul_f32 v5, v5, v4
    v_accvgpr_write_b32 a88, v5
    v_accvgpr_read_b32 v6, a89
    v_mul_f32 v6, v6, v4
    v_accvgpr_write_b32 a89, v6
    v_accvgpr_read_b32 v7, a90
    v_mul_f32 v7, v7, v4
    v_accvgpr_write_b32 a90, v7
    v_accvgpr_read_b32 v8, a91
    v_mul_f32 v8, v8, v4
    v_accvgpr_write_b32 a91, v8
    v_accvgpr_read_b32 v5, a92
    v_mul_f32 v5, v5, v4
    v_accvgpr_write_b32 a92, v5
    v_accvgpr_read_b32 v6, a93
    v_mul_f32 v6, v6, v4
    v_accvgpr_write_b32 a93, v6
    v_accvgpr_read_b32 v7, a94
    v_mul_f32 v7, v7, v4
    v_accvgpr_write_b32 a94, v7
    v_accvgpr_read_b32 v8, a95
    v_mul_f32 v8, v8, v4
    v_accvgpr_write_b32 a95, v8
    v_accvgpr_read_b32 v5, a96
    v_mul_f32 v5, v5, v4
    v_accvgpr_write_b32 a96, v5
    v_accvgpr_read_b32 v6, a97
    v_mul_f32 v6, v6, v4
    v_accvgpr_write_b32 a97, v6
    v_accvgpr_read_b32 v7, a98
    v_mul_f32 v7, v7, v4
    v_accvgpr_write_b32 a98, v7
    v_accvgpr_read_b32 v8, a99
    v_mul_f32 v8, v8, v4
    v_accvgpr_write_b32 a99, v8
    v_accvgpr_read_b32 v5, a100
    v_mul_f32 v5, v5, v4
    v_accvgpr_write_b32 a100, v5
    v_accvgpr_read_b32 v6, a101
    v_mul_f32 v6, v6, v4
    v_accvgpr_write_b32 a101, v6
    v_accvgpr_read_b32 v7, a102
    v_mul_f32 v7, v7, v4
    v_accvgpr_write_b32 a102, v7
    v_accvgpr_read_b32 v8, a103
    v_mul_f32 v8, v8, v4
    v_accvgpr_write_b32 a103, v8
    v_accvgpr_read_b32 v5, a104
    v_mul_f32 v5, v5, v4
    v_accvgpr_write_b32 a104, v5
    v_accvgpr_read_b32 v6, a105
    v_mul_f32 v6, v6, v4
    v_accvgpr_write_b32 a105, v6
    v_accvgpr_read_b32 v7, a106
    v_mul_f32 v7, v7, v4
    v_accvgpr_write_b32 a106, v7
    v_accvgpr_read_b32 v8, a107
    v_mul_f32 v8, v8, v4
    v_accvgpr_write_b32 a107, v8
    v_accvgpr_read_b32 v5, a108
    v_mul_f32 v5, v5, v4
    v_accvgpr_write_b32 a108, v5
    v_accvgpr_read_b32 v6, a109
    v_mul_f32 v6, v6, v4
    v_accvgpr_write_b32 a109, v6
    v_accvgpr_read_b32 v7, a110
    v_mul_f32 v7, v7, v4
    v_accvgpr_write_b32 a110, v7
    v_accvgpr_read_b32 v8, a111
    v_mul_f32 v8, v8, v4
    v_accvgpr_write_b32 a111, v8
    v_accvgpr_read_b32 v5, a112
    v_mul_f32 v5, v5, v4
    v_accvgpr_write_b32 a112, v5
    v_accvgpr_read_b32 v6, a113
    v_mul_f32 v6, v6, v4
    v_accvgpr_write_b32 a113, v6
    v_accvgpr_read_b32 v7, a114
    v_mul_f32 v7, v7, v4
    v_accvgpr_write_b32 a114, v7
    v_accvgpr_read_b32 v8, a115
    v_mul_f32 v8, v8, v4
    v_accvgpr_write_b32 a115, v8
    v_accvgpr_read_b32 v5, a116
    v_mul_f32 v5, v5, v4
    v_accvgpr_write_b32 a116, v5
    v_accvgpr_read_b32 v6, a117
    v_mul_f32 v6, v6, v4
    v_accvgpr_write_b32 a117, v6
    v_accvgpr_read_b32 v7, a118
    v_mul_f32 v7, v7, v4
    v_accvgpr_write_b32 a118, v7
    v_accvgpr_read_b32 v8, a119
    v_mul_f32 v8, v8, v4
    v_accvgpr_write_b32 a119, v8
    v_accvgpr_read_b32 v5, a120
    v_mul_f32 v5, v5, v4
    v_accvgpr_write_b32 a120, v5
    v_accvgpr_read_b32 v6, a121
    v_mul_f32 v6, v6, v4
    v_accvgpr_write_b32 a121, v6
    v_accvgpr_read_b32 v7, a122
    v_mul_f32 v7, v7, v4
    v_accvgpr_write_b32 a122, v7
    v_accvgpr_read_b32 v8, a123
    v_mul_f32 v8, v8, v4
    v_accvgpr_write_b32 a123, v8
    v_accvgpr_read_b32 v5, a124
    v_mul_f32 v5, v5, v4
    v_accvgpr_write_b32 a124, v5
    v_accvgpr_read_b32 v6, a125
    v_mul_f32 v6, v6, v4
    v_accvgpr_write_b32 a125, v6
    v_accvgpr_read_b32 v7, a126
    v_mul_f32 v7, v7, v4
    v_accvgpr_write_b32 a126, v7
    v_accvgpr_read_b32 v8, a127
    v_mul_f32 v8, v8, v4
    v_accvgpr_write_b32 a127, v8
    s_nop 1
    s_branch LRB_22
LRS_23:
    v_max_f32 v3, v32, v2
    v_sub_f32 v4, v32, v3
    v_exp_f32 v4, v4
    v_mov_b32 v32, v3
    s_nop 0
    v_mul_f32 v33, v33, v4
    s_nop 15
    v_accvgpr_read_b32 v5, a0
    v_mul_f32 v5, v5, v4
    v_accvgpr_write_b32 a0, v5
    v_accvgpr_read_b32 v6, a1
    v_mul_f32 v6, v6, v4
    v_accvgpr_write_b32 a1, v6
    v_accvgpr_read_b32 v7, a2
    v_mul_f32 v7, v7, v4
    v_accvgpr_write_b32 a2, v7
    v_accvgpr_read_b32 v8, a3
    v_mul_f32 v8, v8, v4
    v_accvgpr_write_b32 a3, v8
    v_accvgpr_read_b32 v5, a4
    v_mul_f32 v5, v5, v4
    v_accvgpr_write_b32 a4, v5
    v_accvgpr_read_b32 v6, a5
    v_mul_f32 v6, v6, v4
    v_accvgpr_write_b32 a5, v6
    v_accvgpr_read_b32 v7, a6
    v_mul_f32 v7, v7, v4
    v_accvgpr_write_b32 a6, v7
    v_accvgpr_read_b32 v8, a7
    v_mul_f32 v8, v8, v4
    v_accvgpr_write_b32 a7, v8
    v_accvgpr_read_b32 v5, a8
    v_mul_f32 v5, v5, v4
    v_accvgpr_write_b32 a8, v5
    v_accvgpr_read_b32 v6, a9
    v_mul_f32 v6, v6, v4
    v_accvgpr_write_b32 a9, v6
    v_accvgpr_read_b32 v7, a10
    v_mul_f32 v7, v7, v4
    v_accvgpr_write_b32 a10, v7
    v_accvgpr_read_b32 v8, a11
    v_mul_f32 v8, v8, v4
    v_accvgpr_write_b32 a11, v8
    v_accvgpr_read_b32 v5, a12
    v_mul_f32 v5, v5, v4
    v_accvgpr_write_b32 a12, v5
    v_accvgpr_read_b32 v6, a13
    v_mul_f32 v6, v6, v4
    v_accvgpr_write_b32 a13, v6
    v_accvgpr_read_b32 v7, a14
    v_mul_f32 v7, v7, v4
    v_accvgpr_write_b32 a14, v7
    v_accvgpr_read_b32 v8, a15
    v_mul_f32 v8, v8, v4
    v_accvgpr_write_b32 a15, v8
    v_accvgpr_read_b32 v5, a16
    v_mul_f32 v5, v5, v4
    v_accvgpr_write_b32 a16, v5
    v_accvgpr_read_b32 v6, a17
    v_mul_f32 v6, v6, v4
    v_accvgpr_write_b32 a17, v6
    v_accvgpr_read_b32 v7, a18
    v_mul_f32 v7, v7, v4
    v_accvgpr_write_b32 a18, v7
    v_accvgpr_read_b32 v8, a19
    v_mul_f32 v8, v8, v4
    v_accvgpr_write_b32 a19, v8
    v_accvgpr_read_b32 v5, a20
    v_mul_f32 v5, v5, v4
    v_accvgpr_write_b32 a20, v5
    v_accvgpr_read_b32 v6, a21
    v_mul_f32 v6, v6, v4
    v_accvgpr_write_b32 a21, v6
    v_accvgpr_read_b32 v7, a22
    v_mul_f32 v7, v7, v4
    v_accvgpr_write_b32 a22, v7
    v_accvgpr_read_b32 v8, a23
    v_mul_f32 v8, v8, v4
    v_accvgpr_write_b32 a23, v8
    v_accvgpr_read_b32 v5, a24
    v_mul_f32 v5, v5, v4
    v_accvgpr_write_b32 a24, v5
    v_accvgpr_read_b32 v6, a25
    v_mul_f32 v6, v6, v4
    v_accvgpr_write_b32 a25, v6
    v_accvgpr_read_b32 v7, a26
    v_mul_f32 v7, v7, v4
    v_accvgpr_write_b32 a26, v7
    v_accvgpr_read_b32 v8, a27
    v_mul_f32 v8, v8, v4
    v_accvgpr_write_b32 a27, v8
    v_accvgpr_read_b32 v5, a28
    v_mul_f32 v5, v5, v4
    v_accvgpr_write_b32 a28, v5
    v_accvgpr_read_b32 v6, a29
    v_mul_f32 v6, v6, v4
    v_accvgpr_write_b32 a29, v6
    v_accvgpr_read_b32 v7, a30
    v_mul_f32 v7, v7, v4
    v_accvgpr_write_b32 a30, v7
    v_accvgpr_read_b32 v8, a31
    v_mul_f32 v8, v8, v4
    v_accvgpr_write_b32 a31, v8
    v_accvgpr_read_b32 v5, a32
    v_mul_f32 v5, v5, v4
    v_accvgpr_write_b32 a32, v5
    v_accvgpr_read_b32 v6, a33
    v_mul_f32 v6, v6, v4
    v_accvgpr_write_b32 a33, v6
    v_accvgpr_read_b32 v7, a34
    v_mul_f32 v7, v7, v4
    v_accvgpr_write_b32 a34, v7
    v_accvgpr_read_b32 v8, a35
    v_mul_f32 v8, v8, v4
    v_accvgpr_write_b32 a35, v8
    v_accvgpr_read_b32 v5, a36
    v_mul_f32 v5, v5, v4
    v_accvgpr_write_b32 a36, v5
    v_accvgpr_read_b32 v6, a37
    v_mul_f32 v6, v6, v4
    v_accvgpr_write_b32 a37, v6
    v_accvgpr_read_b32 v7, a38
    v_mul_f32 v7, v7, v4
    v_accvgpr_write_b32 a38, v7
    v_accvgpr_read_b32 v8, a39
    v_mul_f32 v8, v8, v4
    v_accvgpr_write_b32 a39, v8
    v_accvgpr_read_b32 v5, a40
    v_mul_f32 v5, v5, v4
    v_accvgpr_write_b32 a40, v5
    v_accvgpr_read_b32 v6, a41
    v_mul_f32 v6, v6, v4
    v_accvgpr_write_b32 a41, v6
    v_accvgpr_read_b32 v7, a42
    v_mul_f32 v7, v7, v4
    v_accvgpr_write_b32 a42, v7
    v_accvgpr_read_b32 v8, a43
    v_mul_f32 v8, v8, v4
    v_accvgpr_write_b32 a43, v8
    v_accvgpr_read_b32 v5, a44
    v_mul_f32 v5, v5, v4
    v_accvgpr_write_b32 a44, v5
    v_accvgpr_read_b32 v6, a45
    v_mul_f32 v6, v6, v4
    v_accvgpr_write_b32 a45, v6
    v_accvgpr_read_b32 v7, a46
    v_mul_f32 v7, v7, v4
    v_accvgpr_write_b32 a46, v7
    v_accvgpr_read_b32 v8, a47
    v_mul_f32 v8, v8, v4
    v_accvgpr_write_b32 a47, v8
    v_accvgpr_read_b32 v5, a48
    v_mul_f32 v5, v5, v4
    v_accvgpr_write_b32 a48, v5
    v_accvgpr_read_b32 v6, a49
    v_mul_f32 v6, v6, v4
    v_accvgpr_write_b32 a49, v6
    v_accvgpr_read_b32 v7, a50
    v_mul_f32 v7, v7, v4
    v_accvgpr_write_b32 a50, v7
    v_accvgpr_read_b32 v8, a51
    v_mul_f32 v8, v8, v4
    v_accvgpr_write_b32 a51, v8
    v_accvgpr_read_b32 v5, a52
    v_mul_f32 v5, v5, v4
    v_accvgpr_write_b32 a52, v5
    v_accvgpr_read_b32 v6, a53
    v_mul_f32 v6, v6, v4
    v_accvgpr_write_b32 a53, v6
    v_accvgpr_read_b32 v7, a54
    v_mul_f32 v7, v7, v4
    v_accvgpr_write_b32 a54, v7
    v_accvgpr_read_b32 v8, a55
    v_mul_f32 v8, v8, v4
    v_accvgpr_write_b32 a55, v8
    v_accvgpr_read_b32 v5, a56
    v_mul_f32 v5, v5, v4
    v_accvgpr_write_b32 a56, v5
    v_accvgpr_read_b32 v6, a57
    v_mul_f32 v6, v6, v4
    v_accvgpr_write_b32 a57, v6
    v_accvgpr_read_b32 v7, a58
    v_mul_f32 v7, v7, v4
    v_accvgpr_write_b32 a58, v7
    v_accvgpr_read_b32 v8, a59
    v_mul_f32 v8, v8, v4
    v_accvgpr_write_b32 a59, v8
    v_accvgpr_read_b32 v5, a60
    v_mul_f32 v5, v5, v4
    v_accvgpr_write_b32 a60, v5
    v_accvgpr_read_b32 v6, a61
    v_mul_f32 v6, v6, v4
    v_accvgpr_write_b32 a61, v6
    v_accvgpr_read_b32 v7, a62
    v_mul_f32 v7, v7, v4
    v_accvgpr_write_b32 a62, v7
    v_accvgpr_read_b32 v8, a63
    v_mul_f32 v8, v8, v4
    v_accvgpr_write_b32 a63, v8
    v_accvgpr_read_b32 v5, a64
    v_mul_f32 v5, v5, v4
    v_accvgpr_write_b32 a64, v5
    v_accvgpr_read_b32 v6, a65
    v_mul_f32 v6, v6, v4
    v_accvgpr_write_b32 a65, v6
    v_accvgpr_read_b32 v7, a66
    v_mul_f32 v7, v7, v4
    v_accvgpr_write_b32 a66, v7
    v_accvgpr_read_b32 v8, a67
    v_mul_f32 v8, v8, v4
    v_accvgpr_write_b32 a67, v8
    v_accvgpr_read_b32 v5, a68
    v_mul_f32 v5, v5, v4
    v_accvgpr_write_b32 a68, v5
    v_accvgpr_read_b32 v6, a69
    v_mul_f32 v6, v6, v4
    v_accvgpr_write_b32 a69, v6
    v_accvgpr_read_b32 v7, a70
    v_mul_f32 v7, v7, v4
    v_accvgpr_write_b32 a70, v7
    v_accvgpr_read_b32 v8, a71
    v_mul_f32 v8, v8, v4
    v_accvgpr_write_b32 a71, v8
    v_accvgpr_read_b32 v5, a72
    v_mul_f32 v5, v5, v4
    v_accvgpr_write_b32 a72, v5
    v_accvgpr_read_b32 v6, a73
    v_mul_f32 v6, v6, v4
    v_accvgpr_write_b32 a73, v6
    v_accvgpr_read_b32 v7, a74
    v_mul_f32 v7, v7, v4
    v_accvgpr_write_b32 a74, v7
    v_accvgpr_read_b32 v8, a75
    v_mul_f32 v8, v8, v4
    v_accvgpr_write_b32 a75, v8
    v_accvgpr_read_b32 v5, a76
    v_mul_f32 v5, v5, v4
    v_accvgpr_write_b32 a76, v5
    v_accvgpr_read_b32 v6, a77
    v_mul_f32 v6, v6, v4
    v_accvgpr_write_b32 a77, v6
    v_accvgpr_read_b32 v7, a78
    v_mul_f32 v7, v7, v4
    v_accvgpr_write_b32 a78, v7
    v_accvgpr_read_b32 v8, a79
    v_mul_f32 v8, v8, v4
    v_accvgpr_write_b32 a79, v8
    v_accvgpr_read_b32 v5, a80
    v_mul_f32 v5, v5, v4
    v_accvgpr_write_b32 a80, v5
    v_accvgpr_read_b32 v6, a81
    v_mul_f32 v6, v6, v4
    v_accvgpr_write_b32 a81, v6
    v_accvgpr_read_b32 v7, a82
    v_mul_f32 v7, v7, v4
    v_accvgpr_write_b32 a82, v7
    v_accvgpr_read_b32 v8, a83
    v_mul_f32 v8, v8, v4
    v_accvgpr_write_b32 a83, v8
    v_accvgpr_read_b32 v5, a84
    v_mul_f32 v5, v5, v4
    v_accvgpr_write_b32 a84, v5
    v_accvgpr_read_b32 v6, a85
    v_mul_f32 v6, v6, v4
    v_accvgpr_write_b32 a85, v6
    v_accvgpr_read_b32 v7, a86
    v_mul_f32 v7, v7, v4
    v_accvgpr_write_b32 a86, v7
    v_accvgpr_read_b32 v8, a87
    v_mul_f32 v8, v8, v4
    v_accvgpr_write_b32 a87, v8
    v_accvgpr_read_b32 v5, a88
    v_mul_f32 v5, v5, v4
    v_accvgpr_write_b32 a88, v5
    v_accvgpr_read_b32 v6, a89
    v_mul_f32 v6, v6, v4
    v_accvgpr_write_b32 a89, v6
    v_accvgpr_read_b32 v7, a90
    v_mul_f32 v7, v7, v4
    v_accvgpr_write_b32 a90, v7
    v_accvgpr_read_b32 v8, a91
    v_mul_f32 v8, v8, v4
    v_accvgpr_write_b32 a91, v8
    v_accvgpr_read_b32 v5, a92
    v_mul_f32 v5, v5, v4
    v_accvgpr_write_b32 a92, v5
    v_accvgpr_read_b32 v6, a93
    v_mul_f32 v6, v6, v4
    v_accvgpr_write_b32 a93, v6
    v_accvgpr_read_b32 v7, a94
    v_mul_f32 v7, v7, v4
    v_accvgpr_write_b32 a94, v7
    v_accvgpr_read_b32 v8, a95
    v_mul_f32 v8, v8, v4
    v_accvgpr_write_b32 a95, v8
    v_accvgpr_read_b32 v5, a96
    v_mul_f32 v5, v5, v4
    v_accvgpr_write_b32 a96, v5
    v_accvgpr_read_b32 v6, a97
    v_mul_f32 v6, v6, v4
    v_accvgpr_write_b32 a97, v6
    v_accvgpr_read_b32 v7, a98
    v_mul_f32 v7, v7, v4
    v_accvgpr_write_b32 a98, v7
    v_accvgpr_read_b32 v8, a99
    v_mul_f32 v8, v8, v4
    v_accvgpr_write_b32 a99, v8
    v_accvgpr_read_b32 v5, a100
    v_mul_f32 v5, v5, v4
    v_accvgpr_write_b32 a100, v5
    v_accvgpr_read_b32 v6, a101
    v_mul_f32 v6, v6, v4
    v_accvgpr_write_b32 a101, v6
    v_accvgpr_read_b32 v7, a102
    v_mul_f32 v7, v7, v4
    v_accvgpr_write_b32 a102, v7
    v_accvgpr_read_b32 v8, a103
    v_mul_f32 v8, v8, v4
    v_accvgpr_write_b32 a103, v8
    v_accvgpr_read_b32 v5, a104
    v_mul_f32 v5, v5, v4
    v_accvgpr_write_b32 a104, v5
    v_accvgpr_read_b32 v6, a105
    v_mul_f32 v6, v6, v4
    v_accvgpr_write_b32 a105, v6
    v_accvgpr_read_b32 v7, a106
    v_mul_f32 v7, v7, v4
    v_accvgpr_write_b32 a106, v7
    v_accvgpr_read_b32 v8, a107
    v_mul_f32 v8, v8, v4
    v_accvgpr_write_b32 a107, v8
    v_accvgpr_read_b32 v5, a108
    v_mul_f32 v5, v5, v4
    v_accvgpr_write_b32 a108, v5
    v_accvgpr_read_b32 v6, a109
    v_mul_f32 v6, v6, v4
    v_accvgpr_write_b32 a109, v6
    v_accvgpr_read_b32 v7, a110
    v_mul_f32 v7, v7, v4
    v_accvgpr_write_b32 a110, v7
    v_accvgpr_read_b32 v8, a111
    v_mul_f32 v8, v8, v4
    v_accvgpr_write_b32 a111, v8
    v_accvgpr_read_b32 v5, a112
    v_mul_f32 v5, v5, v4
    v_accvgpr_write_b32 a112, v5
    v_accvgpr_read_b32 v6, a113
    v_mul_f32 v6, v6, v4
    v_accvgpr_write_b32 a113, v6
    v_accvgpr_read_b32 v7, a114
    v_mul_f32 v7, v7, v4
    v_accvgpr_write_b32 a114, v7
    v_accvgpr_read_b32 v8, a115
    v_mul_f32 v8, v8, v4
    v_accvgpr_write_b32 a115, v8
    v_accvgpr_read_b32 v5, a116
    v_mul_f32 v5, v5, v4
    v_accvgpr_write_b32 a116, v5
    v_accvgpr_read_b32 v6, a117
    v_mul_f32 v6, v6, v4
    v_accvgpr_write_b32 a117, v6
    v_accvgpr_read_b32 v7, a118
    v_mul_f32 v7, v7, v4
    v_accvgpr_write_b32 a118, v7
    v_accvgpr_read_b32 v8, a119
    v_mul_f32 v8, v8, v4
    v_accvgpr_write_b32 a119, v8
    v_accvgpr_read_b32 v5, a120
    v_mul_f32 v5, v5, v4
    v_accvgpr_write_b32 a120, v5
    v_accvgpr_read_b32 v6, a121
    v_mul_f32 v6, v6, v4
    v_accvgpr_write_b32 a121, v6
    v_accvgpr_read_b32 v7, a122
    v_mul_f32 v7, v7, v4
    v_accvgpr_write_b32 a122, v7
    v_accvgpr_read_b32 v8, a123
    v_mul_f32 v8, v8, v4
    v_accvgpr_write_b32 a123, v8
    v_accvgpr_read_b32 v5, a124
    v_mul_f32 v5, v5, v4
    v_accvgpr_write_b32 a124, v5
    v_accvgpr_read_b32 v6, a125
    v_mul_f32 v6, v6, v4
    v_accvgpr_write_b32 a125, v6
    v_accvgpr_read_b32 v7, a126
    v_mul_f32 v7, v7, v4
    v_accvgpr_write_b32 a126, v7
    v_accvgpr_read_b32 v8, a127
    v_mul_f32 v8, v8, v4
    v_accvgpr_write_b32 a127, v8
    s_nop 1
    s_branch LRB_24
LRS_25:
    v_max_f32 v3, v32, v2
    v_sub_f32 v4, v32, v3
    v_exp_f32 v4, v4
    v_mov_b32 v32, v3
    s_nop 0
    v_mul_f32 v33, v33, v4
    s_nop 15
    v_accvgpr_read_b32 v5, a0
    v_mul_f32 v5, v5, v4
    v_accvgpr_write_b32 a0, v5
    v_accvgpr_read_b32 v6, a1
    v_mul_f32 v6, v6, v4
    v_accvgpr_write_b32 a1, v6
    v_accvgpr_read_b32 v7, a2
    v_mul_f32 v7, v7, v4
    v_accvgpr_write_b32 a2, v7
    v_accvgpr_read_b32 v8, a3
    v_mul_f32 v8, v8, v4
    v_accvgpr_write_b32 a3, v8
    v_accvgpr_read_b32 v5, a4
    v_mul_f32 v5, v5, v4
    v_accvgpr_write_b32 a4, v5
    v_accvgpr_read_b32 v6, a5
    v_mul_f32 v6, v6, v4
    v_accvgpr_write_b32 a5, v6
    v_accvgpr_read_b32 v7, a6
    v_mul_f32 v7, v7, v4
    v_accvgpr_write_b32 a6, v7
    v_accvgpr_read_b32 v8, a7
    v_mul_f32 v8, v8, v4
    v_accvgpr_write_b32 a7, v8
    v_accvgpr_read_b32 v5, a8
    v_mul_f32 v5, v5, v4
    v_accvgpr_write_b32 a8, v5
    v_accvgpr_read_b32 v6, a9
    v_mul_f32 v6, v6, v4
    v_accvgpr_write_b32 a9, v6
    v_accvgpr_read_b32 v7, a10
    v_mul_f32 v7, v7, v4
    v_accvgpr_write_b32 a10, v7
    v_accvgpr_read_b32 v8, a11
    v_mul_f32 v8, v8, v4
    v_accvgpr_write_b32 a11, v8
    v_accvgpr_read_b32 v5, a12
    v_mul_f32 v5, v5, v4
    v_accvgpr_write_b32 a12, v5
    v_accvgpr_read_b32 v6, a13
    v_mul_f32 v6, v6, v4
    v_accvgpr_write_b32 a13, v6
    v_accvgpr_read_b32 v7, a14
    v_mul_f32 v7, v7, v4
    v_accvgpr_write_b32 a14, v7
    v_accvgpr_read_b32 v8, a15
    v_mul_f32 v8, v8, v4
    v_accvgpr_write_b32 a15, v8
    v_accvgpr_read_b32 v5, a16
    v_mul_f32 v5, v5, v4
    v_accvgpr_write_b32 a16, v5
    v_accvgpr_read_b32 v6, a17
    v_mul_f32 v6, v6, v4
    v_accvgpr_write_b32 a17, v6
    v_accvgpr_read_b32 v7, a18
    v_mul_f32 v7, v7, v4
    v_accvgpr_write_b32 a18, v7
    v_accvgpr_read_b32 v8, a19
    v_mul_f32 v8, v8, v4
    v_accvgpr_write_b32 a19, v8
    v_accvgpr_read_b32 v5, a20
    v_mul_f32 v5, v5, v4
    v_accvgpr_write_b32 a20, v5
    v_accvgpr_read_b32 v6, a21
    v_mul_f32 v6, v6, v4
    v_accvgpr_write_b32 a21, v6
    v_accvgpr_read_b32 v7, a22
    v_mul_f32 v7, v7, v4
    v_accvgpr_write_b32 a22, v7
    v_accvgpr_read_b32 v8, a23
    v_mul_f32 v8, v8, v4
    v_accvgpr_write_b32 a23, v8
    v_accvgpr_read_b32 v5, a24
    v_mul_f32 v5, v5, v4
    v_accvgpr_write_b32 a24, v5
    v_accvgpr_read_b32 v6, a25
    v_mul_f32 v6, v6, v4
    v_accvgpr_write_b32 a25, v6
    v_accvgpr_read_b32 v7, a26
    v_mul_f32 v7, v7, v4
    v_accvgpr_write_b32 a26, v7
    v_accvgpr_read_b32 v8, a27
    v_mul_f32 v8, v8, v4
    v_accvgpr_write_b32 a27, v8
    v_accvgpr_read_b32 v5, a28
    v_mul_f32 v5, v5, v4
    v_accvgpr_write_b32 a28, v5
    v_accvgpr_read_b32 v6, a29
    v_mul_f32 v6, v6, v4
    v_accvgpr_write_b32 a29, v6
    v_accvgpr_read_b32 v7, a30
    v_mul_f32 v7, v7, v4
    v_accvgpr_write_b32 a30, v7
    v_accvgpr_read_b32 v8, a31
    v_mul_f32 v8, v8, v4
    v_accvgpr_write_b32 a31, v8
    v_accvgpr_read_b32 v5, a32
    v_mul_f32 v5, v5, v4
    v_accvgpr_write_b32 a32, v5
    v_accvgpr_read_b32 v6, a33
    v_mul_f32 v6, v6, v4
    v_accvgpr_write_b32 a33, v6
    v_accvgpr_read_b32 v7, a34
    v_mul_f32 v7, v7, v4
    v_accvgpr_write_b32 a34, v7
    v_accvgpr_read_b32 v8, a35
    v_mul_f32 v8, v8, v4
    v_accvgpr_write_b32 a35, v8
    v_accvgpr_read_b32 v5, a36
    v_mul_f32 v5, v5, v4
    v_accvgpr_write_b32 a36, v5
    v_accvgpr_read_b32 v6, a37
    v_mul_f32 v6, v6, v4
    v_accvgpr_write_b32 a37, v6
    v_accvgpr_read_b32 v7, a38
    v_mul_f32 v7, v7, v4
    v_accvgpr_write_b32 a38, v7
    v_accvgpr_read_b32 v8, a39
    v_mul_f32 v8, v8, v4
    v_accvgpr_write_b32 a39, v8
    v_accvgpr_read_b32 v5, a40
    v_mul_f32 v5, v5, v4
    v_accvgpr_write_b32 a40, v5
    v_accvgpr_read_b32 v6, a41
    v_mul_f32 v6, v6, v4
    v_accvgpr_write_b32 a41, v6
    v_accvgpr_read_b32 v7, a42
    v_mul_f32 v7, v7, v4
    v_accvgpr_write_b32 a42, v7
    v_accvgpr_read_b32 v8, a43
    v_mul_f32 v8, v8, v4
    v_accvgpr_write_b32 a43, v8
    v_accvgpr_read_b32 v5, a44
    v_mul_f32 v5, v5, v4
    v_accvgpr_write_b32 a44, v5
    v_accvgpr_read_b32 v6, a45
    v_mul_f32 v6, v6, v4
    v_accvgpr_write_b32 a45, v6
    v_accvgpr_read_b32 v7, a46
    v_mul_f32 v7, v7, v4
    v_accvgpr_write_b32 a46, v7
    v_accvgpr_read_b32 v8, a47
    v_mul_f32 v8, v8, v4
    v_accvgpr_write_b32 a47, v8
    v_accvgpr_read_b32 v5, a48
    v_mul_f32 v5, v5, v4
    v_accvgpr_write_b32 a48, v5
    v_accvgpr_read_b32 v6, a49
    v_mul_f32 v6, v6, v4
    v_accvgpr_write_b32 a49, v6
    v_accvgpr_read_b32 v7, a50
    v_mul_f32 v7, v7, v4
    v_accvgpr_write_b32 a50, v7
    v_accvgpr_read_b32 v8, a51
    v_mul_f32 v8, v8, v4
    v_accvgpr_write_b32 a51, v8
    v_accvgpr_read_b32 v5, a52
    v_mul_f32 v5, v5, v4
    v_accvgpr_write_b32 a52, v5
    v_accvgpr_read_b32 v6, a53
    v_mul_f32 v6, v6, v4
    v_accvgpr_write_b32 a53, v6
    v_accvgpr_read_b32 v7, a54
    v_mul_f32 v7, v7, v4
    v_accvgpr_write_b32 a54, v7
    v_accvgpr_read_b32 v8, a55
    v_mul_f32 v8, v8, v4
    v_accvgpr_write_b32 a55, v8
    v_accvgpr_read_b32 v5, a56
    v_mul_f32 v5, v5, v4
    v_accvgpr_write_b32 a56, v5
    v_accvgpr_read_b32 v6, a57
    v_mul_f32 v6, v6, v4
    v_accvgpr_write_b32 a57, v6
    v_accvgpr_read_b32 v7, a58
    v_mul_f32 v7, v7, v4
    v_accvgpr_write_b32 a58, v7
    v_accvgpr_read_b32 v8, a59
    v_mul_f32 v8, v8, v4
    v_accvgpr_write_b32 a59, v8
    v_accvgpr_read_b32 v5, a60
    v_mul_f32 v5, v5, v4
    v_accvgpr_write_b32 a60, v5
    v_accvgpr_read_b32 v6, a61
    v_mul_f32 v6, v6, v4
    v_accvgpr_write_b32 a61, v6
    v_accvgpr_read_b32 v7, a62
    v_mul_f32 v7, v7, v4
    v_accvgpr_write_b32 a62, v7
    v_accvgpr_read_b32 v8, a63
    v_mul_f32 v8, v8, v4
    v_accvgpr_write_b32 a63, v8
    v_accvgpr_read_b32 v5, a64
    v_mul_f32 v5, v5, v4
    v_accvgpr_write_b32 a64, v5
    v_accvgpr_read_b32 v6, a65
    v_mul_f32 v6, v6, v4
    v_accvgpr_write_b32 a65, v6
    v_accvgpr_read_b32 v7, a66
    v_mul_f32 v7, v7, v4
    v_accvgpr_write_b32 a66, v7
    v_accvgpr_read_b32 v8, a67
    v_mul_f32 v8, v8, v4
    v_accvgpr_write_b32 a67, v8
    v_accvgpr_read_b32 v5, a68
    v_mul_f32 v5, v5, v4
    v_accvgpr_write_b32 a68, v5
    v_accvgpr_read_b32 v6, a69
    v_mul_f32 v6, v6, v4
    v_accvgpr_write_b32 a69, v6
    v_accvgpr_read_b32 v7, a70
    v_mul_f32 v7, v7, v4
    v_accvgpr_write_b32 a70, v7
    v_accvgpr_read_b32 v8, a71
    v_mul_f32 v8, v8, v4
    v_accvgpr_write_b32 a71, v8
    v_accvgpr_read_b32 v5, a72
    v_mul_f32 v5, v5, v4
    v_accvgpr_write_b32 a72, v5
    v_accvgpr_read_b32 v6, a73
    v_mul_f32 v6, v6, v4
    v_accvgpr_write_b32 a73, v6
    v_accvgpr_read_b32 v7, a74
    v_mul_f32 v7, v7, v4
    v_accvgpr_write_b32 a74, v7
    v_accvgpr_read_b32 v8, a75
    v_mul_f32 v8, v8, v4
    v_accvgpr_write_b32 a75, v8
    v_accvgpr_read_b32 v5, a76
    v_mul_f32 v5, v5, v4
    v_accvgpr_write_b32 a76, v5
    v_accvgpr_read_b32 v6, a77
    v_mul_f32 v6, v6, v4
    v_accvgpr_write_b32 a77, v6
    v_accvgpr_read_b32 v7, a78
    v_mul_f32 v7, v7, v4
    v_accvgpr_write_b32 a78, v7
    v_accvgpr_read_b32 v8, a79
    v_mul_f32 v8, v8, v4
    v_accvgpr_write_b32 a79, v8
    v_accvgpr_read_b32 v5, a80
    v_mul_f32 v5, v5, v4
    v_accvgpr_write_b32 a80, v5
    v_accvgpr_read_b32 v6, a81
    v_mul_f32 v6, v6, v4
    v_accvgpr_write_b32 a81, v6
    v_accvgpr_read_b32 v7, a82
    v_mul_f32 v7, v7, v4
    v_accvgpr_write_b32 a82, v7
    v_accvgpr_read_b32 v8, a83
    v_mul_f32 v8, v8, v4
    v_accvgpr_write_b32 a83, v8
    v_accvgpr_read_b32 v5, a84
    v_mul_f32 v5, v5, v4
    v_accvgpr_write_b32 a84, v5
    v_accvgpr_read_b32 v6, a85
    v_mul_f32 v6, v6, v4
    v_accvgpr_write_b32 a85, v6
    v_accvgpr_read_b32 v7, a86
    v_mul_f32 v7, v7, v4
    v_accvgpr_write_b32 a86, v7
    v_accvgpr_read_b32 v8, a87
    v_mul_f32 v8, v8, v4
    v_accvgpr_write_b32 a87, v8
    v_accvgpr_read_b32 v5, a88
    v_mul_f32 v5, v5, v4
    v_accvgpr_write_b32 a88, v5
    v_accvgpr_read_b32 v6, a89
    v_mul_f32 v6, v6, v4
    v_accvgpr_write_b32 a89, v6
    v_accvgpr_read_b32 v7, a90
    v_mul_f32 v7, v7, v4
    v_accvgpr_write_b32 a90, v7
    v_accvgpr_read_b32 v8, a91
    v_mul_f32 v8, v8, v4
    v_accvgpr_write_b32 a91, v8
    v_accvgpr_read_b32 v5, a92
    v_mul_f32 v5, v5, v4
    v_accvgpr_write_b32 a92, v5
    v_accvgpr_read_b32 v6, a93
    v_mul_f32 v6, v6, v4
    v_accvgpr_write_b32 a93, v6
    v_accvgpr_read_b32 v7, a94
    v_mul_f32 v7, v7, v4
    v_accvgpr_write_b32 a94, v7
    v_accvgpr_read_b32 v8, a95
    v_mul_f32 v8, v8, v4
    v_accvgpr_write_b32 a95, v8
    v_accvgpr_read_b32 v5, a96
    v_mul_f32 v5, v5, v4
    v_accvgpr_write_b32 a96, v5
    v_accvgpr_read_b32 v6, a97
    v_mul_f32 v6, v6, v4
    v_accvgpr_write_b32 a97, v6
    v_accvgpr_read_b32 v7, a98
    v_mul_f32 v7, v7, v4
    v_accvgpr_write_b32 a98, v7
    v_accvgpr_read_b32 v8, a99
    v_mul_f32 v8, v8, v4
    v_accvgpr_write_b32 a99, v8
    v_accvgpr_read_b32 v5, a100
    v_mul_f32 v5, v5, v4
    v_accvgpr_write_b32 a100, v5
    v_accvgpr_read_b32 v6, a101
    v_mul_f32 v6, v6, v4
    v_accvgpr_write_b32 a101, v6
    v_accvgpr_read_b32 v7, a102
    v_mul_f32 v7, v7, v4
    v_accvgpr_write_b32 a102, v7
    v_accvgpr_read_b32 v8, a103
    v_mul_f32 v8, v8, v4
    v_accvgpr_write_b32 a103, v8
    v_accvgpr_read_b32 v5, a104
    v_mul_f32 v5, v5, v4
    v_accvgpr_write_b32 a104, v5
    v_accvgpr_read_b32 v6, a105
    v_mul_f32 v6, v6, v4
    v_accvgpr_write_b32 a105, v6
    v_accvgpr_read_b32 v7, a106
    v_mul_f32 v7, v7, v4
    v_accvgpr_write_b32 a106, v7
    v_accvgpr_read_b32 v8, a107
    v_mul_f32 v8, v8, v4
    v_accvgpr_write_b32 a107, v8
    v_accvgpr_read_b32 v5, a108
    v_mul_f32 v5, v5, v4
    v_accvgpr_write_b32 a108, v5
    v_accvgpr_read_b32 v6, a109
    v_mul_f32 v6, v6, v4
    v_accvgpr_write_b32 a109, v6
    v_accvgpr_read_b32 v7, a110
    v_mul_f32 v7, v7, v4
    v_accvgpr_write_b32 a110, v7
    v_accvgpr_read_b32 v8, a111
    v_mul_f32 v8, v8, v4
    v_accvgpr_write_b32 a111, v8
    v_accvgpr_read_b32 v5, a112
    v_mul_f32 v5, v5, v4
    v_accvgpr_write_b32 a112, v5
    v_accvgpr_read_b32 v6, a113
    v_mul_f32 v6, v6, v4
    v_accvgpr_write_b32 a113, v6
    v_accvgpr_read_b32 v7, a114
    v_mul_f32 v7, v7, v4
    v_accvgpr_write_b32 a114, v7
    v_accvgpr_read_b32 v8, a115
    v_mul_f32 v8, v8, v4
    v_accvgpr_write_b32 a115, v8
    v_accvgpr_read_b32 v5, a116
    v_mul_f32 v5, v5, v4
    v_accvgpr_write_b32 a116, v5
    v_accvgpr_read_b32 v6, a117
    v_mul_f32 v6, v6, v4
    v_accvgpr_write_b32 a117, v6
    v_accvgpr_read_b32 v7, a118
    v_mul_f32 v7, v7, v4
    v_accvgpr_write_b32 a118, v7
    v_accvgpr_read_b32 v8, a119
    v_mul_f32 v8, v8, v4
    v_accvgpr_write_b32 a119, v8
    v_accvgpr_read_b32 v5, a120
    v_mul_f32 v5, v5, v4
    v_accvgpr_write_b32 a120, v5
    v_accvgpr_read_b32 v6, a121
    v_mul_f32 v6, v6, v4
    v_accvgpr_write_b32 a121, v6
    v_accvgpr_read_b32 v7, a122
    v_mul_f32 v7, v7, v4
    v_accvgpr_write_b32 a122, v7
    v_accvgpr_read_b32 v8, a123
    v_mul_f32 v8, v8, v4
    v_accvgpr_write_b32 a123, v8
    v_accvgpr_read_b32 v5, a124
    v_mul_f32 v5, v5, v4
    v_accvgpr_write_b32 a124, v5
    v_accvgpr_read_b32 v6, a125
    v_mul_f32 v6, v6, v4
    v_accvgpr_write_b32 a125, v6
    v_accvgpr_read_b32 v7, a126
    v_mul_f32 v7, v7, v4
    v_accvgpr_write_b32 a126, v7
    v_accvgpr_read_b32 v8, a127
    v_mul_f32 v8, v8, v4
    v_accvgpr_write_b32 a127, v8
    s_nop 1
    s_branch LRB_26
LRS_27:
    v_max_f32 v3, v34, v2
    v_sub_f32 v4, v34, v3
    v_exp_f32 v4, v4
    v_mov_b32 v34, v3
    s_nop 0
    v_mul_f32 v35, v35, v4
    s_nop 15
    v_accvgpr_read_b32 v5, a128
    v_mul_f32 v5, v5, v4
    v_accvgpr_write_b32 a128, v5
    v_accvgpr_read_b32 v6, a129
    v_mul_f32 v6, v6, v4
    v_accvgpr_write_b32 a129, v6
    v_accvgpr_read_b32 v7, a130
    v_mul_f32 v7, v7, v4
    v_accvgpr_write_b32 a130, v7
    v_accvgpr_read_b32 v8, a131
    v_mul_f32 v8, v8, v4
    v_accvgpr_write_b32 a131, v8
    v_accvgpr_read_b32 v5, a132
    v_mul_f32 v5, v5, v4
    v_accvgpr_write_b32 a132, v5
    v_accvgpr_read_b32 v6, a133
    v_mul_f32 v6, v6, v4
    v_accvgpr_write_b32 a133, v6
    v_accvgpr_read_b32 v7, a134
    v_mul_f32 v7, v7, v4
    v_accvgpr_write_b32 a134, v7
    v_accvgpr_read_b32 v8, a135
    v_mul_f32 v8, v8, v4
    v_accvgpr_write_b32 a135, v8
    v_accvgpr_read_b32 v5, a136
    v_mul_f32 v5, v5, v4
    v_accvgpr_write_b32 a136, v5
    v_accvgpr_read_b32 v6, a137
    v_mul_f32 v6, v6, v4
    v_accvgpr_write_b32 a137, v6
    v_accvgpr_read_b32 v7, a138
    v_mul_f32 v7, v7, v4
    v_accvgpr_write_b32 a138, v7
    v_accvgpr_read_b32 v8, a139
    v_mul_f32 v8, v8, v4
    v_accvgpr_write_b32 a139, v8
    v_accvgpr_read_b32 v5, a140
    v_mul_f32 v5, v5, v4
    v_accvgpr_write_b32 a140, v5
    v_accvgpr_read_b32 v6, a141
    v_mul_f32 v6, v6, v4
    v_accvgpr_write_b32 a141, v6
    v_accvgpr_read_b32 v7, a142
    v_mul_f32 v7, v7, v4
    v_accvgpr_write_b32 a142, v7
    v_accvgpr_read_b32 v8, a143
    v_mul_f32 v8, v8, v4
    v_accvgpr_write_b32 a143, v8
    v_accvgpr_read_b32 v5, a144
    v_mul_f32 v5, v5, v4
    v_accvgpr_write_b32 a144, v5
    v_accvgpr_read_b32 v6, a145
    v_mul_f32 v6, v6, v4
    v_accvgpr_write_b32 a145, v6
    v_accvgpr_read_b32 v7, a146
    v_mul_f32 v7, v7, v4
    v_accvgpr_write_b32 a146, v7
    v_accvgpr_read_b32 v8, a147
    v_mul_f32 v8, v8, v4
    v_accvgpr_write_b32 a147, v8
    v_accvgpr_read_b32 v5, a148
    v_mul_f32 v5, v5, v4
    v_accvgpr_write_b32 a148, v5
    v_accvgpr_read_b32 v6, a149
    v_mul_f32 v6, v6, v4
    v_accvgpr_write_b32 a149, v6
    v_accvgpr_read_b32 v7, a150
    v_mul_f32 v7, v7, v4
    v_accvgpr_write_b32 a150, v7
    v_accvgpr_read_b32 v8, a151
    v_mul_f32 v8, v8, v4
    v_accvgpr_write_b32 a151, v8
    v_accvgpr_read_b32 v5, a152
    v_mul_f32 v5, v5, v4
    v_accvgpr_write_b32 a152, v5
    v_accvgpr_read_b32 v6, a153
    v_mul_f32 v6, v6, v4
    v_accvgpr_write_b32 a153, v6
    v_accvgpr_read_b32 v7, a154
    v_mul_f32 v7, v7, v4
    v_accvgpr_write_b32 a154, v7
    v_accvgpr_read_b32 v8, a155
    v_mul_f32 v8, v8, v4
    v_accvgpr_write_b32 a155, v8
    v_accvgpr_read_b32 v5, a156
    v_mul_f32 v5, v5, v4
    v_accvgpr_write_b32 a156, v5
    v_accvgpr_read_b32 v6, a157
    v_mul_f32 v6, v6, v4
    v_accvgpr_write_b32 a157, v6
    v_accvgpr_read_b32 v7, a158
    v_mul_f32 v7, v7, v4
    v_accvgpr_write_b32 a158, v7
    v_accvgpr_read_b32 v8, a159
    v_mul_f32 v8, v8, v4
    v_accvgpr_write_b32 a159, v8
    v_accvgpr_read_b32 v5, a160
    v_mul_f32 v5, v5, v4
    v_accvgpr_write_b32 a160, v5
    v_accvgpr_read_b32 v6, a161
    v_mul_f32 v6, v6, v4
    v_accvgpr_write_b32 a161, v6
    v_accvgpr_read_b32 v7, a162
    v_mul_f32 v7, v7, v4
    v_accvgpr_write_b32 a162, v7
    v_accvgpr_read_b32 v8, a163
    v_mul_f32 v8, v8, v4
    v_accvgpr_write_b32 a163, v8
    v_accvgpr_read_b32 v5, a164
    v_mul_f32 v5, v5, v4
    v_accvgpr_write_b32 a164, v5
    v_accvgpr_read_b32 v6, a165
    v_mul_f32 v6, v6, v4
    v_accvgpr_write_b32 a165, v6
    v_accvgpr_read_b32 v7, a166
    v_mul_f32 v7, v7, v4
    v_accvgpr_write_b32 a166, v7
    v_accvgpr_read_b32 v8, a167
    v_mul_f32 v8, v8, v4
    v_accvgpr_write_b32 a167, v8
    v_accvgpr_read_b32 v5, a168
    v_mul_f32 v5, v5, v4
    v_accvgpr_write_b32 a168, v5
    v_accvgpr_read_b32 v6, a169
    v_mul_f32 v6, v6, v4
    v_accvgpr_write_b32 a169, v6
    v_accvgpr_read_b32 v7, a170
    v_mul_f32 v7, v7, v4
    v_accvgpr_write_b32 a170, v7
    v_accvgpr_read_b32 v8, a171
    v_mul_f32 v8, v8, v4
    v_accvgpr_write_b32 a171, v8
    v_accvgpr_read_b32 v5, a172
    v_mul_f32 v5, v5, v4
    v_accvgpr_write_b32 a172, v5
    v_accvgpr_read_b32 v6, a173
    v_mul_f32 v6, v6, v4
    v_accvgpr_write_b32 a173, v6
    v_accvgpr_read_b32 v7, a174
    v_mul_f32 v7, v7, v4
    v_accvgpr_write_b32 a174, v7
    v_accvgpr_read_b32 v8, a175
    v_mul_f32 v8, v8, v4
    v_accvgpr_write_b32 a175, v8
    v_accvgpr_read_b32 v5, a176
    v_mul_f32 v5, v5, v4
    v_accvgpr_write_b32 a176, v5
    v_accvgpr_read_b32 v6, a177
    v_mul_f32 v6, v6, v4
    v_accvgpr_write_b32 a177, v6
    v_accvgpr_read_b32 v7, a178
    v_mul_f32 v7, v7, v4
    v_accvgpr_write_b32 a178, v7
    v_accvgpr_read_b32 v8, a179
    v_mul_f32 v8, v8, v4
    v_accvgpr_write_b32 a179, v8
    v_accvgpr_read_b32 v5, a180
    v_mul_f32 v5, v5, v4
    v_accvgpr_write_b32 a180, v5
    v_accvgpr_read_b32 v6, a181
    v_mul_f32 v6, v6, v4
    v_accvgpr_write_b32 a181, v6
    v_accvgpr_read_b32 v7, a182
    v_mul_f32 v7, v7, v4
    v_accvgpr_write_b32 a182, v7
    v_accvgpr_read_b32 v8, a183
    v_mul_f32 v8, v8, v4
    v_accvgpr_write_b32 a183, v8
    v_accvgpr_read_b32 v5, a184
    v_mul_f32 v5, v5, v4
    v_accvgpr_write_b32 a184, v5
    v_accvgpr_read_b32 v6, a185
    v_mul_f32 v6, v6, v4
    v_accvgpr_write_b32 a185, v6
    v_accvgpr_read_b32 v7, a186
    v_mul_f32 v7, v7, v4
    v_accvgpr_write_b32 a186, v7
    v_accvgpr_read_b32 v8, a187
    v_mul_f32 v8, v8, v4
    v_accvgpr_write_b32 a187, v8
    v_accvgpr_read_b32 v5, a188
    v_mul_f32 v5, v5, v4
    v_accvgpr_write_b32 a188, v5
    v_accvgpr_read_b32 v6, a189
    v_mul_f32 v6, v6, v4
    v_accvgpr_write_b32 a189, v6
    v_accvgpr_read_b32 v7, a190
    v_mul_f32 v7, v7, v4
    v_accvgpr_write_b32 a190, v7
    v_accvgpr_read_b32 v8, a191
    v_mul_f32 v8, v8, v4
    v_accvgpr_write_b32 a191, v8
    v_accvgpr_read_b32 v5, a192
    v_mul_f32 v5, v5, v4
    v_accvgpr_write_b32 a192, v5
    v_accvgpr_read_b32 v6, a193
    v_mul_f32 v6, v6, v4
    v_accvgpr_write_b32 a193, v6
    v_accvgpr_read_b32 v7, a194
    v_mul_f32 v7, v7, v4
    v_accvgpr_write_b32 a194, v7
    v_accvgpr_read_b32 v8, a195
    v_mul_f32 v8, v8, v4
    v_accvgpr_write_b32 a195, v8
    v_accvgpr_read_b32 v5, a196
    v_mul_f32 v5, v5, v4
    v_accvgpr_write_b32 a196, v5
    v_accvgpr_read_b32 v6, a197
    v_mul_f32 v6, v6, v4
    v_accvgpr_write_b32 a197, v6
    v_accvgpr_read_b32 v7, a198
    v_mul_f32 v7, v7, v4
    v_accvgpr_write_b32 a198, v7
    v_accvgpr_read_b32 v8, a199
    v_mul_f32 v8, v8, v4
    v_accvgpr_write_b32 a199, v8
    v_accvgpr_read_b32 v5, a200
    v_mul_f32 v5, v5, v4
    v_accvgpr_write_b32 a200, v5
    v_accvgpr_read_b32 v6, a201
    v_mul_f32 v6, v6, v4
    v_accvgpr_write_b32 a201, v6
    v_accvgpr_read_b32 v7, a202
    v_mul_f32 v7, v7, v4
    v_accvgpr_write_b32 a202, v7
    v_accvgpr_read_b32 v8, a203
    v_mul_f32 v8, v8, v4
    v_accvgpr_write_b32 a203, v8
    v_accvgpr_read_b32 v5, a204
    v_mul_f32 v5, v5, v4
    v_accvgpr_write_b32 a204, v5
    v_accvgpr_read_b32 v6, a205
    v_mul_f32 v6, v6, v4
    v_accvgpr_write_b32 a205, v6
    v_accvgpr_read_b32 v7, a206
    v_mul_f32 v7, v7, v4
    v_accvgpr_write_b32 a206, v7
    v_accvgpr_read_b32 v8, a207
    v_mul_f32 v8, v8, v4
    v_accvgpr_write_b32 a207, v8
    v_accvgpr_read_b32 v5, a208
    v_mul_f32 v5, v5, v4
    v_accvgpr_write_b32 a208, v5
    v_accvgpr_read_b32 v6, a209
    v_mul_f32 v6, v6, v4
    v_accvgpr_write_b32 a209, v6
    v_accvgpr_read_b32 v7, a210
    v_mul_f32 v7, v7, v4
    v_accvgpr_write_b32 a210, v7
    v_accvgpr_read_b32 v8, a211
    v_mul_f32 v8, v8, v4
    v_accvgpr_write_b32 a211, v8
    v_accvgpr_read_b32 v5, a212
    v_mul_f32 v5, v5, v4
    v_accvgpr_write_b32 a212, v5
    v_accvgpr_read_b32 v6, a213
    v_mul_f32 v6, v6, v4
    v_accvgpr_write_b32 a213, v6
    v_accvgpr_read_b32 v7, a214
    v_mul_f32 v7, v7, v4
    v_accvgpr_write_b32 a214, v7
    v_accvgpr_read_b32 v8, a215
    v_mul_f32 v8, v8, v4
    v_accvgpr_write_b32 a215, v8
    v_accvgpr_read_b32 v5, a216
    v_mul_f32 v5, v5, v4
    v_accvgpr_write_b32 a216, v5
    v_accvgpr_read_b32 v6, a217
    v_mul_f32 v6, v6, v4
    v_accvgpr_write_b32 a217, v6
    v_accvgpr_read_b32 v7, a218
    v_mul_f32 v7, v7, v4
    v_accvgpr_write_b32 a218, v7
    v_accvgpr_read_b32 v8, a219
    v_mul_f32 v8, v8, v4
    v_accvgpr_write_b32 a219, v8
    v_accvgpr_read_b32 v5, a220
    v_mul_f32 v5, v5, v4
    v_accvgpr_write_b32 a220, v5
    v_accvgpr_read_b32 v6, a221
    v_mul_f32 v6, v6, v4
    v_accvgpr_write_b32 a221, v6
    v_accvgpr_read_b32 v7, a222
    v_mul_f32 v7, v7, v4
    v_accvgpr_write_b32 a222, v7
    v_accvgpr_read_b32 v8, a223
    v_mul_f32 v8, v8, v4
    v_accvgpr_write_b32 a223, v8
    v_accvgpr_read_b32 v5, a224
    v_mul_f32 v5, v5, v4
    v_accvgpr_write_b32 a224, v5
    v_accvgpr_read_b32 v6, a225
    v_mul_f32 v6, v6, v4
    v_accvgpr_write_b32 a225, v6
    v_accvgpr_read_b32 v7, a226
    v_mul_f32 v7, v7, v4
    v_accvgpr_write_b32 a226, v7
    v_accvgpr_read_b32 v8, a227
    v_mul_f32 v8, v8, v4
    v_accvgpr_write_b32 a227, v8
    v_accvgpr_read_b32 v5, a228
    v_mul_f32 v5, v5, v4
    v_accvgpr_write_b32 a228, v5
    v_accvgpr_read_b32 v6, a229
    v_mul_f32 v6, v6, v4
    v_accvgpr_write_b32 a229, v6
    v_accvgpr_read_b32 v7, a230
    v_mul_f32 v7, v7, v4
    v_accvgpr_write_b32 a230, v7
    v_accvgpr_read_b32 v8, a231
    v_mul_f32 v8, v8, v4
    v_accvgpr_write_b32 a231, v8
    v_accvgpr_read_b32 v5, a232
    v_mul_f32 v5, v5, v4
    v_accvgpr_write_b32 a232, v5
    v_accvgpr_read_b32 v6, a233
    v_mul_f32 v6, v6, v4
    v_accvgpr_write_b32 a233, v6
    v_accvgpr_read_b32 v7, a234
    v_mul_f32 v7, v7, v4
    v_accvgpr_write_b32 a234, v7
    v_accvgpr_read_b32 v8, a235
    v_mul_f32 v8, v8, v4
    v_accvgpr_write_b32 a235, v8
    v_accvgpr_read_b32 v5, a236
    v_mul_f32 v5, v5, v4
    v_accvgpr_write_b32 a236, v5
    v_accvgpr_read_b32 v6, a237
    v_mul_f32 v6, v6, v4
    v_accvgpr_write_b32 a237, v6
    v_accvgpr_read_b32 v7, a238
    v_mul_f32 v7, v7, v4
    v_accvgpr_write_b32 a238, v7
    v_accvgpr_read_b32 v8, a239
    v_mul_f32 v8, v8, v4
    v_accvgpr_write_b32 a239, v8
    v_accvgpr_read_b32 v5, a240
    v_mul_f32 v5, v5, v4
    v_accvgpr_write_b32 a240, v5
    v_accvgpr_read_b32 v6, a241
    v_mul_f32 v6, v6, v4
    v_accvgpr_write_b32 a241, v6
    v_accvgpr_read_b32 v7, a242
    v_mul_f32 v7, v7, v4
    v_accvgpr_write_b32 a242, v7
    v_accvgpr_read_b32 v8, a243
    v_mul_f32 v8, v8, v4
    v_accvgpr_write_b32 a243, v8
    v_accvgpr_read_b32 v5, a244
    v_mul_f32 v5, v5, v4
    v_accvgpr_write_b32 a244, v5
    v_accvgpr_read_b32 v6, a245
    v_mul_f32 v6, v6, v4
    v_accvgpr_write_b32 a245, v6
    v_accvgpr_read_b32 v7, a246
    v_mul_f32 v7, v7, v4
    v_accvgpr_write_b32 a246, v7
    v_accvgpr_read_b32 v8, a247
    v_mul_f32 v8, v8, v4
    v_accvgpr_write_b32 a247, v8
    v_accvgpr_read_b32 v5, a248
    v_mul_f32 v5, v5, v4
    v_accvgpr_write_b32 a248, v5
    v_accvgpr_read_b32 v6, a249
    v_mul_f32 v6, v6, v4
    v_accvgpr_write_b32 a249, v6
    v_accvgpr_read_b32 v7, a250
    v_mul_f32 v7, v7, v4
    v_accvgpr_write_b32 a250, v7
    v_accvgpr_read_b32 v8, a251
    v_mul_f32 v8, v8, v4
    v_accvgpr_write_b32 a251, v8
    v_accvgpr_read_b32 v5, a252
    v_mul_f32 v5, v5, v4
    v_accvgpr_write_b32 a252, v5
    v_accvgpr_read_b32 v6, a253
    v_mul_f32 v6, v6, v4
    v_accvgpr_write_b32 a253, v6
    v_accvgpr_read_b32 v7, a254
    v_mul_f32 v7, v7, v4
    v_accvgpr_write_b32 a254, v7
    v_accvgpr_read_b32 v8, a255
    v_mul_f32 v8, v8, v4
    v_accvgpr_write_b32 a255, v8
    s_nop 1
    s_branch LRB_28
LRS_35:
    v_max_f32 v3, v32, v2
    v_sub_f32 v4, v32, v3
    v_exp_f32 v4, v4
    v_mov_b32 v32, v3
    s_nop 0
    v_mul_f32 v33, v33, v4
    s_nop 15
    v_accvgpr_read_b32 v5, a0
    v_mul_f32 v5, v5, v4
    v_accvgpr_write_b32 a0, v5
    v_accvgpr_read_b32 v6, a1
    v_mul_f32 v6, v6, v4
    v_accvgpr_write_b32 a1, v6
    v_accvgpr_read_b32 v7, a2
    v_mul_f32 v7, v7, v4
    v_accvgpr_write_b32 a2, v7
    v_accvgpr_read_b32 v8, a3
    v_mul_f32 v8, v8, v4
    v_accvgpr_write_b32 a3, v8
    v_accvgpr_read_b32 v5, a4
    v_mul_f32 v5, v5, v4
    v_accvgpr_write_b32 a4, v5
    v_accvgpr_read_b32 v6, a5
    v_mul_f32 v6, v6, v4
    v_accvgpr_write_b32 a5, v6
    v_accvgpr_read_b32 v7, a6
    v_mul_f32 v7, v7, v4
    v_accvgpr_write_b32 a6, v7
    v_accvgpr_read_b32 v8, a7
    v_mul_f32 v8, v8, v4
    v_accvgpr_write_b32 a7, v8
    v_accvgpr_read_b32 v5, a8
    v_mul_f32 v5, v5, v4
    v_accvgpr_write_b32 a8, v5
    v_accvgpr_read_b32 v6, a9
    v_mul_f32 v6, v6, v4
    v_accvgpr_write_b32 a9, v6
    v_accvgpr_read_b32 v7, a10
    v_mul_f32 v7, v7, v4
    v_accvgpr_write_b32 a10, v7
    v_accvgpr_read_b32 v8, a11
    v_mul_f32 v8, v8, v4
    v_accvgpr_write_b32 a11, v8
    v_accvgpr_read_b32 v5, a12
    v_mul_f32 v5, v5, v4
    v_accvgpr_write_b32 a12, v5
    v_accvgpr_read_b32 v6, a13
    v_mul_f32 v6, v6, v4
    v_accvgpr_write_b32 a13, v6
    v_accvgpr_read_b32 v7, a14
    v_mul_f32 v7, v7, v4
    v_accvgpr_write_b32 a14, v7
    v_accvgpr_read_b32 v8, a15
    v_mul_f32 v8, v8, v4
    v_accvgpr_write_b32 a15, v8
    v_accvgpr_read_b32 v5, a16
    v_mul_f32 v5, v5, v4
    v_accvgpr_write_b32 a16, v5
    v_accvgpr_read_b32 v6, a17
    v_mul_f32 v6, v6, v4
    v_accvgpr_write_b32 a17, v6
    v_accvgpr_read_b32 v7, a18
    v_mul_f32 v7, v7, v4
    v_accvgpr_write_b32 a18, v7
    v_accvgpr_read_b32 v8, a19
    v_mul_f32 v8, v8, v4
    v_accvgpr_write_b32 a19, v8
    v_accvgpr_read_b32 v5, a20
    v_mul_f32 v5, v5, v4
    v_accvgpr_write_b32 a20, v5
    v_accvgpr_read_b32 v6, a21
    v_mul_f32 v6, v6, v4
    v_accvgpr_write_b32 a21, v6
    v_accvgpr_read_b32 v7, a22
    v_mul_f32 v7, v7, v4
    v_accvgpr_write_b32 a22, v7
    v_accvgpr_read_b32 v8, a23
    v_mul_f32 v8, v8, v4
    v_accvgpr_write_b32 a23, v8
    v_accvgpr_read_b32 v5, a24
    v_mul_f32 v5, v5, v4
    v_accvgpr_write_b32 a24, v5
    v_accvgpr_read_b32 v6, a25
    v_mul_f32 v6, v6, v4
    v_accvgpr_write_b32 a25, v6
    v_accvgpr_read_b32 v7, a26
    v_mul_f32 v7, v7, v4
    v_accvgpr_write_b32 a26, v7
    v_accvgpr_read_b32 v8, a27
    v_mul_f32 v8, v8, v4
    v_accvgpr_write_b32 a27, v8
    v_accvgpr_read_b32 v5, a28
    v_mul_f32 v5, v5, v4
    v_accvgpr_write_b32 a28, v5
    v_accvgpr_read_b32 v6, a29
    v_mul_f32 v6, v6, v4
    v_accvgpr_write_b32 a29, v6
    v_accvgpr_read_b32 v7, a30
    v_mul_f32 v7, v7, v4
    v_accvgpr_write_b32 a30, v7
    v_accvgpr_read_b32 v8, a31
    v_mul_f32 v8, v8, v4
    v_accvgpr_write_b32 a31, v8
    v_accvgpr_read_b32 v5, a32
    v_mul_f32 v5, v5, v4
    v_accvgpr_write_b32 a32, v5
    v_accvgpr_read_b32 v6, a33
    v_mul_f32 v6, v6, v4
    v_accvgpr_write_b32 a33, v6
    v_accvgpr_read_b32 v7, a34
    v_mul_f32 v7, v7, v4
    v_accvgpr_write_b32 a34, v7
    v_accvgpr_read_b32 v8, a35
    v_mul_f32 v8, v8, v4
    v_accvgpr_write_b32 a35, v8
    v_accvgpr_read_b32 v5, a36
    v_mul_f32 v5, v5, v4
    v_accvgpr_write_b32 a36, v5
    v_accvgpr_read_b32 v6, a37
    v_mul_f32 v6, v6, v4
    v_accvgpr_write_b32 a37, v6
    v_accvgpr_read_b32 v7, a38
    v_mul_f32 v7, v7, v4
    v_accvgpr_write_b32 a38, v7
    v_accvgpr_read_b32 v8, a39
    v_mul_f32 v8, v8, v4
    v_accvgpr_write_b32 a39, v8
    v_accvgpr_read_b32 v5, a40
    v_mul_f32 v5, v5, v4
    v_accvgpr_write_b32 a40, v5
    v_accvgpr_read_b32 v6, a41
    v_mul_f32 v6, v6, v4
    v_accvgpr_write_b32 a41, v6
    v_accvgpr_read_b32 v7, a42
    v_mul_f32 v7, v7, v4
    v_accvgpr_write_b32 a42, v7
    v_accvgpr_read_b32 v8, a43
    v_mul_f32 v8, v8, v4
    v_accvgpr_write_b32 a43, v8
    v_accvgpr_read_b32 v5, a44
    v_mul_f32 v5, v5, v4
    v_accvgpr_write_b32 a44, v5
    v_accvgpr_read_b32 v6, a45
    v_mul_f32 v6, v6, v4
    v_accvgpr_write_b32 a45, v6
    v_accvgpr_read_b32 v7, a46
    v_mul_f32 v7, v7, v4
    v_accvgpr_write_b32 a46, v7
    v_accvgpr_read_b32 v8, a47
    v_mul_f32 v8, v8, v4
    v_accvgpr_write_b32 a47, v8
    v_accvgpr_read_b32 v5, a48
    v_mul_f32 v5, v5, v4
    v_accvgpr_write_b32 a48, v5
    v_accvgpr_read_b32 v6, a49
    v_mul_f32 v6, v6, v4
    v_accvgpr_write_b32 a49, v6
    v_accvgpr_read_b32 v7, a50
    v_mul_f32 v7, v7, v4
    v_accvgpr_write_b32 a50, v7
    v_accvgpr_read_b32 v8, a51
    v_mul_f32 v8, v8, v4
    v_accvgpr_write_b32 a51, v8
    v_accvgpr_read_b32 v5, a52
    v_mul_f32 v5, v5, v4
    v_accvgpr_write_b32 a52, v5
    v_accvgpr_read_b32 v6, a53
    v_mul_f32 v6, v6, v4
    v_accvgpr_write_b32 a53, v6
    v_accvgpr_read_b32 v7, a54
    v_mul_f32 v7, v7, v4
    v_accvgpr_write_b32 a54, v7
    v_accvgpr_read_b32 v8, a55
    v_mul_f32 v8, v8, v4
    v_accvgpr_write_b32 a55, v8
    v_accvgpr_read_b32 v5, a56
    v_mul_f32 v5, v5, v4
    v_accvgpr_write_b32 a56, v5
    v_accvgpr_read_b32 v6, a57
    v_mul_f32 v6, v6, v4
    v_accvgpr_write_b32 a57, v6
    v_accvgpr_read_b32 v7, a58
    v_mul_f32 v7, v7, v4
    v_accvgpr_write_b32 a58, v7
    v_accvgpr_read_b32 v8, a59
    v_mul_f32 v8, v8, v4
    v_accvgpr_write_b32 a59, v8
    v_accvgpr_read_b32 v5, a60
    v_mul_f32 v5, v5, v4
    v_accvgpr_write_b32 a60, v5
    v_accvgpr_read_b32 v6, a61
    v_mul_f32 v6, v6, v4
    v_accvgpr_write_b32 a61, v6
    v_accvgpr_read_b32 v7, a62
    v_mul_f32 v7, v7, v4
    v_accvgpr_write_b32 a62, v7
    v_accvgpr_read_b32 v8, a63
    v_mul_f32 v8, v8, v4
    v_accvgpr_write_b32 a63, v8
    v_accvgpr_read_b32 v5, a64
    v_mul_f32 v5, v5, v4
    v_accvgpr_write_b32 a64, v5
    v_accvgpr_read_b32 v6, a65
    v_mul_f32 v6, v6, v4
    v_accvgpr_write_b32 a65, v6
    v_accvgpr_read_b32 v7, a66
    v_mul_f32 v7, v7, v4
    v_accvgpr_write_b32 a66, v7
    v_accvgpr_read_b32 v8, a67
    v_mul_f32 v8, v8, v4
    v_accvgpr_write_b32 a67, v8
    v_accvgpr_read_b32 v5, a68
    v_mul_f32 v5, v5, v4
    v_accvgpr_write_b32 a68, v5
    v_accvgpr_read_b32 v6, a69
    v_mul_f32 v6, v6, v4
    v_accvgpr_write_b32 a69, v6
    v_accvgpr_read_b32 v7, a70
    v_mul_f32 v7, v7, v4
    v_accvgpr_write_b32 a70, v7
    v_accvgpr_read_b32 v8, a71
    v_mul_f32 v8, v8, v4
    v_accvgpr_write_b32 a71, v8
    v_accvgpr_read_b32 v5, a72
    v_mul_f32 v5, v5, v4
    v_accvgpr_write_b32 a72, v5
    v_accvgpr_read_b32 v6, a73
    v_mul_f32 v6, v6, v4
    v_accvgpr_write_b32 a73, v6
    v_accvgpr_read_b32 v7, a74
    v_mul_f32 v7, v7, v4
    v_accvgpr_write_b32 a74, v7
    v_accvgpr_read_b32 v8, a75
    v_mul_f32 v8, v8, v4
    v_accvgpr_write_b32 a75, v8
    v_accvgpr_read_b32 v5, a76
    v_mul_f32 v5, v5, v4
    v_accvgpr_write_b32 a76, v5
    v_accvgpr_read_b32 v6, a77
    v_mul_f32 v6, v6, v4
    v_accvgpr_write_b32 a77, v6
    v_accvgpr_read_b32 v7, a78
    v_mul_f32 v7, v7, v4
    v_accvgpr_write_b32 a78, v7
    v_accvgpr_read_b32 v8, a79
    v_mul_f32 v8, v8, v4
    v_accvgpr_write_b32 a79, v8
    v_accvgpr_read_b32 v5, a80
    v_mul_f32 v5, v5, v4
    v_accvgpr_write_b32 a80, v5
    v_accvgpr_read_b32 v6, a81
    v_mul_f32 v6, v6, v4
    v_accvgpr_write_b32 a81, v6
    v_accvgpr_read_b32 v7, a82
    v_mul_f32 v7, v7, v4
    v_accvgpr_write_b32 a82, v7
    v_accvgpr_read_b32 v8, a83
    v_mul_f32 v8, v8, v4
    v_accvgpr_write_b32 a83, v8
    v_accvgpr_read_b32 v5, a84
    v_mul_f32 v5, v5, v4
    v_accvgpr_write_b32 a84, v5
    v_accvgpr_read_b32 v6, a85
    v_mul_f32 v6, v6, v4
    v_accvgpr_write_b32 a85, v6
    v_accvgpr_read_b32 v7, a86
    v_mul_f32 v7, v7, v4
    v_accvgpr_write_b32 a86, v7
    v_accvgpr_read_b32 v8, a87
    v_mul_f32 v8, v8, v4
    v_accvgpr_write_b32 a87, v8
    v_accvgpr_read_b32 v5, a88
    v_mul_f32 v5, v5, v4
    v_accvgpr_write_b32 a88, v5
    v_accvgpr_read_b32 v6, a89
    v_mul_f32 v6, v6, v4
    v_accvgpr_write_b32 a89, v6
    v_accvgpr_read_b32 v7, a90
    v_mul_f32 v7, v7, v4
    v_accvgpr_write_b32 a90, v7
    v_accvgpr_read_b32 v8, a91
    v_mul_f32 v8, v8, v4
    v_accvgpr_write_b32 a91, v8
    v_accvgpr_read_b32 v5, a92
    v_mul_f32 v5, v5, v4
    v_accvgpr_write_b32 a92, v5
    v_accvgpr_read_b32 v6, a93
    v_mul_f32 v6, v6, v4
    v_accvgpr_write_b32 a93, v6
    v_accvgpr_read_b32 v7, a94
    v_mul_f32 v7, v7, v4
    v_accvgpr_write_b32 a94, v7
    v_accvgpr_read_b32 v8, a95
    v_mul_f32 v8, v8, v4
    v_accvgpr_write_b32 a95, v8
    v_accvgpr_read_b32 v5, a96
    v_mul_f32 v5, v5, v4
    v_accvgpr_write_b32 a96, v5
    v_accvgpr_read_b32 v6, a97
    v_mul_f32 v6, v6, v4
    v_accvgpr_write_b32 a97, v6
    v_accvgpr_read_b32 v7, a98
    v_mul_f32 v7, v7, v4
    v_accvgpr_write_b32 a98, v7
    v_accvgpr_read_b32 v8, a99
    v_mul_f32 v8, v8, v4
    v_accvgpr_write_b32 a99, v8
    v_accvgpr_read_b32 v5, a100
    v_mul_f32 v5, v5, v4
    v_accvgpr_write_b32 a100, v5
    v_accvgpr_read_b32 v6, a101
    v_mul_f32 v6, v6, v4
    v_accvgpr_write_b32 a101, v6
    v_accvgpr_read_b32 v7, a102
    v_mul_f32 v7, v7, v4
    v_accvgpr_write_b32 a102, v7
    v_accvgpr_read_b32 v8, a103
    v_mul_f32 v8, v8, v4
    v_accvgpr_write_b32 a103, v8
    v_accvgpr_read_b32 v5, a104
    v_mul_f32 v5, v5, v4
    v_accvgpr_write_b32 a104, v5
    v_accvgpr_read_b32 v6, a105
    v_mul_f32 v6, v6, v4
    v_accvgpr_write_b32 a105, v6
    v_accvgpr_read_b32 v7, a106
    v_mul_f32 v7, v7, v4
    v_accvgpr_write_b32 a106, v7
    v_accvgpr_read_b32 v8, a107
    v_mul_f32 v8, v8, v4
    v_accvgpr_write_b32 a107, v8
    v_accvgpr_read_b32 v5, a108
    v_mul_f32 v5, v5, v4
    v_accvgpr_write_b32 a108, v5
    v_accvgpr_read_b32 v6, a109
    v_mul_f32 v6, v6, v4
    v_accvgpr_write_b32 a109, v6
    v_accvgpr_read_b32 v7, a110
    v_mul_f32 v7, v7, v4
    v_accvgpr_write_b32 a110, v7
    v_accvgpr_read_b32 v8, a111
    v_mul_f32 v8, v8, v4
    v_accvgpr_write_b32 a111, v8
    v_accvgpr_read_b32 v5, a112
    v_mul_f32 v5, v5, v4
    v_accvgpr_write_b32 a112, v5
    v_accvgpr_read_b32 v6, a113
    v_mul_f32 v6, v6, v4
    v_accvgpr_write_b32 a113, v6
    v_accvgpr_read_b32 v7, a114
    v_mul_f32 v7, v7, v4
    v_accvgpr_write_b32 a114, v7
    v_accvgpr_read_b32 v8, a115
    v_mul_f32 v8, v8, v4
    v_accvgpr_write_b32 a115, v8
    v_accvgpr_read_b32 v5, a116
    v_mul_f32 v5, v5, v4
    v_accvgpr_write_b32 a116, v5
    v_accvgpr_read_b32 v6, a117
    v_mul_f32 v6, v6, v4
    v_accvgpr_write_b32 a117, v6
    v_accvgpr_read_b32 v7, a118
    v_mul_f32 v7, v7, v4
    v_accvgpr_write_b32 a118, v7
    v_accvgpr_read_b32 v8, a119
    v_mul_f32 v8, v8, v4
    v_accvgpr_write_b32 a119, v8
    v_accvgpr_read_b32 v5, a120
    v_mul_f32 v5, v5, v4
    v_accvgpr_write_b32 a120, v5
    v_accvgpr_read_b32 v6, a121
    v_mul_f32 v6, v6, v4
    v_accvgpr_write_b32 a121, v6
    v_accvgpr_read_b32 v7, a122
    v_mul_f32 v7, v7, v4
    v_accvgpr_write_b32 a122, v7
    v_accvgpr_read_b32 v8, a123
    v_mul_f32 v8, v8, v4
    v_accvgpr_write_b32 a123, v8
    v_accvgpr_read_b32 v5, a124
    v_mul_f32 v5, v5, v4
    v_accvgpr_write_b32 a124, v5
    v_accvgpr_read_b32 v6, a125
    v_mul_f32 v6, v6, v4
    v_accvgpr_write_b32 a125, v6
    v_accvgpr_read_b32 v7, a126
    v_mul_f32 v7, v7, v4
    v_accvgpr_write_b32 a126, v7
    v_accvgpr_read_b32 v8, a127
    v_mul_f32 v8, v8, v4
    v_accvgpr_write_b32 a127, v8
    s_nop 1
    s_branch LRB_36
LRS_37:
    v_max_f32 v3, v32, v2
    v_sub_f32 v4, v32, v3
    v_exp_f32 v4, v4
    v_mov_b32 v32, v3
    s_nop 0
    v_mul_f32 v33, v33, v4
    s_nop 15
    v_accvgpr_read_b32 v5, a0
    v_mul_f32 v5, v5, v4
    v_accvgpr_write_b32 a0, v5
    v_accvgpr_read_b32 v6, a1
    v_mul_f32 v6, v6, v4
    v_accvgpr_write_b32 a1, v6
    v_accvgpr_read_b32 v7, a2
    v_mul_f32 v7, v7, v4
    v_accvgpr_write_b32 a2, v7
    v_accvgpr_read_b32 v8, a3
    v_mul_f32 v8, v8, v4
    v_accvgpr_write_b32 a3, v8
    v_accvgpr_read_b32 v5, a4
    v_mul_f32 v5, v5, v4
    v_accvgpr_write_b32 a4, v5
    v_accvgpr_read_b32 v6, a5
    v_mul_f32 v6, v6, v4
    v_accvgpr_write_b32 a5, v6
    v_accvgpr_read_b32 v7, a6
    v_mul_f32 v7, v7, v4
    v_accvgpr_write_b32 a6, v7
    v_accvgpr_read_b32 v8, a7
    v_mul_f32 v8, v8, v4
    v_accvgpr_write_b32 a7, v8
    v_accvgpr_read_b32 v5, a8
    v_mul_f32 v5, v5, v4
    v_accvgpr_write_b32 a8, v5
    v_accvgpr_read_b32 v6, a9
    v_mul_f32 v6, v6, v4
    v_accvgpr_write_b32 a9, v6
    v_accvgpr_read_b32 v7, a10
    v_mul_f32 v7, v7, v4
    v_accvgpr_write_b32 a10, v7
    v_accvgpr_read_b32 v8, a11
    v_mul_f32 v8, v8, v4
    v_accvgpr_write_b32 a11, v8
    v_accvgpr_read_b32 v5, a12
    v_mul_f32 v5, v5, v4
    v_accvgpr_write_b32 a12, v5
    v_accvgpr_read_b32 v6, a13
    v_mul_f32 v6, v6, v4
    v_accvgpr_write_b32 a13, v6
    v_accvgpr_read_b32 v7, a14
    v_mul_f32 v7, v7, v4
    v_accvgpr_write_b32 a14, v7
    v_accvgpr_read_b32 v8, a15
    v_mul_f32 v8, v8, v4
    v_accvgpr_write_b32 a15, v8
    v_accvgpr_read_b32 v5, a16
    v_mul_f32 v5, v5, v4
    v_accvgpr_write_b32 a16, v5
    v_accvgpr_read_b32 v6, a17
    v_mul_f32 v6, v6, v4
    v_accvgpr_write_b32 a17, v6
    v_accvgpr_read_b32 v7, a18
    v_mul_f32 v7, v7, v4
    v_accvgpr_write_b32 a18, v7
    v_accvgpr_read_b32 v8, a19
    v_mul_f32 v8, v8, v4
    v_accvgpr_write_b32 a19, v8
    v_accvgpr_read_b32 v5, a20
    v_mul_f32 v5, v5, v4
    v_accvgpr_write_b32 a20, v5
    v_accvgpr_read_b32 v6, a21
    v_mul_f32 v6, v6, v4
    v_accvgpr_write_b32 a21, v6
    v_accvgpr_read_b32 v7, a22
    v_mul_f32 v7, v7, v4
    v_accvgpr_write_b32 a22, v7
    v_accvgpr_read_b32 v8, a23
    v_mul_f32 v8, v8, v4
    v_accvgpr_write_b32 a23, v8
    v_accvgpr_read_b32 v5, a24
    v_mul_f32 v5, v5, v4
    v_accvgpr_write_b32 a24, v5
    v_accvgpr_read_b32 v6, a25
    v_mul_f32 v6, v6, v4
    v_accvgpr_write_b32 a25, v6
    v_accvgpr_read_b32 v7, a26
    v_mul_f32 v7, v7, v4
    v_accvgpr_write_b32 a26, v7
    v_accvgpr_read_b32 v8, a27
    v_mul_f32 v8, v8, v4
    v_accvgpr_write_b32 a27, v8
    v_accvgpr_read_b32 v5, a28
    v_mul_f32 v5, v5, v4
    v_accvgpr_write_b32 a28, v5
    v_accvgpr_read_b32 v6, a29
    v_mul_f32 v6, v6, v4
    v_accvgpr_write_b32 a29, v6
    v_accvgpr_read_b32 v7, a30
    v_mul_f32 v7, v7, v4
    v_accvgpr_write_b32 a30, v7
    v_accvgpr_read_b32 v8, a31
    v_mul_f32 v8, v8, v4
    v_accvgpr_write_b32 a31, v8
    v_accvgpr_read_b32 v5, a32
    v_mul_f32 v5, v5, v4
    v_accvgpr_write_b32 a32, v5
    v_accvgpr_read_b32 v6, a33
    v_mul_f32 v6, v6, v4
    v_accvgpr_write_b32 a33, v6
    v_accvgpr_read_b32 v7, a34
    v_mul_f32 v7, v7, v4
    v_accvgpr_write_b32 a34, v7
    v_accvgpr_read_b32 v8, a35
    v_mul_f32 v8, v8, v4
    v_accvgpr_write_b32 a35, v8
    v_accvgpr_read_b32 v5, a36
    v_mul_f32 v5, v5, v4
    v_accvgpr_write_b32 a36, v5
    v_accvgpr_read_b32 v6, a37
    v_mul_f32 v6, v6, v4
    v_accvgpr_write_b32 a37, v6
    v_accvgpr_read_b32 v7, a38
    v_mul_f32 v7, v7, v4
    v_accvgpr_write_b32 a38, v7
    v_accvgpr_read_b32 v8, a39
    v_mul_f32 v8, v8, v4
    v_accvgpr_write_b32 a39, v8
    v_accvgpr_read_b32 v5, a40
    v_mul_f32 v5, v5, v4
    v_accvgpr_write_b32 a40, v5
    v_accvgpr_read_b32 v6, a41
    v_mul_f32 v6, v6, v4
    v_accvgpr_write_b32 a41, v6
    v_accvgpr_read_b32 v7, a42
    v_mul_f32 v7, v7, v4
    v_accvgpr_write_b32 a42, v7
    v_accvgpr_read_b32 v8, a43
    v_mul_f32 v8, v8, v4
    v_accvgpr_write_b32 a43, v8
    v_accvgpr_read_b32 v5, a44
    v_mul_f32 v5, v5, v4
    v_accvgpr_write_b32 a44, v5
    v_accvgpr_read_b32 v6, a45
    v_mul_f32 v6, v6, v4
    v_accvgpr_write_b32 a45, v6
    v_accvgpr_read_b32 v7, a46
    v_mul_f32 v7, v7, v4
    v_accvgpr_write_b32 a46, v7
    v_accvgpr_read_b32 v8, a47
    v_mul_f32 v8, v8, v4
    v_accvgpr_write_b32 a47, v8
    v_accvgpr_read_b32 v5, a48
    v_mul_f32 v5, v5, v4
    v_accvgpr_write_b32 a48, v5
    v_accvgpr_read_b32 v6, a49
    v_mul_f32 v6, v6, v4
    v_accvgpr_write_b32 a49, v6
    v_accvgpr_read_b32 v7, a50
    v_mul_f32 v7, v7, v4
    v_accvgpr_write_b32 a50, v7
    v_accvgpr_read_b32 v8, a51
    v_mul_f32 v8, v8, v4
    v_accvgpr_write_b32 a51, v8
    v_accvgpr_read_b32 v5, a52
    v_mul_f32 v5, v5, v4
    v_accvgpr_write_b32 a52, v5
    v_accvgpr_read_b32 v6, a53
    v_mul_f32 v6, v6, v4
    v_accvgpr_write_b32 a53, v6
    v_accvgpr_read_b32 v7, a54
    v_mul_f32 v7, v7, v4
    v_accvgpr_write_b32 a54, v7
    v_accvgpr_read_b32 v8, a55
    v_mul_f32 v8, v8, v4
    v_accvgpr_write_b32 a55, v8
    v_accvgpr_read_b32 v5, a56
    v_mul_f32 v5, v5, v4
    v_accvgpr_write_b32 a56, v5
    v_accvgpr_read_b32 v6, a57
    v_mul_f32 v6, v6, v4
    v_accvgpr_write_b32 a57, v6
    v_accvgpr_read_b32 v7, a58
    v_mul_f32 v7, v7, v4
    v_accvgpr_write_b32 a58, v7
    v_accvgpr_read_b32 v8, a59
    v_mul_f32 v8, v8, v4
    v_accvgpr_write_b32 a59, v8
    v_accvgpr_read_b32 v5, a60
    v_mul_f32 v5, v5, v4
    v_accvgpr_write_b32 a60, v5
    v_accvgpr_read_b32 v6, a61
    v_mul_f32 v6, v6, v4
    v_accvgpr_write_b32 a61, v6
    v_accvgpr_read_b32 v7, a62
    v_mul_f32 v7, v7, v4
    v_accvgpr_write_b32 a62, v7
    v_accvgpr_read_b32 v8, a63
    v_mul_f32 v8, v8, v4
    v_accvgpr_write_b32 a63, v8
    v_accvgpr_read_b32 v5, a64
    v_mul_f32 v5, v5, v4
    v_accvgpr_write_b32 a64, v5
    v_accvgpr_read_b32 v6, a65
    v_mul_f32 v6, v6, v4
    v_accvgpr_write_b32 a65, v6
    v_accvgpr_read_b32 v7, a66
    v_mul_f32 v7, v7, v4
    v_accvgpr_write_b32 a66, v7
    v_accvgpr_read_b32 v8, a67
    v_mul_f32 v8, v8, v4
    v_accvgpr_write_b32 a67, v8
    v_accvgpr_read_b32 v5, a68
    v_mul_f32 v5, v5, v4
    v_accvgpr_write_b32 a68, v5
    v_accvgpr_read_b32 v6, a69
    v_mul_f32 v6, v6, v4
    v_accvgpr_write_b32 a69, v6
    v_accvgpr_read_b32 v7, a70
    v_mul_f32 v7, v7, v4
    v_accvgpr_write_b32 a70, v7
    v_accvgpr_read_b32 v8, a71
    v_mul_f32 v8, v8, v4
    v_accvgpr_write_b32 a71, v8
    v_accvgpr_read_b32 v5, a72
    v_mul_f32 v5, v5, v4
    v_accvgpr_write_b32 a72, v5
    v_accvgpr_read_b32 v6, a73
    v_mul_f32 v6, v6, v4
    v_accvgpr_write_b32 a73, v6
    v_accvgpr_read_b32 v7, a74
    v_mul_f32 v7, v7, v4
    v_accvgpr_write_b32 a74, v7
    v_accvgpr_read_b32 v8, a75
    v_mul_f32 v8, v8, v4
    v_accvgpr_write_b32 a75, v8
    v_accvgpr_read_b32 v5, a76
    v_mul_f32 v5, v5, v4
    v_accvgpr_write_b32 a76, v5
    v_accvgpr_read_b32 v6, a77
    v_mul_f32 v6, v6, v4
    v_accvgpr_write_b32 a77, v6
    v_accvgpr_read_b32 v7, a78
    v_mul_f32 v7, v7, v4
    v_accvgpr_write_b32 a78, v7
    v_accvgpr_read_b32 v8, a79
    v_mul_f32 v8, v8, v4
    v_accvgpr_write_b32 a79, v8
    v_accvgpr_read_b32 v5, a80
    v_mul_f32 v5, v5, v4
    v_accvgpr_write_b32 a80, v5
    v_accvgpr_read_b32 v6, a81
    v_mul_f32 v6, v6, v4
    v_accvgpr_write_b32 a81, v6
    v_accvgpr_read_b32 v7, a82
    v_mul_f32 v7, v7, v4
    v_accvgpr_write_b32 a82, v7
    v_accvgpr_read_b32 v8, a83
    v_mul_f32 v8, v8, v4
    v_accvgpr_write_b32 a83, v8
    v_accvgpr_read_b32 v5, a84
    v_mul_f32 v5, v5, v4
    v_accvgpr_write_b32 a84, v5
    v_accvgpr_read_b32 v6, a85
    v_mul_f32 v6, v6, v4
    v_accvgpr_write_b32 a85, v6
    v_accvgpr_read_b32 v7, a86
    v_mul_f32 v7, v7, v4
    v_accvgpr_write_b32 a86, v7
    v_accvgpr_read_b32 v8, a87
    v_mul_f32 v8, v8, v4
    v_accvgpr_write_b32 a87, v8
    v_accvgpr_read_b32 v5, a88
    v_mul_f32 v5, v5, v4
    v_accvgpr_write_b32 a88, v5
    v_accvgpr_read_b32 v6, a89
    v_mul_f32 v6, v6, v4
    v_accvgpr_write_b32 a89, v6
    v_accvgpr_read_b32 v7, a90
    v_mul_f32 v7, v7, v4
    v_accvgpr_write_b32 a90, v7
    v_accvgpr_read_b32 v8, a91
    v_mul_f32 v8, v8, v4
    v_accvgpr_write_b32 a91, v8
    v_accvgpr_read_b32 v5, a92
    v_mul_f32 v5, v5, v4
    v_accvgpr_write_b32 a92, v5
    v_accvgpr_read_b32 v6, a93
    v_mul_f32 v6, v6, v4
    v_accvgpr_write_b32 a93, v6
    v_accvgpr_read_b32 v7, a94
    v_mul_f32 v7, v7, v4
    v_accvgpr_write_b32 a94, v7
    v_accvgpr_read_b32 v8, a95
    v_mul_f32 v8, v8, v4
    v_accvgpr_write_b32 a95, v8
    v_accvgpr_read_b32 v5, a96
    v_mul_f32 v5, v5, v4
    v_accvgpr_write_b32 a96, v5
    v_accvgpr_read_b32 v6, a97
    v_mul_f32 v6, v6, v4
    v_accvgpr_write_b32 a97, v6
    v_accvgpr_read_b32 v7, a98
    v_mul_f32 v7, v7, v4
    v_accvgpr_write_b32 a98, v7
    v_accvgpr_read_b32 v8, a99
    v_mul_f32 v8, v8, v4
    v_accvgpr_write_b32 a99, v8
    v_accvgpr_read_b32 v5, a100
    v_mul_f32 v5, v5, v4
    v_accvgpr_write_b32 a100, v5
    v_accvgpr_read_b32 v6, a101
    v_mul_f32 v6, v6, v4
    v_accvgpr_write_b32 a101, v6
    v_accvgpr_read_b32 v7, a102
    v_mul_f32 v7, v7, v4
    v_accvgpr_write_b32 a102, v7
    v_accvgpr_read_b32 v8, a103
    v_mul_f32 v8, v8, v4
    v_accvgpr_write_b32 a103, v8
    v_accvgpr_read_b32 v5, a104
    v_mul_f32 v5, v5, v4
    v_accvgpr_write_b32 a104, v5
    v_accvgpr_read_b32 v6, a105
    v_mul_f32 v6, v6, v4
    v_accvgpr_write_b32 a105, v6
    v_accvgpr_read_b32 v7, a106
    v_mul_f32 v7, v7, v4
    v_accvgpr_write_b32 a106, v7
    v_accvgpr_read_b32 v8, a107
    v_mul_f32 v8, v8, v4
    v_accvgpr_write_b32 a107, v8
    v_accvgpr_read_b32 v5, a108
    v_mul_f32 v5, v5, v4
    v_accvgpr_write_b32 a108, v5
    v_accvgpr_read_b32 v6, a109
    v_mul_f32 v6, v6, v4
    v_accvgpr_write_b32 a109, v6
    v_accvgpr_read_b32 v7, a110
    v_mul_f32 v7, v7, v4
    v_accvgpr_write_b32 a110, v7
    v_accvgpr_read_b32 v8, a111
    v_mul_f32 v8, v8, v4
    v_accvgpr_write_b32 a111, v8
    v_accvgpr_read_b32 v5, a112
    v_mul_f32 v5, v5, v4
    v_accvgpr_write_b32 a112, v5
    v_accvgpr_read_b32 v6, a113
    v_mul_f32 v6, v6, v4
    v_accvgpr_write_b32 a113, v6
    v_accvgpr_read_b32 v7, a114
    v_mul_f32 v7, v7, v4
    v_accvgpr_write_b32 a114, v7
    v_accvgpr_read_b32 v8, a115
    v_mul_f32 v8, v8, v4
    v_accvgpr_write_b32 a115, v8
    v_accvgpr_read_b32 v5, a116
    v_mul_f32 v5, v5, v4
    v_accvgpr_write_b32 a116, v5
    v_accvgpr_read_b32 v6, a117
    v_mul_f32 v6, v6, v4
    v_accvgpr_write_b32 a117, v6
    v_accvgpr_read_b32 v7, a118
    v_mul_f32 v7, v7, v4
    v_accvgpr_write_b32 a118, v7
    v_accvgpr_read_b32 v8, a119
    v_mul_f32 v8, v8, v4
    v_accvgpr_write_b32 a119, v8
    v_accvgpr_read_b32 v5, a120
    v_mul_f32 v5, v5, v4
    v_accvgpr_write_b32 a120, v5
    v_accvgpr_read_b32 v6, a121
    v_mul_f32 v6, v6, v4
    v_accvgpr_write_b32 a121, v6
    v_accvgpr_read_b32 v7, a122
    v_mul_f32 v7, v7, v4
    v_accvgpr_write_b32 a122, v7
    v_accvgpr_read_b32 v8, a123
    v_mul_f32 v8, v8, v4
    v_accvgpr_write_b32 a123, v8
    v_accvgpr_read_b32 v5, a124
    v_mul_f32 v5, v5, v4
    v_accvgpr_write_b32 a124, v5
    v_accvgpr_read_b32 v6, a125
    v_mul_f32 v6, v6, v4
    v_accvgpr_write_b32 a125, v6
    v_accvgpr_read_b32 v7, a126
    v_mul_f32 v7, v7, v4
    v_accvgpr_write_b32 a126, v7
    v_accvgpr_read_b32 v8, a127
    v_mul_f32 v8, v8, v4
    v_accvgpr_write_b32 a127, v8
    s_nop 1
    s_branch LRB_38
LRS_39:
    v_max_f32 v3, v32, v2
    v_sub_f32 v4, v32, v3
    v_exp_f32 v4, v4
    v_mov_b32 v32, v3
    s_nop 0
    v_mul_f32 v33, v33, v4
    s_nop 15
    v_accvgpr_read_b32 v5, a0
    v_mul_f32 v5, v5, v4
    v_accvgpr_write_b32 a0, v5
    v_accvgpr_read_b32 v6, a1
    v_mul_f32 v6, v6, v4
    v_accvgpr_write_b32 a1, v6
    v_accvgpr_read_b32 v7, a2
    v_mul_f32 v7, v7, v4
    v_accvgpr_write_b32 a2, v7
    v_accvgpr_read_b32 v8, a3
    v_mul_f32 v8, v8, v4
    v_accvgpr_write_b32 a3, v8
    v_accvgpr_read_b32 v5, a4
    v_mul_f32 v5, v5, v4
    v_accvgpr_write_b32 a4, v5
    v_accvgpr_read_b32 v6, a5
    v_mul_f32 v6, v6, v4
    v_accvgpr_write_b32 a5, v6
    v_accvgpr_read_b32 v7, a6
    v_mul_f32 v7, v7, v4
    v_accvgpr_write_b32 a6, v7
    v_accvgpr_read_b32 v8, a7
    v_mul_f32 v8, v8, v4
    v_accvgpr_write_b32 a7, v8
    v_accvgpr_read_b32 v5, a8
    v_mul_f32 v5, v5, v4
    v_accvgpr_write_b32 a8, v5
    v_accvgpr_read_b32 v6, a9
    v_mul_f32 v6, v6, v4
    v_accvgpr_write_b32 a9, v6
    v_accvgpr_read_b32 v7, a10
    v_mul_f32 v7, v7, v4
    v_accvgpr_write_b32 a10, v7
    v_accvgpr_read_b32 v8, a11
    v_mul_f32 v8, v8, v4
    v_accvgpr_write_b32 a11, v8
    v_accvgpr_read_b32 v5, a12
    v_mul_f32 v5, v5, v4
    v_accvgpr_write_b32 a12, v5
    v_accvgpr_read_b32 v6, a13
    v_mul_f32 v6, v6, v4
    v_accvgpr_write_b32 a13, v6
    v_accvgpr_read_b32 v7, a14
    v_mul_f32 v7, v7, v4
    v_accvgpr_write_b32 a14, v7
    v_accvgpr_read_b32 v8, a15
    v_mul_f32 v8, v8, v4
    v_accvgpr_write_b32 a15, v8
    v_accvgpr_read_b32 v5, a16
    v_mul_f32 v5, v5, v4
    v_accvgpr_write_b32 a16, v5
    v_accvgpr_read_b32 v6, a17
    v_mul_f32 v6, v6, v4
    v_accvgpr_write_b32 a17, v6
    v_accvgpr_read_b32 v7, a18
    v_mul_f32 v7, v7, v4
    v_accvgpr_write_b32 a18, v7
    v_accvgpr_read_b32 v8, a19
    v_mul_f32 v8, v8, v4
    v_accvgpr_write_b32 a19, v8
    v_accvgpr_read_b32 v5, a20
    v_mul_f32 v5, v5, v4
    v_accvgpr_write_b32 a20, v5
    v_accvgpr_read_b32 v6, a21
    v_mul_f32 v6, v6, v4
    v_accvgpr_write_b32 a21, v6
    v_accvgpr_read_b32 v7, a22
    v_mul_f32 v7, v7, v4
    v_accvgpr_write_b32 a22, v7
    v_accvgpr_read_b32 v8, a23
    v_mul_f32 v8, v8, v4
    v_accvgpr_write_b32 a23, v8
    v_accvgpr_read_b32 v5, a24
    v_mul_f32 v5, v5, v4
    v_accvgpr_write_b32 a24, v5
    v_accvgpr_read_b32 v6, a25
    v_mul_f32 v6, v6, v4
    v_accvgpr_write_b32 a25, v6
    v_accvgpr_read_b32 v7, a26
    v_mul_f32 v7, v7, v4
    v_accvgpr_write_b32 a26, v7
    v_accvgpr_read_b32 v8, a27
    v_mul_f32 v8, v8, v4
    v_accvgpr_write_b32 a27, v8
    v_accvgpr_read_b32 v5, a28
    v_mul_f32 v5, v5, v4
    v_accvgpr_write_b32 a28, v5
    v_accvgpr_read_b32 v6, a29
    v_mul_f32 v6, v6, v4
    v_accvgpr_write_b32 a29, v6
    v_accvgpr_read_b32 v7, a30
    v_mul_f32 v7, v7, v4
    v_accvgpr_write_b32 a30, v7
    v_accvgpr_read_b32 v8, a31
    v_mul_f32 v8, v8, v4
    v_accvgpr_write_b32 a31, v8
    v_accvgpr_read_b32 v5, a32
    v_mul_f32 v5, v5, v4
    v_accvgpr_write_b32 a32, v5
    v_accvgpr_read_b32 v6, a33
    v_mul_f32 v6, v6, v4
    v_accvgpr_write_b32 a33, v6
    v_accvgpr_read_b32 v7, a34
    v_mul_f32 v7, v7, v4
    v_accvgpr_write_b32 a34, v7
    v_accvgpr_read_b32 v8, a35
    v_mul_f32 v8, v8, v4
    v_accvgpr_write_b32 a35, v8
    v_accvgpr_read_b32 v5, a36
    v_mul_f32 v5, v5, v4
    v_accvgpr_write_b32 a36, v5
    v_accvgpr_read_b32 v6, a37
    v_mul_f32 v6, v6, v4
    v_accvgpr_write_b32 a37, v6
    v_accvgpr_read_b32 v7, a38
    v_mul_f32 v7, v7, v4
    v_accvgpr_write_b32 a38, v7
    v_accvgpr_read_b32 v8, a39
    v_mul_f32 v8, v8, v4
    v_accvgpr_write_b32 a39, v8
    v_accvgpr_read_b32 v5, a40
    v_mul_f32 v5, v5, v4
    v_accvgpr_write_b32 a40, v5
    v_accvgpr_read_b32 v6, a41
    v_mul_f32 v6, v6, v4
    v_accvgpr_write_b32 a41, v6
    v_accvgpr_read_b32 v7, a42
    v_mul_f32 v7, v7, v4
    v_accvgpr_write_b32 a42, v7
    v_accvgpr_read_b32 v8, a43
    v_mul_f32 v8, v8, v4
    v_accvgpr_write_b32 a43, v8
    v_accvgpr_read_b32 v5, a44
    v_mul_f32 v5, v5, v4
    v_accvgpr_write_b32 a44, v5
    v_accvgpr_read_b32 v6, a45
    v_mul_f32 v6, v6, v4
    v_accvgpr_write_b32 a45, v6
    v_accvgpr_read_b32 v7, a46
    v_mul_f32 v7, v7, v4
    v_accvgpr_write_b32 a46, v7
    v_accvgpr_read_b32 v8, a47
    v_mul_f32 v8, v8, v4
    v_accvgpr_write_b32 a47, v8
    v_accvgpr_read_b32 v5, a48
    v_mul_f32 v5, v5, v4
    v_accvgpr_write_b32 a48, v5
    v_accvgpr_read_b32 v6, a49
    v_mul_f32 v6, v6, v4
    v_accvgpr_write_b32 a49, v6
    v_accvgpr_read_b32 v7, a50
    v_mul_f32 v7, v7, v4
    v_accvgpr_write_b32 a50, v7
    v_accvgpr_read_b32 v8, a51
    v_mul_f32 v8, v8, v4
    v_accvgpr_write_b32 a51, v8
    v_accvgpr_read_b32 v5, a52
    v_mul_f32 v5, v5, v4
    v_accvgpr_write_b32 a52, v5
    v_accvgpr_read_b32 v6, a53
    v_mul_f32 v6, v6, v4
    v_accvgpr_write_b32 a53, v6
    v_accvgpr_read_b32 v7, a54
    v_mul_f32 v7, v7, v4
    v_accvgpr_write_b32 a54, v7
    v_accvgpr_read_b32 v8, a55
    v_mul_f32 v8, v8, v4
    v_accvgpr_write_b32 a55, v8
    v_accvgpr_read_b32 v5, a56
    v_mul_f32 v5, v5, v4
    v_accvgpr_write_b32 a56, v5
    v_accvgpr_read_b32 v6, a57
    v_mul_f32 v6, v6, v4
    v_accvgpr_write_b32 a57, v6
    v_accvgpr_read_b32 v7, a58
    v_mul_f32 v7, v7, v4
    v_accvgpr_write_b32 a58, v7
    v_accvgpr_read_b32 v8, a59
    v_mul_f32 v8, v8, v4
    v_accvgpr_write_b32 a59, v8
    v_accvgpr_read_b32 v5, a60
    v_mul_f32 v5, v5, v4
    v_accvgpr_write_b32 a60, v5
    v_accvgpr_read_b32 v6, a61
    v_mul_f32 v6, v6, v4
    v_accvgpr_write_b32 a61, v6
    v_accvgpr_read_b32 v7, a62
    v_mul_f32 v7, v7, v4
    v_accvgpr_write_b32 a62, v7
    v_accvgpr_read_b32 v8, a63
    v_mul_f32 v8, v8, v4
    v_accvgpr_write_b32 a63, v8
    v_accvgpr_read_b32 v5, a64
    v_mul_f32 v5, v5, v4
    v_accvgpr_write_b32 a64, v5
    v_accvgpr_read_b32 v6, a65
    v_mul_f32 v6, v6, v4
    v_accvgpr_write_b32 a65, v6
    v_accvgpr_read_b32 v7, a66
    v_mul_f32 v7, v7, v4
    v_accvgpr_write_b32 a66, v7
    v_accvgpr_read_b32 v8, a67
    v_mul_f32 v8, v8, v4
    v_accvgpr_write_b32 a67, v8
    v_accvgpr_read_b32 v5, a68
    v_mul_f32 v5, v5, v4
    v_accvgpr_write_b32 a68, v5
    v_accvgpr_read_b32 v6, a69
    v_mul_f32 v6, v6, v4
    v_accvgpr_write_b32 a69, v6
    v_accvgpr_read_b32 v7, a70
    v_mul_f32 v7, v7, v4
    v_accvgpr_write_b32 a70, v7
    v_accvgpr_read_b32 v8, a71
    v_mul_f32 v8, v8, v4
    v_accvgpr_write_b32 a71, v8
    v_accvgpr_read_b32 v5, a72
    v_mul_f32 v5, v5, v4
    v_accvgpr_write_b32 a72, v5
    v_accvgpr_read_b32 v6, a73
    v_mul_f32 v6, v6, v4
    v_accvgpr_write_b32 a73, v6
    v_accvgpr_read_b32 v7, a74
    v_mul_f32 v7, v7, v4
    v_accvgpr_write_b32 a74, v7
    v_accvgpr_read_b32 v8, a75
    v_mul_f32 v8, v8, v4
    v_accvgpr_write_b32 a75, v8
    v_accvgpr_read_b32 v5, a76
    v_mul_f32 v5, v5, v4
    v_accvgpr_write_b32 a76, v5
    v_accvgpr_read_b32 v6, a77
    v_mul_f32 v6, v6, v4
    v_accvgpr_write_b32 a77, v6
    v_accvgpr_read_b32 v7, a78
    v_mul_f32 v7, v7, v4
    v_accvgpr_write_b32 a78, v7
    v_accvgpr_read_b32 v8, a79
    v_mul_f32 v8, v8, v4
    v_accvgpr_write_b32 a79, v8
    v_accvgpr_read_b32 v5, a80
    v_mul_f32 v5, v5, v4
    v_accvgpr_write_b32 a80, v5
    v_accvgpr_read_b32 v6, a81
    v_mul_f32 v6, v6, v4
    v_accvgpr_write_b32 a81, v6
    v_accvgpr_read_b32 v7, a82
    v_mul_f32 v7, v7, v4
    v_accvgpr_write_b32 a82, v7
    v_accvgpr_read_b32 v8, a83
    v_mul_f32 v8, v8, v4
    v_accvgpr_write_b32 a83, v8
    v_accvgpr_read_b32 v5, a84
    v_mul_f32 v5, v5, v4
    v_accvgpr_write_b32 a84, v5
    v_accvgpr_read_b32 v6, a85
    v_mul_f32 v6, v6, v4
    v_accvgpr_write_b32 a85, v6
    v_accvgpr_read_b32 v7, a86
    v_mul_f32 v7, v7, v4
    v_accvgpr_write_b32 a86, v7
    v_accvgpr_read_b32 v8, a87
    v_mul_f32 v8, v8, v4
    v_accvgpr_write_b32 a87, v8
    v_accvgpr_read_b32 v5, a88
    v_mul_f32 v5, v5, v4
    v_accvgpr_write_b32 a88, v5
    v_accvgpr_read_b32 v6, a89
    v_mul_f32 v6, v6, v4
    v_accvgpr_write_b32 a89, v6
    v_accvgpr_read_b32 v7, a90
    v_mul_f32 v7, v7, v4
    v_accvgpr_write_b32 a90, v7
    v_accvgpr_read_b32 v8, a91
    v_mul_f32 v8, v8, v4
    v_accvgpr_write_b32 a91, v8
    v_accvgpr_read_b32 v5, a92
    v_mul_f32 v5, v5, v4
    v_accvgpr_write_b32 a92, v5
    v_accvgpr_read_b32 v6, a93
    v_mul_f32 v6, v6, v4
    v_accvgpr_write_b32 a93, v6
    v_accvgpr_read_b32 v7, a94
    v_mul_f32 v7, v7, v4
    v_accvgpr_write_b32 a94, v7
    v_accvgpr_read_b32 v8, a95
    v_mul_f32 v8, v8, v4
    v_accvgpr_write_b32 a95, v8
    v_accvgpr_read_b32 v5, a96
    v_mul_f32 v5, v5, v4
    v_accvgpr_write_b32 a96, v5
    v_accvgpr_read_b32 v6, a97
    v_mul_f32 v6, v6, v4
    v_accvgpr_write_b32 a97, v6
    v_accvgpr_read_b32 v7, a98
    v_mul_f32 v7, v7, v4
    v_accvgpr_write_b32 a98, v7
    v_accvgpr_read_b32 v8, a99
    v_mul_f32 v8, v8, v4
    v_accvgpr_write_b32 a99, v8
    v_accvgpr_read_b32 v5, a100
    v_mul_f32 v5, v5, v4
    v_accvgpr_write_b32 a100, v5
    v_accvgpr_read_b32 v6, a101
    v_mul_f32 v6, v6, v4
    v_accvgpr_write_b32 a101, v6
    v_accvgpr_read_b32 v7, a102
    v_mul_f32 v7, v7, v4
    v_accvgpr_write_b32 a102, v7
    v_accvgpr_read_b32 v8, a103
    v_mul_f32 v8, v8, v4
    v_accvgpr_write_b32 a103, v8
    v_accvgpr_read_b32 v5, a104
    v_mul_f32 v5, v5, v4
    v_accvgpr_write_b32 a104, v5
    v_accvgpr_read_b32 v6, a105
    v_mul_f32 v6, v6, v4
    v_accvgpr_write_b32 a105, v6
    v_accvgpr_read_b32 v7, a106
    v_mul_f32 v7, v7, v4
    v_accvgpr_write_b32 a106, v7
    v_accvgpr_read_b32 v8, a107
    v_mul_f32 v8, v8, v4
    v_accvgpr_write_b32 a107, v8
    v_accvgpr_read_b32 v5, a108
    v_mul_f32 v5, v5, v4
    v_accvgpr_write_b32 a108, v5
    v_accvgpr_read_b32 v6, a109
    v_mul_f32 v6, v6, v4
    v_accvgpr_write_b32 a109, v6
    v_accvgpr_read_b32 v7, a110
    v_mul_f32 v7, v7, v4
    v_accvgpr_write_b32 a110, v7
    v_accvgpr_read_b32 v8, a111
    v_mul_f32 v8, v8, v4
    v_accvgpr_write_b32 a111, v8
    v_accvgpr_read_b32 v5, a112
    v_mul_f32 v5, v5, v4
    v_accvgpr_write_b32 a112, v5
    v_accvgpr_read_b32 v6, a113
    v_mul_f32 v6, v6, v4
    v_accvgpr_write_b32 a113, v6
    v_accvgpr_read_b32 v7, a114
    v_mul_f32 v7, v7, v4
    v_accvgpr_write_b32 a114, v7
    v_accvgpr_read_b32 v8, a115
    v_mul_f32 v8, v8, v4
    v_accvgpr_write_b32 a115, v8
    v_accvgpr_read_b32 v5, a116
    v_mul_f32 v5, v5, v4
    v_accvgpr_write_b32 a116, v5
    v_accvgpr_read_b32 v6, a117
    v_mul_f32 v6, v6, v4
    v_accvgpr_write_b32 a117, v6
    v_accvgpr_read_b32 v7, a118
    v_mul_f32 v7, v7, v4
    v_accvgpr_write_b32 a118, v7
    v_accvgpr_read_b32 v8, a119
    v_mul_f32 v8, v8, v4
    v_accvgpr_write_b32 a119, v8
    v_accvgpr_read_b32 v5, a120
    v_mul_f32 v5, v5, v4
    v_accvgpr_write_b32 a120, v5
    v_accvgpr_read_b32 v6, a121
    v_mul_f32 v6, v6, v4
    v_accvgpr_write_b32 a121, v6
    v_accvgpr_read_b32 v7, a122
    v_mul_f32 v7, v7, v4
    v_accvgpr_write_b32 a122, v7
    v_accvgpr_read_b32 v8, a123
    v_mul_f32 v8, v8, v4
    v_accvgpr_write_b32 a123, v8
    v_accvgpr_read_b32 v5, a124
    v_mul_f32 v5, v5, v4
    v_accvgpr_write_b32 a124, v5
    v_accvgpr_read_b32 v6, a125
    v_mul_f32 v6, v6, v4
    v_accvgpr_write_b32 a125, v6
    v_accvgpr_read_b32 v7, a126
    v_mul_f32 v7, v7, v4
    v_accvgpr_write_b32 a126, v7
    v_accvgpr_read_b32 v8, a127
    v_mul_f32 v8, v8, v4
    v_accvgpr_write_b32 a127, v8
    s_nop 1
    s_branch LRB_40
LRS_41:
    v_max_f32 v3, v34, v2
    v_sub_f32 v4, v34, v3
    v_exp_f32 v4, v4
    v_mov_b32 v34, v3
    s_nop 0
    v_mul_f32 v35, v35, v4
    s_nop 15
    v_accvgpr_read_b32 v5, a128
    v_mul_f32 v5, v5, v4
    v_accvgpr_write_b32 a128, v5
    v_accvgpr_read_b32 v6, a129
    v_mul_f32 v6, v6, v4
    v_accvgpr_write_b32 a129, v6
    v_accvgpr_read_b32 v7, a130
    v_mul_f32 v7, v7, v4
    v_accvgpr_write_b32 a130, v7
    v_accvgpr_read_b32 v8, a131
    v_mul_f32 v8, v8, v4
    v_accvgpr_write_b32 a131, v8
    v_accvgpr_read_b32 v5, a132
    v_mul_f32 v5, v5, v4
    v_accvgpr_write_b32 a132, v5
    v_accvgpr_read_b32 v6, a133
    v_mul_f32 v6, v6, v4
    v_accvgpr_write_b32 a133, v6
    v_accvgpr_read_b32 v7, a134
    v_mul_f32 v7, v7, v4
    v_accvgpr_write_b32 a134, v7
    v_accvgpr_read_b32 v8, a135
    v_mul_f32 v8, v8, v4
    v_accvgpr_write_b32 a135, v8
    v_accvgpr_read_b32 v5, a136
    v_mul_f32 v5, v5, v4
    v_accvgpr_write_b32 a136, v5
    v_accvgpr_read_b32 v6, a137
    v_mul_f32 v6, v6, v4
    v_accvgpr_write_b32 a137, v6
    v_accvgpr_read_b32 v7, a138
    v_mul_f32 v7, v7, v4
    v_accvgpr_write_b32 a138, v7
    v_accvgpr_read_b32 v8, a139
    v_mul_f32 v8, v8, v4
    v_accvgpr_write_b32 a139, v8
    v_accvgpr_read_b32 v5, a140
    v_mul_f32 v5, v5, v4
    v_accvgpr_write_b32 a140, v5
    v_accvgpr_read_b32 v6, a141
    v_mul_f32 v6, v6, v4
    v_accvgpr_write_b32 a141, v6
    v_accvgpr_read_b32 v7, a142
    v_mul_f32 v7, v7, v4
    v_accvgpr_write_b32 a142, v7
    v_accvgpr_read_b32 v8, a143
    v_mul_f32 v8, v8, v4
    v_accvgpr_write_b32 a143, v8
    v_accvgpr_read_b32 v5, a144
    v_mul_f32 v5, v5, v4
    v_accvgpr_write_b32 a144, v5
    v_accvgpr_read_b32 v6, a145
    v_mul_f32 v6, v6, v4
    v_accvgpr_write_b32 a145, v6
    v_accvgpr_read_b32 v7, a146
    v_mul_f32 v7, v7, v4
    v_accvgpr_write_b32 a146, v7
    v_accvgpr_read_b32 v8, a147
    v_mul_f32 v8, v8, v4
    v_accvgpr_write_b32 a147, v8
    v_accvgpr_read_b32 v5, a148
    v_mul_f32 v5, v5, v4
    v_accvgpr_write_b32 a148, v5
    v_accvgpr_read_b32 v6, a149
    v_mul_f32 v6, v6, v4
    v_accvgpr_write_b32 a149, v6
    v_accvgpr_read_b32 v7, a150
    v_mul_f32 v7, v7, v4
    v_accvgpr_write_b32 a150, v7
    v_accvgpr_read_b32 v8, a151
    v_mul_f32 v8, v8, v4
    v_accvgpr_write_b32 a151, v8
    v_accvgpr_read_b32 v5, a152
    v_mul_f32 v5, v5, v4
    v_accvgpr_write_b32 a152, v5
    v_accvgpr_read_b32 v6, a153
    v_mul_f32 v6, v6, v4
    v_accvgpr_write_b32 a153, v6
    v_accvgpr_read_b32 v7, a154
    v_mul_f32 v7, v7, v4
    v_accvgpr_write_b32 a154, v7
    v_accvgpr_read_b32 v8, a155
    v_mul_f32 v8, v8, v4
    v_accvgpr_write_b32 a155, v8
    v_accvgpr_read_b32 v5, a156
    v_mul_f32 v5, v5, v4
    v_accvgpr_write_b32 a156, v5
    v_accvgpr_read_b32 v6, a157
    v_mul_f32 v6, v6, v4
    v_accvgpr_write_b32 a157, v6
    v_accvgpr_read_b32 v7, a158
    v_mul_f32 v7, v7, v4
    v_accvgpr_write_b32 a158, v7
    v_accvgpr_read_b32 v8, a159
    v_mul_f32 v8, v8, v4
    v_accvgpr_write_b32 a159, v8
    v_accvgpr_read_b32 v5, a160
    v_mul_f32 v5, v5, v4
    v_accvgpr_write_b32 a160, v5
    v_accvgpr_read_b32 v6, a161
    v_mul_f32 v6, v6, v4
    v_accvgpr_write_b32 a161, v6
    v_accvgpr_read_b32 v7, a162
    v_mul_f32 v7, v7, v4
    v_accvgpr_write_b32 a162, v7
    v_accvgpr_read_b32 v8, a163
    v_mul_f32 v8, v8, v4
    v_accvgpr_write_b32 a163, v8
    v_accvgpr_read_b32 v5, a164
    v_mul_f32 v5, v5, v4
    v_accvgpr_write_b32 a164, v5
    v_accvgpr_read_b32 v6, a165
    v_mul_f32 v6, v6, v4
    v_accvgpr_write_b32 a165, v6
    v_accvgpr_read_b32 v7, a166
    v_mul_f32 v7, v7, v4
    v_accvgpr_write_b32 a166, v7
    v_accvgpr_read_b32 v8, a167
    v_mul_f32 v8, v8, v4
    v_accvgpr_write_b32 a167, v8
    v_accvgpr_read_b32 v5, a168
    v_mul_f32 v5, v5, v4
    v_accvgpr_write_b32 a168, v5
    v_accvgpr_read_b32 v6, a169
    v_mul_f32 v6, v6, v4
    v_accvgpr_write_b32 a169, v6
    v_accvgpr_read_b32 v7, a170
    v_mul_f32 v7, v7, v4
    v_accvgpr_write_b32 a170, v7
    v_accvgpr_read_b32 v8, a171
    v_mul_f32 v8, v8, v4
    v_accvgpr_write_b32 a171, v8
    v_accvgpr_read_b32 v5, a172
    v_mul_f32 v5, v5, v4
    v_accvgpr_write_b32 a172, v5
    v_accvgpr_read_b32 v6, a173
    v_mul_f32 v6, v6, v4
    v_accvgpr_write_b32 a173, v6
    v_accvgpr_read_b32 v7, a174
    v_mul_f32 v7, v7, v4
    v_accvgpr_write_b32 a174, v7
    v_accvgpr_read_b32 v8, a175
    v_mul_f32 v8, v8, v4
    v_accvgpr_write_b32 a175, v8
    v_accvgpr_read_b32 v5, a176
    v_mul_f32 v5, v5, v4
    v_accvgpr_write_b32 a176, v5
    v_accvgpr_read_b32 v6, a177
    v_mul_f32 v6, v6, v4
    v_accvgpr_write_b32 a177, v6
    v_accvgpr_read_b32 v7, a178
    v_mul_f32 v7, v7, v4
    v_accvgpr_write_b32 a178, v7
    v_accvgpr_read_b32 v8, a179
    v_mul_f32 v8, v8, v4
    v_accvgpr_write_b32 a179, v8
    v_accvgpr_read_b32 v5, a180
    v_mul_f32 v5, v5, v4
    v_accvgpr_write_b32 a180, v5
    v_accvgpr_read_b32 v6, a181
    v_mul_f32 v6, v6, v4
    v_accvgpr_write_b32 a181, v6
    v_accvgpr_read_b32 v7, a182
    v_mul_f32 v7, v7, v4
    v_accvgpr_write_b32 a182, v7
    v_accvgpr_read_b32 v8, a183
    v_mul_f32 v8, v8, v4
    v_accvgpr_write_b32 a183, v8
    v_accvgpr_read_b32 v5, a184
    v_mul_f32 v5, v5, v4
    v_accvgpr_write_b32 a184, v5
    v_accvgpr_read_b32 v6, a185
    v_mul_f32 v6, v6, v4
    v_accvgpr_write_b32 a185, v6
    v_accvgpr_read_b32 v7, a186
    v_mul_f32 v7, v7, v4
    v_accvgpr_write_b32 a186, v7
    v_accvgpr_read_b32 v8, a187
    v_mul_f32 v8, v8, v4
    v_accvgpr_write_b32 a187, v8
    v_accvgpr_read_b32 v5, a188
    v_mul_f32 v5, v5, v4
    v_accvgpr_write_b32 a188, v5
    v_accvgpr_read_b32 v6, a189
    v_mul_f32 v6, v6, v4
    v_accvgpr_write_b32 a189, v6
    v_accvgpr_read_b32 v7, a190
    v_mul_f32 v7, v7, v4
    v_accvgpr_write_b32 a190, v7
    v_accvgpr_read_b32 v8, a191
    v_mul_f32 v8, v8, v4
    v_accvgpr_write_b32 a191, v8
    v_accvgpr_read_b32 v5, a192
    v_mul_f32 v5, v5, v4
    v_accvgpr_write_b32 a192, v5
    v_accvgpr_read_b32 v6, a193
    v_mul_f32 v6, v6, v4
    v_accvgpr_write_b32 a193, v6
    v_accvgpr_read_b32 v7, a194
    v_mul_f32 v7, v7, v4
    v_accvgpr_write_b32 a194, v7
    v_accvgpr_read_b32 v8, a195
    v_mul_f32 v8, v8, v4
    v_accvgpr_write_b32 a195, v8
    v_accvgpr_read_b32 v5, a196
    v_mul_f32 v5, v5, v4
    v_accvgpr_write_b32 a196, v5
    v_accvgpr_read_b32 v6, a197
    v_mul_f32 v6, v6, v4
    v_accvgpr_write_b32 a197, v6
    v_accvgpr_read_b32 v7, a198
    v_mul_f32 v7, v7, v4
    v_accvgpr_write_b32 a198, v7
    v_accvgpr_read_b32 v8, a199
    v_mul_f32 v8, v8, v4
    v_accvgpr_write_b32 a199, v8
    v_accvgpr_read_b32 v5, a200
    v_mul_f32 v5, v5, v4
    v_accvgpr_write_b32 a200, v5
    v_accvgpr_read_b32 v6, a201
    v_mul_f32 v6, v6, v4
    v_accvgpr_write_b32 a201, v6
    v_accvgpr_read_b32 v7, a202
    v_mul_f32 v7, v7, v4
    v_accvgpr_write_b32 a202, v7
    v_accvgpr_read_b32 v8, a203
    v_mul_f32 v8, v8, v4
    v_accvgpr_write_b32 a203, v8
    v_accvgpr_read_b32 v5, a204
    v_mul_f32 v5, v5, v4
    v_accvgpr_write_b32 a204, v5
    v_accvgpr_read_b32 v6, a205
    v_mul_f32 v6, v6, v4
    v_accvgpr_write_b32 a205, v6
    v_accvgpr_read_b32 v7, a206
    v_mul_f32 v7, v7, v4
    v_accvgpr_write_b32 a206, v7
    v_accvgpr_read_b32 v8, a207
    v_mul_f32 v8, v8, v4
    v_accvgpr_write_b32 a207, v8
    v_accvgpr_read_b32 v5, a208
    v_mul_f32 v5, v5, v4
    v_accvgpr_write_b32 a208, v5
    v_accvgpr_read_b32 v6, a209
    v_mul_f32 v6, v6, v4
    v_accvgpr_write_b32 a209, v6
    v_accvgpr_read_b32 v7, a210
    v_mul_f32 v7, v7, v4
    v_accvgpr_write_b32 a210, v7
    v_accvgpr_read_b32 v8, a211
    v_mul_f32 v8, v8, v4
    v_accvgpr_write_b32 a211, v8
    v_accvgpr_read_b32 v5, a212
    v_mul_f32 v5, v5, v4
    v_accvgpr_write_b32 a212, v5
    v_accvgpr_read_b32 v6, a213
    v_mul_f32 v6, v6, v4
    v_accvgpr_write_b32 a213, v6
    v_accvgpr_read_b32 v7, a214
    v_mul_f32 v7, v7, v4
    v_accvgpr_write_b32 a214, v7
    v_accvgpr_read_b32 v8, a215
    v_mul_f32 v8, v8, v4
    v_accvgpr_write_b32 a215, v8
    v_accvgpr_read_b32 v5, a216
    v_mul_f32 v5, v5, v4
    v_accvgpr_write_b32 a216, v5
    v_accvgpr_read_b32 v6, a217
    v_mul_f32 v6, v6, v4
    v_accvgpr_write_b32 a217, v6
    v_accvgpr_read_b32 v7, a218
    v_mul_f32 v7, v7, v4
    v_accvgpr_write_b32 a218, v7
    v_accvgpr_read_b32 v8, a219
    v_mul_f32 v8, v8, v4
    v_accvgpr_write_b32 a219, v8
    v_accvgpr_read_b32 v5, a220
    v_mul_f32 v5, v5, v4
    v_accvgpr_write_b32 a220, v5
    v_accvgpr_read_b32 v6, a221
    v_mul_f32 v6, v6, v4
    v_accvgpr_write_b32 a221, v6
    v_accvgpr_read_b32 v7, a222
    v_mul_f32 v7, v7, v4
    v_accvgpr_write_b32 a222, v7
    v_accvgpr_read_b32 v8, a223
    v_mul_f32 v8, v8, v4
    v_accvgpr_write_b32 a223, v8
    v_accvgpr_read_b32 v5, a224
    v_mul_f32 v5, v5, v4
    v_accvgpr_write_b32 a224, v5
    v_accvgpr_read_b32 v6, a225
    v_mul_f32 v6, v6, v4
    v_accvgpr_write_b32 a225, v6
    v_accvgpr_read_b32 v7, a226
    v_mul_f32 v7, v7, v4
    v_accvgpr_write_b32 a226, v7
    v_accvgpr_read_b32 v8, a227
    v_mul_f32 v8, v8, v4
    v_accvgpr_write_b32 a227, v8
    v_accvgpr_read_b32 v5, a228
    v_mul_f32 v5, v5, v4
    v_accvgpr_write_b32 a228, v5
    v_accvgpr_read_b32 v6, a229
    v_mul_f32 v6, v6, v4
    v_accvgpr_write_b32 a229, v6
    v_accvgpr_read_b32 v7, a230
    v_mul_f32 v7, v7, v4
    v_accvgpr_write_b32 a230, v7
    v_accvgpr_read_b32 v8, a231
    v_mul_f32 v8, v8, v4
    v_accvgpr_write_b32 a231, v8
    v_accvgpr_read_b32 v5, a232
    v_mul_f32 v5, v5, v4
    v_accvgpr_write_b32 a232, v5
    v_accvgpr_read_b32 v6, a233
    v_mul_f32 v6, v6, v4
    v_accvgpr_write_b32 a233, v6
    v_accvgpr_read_b32 v7, a234
    v_mul_f32 v7, v7, v4
    v_accvgpr_write_b32 a234, v7
    v_accvgpr_read_b32 v8, a235
    v_mul_f32 v8, v8, v4
    v_accvgpr_write_b32 a235, v8
    v_accvgpr_read_b32 v5, a236
    v_mul_f32 v5, v5, v4
    v_accvgpr_write_b32 a236, v5
    v_accvgpr_read_b32 v6, a237
    v_mul_f32 v6, v6, v4
    v_accvgpr_write_b32 a237, v6
    v_accvgpr_read_b32 v7, a238
    v_mul_f32 v7, v7, v4
    v_accvgpr_write_b32 a238, v7
    v_accvgpr_read_b32 v8, a239
    v_mul_f32 v8, v8, v4
    v_accvgpr_write_b32 a239, v8
    v_accvgpr_read_b32 v5, a240
    v_mul_f32 v5, v5, v4
    v_accvgpr_write_b32 a240, v5
    v_accvgpr_read_b32 v6, a241
    v_mul_f32 v6, v6, v4
    v_accvgpr_write_b32 a241, v6
    v_accvgpr_read_b32 v7, a242
    v_mul_f32 v7, v7, v4
    v_accvgpr_write_b32 a242, v7
    v_accvgpr_read_b32 v8, a243
    v_mul_f32 v8, v8, v4
    v_accvgpr_write_b32 a243, v8
    v_accvgpr_read_b32 v5, a244
    v_mul_f32 v5, v5, v4
    v_accvgpr_write_b32 a244, v5
    v_accvgpr_read_b32 v6, a245
    v_mul_f32 v6, v6, v4
    v_accvgpr_write_b32 a245, v6
    v_accvgpr_read_b32 v7, a246
    v_mul_f32 v7, v7, v4
    v_accvgpr_write_b32 a246, v7
    v_accvgpr_read_b32 v8, a247
    v_mul_f32 v8, v8, v4
    v_accvgpr_write_b32 a247, v8
    v_accvgpr_read_b32 v5, a248
    v_mul_f32 v5, v5, v4
    v_accvgpr_write_b32 a248, v5
    v_accvgpr_read_b32 v6, a249
    v_mul_f32 v6, v6, v4
    v_accvgpr_write_b32 a249, v6
    v_accvgpr_read_b32 v7, a250
    v_mul_f32 v7, v7, v4
    v_accvgpr_write_b32 a250, v7
    v_accvgpr_read_b32 v8, a251
    v_mul_f32 v8, v8, v4
    v_accvgpr_write_b32 a251, v8
    v_accvgpr_read_b32 v5, a252
    v_mul_f32 v5, v5, v4
    v_accvgpr_write_b32 a252, v5
    v_accvgpr_read_b32 v6, a253
    v_mul_f32 v6, v6, v4
    v_accvgpr_write_b32 a253, v6
    v_accvgpr_read_b32 v7, a254
    v_mul_f32 v7, v7, v4
    v_accvgpr_write_b32 a254, v7
    v_accvgpr_read_b32 v8, a255
    v_mul_f32 v8, v8, v4
    v_accvgpr_write_b32 a255, v8
    s_nop 1
    s_branch LRB_42
LRS_49:
    v_max_f32 v3, v32, v2
    v_sub_f32 v4, v32, v3
    v_exp_f32 v4, v4
    v_mov_b32 v32, v3
    s_nop 0
    v_mul_f32 v33, v33, v4
    s_nop 15
    v_accvgpr_read_b32 v5, a0
    v_mul_f32 v5, v5, v4
    v_accvgpr_write_b32 a0, v5
    v_accvgpr_read_b32 v6, a1
    v_mul_f32 v6, v6, v4
    v_accvgpr_write_b32 a1, v6
    v_accvgpr_read_b32 v7, a2
    v_mul_f32 v7, v7, v4
    v_accvgpr_write_b32 a2, v7
    v_accvgpr_read_b32 v8, a3
    v_mul_f32 v8, v8, v4
    v_accvgpr_write_b32 a3, v8
    v_accvgpr_read_b32 v5, a4
    v_mul_f32 v5, v5, v4
    v_accvgpr_write_b32 a4, v5
    v_accvgpr_read_b32 v6, a5
    v_mul_f32 v6, v6, v4
    v_accvgpr_write_b32 a5, v6
    v_accvgpr_read_b32 v7, a6
    v_mul_f32 v7, v7, v4
    v_accvgpr_write_b32 a6, v7
    v_accvgpr_read_b32 v8, a7
    v_mul_f32 v8, v8, v4
    v_accvgpr_write_b32 a7, v8
    v_accvgpr_read_b32 v5, a8
    v_mul_f32 v5, v5, v4
    v_accvgpr_write_b32 a8, v5
    v_accvgpr_read_b32 v6, a9
    v_mul_f32 v6, v6, v4
    v_accvgpr_write_b32 a9, v6
    v_accvgpr_read_b32 v7, a10
    v_mul_f32 v7, v7, v4
    v_accvgpr_write_b32 a10, v7
    v_accvgpr_read_b32 v8, a11
    v_mul_f32 v8, v8, v4
    v_accvgpr_write_b32 a11, v8
    v_accvgpr_read_b32 v5, a12
    v_mul_f32 v5, v5, v4
    v_accvgpr_write_b32 a12, v5
    v_accvgpr_read_b32 v6, a13
    v_mul_f32 v6, v6, v4
    v_accvgpr_write_b32 a13, v6
    v_accvgpr_read_b32 v7, a14
    v_mul_f32 v7, v7, v4
    v_accvgpr_write_b32 a14, v7
    v_accvgpr_read_b32 v8, a15
    v_mul_f32 v8, v8, v4
    v_accvgpr_write_b32 a15, v8
    v_accvgpr_read_b32 v5, a16
    v_mul_f32 v5, v5, v4
    v_accvgpr_write_b32 a16, v5
    v_accvgpr_read_b32 v6, a17
    v_mul_f32 v6, v6, v4
    v_accvgpr_write_b32 a17, v6
    v_accvgpr_read_b32 v7, a18
    v_mul_f32 v7, v7, v4
    v_accvgpr_write_b32 a18, v7
    v_accvgpr_read_b32 v8, a19
    v_mul_f32 v8, v8, v4
    v_accvgpr_write_b32 a19, v8
    v_accvgpr_read_b32 v5, a20
    v_mul_f32 v5, v5, v4
    v_accvgpr_write_b32 a20, v5
    v_accvgpr_read_b32 v6, a21
    v_mul_f32 v6, v6, v4
    v_accvgpr_write_b32 a21, v6
    v_accvgpr_read_b32 v7, a22
    v_mul_f32 v7, v7, v4
    v_accvgpr_write_b32 a22, v7
    v_accvgpr_read_b32 v8, a23
    v_mul_f32 v8, v8, v4
    v_accvgpr_write_b32 a23, v8
    v_accvgpr_read_b32 v5, a24
    v_mul_f32 v5, v5, v4
    v_accvgpr_write_b32 a24, v5
    v_accvgpr_read_b32 v6, a25
    v_mul_f32 v6, v6, v4
    v_accvgpr_write_b32 a25, v6
    v_accvgpr_read_b32 v7, a26
    v_mul_f32 v7, v7, v4
    v_accvgpr_write_b32 a26, v7
    v_accvgpr_read_b32 v8, a27
    v_mul_f32 v8, v8, v4
    v_accvgpr_write_b32 a27, v8
    v_accvgpr_read_b32 v5, a28
    v_mul_f32 v5, v5, v4
    v_accvgpr_write_b32 a28, v5
    v_accvgpr_read_b32 v6, a29
    v_mul_f32 v6, v6, v4
    v_accvgpr_write_b32 a29, v6
    v_accvgpr_read_b32 v7, a30
    v_mul_f32 v7, v7, v4
    v_accvgpr_write_b32 a30, v7
    v_accvgpr_read_b32 v8, a31
    v_mul_f32 v8, v8, v4
    v_accvgpr_write_b32 a31, v8
    v_accvgpr_read_b32 v5, a32
    v_mul_f32 v5, v5, v4
    v_accvgpr_write_b32 a32, v5
    v_accvgpr_read_b32 v6, a33
    v_mul_f32 v6, v6, v4
    v_accvgpr_write_b32 a33, v6
    v_accvgpr_read_b32 v7, a34
    v_mul_f32 v7, v7, v4
    v_accvgpr_write_b32 a34, v7
    v_accvgpr_read_b32 v8, a35
    v_mul_f32 v8, v8, v4
    v_accvgpr_write_b32 a35, v8
    v_accvgpr_read_b32 v5, a36
    v_mul_f32 v5, v5, v4
    v_accvgpr_write_b32 a36, v5
    v_accvgpr_read_b32 v6, a37
    v_mul_f32 v6, v6, v4
    v_accvgpr_write_b32 a37, v6
    v_accvgpr_read_b32 v7, a38
    v_mul_f32 v7, v7, v4
    v_accvgpr_write_b32 a38, v7
    v_accvgpr_read_b32 v8, a39
    v_mul_f32 v8, v8, v4
    v_accvgpr_write_b32 a39, v8
    v_accvgpr_read_b32 v5, a40
    v_mul_f32 v5, v5, v4
    v_accvgpr_write_b32 a40, v5
    v_accvgpr_read_b32 v6, a41
    v_mul_f32 v6, v6, v4
    v_accvgpr_write_b32 a41, v6
    v_accvgpr_read_b32 v7, a42
    v_mul_f32 v7, v7, v4
    v_accvgpr_write_b32 a42, v7
    v_accvgpr_read_b32 v8, a43
    v_mul_f32 v8, v8, v4
    v_accvgpr_write_b32 a43, v8
    v_accvgpr_read_b32 v5, a44
    v_mul_f32 v5, v5, v4
    v_accvgpr_write_b32 a44, v5
    v_accvgpr_read_b32 v6, a45
    v_mul_f32 v6, v6, v4
    v_accvgpr_write_b32 a45, v6
    v_accvgpr_read_b32 v7, a46
    v_mul_f32 v7, v7, v4
    v_accvgpr_write_b32 a46, v7
    v_accvgpr_read_b32 v8, a47
    v_mul_f32 v8, v8, v4
    v_accvgpr_write_b32 a47, v8
    v_accvgpr_read_b32 v5, a48
    v_mul_f32 v5, v5, v4
    v_accvgpr_write_b32 a48, v5
    v_accvgpr_read_b32 v6, a49
    v_mul_f32 v6, v6, v4
    v_accvgpr_write_b32 a49, v6
    v_accvgpr_read_b32 v7, a50
    v_mul_f32 v7, v7, v4
    v_accvgpr_write_b32 a50, v7
    v_accvgpr_read_b32 v8, a51
    v_mul_f32 v8, v8, v4
    v_accvgpr_write_b32 a51, v8
    v_accvgpr_read_b32 v5, a52
    v_mul_f32 v5, v5, v4
    v_accvgpr_write_b32 a52, v5
    v_accvgpr_read_b32 v6, a53
    v_mul_f32 v6, v6, v4
    v_accvgpr_write_b32 a53, v6
    v_accvgpr_read_b32 v7, a54
    v_mul_f32 v7, v7, v4
    v_accvgpr_write_b32 a54, v7
    v_accvgpr_read_b32 v8, a55
    v_mul_f32 v8, v8, v4
    v_accvgpr_write_b32 a55, v8
    v_accvgpr_read_b32 v5, a56
    v_mul_f32 v5, v5, v4
    v_accvgpr_write_b32 a56, v5
    v_accvgpr_read_b32 v6, a57
    v_mul_f32 v6, v6, v4
    v_accvgpr_write_b32 a57, v6
    v_accvgpr_read_b32 v7, a58
    v_mul_f32 v7, v7, v4
    v_accvgpr_write_b32 a58, v7
    v_accvgpr_read_b32 v8, a59
    v_mul_f32 v8, v8, v4
    v_accvgpr_write_b32 a59, v8
    v_accvgpr_read_b32 v5, a60
    v_mul_f32 v5, v5, v4
    v_accvgpr_write_b32 a60, v5
    v_accvgpr_read_b32 v6, a61
    v_mul_f32 v6, v6, v4
    v_accvgpr_write_b32 a61, v6
    v_accvgpr_read_b32 v7, a62
    v_mul_f32 v7, v7, v4
    v_accvgpr_write_b32 a62, v7
    v_accvgpr_read_b32 v8, a63
    v_mul_f32 v8, v8, v4
    v_accvgpr_write_b32 a63, v8
    v_accvgpr_read_b32 v5, a64
    v_mul_f32 v5, v5, v4
    v_accvgpr_write_b32 a64, v5
    v_accvgpr_read_b32 v6, a65
    v_mul_f32 v6, v6, v4
    v_accvgpr_write_b32 a65, v6
    v_accvgpr_read_b32 v7, a66
    v_mul_f32 v7, v7, v4
    v_accvgpr_write_b32 a66, v7
    v_accvgpr_read_b32 v8, a67
    v_mul_f32 v8, v8, v4
    v_accvgpr_write_b32 a67, v8
    v_accvgpr_read_b32 v5, a68
    v_mul_f32 v5, v5, v4
    v_accvgpr_write_b32 a68, v5
    v_accvgpr_read_b32 v6, a69
    v_mul_f32 v6, v6, v4
    v_accvgpr_write_b32 a69, v6
    v_accvgpr_read_b32 v7, a70
    v_mul_f32 v7, v7, v4
    v_accvgpr_write_b32 a70, v7
    v_accvgpr_read_b32 v8, a71
    v_mul_f32 v8, v8, v4
    v_accvgpr_write_b32 a71, v8
    v_accvgpr_read_b32 v5, a72
    v_mul_f32 v5, v5, v4
    v_accvgpr_write_b32 a72, v5
    v_accvgpr_read_b32 v6, a73
    v_mul_f32 v6, v6, v4
    v_accvgpr_write_b32 a73, v6
    v_accvgpr_read_b32 v7, a74
    v_mul_f32 v7, v7, v4
    v_accvgpr_write_b32 a74, v7
    v_accvgpr_read_b32 v8, a75
    v_mul_f32 v8, v8, v4
    v_accvgpr_write_b32 a75, v8
    v_accvgpr_read_b32 v5, a76
    v_mul_f32 v5, v5, v4
    v_accvgpr_write_b32 a76, v5
    v_accvgpr_read_b32 v6, a77
    v_mul_f32 v6, v6, v4
    v_accvgpr_write_b32 a77, v6
    v_accvgpr_read_b32 v7, a78
    v_mul_f32 v7, v7, v4
    v_accvgpr_write_b32 a78, v7
    v_accvgpr_read_b32 v8, a79
    v_mul_f32 v8, v8, v4
    v_accvgpr_write_b32 a79, v8
    v_accvgpr_read_b32 v5, a80
    v_mul_f32 v5, v5, v4
    v_accvgpr_write_b32 a80, v5
    v_accvgpr_read_b32 v6, a81
    v_mul_f32 v6, v6, v4
    v_accvgpr_write_b32 a81, v6
    v_accvgpr_read_b32 v7, a82
    v_mul_f32 v7, v7, v4
    v_accvgpr_write_b32 a82, v7
    v_accvgpr_read_b32 v8, a83
    v_mul_f32 v8, v8, v4
    v_accvgpr_write_b32 a83, v8
    v_accvgpr_read_b32 v5, a84
    v_mul_f32 v5, v5, v4
    v_accvgpr_write_b32 a84, v5
    v_accvgpr_read_b32 v6, a85
    v_mul_f32 v6, v6, v4
    v_accvgpr_write_b32 a85, v6
    v_accvgpr_read_b32 v7, a86
    v_mul_f32 v7, v7, v4
    v_accvgpr_write_b32 a86, v7
    v_accvgpr_read_b32 v8, a87
    v_mul_f32 v8, v8, v4
    v_accvgpr_write_b32 a87, v8
    v_accvgpr_read_b32 v5, a88
    v_mul_f32 v5, v5, v4
    v_accvgpr_write_b32 a88, v5
    v_accvgpr_read_b32 v6, a89
    v_mul_f32 v6, v6, v4
    v_accvgpr_write_b32 a89, v6
    v_accvgpr_read_b32 v7, a90
    v_mul_f32 v7, v7, v4
    v_accvgpr_write_b32 a90, v7
    v_accvgpr_read_b32 v8, a91
    v_mul_f32 v8, v8, v4
    v_accvgpr_write_b32 a91, v8
    v_accvgpr_read_b32 v5, a92
    v_mul_f32 v5, v5, v4
    v_accvgpr_write_b32 a92, v5
    v_accvgpr_read_b32 v6, a93
    v_mul_f32 v6, v6, v4
    v_accvgpr_write_b32 a93, v6
    v_accvgpr_read_b32 v7, a94
    v_mul_f32 v7, v7, v4
    v_accvgpr_write_b32 a94, v7
    v_accvgpr_read_b32 v8, a95
    v_mul_f32 v8, v8, v4
    v_accvgpr_write_b32 a95, v8
    v_accvgpr_read_b32 v5, a96
    v_mul_f32 v5, v5, v4
    v_accvgpr_write_b32 a96, v5
    v_accvgpr_read_b32 v6, a97
    v_mul_f32 v6, v6, v4
    v_accvgpr_write_b32 a97, v6
    v_accvgpr_read_b32 v7, a98
    v_mul_f32 v7, v7, v4
    v_accvgpr_write_b32 a98, v7
    v_accvgpr_read_b32 v8, a99
    v_mul_f32 v8, v8, v4
    v_accvgpr_write_b32 a99, v8
    v_accvgpr_read_b32 v5, a100
    v_mul_f32 v5, v5, v4
    v_accvgpr_write_b32 a100, v5
    v_accvgpr_read_b32 v6, a101
    v_mul_f32 v6, v6, v4
    v_accvgpr_write_b32 a101, v6
    v_accvgpr_read_b32 v7, a102
    v_mul_f32 v7, v7, v4
    v_accvgpr_write_b32 a102, v7
    v_accvgpr_read_b32 v8, a103
    v_mul_f32 v8, v8, v4
    v_accvgpr_write_b32 a103, v8
    v_accvgpr_read_b32 v5, a104
    v_mul_f32 v5, v5, v4
    v_accvgpr_write_b32 a104, v5
    v_accvgpr_read_b32 v6, a105
    v_mul_f32 v6, v6, v4
    v_accvgpr_write_b32 a105, v6
    v_accvgpr_read_b32 v7, a106
    v_mul_f32 v7, v7, v4
    v_accvgpr_write_b32 a106, v7
    v_accvgpr_read_b32 v8, a107
    v_mul_f32 v8, v8, v4
    v_accvgpr_write_b32 a107, v8
    v_accvgpr_read_b32 v5, a108
    v_mul_f32 v5, v5, v4
    v_accvgpr_write_b32 a108, v5
    v_accvgpr_read_b32 v6, a109
    v_mul_f32 v6, v6, v4
    v_accvgpr_write_b32 a109, v6
    v_accvgpr_read_b32 v7, a110
    v_mul_f32 v7, v7, v4
    v_accvgpr_write_b32 a110, v7
    v_accvgpr_read_b32 v8, a111
    v_mul_f32 v8, v8, v4
    v_accvgpr_write_b32 a111, v8
    v_accvgpr_read_b32 v5, a112
    v_mul_f32 v5, v5, v4
    v_accvgpr_write_b32 a112, v5
    v_accvgpr_read_b32 v6, a113
    v_mul_f32 v6, v6, v4
    v_accvgpr_write_b32 a113, v6
    v_accvgpr_read_b32 v7, a114
    v_mul_f32 v7, v7, v4
    v_accvgpr_write_b32 a114, v7
    v_accvgpr_read_b32 v8, a115
    v_mul_f32 v8, v8, v4
    v_accvgpr_write_b32 a115, v8
    v_accvgpr_read_b32 v5, a116
    v_mul_f32 v5, v5, v4
    v_accvgpr_write_b32 a116, v5
    v_accvgpr_read_b32 v6, a117
    v_mul_f32 v6, v6, v4
    v_accvgpr_write_b32 a117, v6
    v_accvgpr_read_b32 v7, a118
    v_mul_f32 v7, v7, v4
    v_accvgpr_write_b32 a118, v7
    v_accvgpr_read_b32 v8, a119
    v_mul_f32 v8, v8, v4
    v_accvgpr_write_b32 a119, v8
    v_accvgpr_read_b32 v5, a120
    v_mul_f32 v5, v5, v4
    v_accvgpr_write_b32 a120, v5
    v_accvgpr_read_b32 v6, a121
    v_mul_f32 v6, v6, v4
    v_accvgpr_write_b32 a121, v6
    v_accvgpr_read_b32 v7, a122
    v_mul_f32 v7, v7, v4
    v_accvgpr_write_b32 a122, v7
    v_accvgpr_read_b32 v8, a123
    v_mul_f32 v8, v8, v4
    v_accvgpr_write_b32 a123, v8
    v_accvgpr_read_b32 v5, a124
    v_mul_f32 v5, v5, v4
    v_accvgpr_write_b32 a124, v5
    v_accvgpr_read_b32 v6, a125
    v_mul_f32 v6, v6, v4
    v_accvgpr_write_b32 a125, v6
    v_accvgpr_read_b32 v7, a126
    v_mul_f32 v7, v7, v4
    v_accvgpr_write_b32 a126, v7
    v_accvgpr_read_b32 v8, a127
    v_mul_f32 v8, v8, v4
    v_accvgpr_write_b32 a127, v8
    s_nop 1
    s_branch LRB_50
LRS_51:
    v_max_f32 v3, v32, v2
    v_sub_f32 v4, v32, v3
    v_exp_f32 v4, v4
    v_mov_b32 v32, v3
    s_nop 0
    v_mul_f32 v33, v33, v4
    s_nop 15
    v_accvgpr_read_b32 v5, a0
    v_mul_f32 v5, v5, v4
    v_accvgpr_write_b32 a0, v5
    v_accvgpr_read_b32 v6, a1
    v_mul_f32 v6, v6, v4
    v_accvgpr_write_b32 a1, v6
    v_accvgpr_read_b32 v7, a2
    v_mul_f32 v7, v7, v4
    v_accvgpr_write_b32 a2, v7
    v_accvgpr_read_b32 v8, a3
    v_mul_f32 v8, v8, v4
    v_accvgpr_write_b32 a3, v8
    v_accvgpr_read_b32 v5, a4
    v_mul_f32 v5, v5, v4
    v_accvgpr_write_b32 a4, v5
    v_accvgpr_read_b32 v6, a5
    v_mul_f32 v6, v6, v4
    v_accvgpr_write_b32 a5, v6
    v_accvgpr_read_b32 v7, a6
    v_mul_f32 v7, v7, v4
    v_accvgpr_write_b32 a6, v7
    v_accvgpr_read_b32 v8, a7
    v_mul_f32 v8, v8, v4
    v_accvgpr_write_b32 a7, v8
    v_accvgpr_read_b32 v5, a8
    v_mul_f32 v5, v5, v4
    v_accvgpr_write_b32 a8, v5
    v_accvgpr_read_b32 v6, a9
    v_mul_f32 v6, v6, v4
    v_accvgpr_write_b32 a9, v6
    v_accvgpr_read_b32 v7, a10
    v_mul_f32 v7, v7, v4
    v_accvgpr_write_b32 a10, v7
    v_accvgpr_read_b32 v8, a11
    v_mul_f32 v8, v8, v4
    v_accvgpr_write_b32 a11, v8
    v_accvgpr_read_b32 v5, a12
    v_mul_f32 v5, v5, v4
    v_accvgpr_write_b32 a12, v5
    v_accvgpr_read_b32 v6, a13
    v_mul_f32 v6, v6, v4
    v_accvgpr_write_b32 a13, v6
    v_accvgpr_read_b32 v7, a14
    v_mul_f32 v7, v7, v4
    v_accvgpr_write_b32 a14, v7
    v_accvgpr_read_b32 v8, a15
    v_mul_f32 v8, v8, v4
    v_accvgpr_write_b32 a15, v8
    v_accvgpr_read_b32 v5, a16
    v_mul_f32 v5, v5, v4
    v_accvgpr_write_b32 a16, v5
    v_accvgpr_read_b32 v6, a17
    v_mul_f32 v6, v6, v4
    v_accvgpr_write_b32 a17, v6
    v_accvgpr_read_b32 v7, a18
    v_mul_f32 v7, v7, v4
    v_accvgpr_write_b32 a18, v7
    v_accvgpr_read_b32 v8, a19
    v_mul_f32 v8, v8, v4
    v_accvgpr_write_b32 a19, v8
    v_accvgpr_read_b32 v5, a20
    v_mul_f32 v5, v5, v4
    v_accvgpr_write_b32 a20, v5
    v_accvgpr_read_b32 v6, a21
    v_mul_f32 v6, v6, v4
    v_accvgpr_write_b32 a21, v6
    v_accvgpr_read_b32 v7, a22
    v_mul_f32 v7, v7, v4
    v_accvgpr_write_b32 a22, v7
    v_accvgpr_read_b32 v8, a23
    v_mul_f32 v8, v8, v4
    v_accvgpr_write_b32 a23, v8
    v_accvgpr_read_b32 v5, a24
    v_mul_f32 v5, v5, v4
    v_accvgpr_write_b32 a24, v5
    v_accvgpr_read_b32 v6, a25
    v_mul_f32 v6, v6, v4
    v_accvgpr_write_b32 a25, v6
    v_accvgpr_read_b32 v7, a26
    v_mul_f32 v7, v7, v4
    v_accvgpr_write_b32 a26, v7
    v_accvgpr_read_b32 v8, a27
    v_mul_f32 v8, v8, v4
    v_accvgpr_write_b32 a27, v8
    v_accvgpr_read_b32 v5, a28
    v_mul_f32 v5, v5, v4
    v_accvgpr_write_b32 a28, v5
    v_accvgpr_read_b32 v6, a29
    v_mul_f32 v6, v6, v4
    v_accvgpr_write_b32 a29, v6
    v_accvgpr_read_b32 v7, a30
    v_mul_f32 v7, v7, v4
    v_accvgpr_write_b32 a30, v7
    v_accvgpr_read_b32 v8, a31
    v_mul_f32 v8, v8, v4
    v_accvgpr_write_b32 a31, v8
    v_accvgpr_read_b32 v5, a32
    v_mul_f32 v5, v5, v4
    v_accvgpr_write_b32 a32, v5
    v_accvgpr_read_b32 v6, a33
    v_mul_f32 v6, v6, v4
    v_accvgpr_write_b32 a33, v6
    v_accvgpr_read_b32 v7, a34
    v_mul_f32 v7, v7, v4
    v_accvgpr_write_b32 a34, v7
    v_accvgpr_read_b32 v8, a35
    v_mul_f32 v8, v8, v4
    v_accvgpr_write_b32 a35, v8
    v_accvgpr_read_b32 v5, a36
    v_mul_f32 v5, v5, v4
    v_accvgpr_write_b32 a36, v5
    v_accvgpr_read_b32 v6, a37
    v_mul_f32 v6, v6, v4
    v_accvgpr_write_b32 a37, v6
    v_accvgpr_read_b32 v7, a38
    v_mul_f32 v7, v7, v4
    v_accvgpr_write_b32 a38, v7
    v_accvgpr_read_b32 v8, a39
    v_mul_f32 v8, v8, v4
    v_accvgpr_write_b32 a39, v8
    v_accvgpr_read_b32 v5, a40
    v_mul_f32 v5, v5, v4
    v_accvgpr_write_b32 a40, v5
    v_accvgpr_read_b32 v6, a41
    v_mul_f32 v6, v6, v4
    v_accvgpr_write_b32 a41, v6
    v_accvgpr_read_b32 v7, a42
    v_mul_f32 v7, v7, v4
    v_accvgpr_write_b32 a42, v7
    v_accvgpr_read_b32 v8, a43
    v_mul_f32 v8, v8, v4
    v_accvgpr_write_b32 a43, v8
    v_accvgpr_read_b32 v5, a44
    v_mul_f32 v5, v5, v4
    v_accvgpr_write_b32 a44, v5
    v_accvgpr_read_b32 v6, a45
    v_mul_f32 v6, v6, v4
    v_accvgpr_write_b32 a45, v6
    v_accvgpr_read_b32 v7, a46
    v_mul_f32 v7, v7, v4
    v_accvgpr_write_b32 a46, v7
    v_accvgpr_read_b32 v8, a47
    v_mul_f32 v8, v8, v4
    v_accvgpr_write_b32 a47, v8
    v_accvgpr_read_b32 v5, a48
    v_mul_f32 v5, v5, v4
    v_accvgpr_write_b32 a48, v5
    v_accvgpr_read_b32 v6, a49
    v_mul_f32 v6, v6, v4
    v_accvgpr_write_b32 a49, v6
    v_accvgpr_read_b32 v7, a50
    v_mul_f32 v7, v7, v4
    v_accvgpr_write_b32 a50, v7
    v_accvgpr_read_b32 v8, a51
    v_mul_f32 v8, v8, v4
    v_accvgpr_write_b32 a51, v8
    v_accvgpr_read_b32 v5, a52
    v_mul_f32 v5, v5, v4
    v_accvgpr_write_b32 a52, v5
    v_accvgpr_read_b32 v6, a53
    v_mul_f32 v6, v6, v4
    v_accvgpr_write_b32 a53, v6
    v_accvgpr_read_b32 v7, a54
    v_mul_f32 v7, v7, v4
    v_accvgpr_write_b32 a54, v7
    v_accvgpr_read_b32 v8, a55
    v_mul_f32 v8, v8, v4
    v_accvgpr_write_b32 a55, v8
    v_accvgpr_read_b32 v5, a56
    v_mul_f32 v5, v5, v4
    v_accvgpr_write_b32 a56, v5
    v_accvgpr_read_b32 v6, a57
    v_mul_f32 v6, v6, v4
    v_accvgpr_write_b32 a57, v6
    v_accvgpr_read_b32 v7, a58
    v_mul_f32 v7, v7, v4
    v_accvgpr_write_b32 a58, v7
    v_accvgpr_read_b32 v8, a59
    v_mul_f32 v8, v8, v4
    v_accvgpr_write_b32 a59, v8
    v_accvgpr_read_b32 v5, a60
    v_mul_f32 v5, v5, v4
    v_accvgpr_write_b32 a60, v5
    v_accvgpr_read_b32 v6, a61
    v_mul_f32 v6, v6, v4
    v_accvgpr_write_b32 a61, v6
    v_accvgpr_read_b32 v7, a62
    v_mul_f32 v7, v7, v4
    v_accvgpr_write_b32 a62, v7
    v_accvgpr_read_b32 v8, a63
    v_mul_f32 v8, v8, v4
    v_accvgpr_write_b32 a63, v8
    v_accvgpr_read_b32 v5, a64
    v_mul_f32 v5, v5, v4
    v_accvgpr_write_b32 a64, v5
    v_accvgpr_read_b32 v6, a65
    v_mul_f32 v6, v6, v4
    v_accvgpr_write_b32 a65, v6
    v_accvgpr_read_b32 v7, a66
    v_mul_f32 v7, v7, v4
    v_accvgpr_write_b32 a66, v7
    v_accvgpr_read_b32 v8, a67
    v_mul_f32 v8, v8, v4
    v_accvgpr_write_b32 a67, v8
    v_accvgpr_read_b32 v5, a68
    v_mul_f32 v5, v5, v4
    v_accvgpr_write_b32 a68, v5
    v_accvgpr_read_b32 v6, a69
    v_mul_f32 v6, v6, v4
    v_accvgpr_write_b32 a69, v6
    v_accvgpr_read_b32 v7, a70
    v_mul_f32 v7, v7, v4
    v_accvgpr_write_b32 a70, v7
    v_accvgpr_read_b32 v8, a71
    v_mul_f32 v8, v8, v4
    v_accvgpr_write_b32 a71, v8
    v_accvgpr_read_b32 v5, a72
    v_mul_f32 v5, v5, v4
    v_accvgpr_write_b32 a72, v5
    v_accvgpr_read_b32 v6, a73
    v_mul_f32 v6, v6, v4
    v_accvgpr_write_b32 a73, v6
    v_accvgpr_read_b32 v7, a74
    v_mul_f32 v7, v7, v4
    v_accvgpr_write_b32 a74, v7
    v_accvgpr_read_b32 v8, a75
    v_mul_f32 v8, v8, v4
    v_accvgpr_write_b32 a75, v8
    v_accvgpr_read_b32 v5, a76
    v_mul_f32 v5, v5, v4
    v_accvgpr_write_b32 a76, v5
    v_accvgpr_read_b32 v6, a77
    v_mul_f32 v6, v6, v4
    v_accvgpr_write_b32 a77, v6
    v_accvgpr_read_b32 v7, a78
    v_mul_f32 v7, v7, v4
    v_accvgpr_write_b32 a78, v7
    v_accvgpr_read_b32 v8, a79
    v_mul_f32 v8, v8, v4
    v_accvgpr_write_b32 a79, v8
    v_accvgpr_read_b32 v5, a80
    v_mul_f32 v5, v5, v4
    v_accvgpr_write_b32 a80, v5
    v_accvgpr_read_b32 v6, a81
    v_mul_f32 v6, v6, v4
    v_accvgpr_write_b32 a81, v6
    v_accvgpr_read_b32 v7, a82
    v_mul_f32 v7, v7, v4
    v_accvgpr_write_b32 a82, v7
    v_accvgpr_read_b32 v8, a83
    v_mul_f32 v8, v8, v4
    v_accvgpr_write_b32 a83, v8
    v_accvgpr_read_b32 v5, a84
    v_mul_f32 v5, v5, v4
    v_accvgpr_write_b32 a84, v5
    v_accvgpr_read_b32 v6, a85
    v_mul_f32 v6, v6, v4
    v_accvgpr_write_b32 a85, v6
    v_accvgpr_read_b32 v7, a86
    v_mul_f32 v7, v7, v4
    v_accvgpr_write_b32 a86, v7
    v_accvgpr_read_b32 v8, a87
    v_mul_f32 v8, v8, v4
    v_accvgpr_write_b32 a87, v8
    v_accvgpr_read_b32 v5, a88
    v_mul_f32 v5, v5, v4
    v_accvgpr_write_b32 a88, v5
    v_accvgpr_read_b32 v6, a89
    v_mul_f32 v6, v6, v4
    v_accvgpr_write_b32 a89, v6
    v_accvgpr_read_b32 v7, a90
    v_mul_f32 v7, v7, v4
    v_accvgpr_write_b32 a90, v7
    v_accvgpr_read_b32 v8, a91
    v_mul_f32 v8, v8, v4
    v_accvgpr_write_b32 a91, v8
    v_accvgpr_read_b32 v5, a92
    v_mul_f32 v5, v5, v4
    v_accvgpr_write_b32 a92, v5
    v_accvgpr_read_b32 v6, a93
    v_mul_f32 v6, v6, v4
    v_accvgpr_write_b32 a93, v6
    v_accvgpr_read_b32 v7, a94
    v_mul_f32 v7, v7, v4
    v_accvgpr_write_b32 a94, v7
    v_accvgpr_read_b32 v8, a95
    v_mul_f32 v8, v8, v4
    v_accvgpr_write_b32 a95, v8
    v_accvgpr_read_b32 v5, a96
    v_mul_f32 v5, v5, v4
    v_accvgpr_write_b32 a96, v5
    v_accvgpr_read_b32 v6, a97
    v_mul_f32 v6, v6, v4
    v_accvgpr_write_b32 a97, v6
    v_accvgpr_read_b32 v7, a98
    v_mul_f32 v7, v7, v4
    v_accvgpr_write_b32 a98, v7
    v_accvgpr_read_b32 v8, a99
    v_mul_f32 v8, v8, v4
    v_accvgpr_write_b32 a99, v8
    v_accvgpr_read_b32 v5, a100
    v_mul_f32 v5, v5, v4
    v_accvgpr_write_b32 a100, v5
    v_accvgpr_read_b32 v6, a101
    v_mul_f32 v6, v6, v4
    v_accvgpr_write_b32 a101, v6
    v_accvgpr_read_b32 v7, a102
    v_mul_f32 v7, v7, v4
    v_accvgpr_write_b32 a102, v7
    v_accvgpr_read_b32 v8, a103
    v_mul_f32 v8, v8, v4
    v_accvgpr_write_b32 a103, v8
    v_accvgpr_read_b32 v5, a104
    v_mul_f32 v5, v5, v4
    v_accvgpr_write_b32 a104, v5
    v_accvgpr_read_b32 v6, a105
    v_mul_f32 v6, v6, v4
    v_accvgpr_write_b32 a105, v6
    v_accvgpr_read_b32 v7, a106
    v_mul_f32 v7, v7, v4
    v_accvgpr_write_b32 a106, v7
    v_accvgpr_read_b32 v8, a107
    v_mul_f32 v8, v8, v4
    v_accvgpr_write_b32 a107, v8
    v_accvgpr_read_b32 v5, a108
    v_mul_f32 v5, v5, v4
    v_accvgpr_write_b32 a108, v5
    v_accvgpr_read_b32 v6, a109
    v_mul_f32 v6, v6, v4
    v_accvgpr_write_b32 a109, v6
    v_accvgpr_read_b32 v7, a110
    v_mul_f32 v7, v7, v4
    v_accvgpr_write_b32 a110, v7
    v_accvgpr_read_b32 v8, a111
    v_mul_f32 v8, v8, v4
    v_accvgpr_write_b32 a111, v8
    v_accvgpr_read_b32 v5, a112
    v_mul_f32 v5, v5, v4
    v_accvgpr_write_b32 a112, v5
    v_accvgpr_read_b32 v6, a113
    v_mul_f32 v6, v6, v4
    v_accvgpr_write_b32 a113, v6
    v_accvgpr_read_b32 v7, a114
    v_mul_f32 v7, v7, v4
    v_accvgpr_write_b32 a114, v7
    v_accvgpr_read_b32 v8, a115
    v_mul_f32 v8, v8, v4
    v_accvgpr_write_b32 a115, v8
    v_accvgpr_read_b32 v5, a116
    v_mul_f32 v5, v5, v4
    v_accvgpr_write_b32 a116, v5
    v_accvgpr_read_b32 v6, a117
    v_mul_f32 v6, v6, v4
    v_accvgpr_write_b32 a117, v6
    v_accvgpr_read_b32 v7, a118
    v_mul_f32 v7, v7, v4
    v_accvgpr_write_b32 a118, v7
    v_accvgpr_read_b32 v8, a119
    v_mul_f32 v8, v8, v4
    v_accvgpr_write_b32 a119, v8
    v_accvgpr_read_b32 v5, a120
    v_mul_f32 v5, v5, v4
    v_accvgpr_write_b32 a120, v5
    v_accvgpr_read_b32 v6, a121
    v_mul_f32 v6, v6, v4
    v_accvgpr_write_b32 a121, v6
    v_accvgpr_read_b32 v7, a122
    v_mul_f32 v7, v7, v4
    v_accvgpr_write_b32 a122, v7
    v_accvgpr_read_b32 v8, a123
    v_mul_f32 v8, v8, v4
    v_accvgpr_write_b32 a123, v8
    v_accvgpr_read_b32 v5, a124
    v_mul_f32 v5, v5, v4
    v_accvgpr_write_b32 a124, v5
    v_accvgpr_read_b32 v6, a125
    v_mul_f32 v6, v6, v4
    v_accvgpr_write_b32 a125, v6
    v_accvgpr_read_b32 v7, a126
    v_mul_f32 v7, v7, v4
    v_accvgpr_write_b32 a126, v7
    v_accvgpr_read_b32 v8, a127
    v_mul_f32 v8, v8, v4
    v_accvgpr_write_b32 a127, v8
    s_nop 1
    s_branch LRB_52
LRS_53:
    v_max_f32 v3, v32, v2
    v_sub_f32 v4, v32, v3
    v_exp_f32 v4, v4
    v_mov_b32 v32, v3
    s_nop 0
    v_mul_f32 v33, v33, v4
    s_nop 15
    v_accvgpr_read_b32 v5, a0
    v_mul_f32 v5, v5, v4
    v_accvgpr_write_b32 a0, v5
    v_accvgpr_read_b32 v6, a1
    v_mul_f32 v6, v6, v4
    v_accvgpr_write_b32 a1, v6
    v_accvgpr_read_b32 v7, a2
    v_mul_f32 v7, v7, v4
    v_accvgpr_write_b32 a2, v7
    v_accvgpr_read_b32 v8, a3
    v_mul_f32 v8, v8, v4
    v_accvgpr_write_b32 a3, v8
    v_accvgpr_read_b32 v5, a4
    v_mul_f32 v5, v5, v4
    v_accvgpr_write_b32 a4, v5
    v_accvgpr_read_b32 v6, a5
    v_mul_f32 v6, v6, v4
    v_accvgpr_write_b32 a5, v6
    v_accvgpr_read_b32 v7, a6
    v_mul_f32 v7, v7, v4
    v_accvgpr_write_b32 a6, v7
    v_accvgpr_read_b32 v8, a7
    v_mul_f32 v8, v8, v4
    v_accvgpr_write_b32 a7, v8
    v_accvgpr_read_b32 v5, a8
    v_mul_f32 v5, v5, v4
    v_accvgpr_write_b32 a8, v5
    v_accvgpr_read_b32 v6, a9
    v_mul_f32 v6, v6, v4
    v_accvgpr_write_b32 a9, v6
    v_accvgpr_read_b32 v7, a10
    v_mul_f32 v7, v7, v4
    v_accvgpr_write_b32 a10, v7
    v_accvgpr_read_b32 v8, a11
    v_mul_f32 v8, v8, v4
    v_accvgpr_write_b32 a11, v8
    v_accvgpr_read_b32 v5, a12
    v_mul_f32 v5, v5, v4
    v_accvgpr_write_b32 a12, v5
    v_accvgpr_read_b32 v6, a13
    v_mul_f32 v6, v6, v4
    v_accvgpr_write_b32 a13, v6
    v_accvgpr_read_b32 v7, a14
    v_mul_f32 v7, v7, v4
    v_accvgpr_write_b32 a14, v7
    v_accvgpr_read_b32 v8, a15
    v_mul_f32 v8, v8, v4
    v_accvgpr_write_b32 a15, v8
    v_accvgpr_read_b32 v5, a16
    v_mul_f32 v5, v5, v4
    v_accvgpr_write_b32 a16, v5
    v_accvgpr_read_b32 v6, a17
    v_mul_f32 v6, v6, v4
    v_accvgpr_write_b32 a17, v6
    v_accvgpr_read_b32 v7, a18
    v_mul_f32 v7, v7, v4
    v_accvgpr_write_b32 a18, v7
    v_accvgpr_read_b32 v8, a19
    v_mul_f32 v8, v8, v4
    v_accvgpr_write_b32 a19, v8
    v_accvgpr_read_b32 v5, a20
    v_mul_f32 v5, v5, v4
    v_accvgpr_write_b32 a20, v5
    v_accvgpr_read_b32 v6, a21
    v_mul_f32 v6, v6, v4
    v_accvgpr_write_b32 a21, v6
    v_accvgpr_read_b32 v7, a22
    v_mul_f32 v7, v7, v4
    v_accvgpr_write_b32 a22, v7
    v_accvgpr_read_b32 v8, a23
    v_mul_f32 v8, v8, v4
    v_accvgpr_write_b32 a23, v8
    v_accvgpr_read_b32 v5, a24
    v_mul_f32 v5, v5, v4
    v_accvgpr_write_b32 a24, v5
    v_accvgpr_read_b32 v6, a25
    v_mul_f32 v6, v6, v4
    v_accvgpr_write_b32 a25, v6
    v_accvgpr_read_b32 v7, a26
    v_mul_f32 v7, v7, v4
    v_accvgpr_write_b32 a26, v7
    v_accvgpr_read_b32 v8, a27
    v_mul_f32 v8, v8, v4
    v_accvgpr_write_b32 a27, v8
    v_accvgpr_read_b32 v5, a28
    v_mul_f32 v5, v5, v4
    v_accvgpr_write_b32 a28, v5
    v_accvgpr_read_b32 v6, a29
    v_mul_f32 v6, v6, v4
    v_accvgpr_write_b32 a29, v6
    v_accvgpr_read_b32 v7, a30
    v_mul_f32 v7, v7, v4
    v_accvgpr_write_b32 a30, v7
    v_accvgpr_read_b32 v8, a31
    v_mul_f32 v8, v8, v4
    v_accvgpr_write_b32 a31, v8
    v_accvgpr_read_b32 v5, a32
    v_mul_f32 v5, v5, v4
    v_accvgpr_write_b32 a32, v5
    v_accvgpr_read_b32 v6, a33
    v_mul_f32 v6, v6, v4
    v_accvgpr_write_b32 a33, v6
    v_accvgpr_read_b32 v7, a34
    v_mul_f32 v7, v7, v4
    v_accvgpr_write_b32 a34, v7
    v_accvgpr_read_b32 v8, a35
    v_mul_f32 v8, v8, v4
    v_accvgpr_write_b32 a35, v8
    v_accvgpr_read_b32 v5, a36
    v_mul_f32 v5, v5, v4
    v_accvgpr_write_b32 a36, v5
    v_accvgpr_read_b32 v6, a37
    v_mul_f32 v6, v6, v4
    v_accvgpr_write_b32 a37, v6
    v_accvgpr_read_b32 v7, a38
    v_mul_f32 v7, v7, v4
    v_accvgpr_write_b32 a38, v7
    v_accvgpr_read_b32 v8, a39
    v_mul_f32 v8, v8, v4
    v_accvgpr_write_b32 a39, v8
    v_accvgpr_read_b32 v5, a40
    v_mul_f32 v5, v5, v4
    v_accvgpr_write_b32 a40, v5
    v_accvgpr_read_b32 v6, a41
    v_mul_f32 v6, v6, v4
    v_accvgpr_write_b32 a41, v6
    v_accvgpr_read_b32 v7, a42
    v_mul_f32 v7, v7, v4
    v_accvgpr_write_b32 a42, v7
    v_accvgpr_read_b32 v8, a43
    v_mul_f32 v8, v8, v4
    v_accvgpr_write_b32 a43, v8
    v_accvgpr_read_b32 v5, a44
    v_mul_f32 v5, v5, v4
    v_accvgpr_write_b32 a44, v5
    v_accvgpr_read_b32 v6, a45
    v_mul_f32 v6, v6, v4
    v_accvgpr_write_b32 a45, v6
    v_accvgpr_read_b32 v7, a46
    v_mul_f32 v7, v7, v4
    v_accvgpr_write_b32 a46, v7
    v_accvgpr_read_b32 v8, a47
    v_mul_f32 v8, v8, v4
    v_accvgpr_write_b32 a47, v8
    v_accvgpr_read_b32 v5, a48
    v_mul_f32 v5, v5, v4
    v_accvgpr_write_b32 a48, v5
    v_accvgpr_read_b32 v6, a49
    v_mul_f32 v6, v6, v4
    v_accvgpr_write_b32 a49, v6
    v_accvgpr_read_b32 v7, a50
    v_mul_f32 v7, v7, v4
    v_accvgpr_write_b32 a50, v7
    v_accvgpr_read_b32 v8, a51
    v_mul_f32 v8, v8, v4
    v_accvgpr_write_b32 a51, v8
    v_accvgpr_read_b32 v5, a52
    v_mul_f32 v5, v5, v4
    v_accvgpr_write_b32 a52, v5
    v_accvgpr_read_b32 v6, a53
    v_mul_f32 v6, v6, v4
    v_accvgpr_write_b32 a53, v6
    v_accvgpr_read_b32 v7, a54
    v_mul_f32 v7, v7, v4
    v_accvgpr_write_b32 a54, v7
    v_accvgpr_read_b32 v8, a55
    v_mul_f32 v8, v8, v4
    v_accvgpr_write_b32 a55, v8
    v_accvgpr_read_b32 v5, a56
    v_mul_f32 v5, v5, v4
    v_accvgpr_write_b32 a56, v5
    v_accvgpr_read_b32 v6, a57
    v_mul_f32 v6, v6, v4
    v_accvgpr_write_b32 a57, v6
    v_accvgpr_read_b32 v7, a58
    v_mul_f32 v7, v7, v4
    v_accvgpr_write_b32 a58, v7
    v_accvgpr_read_b32 v8, a59
    v_mul_f32 v8, v8, v4
    v_accvgpr_write_b32 a59, v8
    v_accvgpr_read_b32 v5, a60
    v_mul_f32 v5, v5, v4
    v_accvgpr_write_b32 a60, v5
    v_accvgpr_read_b32 v6, a61
    v_mul_f32 v6, v6, v4
    v_accvgpr_write_b32 a61, v6
    v_accvgpr_read_b32 v7, a62
    v_mul_f32 v7, v7, v4
    v_accvgpr_write_b32 a62, v7
    v_accvgpr_read_b32 v8, a63
    v_mul_f32 v8, v8, v4
    v_accvgpr_write_b32 a63, v8
    v_accvgpr_read_b32 v5, a64
    v_mul_f32 v5, v5, v4
    v_accvgpr_write_b32 a64, v5
    v_accvgpr_read_b32 v6, a65
    v_mul_f32 v6, v6, v4
    v_accvgpr_write_b32 a65, v6
    v_accvgpr_read_b32 v7, a66
    v_mul_f32 v7, v7, v4
    v_accvgpr_write_b32 a66, v7
    v_accvgpr_read_b32 v8, a67
    v_mul_f32 v8, v8, v4
    v_accvgpr_write_b32 a67, v8
    v_accvgpr_read_b32 v5, a68
    v_mul_f32 v5, v5, v4
    v_accvgpr_write_b32 a68, v5
    v_accvgpr_read_b32 v6, a69
    v_mul_f32 v6, v6, v4
    v_accvgpr_write_b32 a69, v6
    v_accvgpr_read_b32 v7, a70
    v_mul_f32 v7, v7, v4
    v_accvgpr_write_b32 a70, v7
    v_accvgpr_read_b32 v8, a71
    v_mul_f32 v8, v8, v4
    v_accvgpr_write_b32 a71, v8
    v_accvgpr_read_b32 v5, a72
    v_mul_f32 v5, v5, v4
    v_accvgpr_write_b32 a72, v5
    v_accvgpr_read_b32 v6, a73
    v_mul_f32 v6, v6, v4
    v_accvgpr_write_b32 a73, v6
    v_accvgpr_read_b32 v7, a74
    v_mul_f32 v7, v7, v4
    v_accvgpr_write_b32 a74, v7
    v_accvgpr_read_b32 v8, a75
    v_mul_f32 v8, v8, v4
    v_accvgpr_write_b32 a75, v8
    v_accvgpr_read_b32 v5, a76
    v_mul_f32 v5, v5, v4
    v_accvgpr_write_b32 a76, v5
    v_accvgpr_read_b32 v6, a77
    v_mul_f32 v6, v6, v4
    v_accvgpr_write_b32 a77, v6
    v_accvgpr_read_b32 v7, a78
    v_mul_f32 v7, v7, v4
    v_accvgpr_write_b32 a78, v7
    v_accvgpr_read_b32 v8, a79
    v_mul_f32 v8, v8, v4
    v_accvgpr_write_b32 a79, v8
    v_accvgpr_read_b32 v5, a80
    v_mul_f32 v5, v5, v4
    v_accvgpr_write_b32 a80, v5
    v_accvgpr_read_b32 v6, a81
    v_mul_f32 v6, v6, v4
    v_accvgpr_write_b32 a81, v6
    v_accvgpr_read_b32 v7, a82
    v_mul_f32 v7, v7, v4
    v_accvgpr_write_b32 a82, v7
    v_accvgpr_read_b32 v8, a83
    v_mul_f32 v8, v8, v4
    v_accvgpr_write_b32 a83, v8
    v_accvgpr_read_b32 v5, a84
    v_mul_f32 v5, v5, v4
    v_accvgpr_write_b32 a84, v5
    v_accvgpr_read_b32 v6, a85
    v_mul_f32 v6, v6, v4
    v_accvgpr_write_b32 a85, v6
    v_accvgpr_read_b32 v7, a86
    v_mul_f32 v7, v7, v4
    v_accvgpr_write_b32 a86, v7
    v_accvgpr_read_b32 v8, a87
    v_mul_f32 v8, v8, v4
    v_accvgpr_write_b32 a87, v8
    v_accvgpr_read_b32 v5, a88
    v_mul_f32 v5, v5, v4
    v_accvgpr_write_b32 a88, v5
    v_accvgpr_read_b32 v6, a89
    v_mul_f32 v6, v6, v4
    v_accvgpr_write_b32 a89, v6
    v_accvgpr_read_b32 v7, a90
    v_mul_f32 v7, v7, v4
    v_accvgpr_write_b32 a90, v7
    v_accvgpr_read_b32 v8, a91
    v_mul_f32 v8, v8, v4
    v_accvgpr_write_b32 a91, v8
    v_accvgpr_read_b32 v5, a92
    v_mul_f32 v5, v5, v4
    v_accvgpr_write_b32 a92, v5
    v_accvgpr_read_b32 v6, a93
    v_mul_f32 v6, v6, v4
    v_accvgpr_write_b32 a93, v6
    v_accvgpr_read_b32 v7, a94
    v_mul_f32 v7, v7, v4
    v_accvgpr_write_b32 a94, v7
    v_accvgpr_read_b32 v8, a95
    v_mul_f32 v8, v8, v4
    v_accvgpr_write_b32 a95, v8
    v_accvgpr_read_b32 v5, a96
    v_mul_f32 v5, v5, v4
    v_accvgpr_write_b32 a96, v5
    v_accvgpr_read_b32 v6, a97
    v_mul_f32 v6, v6, v4
    v_accvgpr_write_b32 a97, v6
    v_accvgpr_read_b32 v7, a98
    v_mul_f32 v7, v7, v4
    v_accvgpr_write_b32 a98, v7
    v_accvgpr_read_b32 v8, a99
    v_mul_f32 v8, v8, v4
    v_accvgpr_write_b32 a99, v8
    v_accvgpr_read_b32 v5, a100
    v_mul_f32 v5, v5, v4
    v_accvgpr_write_b32 a100, v5
    v_accvgpr_read_b32 v6, a101
    v_mul_f32 v6, v6, v4
    v_accvgpr_write_b32 a101, v6
    v_accvgpr_read_b32 v7, a102
    v_mul_f32 v7, v7, v4
    v_accvgpr_write_b32 a102, v7
    v_accvgpr_read_b32 v8, a103
    v_mul_f32 v8, v8, v4
    v_accvgpr_write_b32 a103, v8
    v_accvgpr_read_b32 v5, a104
    v_mul_f32 v5, v5, v4
    v_accvgpr_write_b32 a104, v5
    v_accvgpr_read_b32 v6, a105
    v_mul_f32 v6, v6, v4
    v_accvgpr_write_b32 a105, v6
    v_accvgpr_read_b32 v7, a106
    v_mul_f32 v7, v7, v4
    v_accvgpr_write_b32 a106, v7
    v_accvgpr_read_b32 v8, a107
    v_mul_f32 v8, v8, v4
    v_accvgpr_write_b32 a107, v8
    v_accvgpr_read_b32 v5, a108
    v_mul_f32 v5, v5, v4
    v_accvgpr_write_b32 a108, v5
    v_accvgpr_read_b32 v6, a109
    v_mul_f32 v6, v6, v4
    v_accvgpr_write_b32 a109, v6
    v_accvgpr_read_b32 v7, a110
    v_mul_f32 v7, v7, v4
    v_accvgpr_write_b32 a110, v7
    v_accvgpr_read_b32 v8, a111
    v_mul_f32 v8, v8, v4
    v_accvgpr_write_b32 a111, v8
    v_accvgpr_read_b32 v5, a112
    v_mul_f32 v5, v5, v4
    v_accvgpr_write_b32 a112, v5
    v_accvgpr_read_b32 v6, a113
    v_mul_f32 v6, v6, v4
    v_accvgpr_write_b32 a113, v6
    v_accvgpr_read_b32 v7, a114
    v_mul_f32 v7, v7, v4
    v_accvgpr_write_b32 a114, v7
    v_accvgpr_read_b32 v8, a115
    v_mul_f32 v8, v8, v4
    v_accvgpr_write_b32 a115, v8
    v_accvgpr_read_b32 v5, a116
    v_mul_f32 v5, v5, v4
    v_accvgpr_write_b32 a116, v5
    v_accvgpr_read_b32 v6, a117
    v_mul_f32 v6, v6, v4
    v_accvgpr_write_b32 a117, v6
    v_accvgpr_read_b32 v7, a118
    v_mul_f32 v7, v7, v4
    v_accvgpr_write_b32 a118, v7
    v_accvgpr_read_b32 v8, a119
    v_mul_f32 v8, v8, v4
    v_accvgpr_write_b32 a119, v8
    v_accvgpr_read_b32 v5, a120
    v_mul_f32 v5, v5, v4
    v_accvgpr_write_b32 a120, v5
    v_accvgpr_read_b32 v6, a121
    v_mul_f32 v6, v6, v4
    v_accvgpr_write_b32 a121, v6
    v_accvgpr_read_b32 v7, a122
    v_mul_f32 v7, v7, v4
    v_accvgpr_write_b32 a122, v7
    v_accvgpr_read_b32 v8, a123
    v_mul_f32 v8, v8, v4
    v_accvgpr_write_b32 a123, v8
    v_accvgpr_read_b32 v5, a124
    v_mul_f32 v5, v5, v4
    v_accvgpr_write_b32 a124, v5
    v_accvgpr_read_b32 v6, a125
    v_mul_f32 v6, v6, v4
    v_accvgpr_write_b32 a125, v6
    v_accvgpr_read_b32 v7, a126
    v_mul_f32 v7, v7, v4
    v_accvgpr_write_b32 a126, v7
    v_accvgpr_read_b32 v8, a127
    v_mul_f32 v8, v8, v4
    v_accvgpr_write_b32 a127, v8
    s_nop 1
    s_branch LRB_54
LRS_55:
    v_max_f32 v3, v34, v2
    v_sub_f32 v4, v34, v3
    v_exp_f32 v4, v4
    v_mov_b32 v34, v3
    s_nop 0
    v_mul_f32 v35, v35, v4
    s_nop 15
    v_accvgpr_read_b32 v5, a128
    v_mul_f32 v5, v5, v4
    v_accvgpr_write_b32 a128, v5
    v_accvgpr_read_b32 v6, a129
    v_mul_f32 v6, v6, v4
    v_accvgpr_write_b32 a129, v6
    v_accvgpr_read_b32 v7, a130
    v_mul_f32 v7, v7, v4
    v_accvgpr_write_b32 a130, v7
    v_accvgpr_read_b32 v8, a131
    v_mul_f32 v8, v8, v4
    v_accvgpr_write_b32 a131, v8
    v_accvgpr_read_b32 v5, a132
    v_mul_f32 v5, v5, v4
    v_accvgpr_write_b32 a132, v5
    v_accvgpr_read_b32 v6, a133
    v_mul_f32 v6, v6, v4
    v_accvgpr_write_b32 a133, v6
    v_accvgpr_read_b32 v7, a134
    v_mul_f32 v7, v7, v4
    v_accvgpr_write_b32 a134, v7
    v_accvgpr_read_b32 v8, a135
    v_mul_f32 v8, v8, v4
    v_accvgpr_write_b32 a135, v8
    v_accvgpr_read_b32 v5, a136
    v_mul_f32 v5, v5, v4
    v_accvgpr_write_b32 a136, v5
    v_accvgpr_read_b32 v6, a137
    v_mul_f32 v6, v6, v4
    v_accvgpr_write_b32 a137, v6
    v_accvgpr_read_b32 v7, a138
    v_mul_f32 v7, v7, v4
    v_accvgpr_write_b32 a138, v7
    v_accvgpr_read_b32 v8, a139
    v_mul_f32 v8, v8, v4
    v_accvgpr_write_b32 a139, v8
    v_accvgpr_read_b32 v5, a140
    v_mul_f32 v5, v5, v4
    v_accvgpr_write_b32 a140, v5
    v_accvgpr_read_b32 v6, a141
    v_mul_f32 v6, v6, v4
    v_accvgpr_write_b32 a141, v6
    v_accvgpr_read_b32 v7, a142
    v_mul_f32 v7, v7, v4
    v_accvgpr_write_b32 a142, v7
    v_accvgpr_read_b32 v8, a143
    v_mul_f32 v8, v8, v4
    v_accvgpr_write_b32 a143, v8
    v_accvgpr_read_b32 v5, a144
    v_mul_f32 v5, v5, v4
    v_accvgpr_write_b32 a144, v5
    v_accvgpr_read_b32 v6, a145
    v_mul_f32 v6, v6, v4
    v_accvgpr_write_b32 a145, v6
    v_accvgpr_read_b32 v7, a146
    v_mul_f32 v7, v7, v4
    v_accvgpr_write_b32 a146, v7
    v_accvgpr_read_b32 v8, a147
    v_mul_f32 v8, v8, v4
    v_accvgpr_write_b32 a147, v8
    v_accvgpr_read_b32 v5, a148
    v_mul_f32 v5, v5, v4
    v_accvgpr_write_b32 a148, v5
    v_accvgpr_read_b32 v6, a149
    v_mul_f32 v6, v6, v4
    v_accvgpr_write_b32 a149, v6
    v_accvgpr_read_b32 v7, a150
    v_mul_f32 v7, v7, v4
    v_accvgpr_write_b32 a150, v7
    v_accvgpr_read_b32 v8, a151
    v_mul_f32 v8, v8, v4
    v_accvgpr_write_b32 a151, v8
    v_accvgpr_read_b32 v5, a152
    v_mul_f32 v5, v5, v4
    v_accvgpr_write_b32 a152, v5
    v_accvgpr_read_b32 v6, a153
    v_mul_f32 v6, v6, v4
    v_accvgpr_write_b32 a153, v6
    v_accvgpr_read_b32 v7, a154
    v_mul_f32 v7, v7, v4
    v_accvgpr_write_b32 a154, v7
    v_accvgpr_read_b32 v8, a155
    v_mul_f32 v8, v8, v4
    v_accvgpr_write_b32 a155, v8
    v_accvgpr_read_b32 v5, a156
    v_mul_f32 v5, v5, v4
    v_accvgpr_write_b32 a156, v5
    v_accvgpr_read_b32 v6, a157
    v_mul_f32 v6, v6, v4
    v_accvgpr_write_b32 a157, v6
    v_accvgpr_read_b32 v7, a158
    v_mul_f32 v7, v7, v4
    v_accvgpr_write_b32 a158, v7
    v_accvgpr_read_b32 v8, a159
    v_mul_f32 v8, v8, v4
    v_accvgpr_write_b32 a159, v8
    v_accvgpr_read_b32 v5, a160
    v_mul_f32 v5, v5, v4
    v_accvgpr_write_b32 a160, v5
    v_accvgpr_read_b32 v6, a161
    v_mul_f32 v6, v6, v4
    v_accvgpr_write_b32 a161, v6
    v_accvgpr_read_b32 v7, a162
    v_mul_f32 v7, v7, v4
    v_accvgpr_write_b32 a162, v7
    v_accvgpr_read_b32 v8, a163
    v_mul_f32 v8, v8, v4
    v_accvgpr_write_b32 a163, v8
    v_accvgpr_read_b32 v5, a164
    v_mul_f32 v5, v5, v4
    v_accvgpr_write_b32 a164, v5
    v_accvgpr_read_b32 v6, a165
    v_mul_f32 v6, v6, v4
    v_accvgpr_write_b32 a165, v6
    v_accvgpr_read_b32 v7, a166
    v_mul_f32 v7, v7, v4
    v_accvgpr_write_b32 a166, v7
    v_accvgpr_read_b32 v8, a167
    v_mul_f32 v8, v8, v4
    v_accvgpr_write_b32 a167, v8
    v_accvgpr_read_b32 v5, a168
    v_mul_f32 v5, v5, v4
    v_accvgpr_write_b32 a168, v5
    v_accvgpr_read_b32 v6, a169
    v_mul_f32 v6, v6, v4
    v_accvgpr_write_b32 a169, v6
    v_accvgpr_read_b32 v7, a170
    v_mul_f32 v7, v7, v4
    v_accvgpr_write_b32 a170, v7
    v_accvgpr_read_b32 v8, a171
    v_mul_f32 v8, v8, v4
    v_accvgpr_write_b32 a171, v8
    v_accvgpr_read_b32 v5, a172
    v_mul_f32 v5, v5, v4
    v_accvgpr_write_b32 a172, v5
    v_accvgpr_read_b32 v6, a173
    v_mul_f32 v6, v6, v4
    v_accvgpr_write_b32 a173, v6
    v_accvgpr_read_b32 v7, a174
    v_mul_f32 v7, v7, v4
    v_accvgpr_write_b32 a174, v7
    v_accvgpr_read_b32 v8, a175
    v_mul_f32 v8, v8, v4
    v_accvgpr_write_b32 a175, v8
    v_accvgpr_read_b32 v5, a176
    v_mul_f32 v5, v5, v4
    v_accvgpr_write_b32 a176, v5
    v_accvgpr_read_b32 v6, a177
    v_mul_f32 v6, v6, v4
    v_accvgpr_write_b32 a177, v6
    v_accvgpr_read_b32 v7, a178
    v_mul_f32 v7, v7, v4
    v_accvgpr_write_b32 a178, v7
    v_accvgpr_read_b32 v8, a179
    v_mul_f32 v8, v8, v4
    v_accvgpr_write_b32 a179, v8
    v_accvgpr_read_b32 v5, a180
    v_mul_f32 v5, v5, v4
    v_accvgpr_write_b32 a180, v5
    v_accvgpr_read_b32 v6, a181
    v_mul_f32 v6, v6, v4
    v_accvgpr_write_b32 a181, v6
    v_accvgpr_read_b32 v7, a182
    v_mul_f32 v7, v7, v4
    v_accvgpr_write_b32 a182, v7
    v_accvgpr_read_b32 v8, a183
    v_mul_f32 v8, v8, v4
    v_accvgpr_write_b32 a183, v8
    v_accvgpr_read_b32 v5, a184
    v_mul_f32 v5, v5, v4
    v_accvgpr_write_b32 a184, v5
    v_accvgpr_read_b32 v6, a185
    v_mul_f32 v6, v6, v4
    v_accvgpr_write_b32 a185, v6
    v_accvgpr_read_b32 v7, a186
    v_mul_f32 v7, v7, v4
    v_accvgpr_write_b32 a186, v7
    v_accvgpr_read_b32 v8, a187
    v_mul_f32 v8, v8, v4
    v_accvgpr_write_b32 a187, v8
    v_accvgpr_read_b32 v5, a188
    v_mul_f32 v5, v5, v4
    v_accvgpr_write_b32 a188, v5
    v_accvgpr_read_b32 v6, a189
    v_mul_f32 v6, v6, v4
    v_accvgpr_write_b32 a189, v6
    v_accvgpr_read_b32 v7, a190
    v_mul_f32 v7, v7, v4
    v_accvgpr_write_b32 a190, v7
    v_accvgpr_read_b32 v8, a191
    v_mul_f32 v8, v8, v4
    v_accvgpr_write_b32 a191, v8
    v_accvgpr_read_b32 v5, a192
    v_mul_f32 v5, v5, v4
    v_accvgpr_write_b32 a192, v5
    v_accvgpr_read_b32 v6, a193
    v_mul_f32 v6, v6, v4
    v_accvgpr_write_b32 a193, v6
    v_accvgpr_read_b32 v7, a194
    v_mul_f32 v7, v7, v4
    v_accvgpr_write_b32 a194, v7
    v_accvgpr_read_b32 v8, a195
    v_mul_f32 v8, v8, v4
    v_accvgpr_write_b32 a195, v8
    v_accvgpr_read_b32 v5, a196
    v_mul_f32 v5, v5, v4
    v_accvgpr_write_b32 a196, v5
    v_accvgpr_read_b32 v6, a197
    v_mul_f32 v6, v6, v4
    v_accvgpr_write_b32 a197, v6
    v_accvgpr_read_b32 v7, a198
    v_mul_f32 v7, v7, v4
    v_accvgpr_write_b32 a198, v7
    v_accvgpr_read_b32 v8, a199
    v_mul_f32 v8, v8, v4
    v_accvgpr_write_b32 a199, v8
    v_accvgpr_read_b32 v5, a200
    v_mul_f32 v5, v5, v4
    v_accvgpr_write_b32 a200, v5
    v_accvgpr_read_b32 v6, a201
    v_mul_f32 v6, v6, v4
    v_accvgpr_write_b32 a201, v6
    v_accvgpr_read_b32 v7, a202
    v_mul_f32 v7, v7, v4
    v_accvgpr_write_b32 a202, v7
    v_accvgpr_read_b32 v8, a203
    v_mul_f32 v8, v8, v4
    v_accvgpr_write_b32 a203, v8
    v_accvgpr_read_b32 v5, a204
    v_mul_f32 v5, v5, v4
    v_accvgpr_write_b32 a204, v5
    v_accvgpr_read_b32 v6, a205
    v_mul_f32 v6, v6, v4
    v_accvgpr_write_b32 a205, v6
    v_accvgpr_read_b32 v7, a206
    v_mul_f32 v7, v7, v4
    v_accvgpr_write_b32 a206, v7
    v_accvgpr_read_b32 v8, a207
    v_mul_f32 v8, v8, v4
    v_accvgpr_write_b32 a207, v8
    v_accvgpr_read_b32 v5, a208
    v_mul_f32 v5, v5, v4
    v_accvgpr_write_b32 a208, v5
    v_accvgpr_read_b32 v6, a209
    v_mul_f32 v6, v6, v4
    v_accvgpr_write_b32 a209, v6
    v_accvgpr_read_b32 v7, a210
    v_mul_f32 v7, v7, v4
    v_accvgpr_write_b32 a210, v7
    v_accvgpr_read_b32 v8, a211
    v_mul_f32 v8, v8, v4
    v_accvgpr_write_b32 a211, v8
    v_accvgpr_read_b32 v5, a212
    v_mul_f32 v5, v5, v4
    v_accvgpr_write_b32 a212, v5
    v_accvgpr_read_b32 v6, a213
    v_mul_f32 v6, v6, v4
    v_accvgpr_write_b32 a213, v6
    v_accvgpr_read_b32 v7, a214
    v_mul_f32 v7, v7, v4
    v_accvgpr_write_b32 a214, v7
    v_accvgpr_read_b32 v8, a215
    v_mul_f32 v8, v8, v4
    v_accvgpr_write_b32 a215, v8
    v_accvgpr_read_b32 v5, a216
    v_mul_f32 v5, v5, v4
    v_accvgpr_write_b32 a216, v5
    v_accvgpr_read_b32 v6, a217
    v_mul_f32 v6, v6, v4
    v_accvgpr_write_b32 a217, v6
    v_accvgpr_read_b32 v7, a218
    v_mul_f32 v7, v7, v4
    v_accvgpr_write_b32 a218, v7
    v_accvgpr_read_b32 v8, a219
    v_mul_f32 v8, v8, v4
    v_accvgpr_write_b32 a219, v8
    v_accvgpr_read_b32 v5, a220
    v_mul_f32 v5, v5, v4
    v_accvgpr_write_b32 a220, v5
    v_accvgpr_read_b32 v6, a221
    v_mul_f32 v6, v6, v4
    v_accvgpr_write_b32 a221, v6
    v_accvgpr_read_b32 v7, a222
    v_mul_f32 v7, v7, v4
    v_accvgpr_write_b32 a222, v7
    v_accvgpr_read_b32 v8, a223
    v_mul_f32 v8, v8, v4
    v_accvgpr_write_b32 a223, v8
    v_accvgpr_read_b32 v5, a224
    v_mul_f32 v5, v5, v4
    v_accvgpr_write_b32 a224, v5
    v_accvgpr_read_b32 v6, a225
    v_mul_f32 v6, v6, v4
    v_accvgpr_write_b32 a225, v6
    v_accvgpr_read_b32 v7, a226
    v_mul_f32 v7, v7, v4
    v_accvgpr_write_b32 a226, v7
    v_accvgpr_read_b32 v8, a227
    v_mul_f32 v8, v8, v4
    v_accvgpr_write_b32 a227, v8
    v_accvgpr_read_b32 v5, a228
    v_mul_f32 v5, v5, v4
    v_accvgpr_write_b32 a228, v5
    v_accvgpr_read_b32 v6, a229
    v_mul_f32 v6, v6, v4
    v_accvgpr_write_b32 a229, v6
    v_accvgpr_read_b32 v7, a230
    v_mul_f32 v7, v7, v4
    v_accvgpr_write_b32 a230, v7
    v_accvgpr_read_b32 v8, a231
    v_mul_f32 v8, v8, v4
    v_accvgpr_write_b32 a231, v8
    v_accvgpr_read_b32 v5, a232
    v_mul_f32 v5, v5, v4
    v_accvgpr_write_b32 a232, v5
    v_accvgpr_read_b32 v6, a233
    v_mul_f32 v6, v6, v4
    v_accvgpr_write_b32 a233, v6
    v_accvgpr_read_b32 v7, a234
    v_mul_f32 v7, v7, v4
    v_accvgpr_write_b32 a234, v7
    v_accvgpr_read_b32 v8, a235
    v_mul_f32 v8, v8, v4
    v_accvgpr_write_b32 a235, v8
    v_accvgpr_read_b32 v5, a236
    v_mul_f32 v5, v5, v4
    v_accvgpr_write_b32 a236, v5
    v_accvgpr_read_b32 v6, a237
    v_mul_f32 v6, v6, v4
    v_accvgpr_write_b32 a237, v6
    v_accvgpr_read_b32 v7, a238
    v_mul_f32 v7, v7, v4
    v_accvgpr_write_b32 a238, v7
    v_accvgpr_read_b32 v8, a239
    v_mul_f32 v8, v8, v4
    v_accvgpr_write_b32 a239, v8
    v_accvgpr_read_b32 v5, a240
    v_mul_f32 v5, v5, v4
    v_accvgpr_write_b32 a240, v5
    v_accvgpr_read_b32 v6, a241
    v_mul_f32 v6, v6, v4
    v_accvgpr_write_b32 a241, v6
    v_accvgpr_read_b32 v7, a242
    v_mul_f32 v7, v7, v4
    v_accvgpr_write_b32 a242, v7
    v_accvgpr_read_b32 v8, a243
    v_mul_f32 v8, v8, v4
    v_accvgpr_write_b32 a243, v8
    v_accvgpr_read_b32 v5, a244
    v_mul_f32 v5, v5, v4
    v_accvgpr_write_b32 a244, v5
    v_accvgpr_read_b32 v6, a245
    v_mul_f32 v6, v6, v4
    v_accvgpr_write_b32 a245, v6
    v_accvgpr_read_b32 v7, a246
    v_mul_f32 v7, v7, v4
    v_accvgpr_write_b32 a246, v7
    v_accvgpr_read_b32 v8, a247
    v_mul_f32 v8, v8, v4
    v_accvgpr_write_b32 a247, v8
    v_accvgpr_read_b32 v5, a248
    v_mul_f32 v5, v5, v4
    v_accvgpr_write_b32 a248, v5
    v_accvgpr_read_b32 v6, a249
    v_mul_f32 v6, v6, v4
    v_accvgpr_write_b32 a249, v6
    v_accvgpr_read_b32 v7, a250
    v_mul_f32 v7, v7, v4
    v_accvgpr_write_b32 a250, v7
    v_accvgpr_read_b32 v8, a251
    v_mul_f32 v8, v8, v4
    v_accvgpr_write_b32 a251, v8
    v_accvgpr_read_b32 v5, a252
    v_mul_f32 v5, v5, v4
    v_accvgpr_write_b32 a252, v5
    v_accvgpr_read_b32 v6, a253
    v_mul_f32 v6, v6, v4
    v_accvgpr_write_b32 a253, v6
    v_accvgpr_read_b32 v7, a254
    v_mul_f32 v7, v7, v4
    v_accvgpr_write_b32 a254, v7
    v_accvgpr_read_b32 v8, a255
    v_mul_f32 v8, v8, v4
    v_accvgpr_write_b32 a255, v8
    s_nop 1
    s_branch LRB_56
LRS_63:
    v_max_f32 v3, v32, v2
    v_sub_f32 v4, v32, v3
    v_exp_f32 v4, v4
    v_mov_b32 v32, v3
    s_nop 0
    v_mul_f32 v33, v33, v4
    s_nop 15
    v_accvgpr_read_b32 v5, a0
    v_mul_f32 v5, v5, v4
    v_accvgpr_write_b32 a0, v5
    v_accvgpr_read_b32 v6, a1
    v_mul_f32 v6, v6, v4
    v_accvgpr_write_b32 a1, v6
    v_accvgpr_read_b32 v7, a2
    v_mul_f32 v7, v7, v4
    v_accvgpr_write_b32 a2, v7
    v_accvgpr_read_b32 v8, a3
    v_mul_f32 v8, v8, v4
    v_accvgpr_write_b32 a3, v8
    v_accvgpr_read_b32 v5, a4
    v_mul_f32 v5, v5, v4
    v_accvgpr_write_b32 a4, v5
    v_accvgpr_read_b32 v6, a5
    v_mul_f32 v6, v6, v4
    v_accvgpr_write_b32 a5, v6
    v_accvgpr_read_b32 v7, a6
    v_mul_f32 v7, v7, v4
    v_accvgpr_write_b32 a6, v7
    v_accvgpr_read_b32 v8, a7
    v_mul_f32 v8, v8, v4
    v_accvgpr_write_b32 a7, v8
    v_accvgpr_read_b32 v5, a8
    v_mul_f32 v5, v5, v4
    v_accvgpr_write_b32 a8, v5
    v_accvgpr_read_b32 v6, a9
    v_mul_f32 v6, v6, v4
    v_accvgpr_write_b32 a9, v6
    v_accvgpr_read_b32 v7, a10
    v_mul_f32 v7, v7, v4
    v_accvgpr_write_b32 a10, v7
    v_accvgpr_read_b32 v8, a11
    v_mul_f32 v8, v8, v4
    v_accvgpr_write_b32 a11, v8
    v_accvgpr_read_b32 v5, a12
    v_mul_f32 v5, v5, v4
    v_accvgpr_write_b32 a12, v5
    v_accvgpr_read_b32 v6, a13
    v_mul_f32 v6, v6, v4
    v_accvgpr_write_b32 a13, v6
    v_accvgpr_read_b32 v7, a14
    v_mul_f32 v7, v7, v4
    v_accvgpr_write_b32 a14, v7
    v_accvgpr_read_b32 v8, a15
    v_mul_f32 v8, v8, v4
    v_accvgpr_write_b32 a15, v8
    v_accvgpr_read_b32 v5, a16
    v_mul_f32 v5, v5, v4
    v_accvgpr_write_b32 a16, v5
    v_accvgpr_read_b32 v6, a17
    v_mul_f32 v6, v6, v4
    v_accvgpr_write_b32 a17, v6
    v_accvgpr_read_b32 v7, a18
    v_mul_f32 v7, v7, v4
    v_accvgpr_write_b32 a18, v7
    v_accvgpr_read_b32 v8, a19
    v_mul_f32 v8, v8, v4
    v_accvgpr_write_b32 a19, v8
    v_accvgpr_read_b32 v5, a20
    v_mul_f32 v5, v5, v4
    v_accvgpr_write_b32 a20, v5
    v_accvgpr_read_b32 v6, a21
    v_mul_f32 v6, v6, v4
    v_accvgpr_write_b32 a21, v6
    v_accvgpr_read_b32 v7, a22
    v_mul_f32 v7, v7, v4
    v_accvgpr_write_b32 a22, v7
    v_accvgpr_read_b32 v8, a23
    v_mul_f32 v8, v8, v4
    v_accvgpr_write_b32 a23, v8
    v_accvgpr_read_b32 v5, a24
    v_mul_f32 v5, v5, v4
    v_accvgpr_write_b32 a24, v5
    v_accvgpr_read_b32 v6, a25
    v_mul_f32 v6, v6, v4
    v_accvgpr_write_b32 a25, v6
    v_accvgpr_read_b32 v7, a26
    v_mul_f32 v7, v7, v4
    v_accvgpr_write_b32 a26, v7
    v_accvgpr_read_b32 v8, a27
    v_mul_f32 v8, v8, v4
    v_accvgpr_write_b32 a27, v8
    v_accvgpr_read_b32 v5, a28
    v_mul_f32 v5, v5, v4
    v_accvgpr_write_b32 a28, v5
    v_accvgpr_read_b32 v6, a29
    v_mul_f32 v6, v6, v4
    v_accvgpr_write_b32 a29, v6
    v_accvgpr_read_b32 v7, a30
    v_mul_f32 v7, v7, v4
    v_accvgpr_write_b32 a30, v7
    v_accvgpr_read_b32 v8, a31
    v_mul_f32 v8, v8, v4
    v_accvgpr_write_b32 a31, v8
    v_accvgpr_read_b32 v5, a32
    v_mul_f32 v5, v5, v4
    v_accvgpr_write_b32 a32, v5
    v_accvgpr_read_b32 v6, a33
    v_mul_f32 v6, v6, v4
    v_accvgpr_write_b32 a33, v6
    v_accvgpr_read_b32 v7, a34
    v_mul_f32 v7, v7, v4
    v_accvgpr_write_b32 a34, v7
    v_accvgpr_read_b32 v8, a35
    v_mul_f32 v8, v8, v4
    v_accvgpr_write_b32 a35, v8
    v_accvgpr_read_b32 v5, a36
    v_mul_f32 v5, v5, v4
    v_accvgpr_write_b32 a36, v5
    v_accvgpr_read_b32 v6, a37
    v_mul_f32 v6, v6, v4
    v_accvgpr_write_b32 a37, v6
    v_accvgpr_read_b32 v7, a38
    v_mul_f32 v7, v7, v4
    v_accvgpr_write_b32 a38, v7
    v_accvgpr_read_b32 v8, a39
    v_mul_f32 v8, v8, v4
    v_accvgpr_write_b32 a39, v8
    v_accvgpr_read_b32 v5, a40
    v_mul_f32 v5, v5, v4
    v_accvgpr_write_b32 a40, v5
    v_accvgpr_read_b32 v6, a41
    v_mul_f32 v6, v6, v4
    v_accvgpr_write_b32 a41, v6
    v_accvgpr_read_b32 v7, a42
    v_mul_f32 v7, v7, v4
    v_accvgpr_write_b32 a42, v7
    v_accvgpr_read_b32 v8, a43
    v_mul_f32 v8, v8, v4
    v_accvgpr_write_b32 a43, v8
    v_accvgpr_read_b32 v5, a44
    v_mul_f32 v5, v5, v4
    v_accvgpr_write_b32 a44, v5
    v_accvgpr_read_b32 v6, a45
    v_mul_f32 v6, v6, v4
    v_accvgpr_write_b32 a45, v6
    v_accvgpr_read_b32 v7, a46
    v_mul_f32 v7, v7, v4
    v_accvgpr_write_b32 a46, v7
    v_accvgpr_read_b32 v8, a47
    v_mul_f32 v8, v8, v4
    v_accvgpr_write_b32 a47, v8
    v_accvgpr_read_b32 v5, a48
    v_mul_f32 v5, v5, v4
    v_accvgpr_write_b32 a48, v5
    v_accvgpr_read_b32 v6, a49
    v_mul_f32 v6, v6, v4
    v_accvgpr_write_b32 a49, v6
    v_accvgpr_read_b32 v7, a50
    v_mul_f32 v7, v7, v4
    v_accvgpr_write_b32 a50, v7
    v_accvgpr_read_b32 v8, a51
    v_mul_f32 v8, v8, v4
    v_accvgpr_write_b32 a51, v8
    v_accvgpr_read_b32 v5, a52
    v_mul_f32 v5, v5, v4
    v_accvgpr_write_b32 a52, v5
    v_accvgpr_read_b32 v6, a53
    v_mul_f32 v6, v6, v4
    v_accvgpr_write_b32 a53, v6
    v_accvgpr_read_b32 v7, a54
    v_mul_f32 v7, v7, v4
    v_accvgpr_write_b32 a54, v7
    v_accvgpr_read_b32 v8, a55
    v_mul_f32 v8, v8, v4
    v_accvgpr_write_b32 a55, v8
    v_accvgpr_read_b32 v5, a56
    v_mul_f32 v5, v5, v4
    v_accvgpr_write_b32 a56, v5
    v_accvgpr_read_b32 v6, a57
    v_mul_f32 v6, v6, v4
    v_accvgpr_write_b32 a57, v6
    v_accvgpr_read_b32 v7, a58
    v_mul_f32 v7, v7, v4
    v_accvgpr_write_b32 a58, v7
    v_accvgpr_read_b32 v8, a59
    v_mul_f32 v8, v8, v4
    v_accvgpr_write_b32 a59, v8
    v_accvgpr_read_b32 v5, a60
    v_mul_f32 v5, v5, v4
    v_accvgpr_write_b32 a60, v5
    v_accvgpr_read_b32 v6, a61
    v_mul_f32 v6, v6, v4
    v_accvgpr_write_b32 a61, v6
    v_accvgpr_read_b32 v7, a62
    v_mul_f32 v7, v7, v4
    v_accvgpr_write_b32 a62, v7
    v_accvgpr_read_b32 v8, a63
    v_mul_f32 v8, v8, v4
    v_accvgpr_write_b32 a63, v8
    v_accvgpr_read_b32 v5, a64
    v_mul_f32 v5, v5, v4
    v_accvgpr_write_b32 a64, v5
    v_accvgpr_read_b32 v6, a65
    v_mul_f32 v6, v6, v4
    v_accvgpr_write_b32 a65, v6
    v_accvgpr_read_b32 v7, a66
    v_mul_f32 v7, v7, v4
    v_accvgpr_write_b32 a66, v7
    v_accvgpr_read_b32 v8, a67
    v_mul_f32 v8, v8, v4
    v_accvgpr_write_b32 a67, v8
    v_accvgpr_read_b32 v5, a68
    v_mul_f32 v5, v5, v4
    v_accvgpr_write_b32 a68, v5
    v_accvgpr_read_b32 v6, a69
    v_mul_f32 v6, v6, v4
    v_accvgpr_write_b32 a69, v6
    v_accvgpr_read_b32 v7, a70
    v_mul_f32 v7, v7, v4
    v_accvgpr_write_b32 a70, v7
    v_accvgpr_read_b32 v8, a71
    v_mul_f32 v8, v8, v4
    v_accvgpr_write_b32 a71, v8
    v_accvgpr_read_b32 v5, a72
    v_mul_f32 v5, v5, v4
    v_accvgpr_write_b32 a72, v5
    v_accvgpr_read_b32 v6, a73
    v_mul_f32 v6, v6, v4
    v_accvgpr_write_b32 a73, v6
    v_accvgpr_read_b32 v7, a74
    v_mul_f32 v7, v7, v4
    v_accvgpr_write_b32 a74, v7
    v_accvgpr_read_b32 v8, a75
    v_mul_f32 v8, v8, v4
    v_accvgpr_write_b32 a75, v8
    v_accvgpr_read_b32 v5, a76
    v_mul_f32 v5, v5, v4
    v_accvgpr_write_b32 a76, v5
    v_accvgpr_read_b32 v6, a77
    v_mul_f32 v6, v6, v4
    v_accvgpr_write_b32 a77, v6
    v_accvgpr_read_b32 v7, a78
    v_mul_f32 v7, v7, v4
    v_accvgpr_write_b32 a78, v7
    v_accvgpr_read_b32 v8, a79
    v_mul_f32 v8, v8, v4
    v_accvgpr_write_b32 a79, v8
    v_accvgpr_read_b32 v5, a80
    v_mul_f32 v5, v5, v4
    v_accvgpr_write_b32 a80, v5
    v_accvgpr_read_b32 v6, a81
    v_mul_f32 v6, v6, v4
    v_accvgpr_write_b32 a81, v6
    v_accvgpr_read_b32 v7, a82
    v_mul_f32 v7, v7, v4
    v_accvgpr_write_b32 a82, v7
    v_accvgpr_read_b32 v8, a83
    v_mul_f32 v8, v8, v4
    v_accvgpr_write_b32 a83, v8
    v_accvgpr_read_b32 v5, a84
    v_mul_f32 v5, v5, v4
    v_accvgpr_write_b32 a84, v5
    v_accvgpr_read_b32 v6, a85
    v_mul_f32 v6, v6, v4
    v_accvgpr_write_b32 a85, v6
    v_accvgpr_read_b32 v7, a86
    v_mul_f32 v7, v7, v4
    v_accvgpr_write_b32 a86, v7
    v_accvgpr_read_b32 v8, a87
    v_mul_f32 v8, v8, v4
    v_accvgpr_write_b32 a87, v8
    v_accvgpr_read_b32 v5, a88
    v_mul_f32 v5, v5, v4
    v_accvgpr_write_b32 a88, v5
    v_accvgpr_read_b32 v6, a89
    v_mul_f32 v6, v6, v4
    v_accvgpr_write_b32 a89, v6
    v_accvgpr_read_b32 v7, a90
    v_mul_f32 v7, v7, v4
    v_accvgpr_write_b32 a90, v7
    v_accvgpr_read_b32 v8, a91
    v_mul_f32 v8, v8, v4
    v_accvgpr_write_b32 a91, v8
    v_accvgpr_read_b32 v5, a92
    v_mul_f32 v5, v5, v4
    v_accvgpr_write_b32 a92, v5
    v_accvgpr_read_b32 v6, a93
    v_mul_f32 v6, v6, v4
    v_accvgpr_write_b32 a93, v6
    v_accvgpr_read_b32 v7, a94
    v_mul_f32 v7, v7, v4
    v_accvgpr_write_b32 a94, v7
    v_accvgpr_read_b32 v8, a95
    v_mul_f32 v8, v8, v4
    v_accvgpr_write_b32 a95, v8
    v_accvgpr_read_b32 v5, a96
    v_mul_f32 v5, v5, v4
    v_accvgpr_write_b32 a96, v5
    v_accvgpr_read_b32 v6, a97
    v_mul_f32 v6, v6, v4
    v_accvgpr_write_b32 a97, v6
    v_accvgpr_read_b32 v7, a98
    v_mul_f32 v7, v7, v4
    v_accvgpr_write_b32 a98, v7
    v_accvgpr_read_b32 v8, a99
    v_mul_f32 v8, v8, v4
    v_accvgpr_write_b32 a99, v8
    v_accvgpr_read_b32 v5, a100
    v_mul_f32 v5, v5, v4
    v_accvgpr_write_b32 a100, v5
    v_accvgpr_read_b32 v6, a101
    v_mul_f32 v6, v6, v4
    v_accvgpr_write_b32 a101, v6
    v_accvgpr_read_b32 v7, a102
    v_mul_f32 v7, v7, v4
    v_accvgpr_write_b32 a102, v7
    v_accvgpr_read_b32 v8, a103
    v_mul_f32 v8, v8, v4
    v_accvgpr_write_b32 a103, v8
    v_accvgpr_read_b32 v5, a104
    v_mul_f32 v5, v5, v4
    v_accvgpr_write_b32 a104, v5
    v_accvgpr_read_b32 v6, a105
    v_mul_f32 v6, v6, v4
    v_accvgpr_write_b32 a105, v6
    v_accvgpr_read_b32 v7, a106
    v_mul_f32 v7, v7, v4
    v_accvgpr_write_b32 a106, v7
    v_accvgpr_read_b32 v8, a107
    v_mul_f32 v8, v8, v4
    v_accvgpr_write_b32 a107, v8
    v_accvgpr_read_b32 v5, a108
    v_mul_f32 v5, v5, v4
    v_accvgpr_write_b32 a108, v5
    v_accvgpr_read_b32 v6, a109
    v_mul_f32 v6, v6, v4
    v_accvgpr_write_b32 a109, v6
    v_accvgpr_read_b32 v7, a110
    v_mul_f32 v7, v7, v4
    v_accvgpr_write_b32 a110, v7
    v_accvgpr_read_b32 v8, a111
    v_mul_f32 v8, v8, v4
    v_accvgpr_write_b32 a111, v8
    v_accvgpr_read_b32 v5, a112
    v_mul_f32 v5, v5, v4
    v_accvgpr_write_b32 a112, v5
    v_accvgpr_read_b32 v6, a113
    v_mul_f32 v6, v6, v4
    v_accvgpr_write_b32 a113, v6
    v_accvgpr_read_b32 v7, a114
    v_mul_f32 v7, v7, v4
    v_accvgpr_write_b32 a114, v7
    v_accvgpr_read_b32 v8, a115
    v_mul_f32 v8, v8, v4
    v_accvgpr_write_b32 a115, v8
    v_accvgpr_read_b32 v5, a116
    v_mul_f32 v5, v5, v4
    v_accvgpr_write_b32 a116, v5
    v_accvgpr_read_b32 v6, a117
    v_mul_f32 v6, v6, v4
    v_accvgpr_write_b32 a117, v6
    v_accvgpr_read_b32 v7, a118
    v_mul_f32 v7, v7, v4
    v_accvgpr_write_b32 a118, v7
    v_accvgpr_read_b32 v8, a119
    v_mul_f32 v8, v8, v4
    v_accvgpr_write_b32 a119, v8
    v_accvgpr_read_b32 v5, a120
    v_mul_f32 v5, v5, v4
    v_accvgpr_write_b32 a120, v5
    v_accvgpr_read_b32 v6, a121
    v_mul_f32 v6, v6, v4
    v_accvgpr_write_b32 a121, v6
    v_accvgpr_read_b32 v7, a122
    v_mul_f32 v7, v7, v4
    v_accvgpr_write_b32 a122, v7
    v_accvgpr_read_b32 v8, a123
    v_mul_f32 v8, v8, v4
    v_accvgpr_write_b32 a123, v8
    v_accvgpr_read_b32 v5, a124
    v_mul_f32 v5, v5, v4
    v_accvgpr_write_b32 a124, v5
    v_accvgpr_read_b32 v6, a125
    v_mul_f32 v6, v6, v4
    v_accvgpr_write_b32 a125, v6
    v_accvgpr_read_b32 v7, a126
    v_mul_f32 v7, v7, v4
    v_accvgpr_write_b32 a126, v7
    v_accvgpr_read_b32 v8, a127
    v_mul_f32 v8, v8, v4
    v_accvgpr_write_b32 a127, v8
    s_nop 1
    s_branch LRB_64
LRS_65:
    v_max_f32 v3, v32, v2
    v_sub_f32 v4, v32, v3
    v_exp_f32 v4, v4
    v_mov_b32 v32, v3
    s_nop 0
    v_mul_f32 v33, v33, v4
    s_nop 15
    v_accvgpr_read_b32 v5, a0
    v_mul_f32 v5, v5, v4
    v_accvgpr_write_b32 a0, v5
    v_accvgpr_read_b32 v6, a1
    v_mul_f32 v6, v6, v4
    v_accvgpr_write_b32 a1, v6
    v_accvgpr_read_b32 v7, a2
    v_mul_f32 v7, v7, v4
    v_accvgpr_write_b32 a2, v7
    v_accvgpr_read_b32 v8, a3
    v_mul_f32 v8, v8, v4
    v_accvgpr_write_b32 a3, v8
    v_accvgpr_read_b32 v5, a4
    v_mul_f32 v5, v5, v4
    v_accvgpr_write_b32 a4, v5
    v_accvgpr_read_b32 v6, a5
    v_mul_f32 v6, v6, v4
    v_accvgpr_write_b32 a5, v6
    v_accvgpr_read_b32 v7, a6
    v_mul_f32 v7, v7, v4
    v_accvgpr_write_b32 a6, v7
    v_accvgpr_read_b32 v8, a7
    v_mul_f32 v8, v8, v4
    v_accvgpr_write_b32 a7, v8
    v_accvgpr_read_b32 v5, a8
    v_mul_f32 v5, v5, v4
    v_accvgpr_write_b32 a8, v5
    v_accvgpr_read_b32 v6, a9
    v_mul_f32 v6, v6, v4
    v_accvgpr_write_b32 a9, v6
    v_accvgpr_read_b32 v7, a10
    v_mul_f32 v7, v7, v4
    v_accvgpr_write_b32 a10, v7
    v_accvgpr_read_b32 v8, a11
    v_mul_f32 v8, v8, v4
    v_accvgpr_write_b32 a11, v8
    v_accvgpr_read_b32 v5, a12
    v_mul_f32 v5, v5, v4
    v_accvgpr_write_b32 a12, v5
    v_accvgpr_read_b32 v6, a13
    v_mul_f32 v6, v6, v4
    v_accvgpr_write_b32 a13, v6
    v_accvgpr_read_b32 v7, a14
    v_mul_f32 v7, v7, v4
    v_accvgpr_write_b32 a14, v7
    v_accvgpr_read_b32 v8, a15
    v_mul_f32 v8, v8, v4
    v_accvgpr_write_b32 a15, v8
    v_accvgpr_read_b32 v5, a16
    v_mul_f32 v5, v5, v4
    v_accvgpr_write_b32 a16, v5
    v_accvgpr_read_b32 v6, a17
    v_mul_f32 v6, v6, v4
    v_accvgpr_write_b32 a17, v6
    v_accvgpr_read_b32 v7, a18
    v_mul_f32 v7, v7, v4
    v_accvgpr_write_b32 a18, v7
    v_accvgpr_read_b32 v8, a19
    v_mul_f32 v8, v8, v4
    v_accvgpr_write_b32 a19, v8
    v_accvgpr_read_b32 v5, a20
    v_mul_f32 v5, v5, v4
    v_accvgpr_write_b32 a20, v5
    v_accvgpr_read_b32 v6, a21
    v_mul_f32 v6, v6, v4
    v_accvgpr_write_b32 a21, v6
    v_accvgpr_read_b32 v7, a22
    v_mul_f32 v7, v7, v4
    v_accvgpr_write_b32 a22, v7
    v_accvgpr_read_b32 v8, a23
    v_mul_f32 v8, v8, v4
    v_accvgpr_write_b32 a23, v8
    v_accvgpr_read_b32 v5, a24
    v_mul_f32 v5, v5, v4
    v_accvgpr_write_b32 a24, v5
    v_accvgpr_read_b32 v6, a25
    v_mul_f32 v6, v6, v4
    v_accvgpr_write_b32 a25, v6
    v_accvgpr_read_b32 v7, a26
    v_mul_f32 v7, v7, v4
    v_accvgpr_write_b32 a26, v7
    v_accvgpr_read_b32 v8, a27
    v_mul_f32 v8, v8, v4
    v_accvgpr_write_b32 a27, v8
    v_accvgpr_read_b32 v5, a28
    v_mul_f32 v5, v5, v4
    v_accvgpr_write_b32 a28, v5
    v_accvgpr_read_b32 v6, a29
    v_mul_f32 v6, v6, v4
    v_accvgpr_write_b32 a29, v6
    v_accvgpr_read_b32 v7, a30
    v_mul_f32 v7, v7, v4
    v_accvgpr_write_b32 a30, v7
    v_accvgpr_read_b32 v8, a31
    v_mul_f32 v8, v8, v4
    v_accvgpr_write_b32 a31, v8
    v_accvgpr_read_b32 v5, a32
    v_mul_f32 v5, v5, v4
    v_accvgpr_write_b32 a32, v5
    v_accvgpr_read_b32 v6, a33
    v_mul_f32 v6, v6, v4
    v_accvgpr_write_b32 a33, v6
    v_accvgpr_read_b32 v7, a34
    v_mul_f32 v7, v7, v4
    v_accvgpr_write_b32 a34, v7
    v_accvgpr_read_b32 v8, a35
    v_mul_f32 v8, v8, v4
    v_accvgpr_write_b32 a35, v8
    v_accvgpr_read_b32 v5, a36
    v_mul_f32 v5, v5, v4
    v_accvgpr_write_b32 a36, v5
    v_accvgpr_read_b32 v6, a37
    v_mul_f32 v6, v6, v4
    v_accvgpr_write_b32 a37, v6
    v_accvgpr_read_b32 v7, a38
    v_mul_f32 v7, v7, v4
    v_accvgpr_write_b32 a38, v7
    v_accvgpr_read_b32 v8, a39
    v_mul_f32 v8, v8, v4
    v_accvgpr_write_b32 a39, v8
    v_accvgpr_read_b32 v5, a40
    v_mul_f32 v5, v5, v4
    v_accvgpr_write_b32 a40, v5
    v_accvgpr_read_b32 v6, a41
    v_mul_f32 v6, v6, v4
    v_accvgpr_write_b32 a41, v6
    v_accvgpr_read_b32 v7, a42
    v_mul_f32 v7, v7, v4
    v_accvgpr_write_b32 a42, v7
    v_accvgpr_read_b32 v8, a43
    v_mul_f32 v8, v8, v4
    v_accvgpr_write_b32 a43, v8
    v_accvgpr_read_b32 v5, a44
    v_mul_f32 v5, v5, v4
    v_accvgpr_write_b32 a44, v5
    v_accvgpr_read_b32 v6, a45
    v_mul_f32 v6, v6, v4
    v_accvgpr_write_b32 a45, v6
    v_accvgpr_read_b32 v7, a46
    v_mul_f32 v7, v7, v4
    v_accvgpr_write_b32 a46, v7
    v_accvgpr_read_b32 v8, a47
    v_mul_f32 v8, v8, v4
    v_accvgpr_write_b32 a47, v8
    v_accvgpr_read_b32 v5, a48
    v_mul_f32 v5, v5, v4
    v_accvgpr_write_b32 a48, v5
    v_accvgpr_read_b32 v6, a49
    v_mul_f32 v6, v6, v4
    v_accvgpr_write_b32 a49, v6
    v_accvgpr_read_b32 v7, a50
    v_mul_f32 v7, v7, v4
    v_accvgpr_write_b32 a50, v7
    v_accvgpr_read_b32 v8, a51
    v_mul_f32 v8, v8, v4
    v_accvgpr_write_b32 a51, v8
    v_accvgpr_read_b32 v5, a52
    v_mul_f32 v5, v5, v4
    v_accvgpr_write_b32 a52, v5
    v_accvgpr_read_b32 v6, a53
    v_mul_f32 v6, v6, v4
    v_accvgpr_write_b32 a53, v6
    v_accvgpr_read_b32 v7, a54
    v_mul_f32 v7, v7, v4
    v_accvgpr_write_b32 a54, v7
    v_accvgpr_read_b32 v8, a55
    v_mul_f32 v8, v8, v4
    v_accvgpr_write_b32 a55, v8
    v_accvgpr_read_b32 v5, a56
    v_mul_f32 v5, v5, v4
    v_accvgpr_write_b32 a56, v5
    v_accvgpr_read_b32 v6, a57
    v_mul_f32 v6, v6, v4
    v_accvgpr_write_b32 a57, v6
    v_accvgpr_read_b32 v7, a58
    v_mul_f32 v7, v7, v4
    v_accvgpr_write_b32 a58, v7
    v_accvgpr_read_b32 v8, a59
    v_mul_f32 v8, v8, v4
    v_accvgpr_write_b32 a59, v8
    v_accvgpr_read_b32 v5, a60
    v_mul_f32 v5, v5, v4
    v_accvgpr_write_b32 a60, v5
    v_accvgpr_read_b32 v6, a61
    v_mul_f32 v6, v6, v4
    v_accvgpr_write_b32 a61, v6
    v_accvgpr_read_b32 v7, a62
    v_mul_f32 v7, v7, v4
    v_accvgpr_write_b32 a62, v7
    v_accvgpr_read_b32 v8, a63
    v_mul_f32 v8, v8, v4
    v_accvgpr_write_b32 a63, v8
    v_accvgpr_read_b32 v5, a64
    v_mul_f32 v5, v5, v4
    v_accvgpr_write_b32 a64, v5
    v_accvgpr_read_b32 v6, a65
    v_mul_f32 v6, v6, v4
    v_accvgpr_write_b32 a65, v6
    v_accvgpr_read_b32 v7, a66
    v_mul_f32 v7, v7, v4
    v_accvgpr_write_b32 a66, v7
    v_accvgpr_read_b32 v8, a67
    v_mul_f32 v8, v8, v4
    v_accvgpr_write_b32 a67, v8
    v_accvgpr_read_b32 v5, a68
    v_mul_f32 v5, v5, v4
    v_accvgpr_write_b32 a68, v5
    v_accvgpr_read_b32 v6, a69
    v_mul_f32 v6, v6, v4
    v_accvgpr_write_b32 a69, v6
    v_accvgpr_read_b32 v7, a70
    v_mul_f32 v7, v7, v4
    v_accvgpr_write_b32 a70, v7
    v_accvgpr_read_b32 v8, a71
    v_mul_f32 v8, v8, v4
    v_accvgpr_write_b32 a71, v8
    v_accvgpr_read_b32 v5, a72
    v_mul_f32 v5, v5, v4
    v_accvgpr_write_b32 a72, v5
    v_accvgpr_read_b32 v6, a73
    v_mul_f32 v6, v6, v4
    v_accvgpr_write_b32 a73, v6
    v_accvgpr_read_b32 v7, a74
    v_mul_f32 v7, v7, v4
    v_accvgpr_write_b32 a74, v7
    v_accvgpr_read_b32 v8, a75
    v_mul_f32 v8, v8, v4
    v_accvgpr_write_b32 a75, v8
    v_accvgpr_read_b32 v5, a76
    v_mul_f32 v5, v5, v4
    v_accvgpr_write_b32 a76, v5
    v_accvgpr_read_b32 v6, a77
    v_mul_f32 v6, v6, v4
    v_accvgpr_write_b32 a77, v6
    v_accvgpr_read_b32 v7, a78
    v_mul_f32 v7, v7, v4
    v_accvgpr_write_b32 a78, v7
    v_accvgpr_read_b32 v8, a79
    v_mul_f32 v8, v8, v4
    v_accvgpr_write_b32 a79, v8
    v_accvgpr_read_b32 v5, a80
    v_mul_f32 v5, v5, v4
    v_accvgpr_write_b32 a80, v5
    v_accvgpr_read_b32 v6, a81
    v_mul_f32 v6, v6, v4
    v_accvgpr_write_b32 a81, v6
    v_accvgpr_read_b32 v7, a82
    v_mul_f32 v7, v7, v4
    v_accvgpr_write_b32 a82, v7
    v_accvgpr_read_b32 v8, a83
    v_mul_f32 v8, v8, v4
    v_accvgpr_write_b32 a83, v8
    v_accvgpr_read_b32 v5, a84
    v_mul_f32 v5, v5, v4
    v_accvgpr_write_b32 a84, v5
    v_accvgpr_read_b32 v6, a85
    v_mul_f32 v6, v6, v4
    v_accvgpr_write_b32 a85, v6
    v_accvgpr_read_b32 v7, a86
    v_mul_f32 v7, v7, v4
    v_accvgpr_write_b32 a86, v7
    v_accvgpr_read_b32 v8, a87
    v_mul_f32 v8, v8, v4
    v_accvgpr_write_b32 a87, v8
    v_accvgpr_read_b32 v5, a88
    v_mul_f32 v5, v5, v4
    v_accvgpr_write_b32 a88, v5
    v_accvgpr_read_b32 v6, a89
    v_mul_f32 v6, v6, v4
    v_accvgpr_write_b32 a89, v6
    v_accvgpr_read_b32 v7, a90
    v_mul_f32 v7, v7, v4
    v_accvgpr_write_b32 a90, v7
    v_accvgpr_read_b32 v8, a91
    v_mul_f32 v8, v8, v4
    v_accvgpr_write_b32 a91, v8
    v_accvgpr_read_b32 v5, a92
    v_mul_f32 v5, v5, v4
    v_accvgpr_write_b32 a92, v5
    v_accvgpr_read_b32 v6, a93
    v_mul_f32 v6, v6, v4
    v_accvgpr_write_b32 a93, v6
    v_accvgpr_read_b32 v7, a94
    v_mul_f32 v7, v7, v4
    v_accvgpr_write_b32 a94, v7
    v_accvgpr_read_b32 v8, a95
    v_mul_f32 v8, v8, v4
    v_accvgpr_write_b32 a95, v8
    v_accvgpr_read_b32 v5, a96
    v_mul_f32 v5, v5, v4
    v_accvgpr_write_b32 a96, v5
    v_accvgpr_read_b32 v6, a97
    v_mul_f32 v6, v6, v4
    v_accvgpr_write_b32 a97, v6
    v_accvgpr_read_b32 v7, a98
    v_mul_f32 v7, v7, v4
    v_accvgpr_write_b32 a98, v7
    v_accvgpr_read_b32 v8, a99
    v_mul_f32 v8, v8, v4
    v_accvgpr_write_b32 a99, v8
    v_accvgpr_read_b32 v5, a100
    v_mul_f32 v5, v5, v4
    v_accvgpr_write_b32 a100, v5
    v_accvgpr_read_b32 v6, a101
    v_mul_f32 v6, v6, v4
    v_accvgpr_write_b32 a101, v6
    v_accvgpr_read_b32 v7, a102
    v_mul_f32 v7, v7, v4
    v_accvgpr_write_b32 a102, v7
    v_accvgpr_read_b32 v8, a103
    v_mul_f32 v8, v8, v4
    v_accvgpr_write_b32 a103, v8
    v_accvgpr_read_b32 v5, a104
    v_mul_f32 v5, v5, v4
    v_accvgpr_write_b32 a104, v5
    v_accvgpr_read_b32 v6, a105
    v_mul_f32 v6, v6, v4
    v_accvgpr_write_b32 a105, v6
    v_accvgpr_read_b32 v7, a106
    v_mul_f32 v7, v7, v4
    v_accvgpr_write_b32 a106, v7
    v_accvgpr_read_b32 v8, a107
    v_mul_f32 v8, v8, v4
    v_accvgpr_write_b32 a107, v8
    v_accvgpr_read_b32 v5, a108
    v_mul_f32 v5, v5, v4
    v_accvgpr_write_b32 a108, v5
    v_accvgpr_read_b32 v6, a109
    v_mul_f32 v6, v6, v4
    v_accvgpr_write_b32 a109, v6
    v_accvgpr_read_b32 v7, a110
    v_mul_f32 v7, v7, v4
    v_accvgpr_write_b32 a110, v7
    v_accvgpr_read_b32 v8, a111
    v_mul_f32 v8, v8, v4
    v_accvgpr_write_b32 a111, v8
    v_accvgpr_read_b32 v5, a112
    v_mul_f32 v5, v5, v4
    v_accvgpr_write_b32 a112, v5
    v_accvgpr_read_b32 v6, a113
    v_mul_f32 v6, v6, v4
    v_accvgpr_write_b32 a113, v6
    v_accvgpr_read_b32 v7, a114
    v_mul_f32 v7, v7, v4
    v_accvgpr_write_b32 a114, v7
    v_accvgpr_read_b32 v8, a115
    v_mul_f32 v8, v8, v4
    v_accvgpr_write_b32 a115, v8
    v_accvgpr_read_b32 v5, a116
    v_mul_f32 v5, v5, v4
    v_accvgpr_write_b32 a116, v5
    v_accvgpr_read_b32 v6, a117
    v_mul_f32 v6, v6, v4
    v_accvgpr_write_b32 a117, v6
    v_accvgpr_read_b32 v7, a118
    v_mul_f32 v7, v7, v4
    v_accvgpr_write_b32 a118, v7
    v_accvgpr_read_b32 v8, a119
    v_mul_f32 v8, v8, v4
    v_accvgpr_write_b32 a119, v8
    v_accvgpr_read_b32 v5, a120
    v_mul_f32 v5, v5, v4
    v_accvgpr_write_b32 a120, v5
    v_accvgpr_read_b32 v6, a121
    v_mul_f32 v6, v6, v4
    v_accvgpr_write_b32 a121, v6
    v_accvgpr_read_b32 v7, a122
    v_mul_f32 v7, v7, v4
    v_accvgpr_write_b32 a122, v7
    v_accvgpr_read_b32 v8, a123
    v_mul_f32 v8, v8, v4
    v_accvgpr_write_b32 a123, v8
    v_accvgpr_read_b32 v5, a124
    v_mul_f32 v5, v5, v4
    v_accvgpr_write_b32 a124, v5
    v_accvgpr_read_b32 v6, a125
    v_mul_f32 v6, v6, v4
    v_accvgpr_write_b32 a125, v6
    v_accvgpr_read_b32 v7, a126
    v_mul_f32 v7, v7, v4
    v_accvgpr_write_b32 a126, v7
    v_accvgpr_read_b32 v8, a127
    v_mul_f32 v8, v8, v4
    v_accvgpr_write_b32 a127, v8
    s_nop 1
    s_branch LRB_66
LRS_67:
    v_max_f32 v3, v32, v2
    v_sub_f32 v4, v32, v3
    v_exp_f32 v4, v4
    v_mov_b32 v32, v3
    s_nop 0
    v_mul_f32 v33, v33, v4
    s_nop 15
    v_accvgpr_read_b32 v5, a0
    v_mul_f32 v5, v5, v4
    v_accvgpr_write_b32 a0, v5
    v_accvgpr_read_b32 v6, a1
    v_mul_f32 v6, v6, v4
    v_accvgpr_write_b32 a1, v6
    v_accvgpr_read_b32 v7, a2
    v_mul_f32 v7, v7, v4
    v_accvgpr_write_b32 a2, v7
    v_accvgpr_read_b32 v8, a3
    v_mul_f32 v8, v8, v4
    v_accvgpr_write_b32 a3, v8
    v_accvgpr_read_b32 v5, a4
    v_mul_f32 v5, v5, v4
    v_accvgpr_write_b32 a4, v5
    v_accvgpr_read_b32 v6, a5
    v_mul_f32 v6, v6, v4
    v_accvgpr_write_b32 a5, v6
    v_accvgpr_read_b32 v7, a6
    v_mul_f32 v7, v7, v4
    v_accvgpr_write_b32 a6, v7
    v_accvgpr_read_b32 v8, a7
    v_mul_f32 v8, v8, v4
    v_accvgpr_write_b32 a7, v8
    v_accvgpr_read_b32 v5, a8
    v_mul_f32 v5, v5, v4
    v_accvgpr_write_b32 a8, v5
    v_accvgpr_read_b32 v6, a9
    v_mul_f32 v6, v6, v4
    v_accvgpr_write_b32 a9, v6
    v_accvgpr_read_b32 v7, a10
    v_mul_f32 v7, v7, v4
    v_accvgpr_write_b32 a10, v7
    v_accvgpr_read_b32 v8, a11
    v_mul_f32 v8, v8, v4
    v_accvgpr_write_b32 a11, v8
    v_accvgpr_read_b32 v5, a12
    v_mul_f32 v5, v5, v4
    v_accvgpr_write_b32 a12, v5
    v_accvgpr_read_b32 v6, a13
    v_mul_f32 v6, v6, v4
    v_accvgpr_write_b32 a13, v6
    v_accvgpr_read_b32 v7, a14
    v_mul_f32 v7, v7, v4
    v_accvgpr_write_b32 a14, v7
    v_accvgpr_read_b32 v8, a15
    v_mul_f32 v8, v8, v4
    v_accvgpr_write_b32 a15, v8
    v_accvgpr_read_b32 v5, a16
    v_mul_f32 v5, v5, v4
    v_accvgpr_write_b32 a16, v5
    v_accvgpr_read_b32 v6, a17
    v_mul_f32 v6, v6, v4
    v_accvgpr_write_b32 a17, v6
    v_accvgpr_read_b32 v7, a18
    v_mul_f32 v7, v7, v4
    v_accvgpr_write_b32 a18, v7
    v_accvgpr_read_b32 v8, a19
    v_mul_f32 v8, v8, v4
    v_accvgpr_write_b32 a19, v8
    v_accvgpr_read_b32 v5, a20
    v_mul_f32 v5, v5, v4
    v_accvgpr_write_b32 a20, v5
    v_accvgpr_read_b32 v6, a21
    v_mul_f32 v6, v6, v4
    v_accvgpr_write_b32 a21, v6
    v_accvgpr_read_b32 v7, a22
    v_mul_f32 v7, v7, v4
    v_accvgpr_write_b32 a22, v7
    v_accvgpr_read_b32 v8, a23
    v_mul_f32 v8, v8, v4
    v_accvgpr_write_b32 a23, v8
    v_accvgpr_read_b32 v5, a24
    v_mul_f32 v5, v5, v4
    v_accvgpr_write_b32 a24, v5
    v_accvgpr_read_b32 v6, a25
    v_mul_f32 v6, v6, v4
    v_accvgpr_write_b32 a25, v6
    v_accvgpr_read_b32 v7, a26
    v_mul_f32 v7, v7, v4
    v_accvgpr_write_b32 a26, v7
    v_accvgpr_read_b32 v8, a27
    v_mul_f32 v8, v8, v4
    v_accvgpr_write_b32 a27, v8
    v_accvgpr_read_b32 v5, a28
    v_mul_f32 v5, v5, v4
    v_accvgpr_write_b32 a28, v5
    v_accvgpr_read_b32 v6, a29
    v_mul_f32 v6, v6, v4
    v_accvgpr_write_b32 a29, v6
    v_accvgpr_read_b32 v7, a30
    v_mul_f32 v7, v7, v4
    v_accvgpr_write_b32 a30, v7
    v_accvgpr_read_b32 v8, a31
    v_mul_f32 v8, v8, v4
    v_accvgpr_write_b32 a31, v8
    v_accvgpr_read_b32 v5, a32
    v_mul_f32 v5, v5, v4
    v_accvgpr_write_b32 a32, v5
    v_accvgpr_read_b32 v6, a33
    v_mul_f32 v6, v6, v4
    v_accvgpr_write_b32 a33, v6
    v_accvgpr_read_b32 v7, a34
    v_mul_f32 v7, v7, v4
    v_accvgpr_write_b32 a34, v7
    v_accvgpr_read_b32 v8, a35
    v_mul_f32 v8, v8, v4
    v_accvgpr_write_b32 a35, v8
    v_accvgpr_read_b32 v5, a36
    v_mul_f32 v5, v5, v4
    v_accvgpr_write_b32 a36, v5
    v_accvgpr_read_b32 v6, a37
    v_mul_f32 v6, v6, v4
    v_accvgpr_write_b32 a37, v6
    v_accvgpr_read_b32 v7, a38
    v_mul_f32 v7, v7, v4
    v_accvgpr_write_b32 a38, v7
    v_accvgpr_read_b32 v8, a39
    v_mul_f32 v8, v8, v4
    v_accvgpr_write_b32 a39, v8
    v_accvgpr_read_b32 v5, a40
    v_mul_f32 v5, v5, v4
    v_accvgpr_write_b32 a40, v5
    v_accvgpr_read_b32 v6, a41
    v_mul_f32 v6, v6, v4
    v_accvgpr_write_b32 a41, v6
    v_accvgpr_read_b32 v7, a42
    v_mul_f32 v7, v7, v4
    v_accvgpr_write_b32 a42, v7
    v_accvgpr_read_b32 v8, a43
    v_mul_f32 v8, v8, v4
    v_accvgpr_write_b32 a43, v8
    v_accvgpr_read_b32 v5, a44
    v_mul_f32 v5, v5, v4
    v_accvgpr_write_b32 a44, v5
    v_accvgpr_read_b32 v6, a45
    v_mul_f32 v6, v6, v4
    v_accvgpr_write_b32 a45, v6
    v_accvgpr_read_b32 v7, a46
    v_mul_f32 v7, v7, v4
    v_accvgpr_write_b32 a46, v7
    v_accvgpr_read_b32 v8, a47
    v_mul_f32 v8, v8, v4
    v_accvgpr_write_b32 a47, v8
    v_accvgpr_read_b32 v5, a48
    v_mul_f32 v5, v5, v4
    v_accvgpr_write_b32 a48, v5
    v_accvgpr_read_b32 v6, a49
    v_mul_f32 v6, v6, v4
    v_accvgpr_write_b32 a49, v6
    v_accvgpr_read_b32 v7, a50
    v_mul_f32 v7, v7, v4
    v_accvgpr_write_b32 a50, v7
    v_accvgpr_read_b32 v8, a51
    v_mul_f32 v8, v8, v4
    v_accvgpr_write_b32 a51, v8
    v_accvgpr_read_b32 v5, a52
    v_mul_f32 v5, v5, v4
    v_accvgpr_write_b32 a52, v5
    v_accvgpr_read_b32 v6, a53
    v_mul_f32 v6, v6, v4
    v_accvgpr_write_b32 a53, v6
    v_accvgpr_read_b32 v7, a54
    v_mul_f32 v7, v7, v4
    v_accvgpr_write_b32 a54, v7
    v_accvgpr_read_b32 v8, a55
    v_mul_f32 v8, v8, v4
    v_accvgpr_write_b32 a55, v8
    v_accvgpr_read_b32 v5, a56
    v_mul_f32 v5, v5, v4
    v_accvgpr_write_b32 a56, v5
    v_accvgpr_read_b32 v6, a57
    v_mul_f32 v6, v6, v4
    v_accvgpr_write_b32 a57, v6
    v_accvgpr_read_b32 v7, a58
    v_mul_f32 v7, v7, v4
    v_accvgpr_write_b32 a58, v7
    v_accvgpr_read_b32 v8, a59
    v_mul_f32 v8, v8, v4
    v_accvgpr_write_b32 a59, v8
    v_accvgpr_read_b32 v5, a60
    v_mul_f32 v5, v5, v4
    v_accvgpr_write_b32 a60, v5
    v_accvgpr_read_b32 v6, a61
    v_mul_f32 v6, v6, v4
    v_accvgpr_write_b32 a61, v6
    v_accvgpr_read_b32 v7, a62
    v_mul_f32 v7, v7, v4
    v_accvgpr_write_b32 a62, v7
    v_accvgpr_read_b32 v8, a63
    v_mul_f32 v8, v8, v4
    v_accvgpr_write_b32 a63, v8
    v_accvgpr_read_b32 v5, a64
    v_mul_f32 v5, v5, v4
    v_accvgpr_write_b32 a64, v5
    v_accvgpr_read_b32 v6, a65
    v_mul_f32 v6, v6, v4
    v_accvgpr_write_b32 a65, v6
    v_accvgpr_read_b32 v7, a66
    v_mul_f32 v7, v7, v4
    v_accvgpr_write_b32 a66, v7
    v_accvgpr_read_b32 v8, a67
    v_mul_f32 v8, v8, v4
    v_accvgpr_write_b32 a67, v8
    v_accvgpr_read_b32 v5, a68
    v_mul_f32 v5, v5, v4
    v_accvgpr_write_b32 a68, v5
    v_accvgpr_read_b32 v6, a69
    v_mul_f32 v6, v6, v4
    v_accvgpr_write_b32 a69, v6
    v_accvgpr_read_b32 v7, a70
    v_mul_f32 v7, v7, v4
    v_accvgpr_write_b32 a70, v7
    v_accvgpr_read_b32 v8, a71
    v_mul_f32 v8, v8, v4
    v_accvgpr_write_b32 a71, v8
    v_accvgpr_read_b32 v5, a72
    v_mul_f32 v5, v5, v4
    v_accvgpr_write_b32 a72, v5
    v_accvgpr_read_b32 v6, a73
    v_mul_f32 v6, v6, v4
    v_accvgpr_write_b32 a73, v6
    v_accvgpr_read_b32 v7, a74
    v_mul_f32 v7, v7, v4
    v_accvgpr_write_b32 a74, v7
    v_accvgpr_read_b32 v8, a75
    v_mul_f32 v8, v8, v4
    v_accvgpr_write_b32 a75, v8
    v_accvgpr_read_b32 v5, a76
    v_mul_f32 v5, v5, v4
    v_accvgpr_write_b32 a76, v5
    v_accvgpr_read_b32 v6, a77
    v_mul_f32 v6, v6, v4
    v_accvgpr_write_b32 a77, v6
    v_accvgpr_read_b32 v7, a78
    v_mul_f32 v7, v7, v4
    v_accvgpr_write_b32 a78, v7
    v_accvgpr_read_b32 v8, a79
    v_mul_f32 v8, v8, v4
    v_accvgpr_write_b32 a79, v8
    v_accvgpr_read_b32 v5, a80
    v_mul_f32 v5, v5, v4
    v_accvgpr_write_b32 a80, v5
    v_accvgpr_read_b32 v6, a81
    v_mul_f32 v6, v6, v4
    v_accvgpr_write_b32 a81, v6
    v_accvgpr_read_b32 v7, a82
    v_mul_f32 v7, v7, v4
    v_accvgpr_write_b32 a82, v7
    v_accvgpr_read_b32 v8, a83
    v_mul_f32 v8, v8, v4
    v_accvgpr_write_b32 a83, v8
    v_accvgpr_read_b32 v5, a84
    v_mul_f32 v5, v5, v4
    v_accvgpr_write_b32 a84, v5
    v_accvgpr_read_b32 v6, a85
    v_mul_f32 v6, v6, v4
    v_accvgpr_write_b32 a85, v6
    v_accvgpr_read_b32 v7, a86
    v_mul_f32 v7, v7, v4
    v_accvgpr_write_b32 a86, v7
    v_accvgpr_read_b32 v8, a87
    v_mul_f32 v8, v8, v4
    v_accvgpr_write_b32 a87, v8
    v_accvgpr_read_b32 v5, a88
    v_mul_f32 v5, v5, v4
    v_accvgpr_write_b32 a88, v5
    v_accvgpr_read_b32 v6, a89
    v_mul_f32 v6, v6, v4
    v_accvgpr_write_b32 a89, v6
    v_accvgpr_read_b32 v7, a90
    v_mul_f32 v7, v7, v4
    v_accvgpr_write_b32 a90, v7
    v_accvgpr_read_b32 v8, a91
    v_mul_f32 v8, v8, v4
    v_accvgpr_write_b32 a91, v8
    v_accvgpr_read_b32 v5, a92
    v_mul_f32 v5, v5, v4
    v_accvgpr_write_b32 a92, v5
    v_accvgpr_read_b32 v6, a93
    v_mul_f32 v6, v6, v4
    v_accvgpr_write_b32 a93, v6
    v_accvgpr_read_b32 v7, a94
    v_mul_f32 v7, v7, v4
    v_accvgpr_write_b32 a94, v7
    v_accvgpr_read_b32 v8, a95
    v_mul_f32 v8, v8, v4
    v_accvgpr_write_b32 a95, v8
    v_accvgpr_read_b32 v5, a96
    v_mul_f32 v5, v5, v4
    v_accvgpr_write_b32 a96, v5
    v_accvgpr_read_b32 v6, a97
    v_mul_f32 v6, v6, v4
    v_accvgpr_write_b32 a97, v6
    v_accvgpr_read_b32 v7, a98
    v_mul_f32 v7, v7, v4
    v_accvgpr_write_b32 a98, v7
    v_accvgpr_read_b32 v8, a99
    v_mul_f32 v8, v8, v4
    v_accvgpr_write_b32 a99, v8
    v_accvgpr_read_b32 v5, a100
    v_mul_f32 v5, v5, v4
    v_accvgpr_write_b32 a100, v5
    v_accvgpr_read_b32 v6, a101
    v_mul_f32 v6, v6, v4
    v_accvgpr_write_b32 a101, v6
    v_accvgpr_read_b32 v7, a102
    v_mul_f32 v7, v7, v4
    v_accvgpr_write_b32 a102, v7
    v_accvgpr_read_b32 v8, a103
    v_mul_f32 v8, v8, v4
    v_accvgpr_write_b32 a103, v8
    v_accvgpr_read_b32 v5, a104
    v_mul_f32 v5, v5, v4
    v_accvgpr_write_b32 a104, v5
    v_accvgpr_read_b32 v6, a105
    v_mul_f32 v6, v6, v4
    v_accvgpr_write_b32 a105, v6
    v_accvgpr_read_b32 v7, a106
    v_mul_f32 v7, v7, v4
    v_accvgpr_write_b32 a106, v7
    v_accvgpr_read_b32 v8, a107
    v_mul_f32 v8, v8, v4
    v_accvgpr_write_b32 a107, v8
    v_accvgpr_read_b32 v5, a108
    v_mul_f32 v5, v5, v4
    v_accvgpr_write_b32 a108, v5
    v_accvgpr_read_b32 v6, a109
    v_mul_f32 v6, v6, v4
    v_accvgpr_write_b32 a109, v6
    v_accvgpr_read_b32 v7, a110
    v_mul_f32 v7, v7, v4
    v_accvgpr_write_b32 a110, v7
    v_accvgpr_read_b32 v8, a111
    v_mul_f32 v8, v8, v4
    v_accvgpr_write_b32 a111, v8
    v_accvgpr_read_b32 v5, a112
    v_mul_f32 v5, v5, v4
    v_accvgpr_write_b32 a112, v5
    v_accvgpr_read_b32 v6, a113
    v_mul_f32 v6, v6, v4
    v_accvgpr_write_b32 a113, v6
    v_accvgpr_read_b32 v7, a114
    v_mul_f32 v7, v7, v4
    v_accvgpr_write_b32 a114, v7
    v_accvgpr_read_b32 v8, a115
    v_mul_f32 v8, v8, v4
    v_accvgpr_write_b32 a115, v8
    v_accvgpr_read_b32 v5, a116
    v_mul_f32 v5, v5, v4
    v_accvgpr_write_b32 a116, v5
    v_accvgpr_read_b32 v6, a117
    v_mul_f32 v6, v6, v4
    v_accvgpr_write_b32 a117, v6
    v_accvgpr_read_b32 v7, a118
    v_mul_f32 v7, v7, v4
    v_accvgpr_write_b32 a118, v7
    v_accvgpr_read_b32 v8, a119
    v_mul_f32 v8, v8, v4
    v_accvgpr_write_b32 a119, v8
    v_accvgpr_read_b32 v5, a120
    v_mul_f32 v5, v5, v4
    v_accvgpr_write_b32 a120, v5
    v_accvgpr_read_b32 v6, a121
    v_mul_f32 v6, v6, v4
    v_accvgpr_write_b32 a121, v6
    v_accvgpr_read_b32 v7, a122
    v_mul_f32 v7, v7, v4
    v_accvgpr_write_b32 a122, v7
    v_accvgpr_read_b32 v8, a123
    v_mul_f32 v8, v8, v4
    v_accvgpr_write_b32 a123, v8
    v_accvgpr_read_b32 v5, a124
    v_mul_f32 v5, v5, v4
    v_accvgpr_write_b32 a124, v5
    v_accvgpr_read_b32 v6, a125
    v_mul_f32 v6, v6, v4
    v_accvgpr_write_b32 a125, v6
    v_accvgpr_read_b32 v7, a126
    v_mul_f32 v7, v7, v4
    v_accvgpr_write_b32 a126, v7
    v_accvgpr_read_b32 v8, a127
    v_mul_f32 v8, v8, v4
    v_accvgpr_write_b32 a127, v8
    s_nop 1
    s_branch LRB_68
LRS_69:
    v_max_f32 v3, v34, v2
    v_sub_f32 v4, v34, v3
    v_exp_f32 v4, v4
    v_mov_b32 v34, v3
    s_nop 0
    v_mul_f32 v35, v35, v4
    s_nop 15
    v_accvgpr_read_b32 v5, a128
    v_mul_f32 v5, v5, v4
    v_accvgpr_write_b32 a128, v5
    v_accvgpr_read_b32 v6, a129
    v_mul_f32 v6, v6, v4
    v_accvgpr_write_b32 a129, v6
    v_accvgpr_read_b32 v7, a130
    v_mul_f32 v7, v7, v4
    v_accvgpr_write_b32 a130, v7
    v_accvgpr_read_b32 v8, a131
    v_mul_f32 v8, v8, v4
    v_accvgpr_write_b32 a131, v8
    v_accvgpr_read_b32 v5, a132
    v_mul_f32 v5, v5, v4
    v_accvgpr_write_b32 a132, v5
    v_accvgpr_read_b32 v6, a133
    v_mul_f32 v6, v6, v4
    v_accvgpr_write_b32 a133, v6
    v_accvgpr_read_b32 v7, a134
    v_mul_f32 v7, v7, v4
    v_accvgpr_write_b32 a134, v7
    v_accvgpr_read_b32 v8, a135
    v_mul_f32 v8, v8, v4
    v_accvgpr_write_b32 a135, v8
    v_accvgpr_read_b32 v5, a136
    v_mul_f32 v5, v5, v4
    v_accvgpr_write_b32 a136, v5
    v_accvgpr_read_b32 v6, a137
    v_mul_f32 v6, v6, v4
    v_accvgpr_write_b32 a137, v6
    v_accvgpr_read_b32 v7, a138
    v_mul_f32 v7, v7, v4
    v_accvgpr_write_b32 a138, v7
    v_accvgpr_read_b32 v8, a139
    v_mul_f32 v8, v8, v4
    v_accvgpr_write_b32 a139, v8
    v_accvgpr_read_b32 v5, a140
    v_mul_f32 v5, v5, v4
    v_accvgpr_write_b32 a140, v5
    v_accvgpr_read_b32 v6, a141
    v_mul_f32 v6, v6, v4
    v_accvgpr_write_b32 a141, v6
    v_accvgpr_read_b32 v7, a142
    v_mul_f32 v7, v7, v4
    v_accvgpr_write_b32 a142, v7
    v_accvgpr_read_b32 v8, a143
    v_mul_f32 v8, v8, v4
    v_accvgpr_write_b32 a143, v8
    v_accvgpr_read_b32 v5, a144
    v_mul_f32 v5, v5, v4
    v_accvgpr_write_b32 a144, v5
    v_accvgpr_read_b32 v6, a145
    v_mul_f32 v6, v6, v4
    v_accvgpr_write_b32 a145, v6
    v_accvgpr_read_b32 v7, a146
    v_mul_f32 v7, v7, v4
    v_accvgpr_write_b32 a146, v7
    v_accvgpr_read_b32 v8, a147
    v_mul_f32 v8, v8, v4
    v_accvgpr_write_b32 a147, v8
    v_accvgpr_read_b32 v5, a148
    v_mul_f32 v5, v5, v4
    v_accvgpr_write_b32 a148, v5
    v_accvgpr_read_b32 v6, a149
    v_mul_f32 v6, v6, v4
    v_accvgpr_write_b32 a149, v6
    v_accvgpr_read_b32 v7, a150
    v_mul_f32 v7, v7, v4
    v_accvgpr_write_b32 a150, v7
    v_accvgpr_read_b32 v8, a151
    v_mul_f32 v8, v8, v4
    v_accvgpr_write_b32 a151, v8
    v_accvgpr_read_b32 v5, a152
    v_mul_f32 v5, v5, v4
    v_accvgpr_write_b32 a152, v5
    v_accvgpr_read_b32 v6, a153
    v_mul_f32 v6, v6, v4
    v_accvgpr_write_b32 a153, v6
    v_accvgpr_read_b32 v7, a154
    v_mul_f32 v7, v7, v4
    v_accvgpr_write_b32 a154, v7
    v_accvgpr_read_b32 v8, a155
    v_mul_f32 v8, v8, v4
    v_accvgpr_write_b32 a155, v8
    v_accvgpr_read_b32 v5, a156
    v_mul_f32 v5, v5, v4
    v_accvgpr_write_b32 a156, v5
    v_accvgpr_read_b32 v6, a157
    v_mul_f32 v6, v6, v4
    v_accvgpr_write_b32 a157, v6
    v_accvgpr_read_b32 v7, a158
    v_mul_f32 v7, v7, v4
    v_accvgpr_write_b32 a158, v7
    v_accvgpr_read_b32 v8, a159
    v_mul_f32 v8, v8, v4
    v_accvgpr_write_b32 a159, v8
    v_accvgpr_read_b32 v5, a160
    v_mul_f32 v5, v5, v4
    v_accvgpr_write_b32 a160, v5
    v_accvgpr_read_b32 v6, a161
    v_mul_f32 v6, v6, v4
    v_accvgpr_write_b32 a161, v6
    v_accvgpr_read_b32 v7, a162
    v_mul_f32 v7, v7, v4
    v_accvgpr_write_b32 a162, v7
    v_accvgpr_read_b32 v8, a163
    v_mul_f32 v8, v8, v4
    v_accvgpr_write_b32 a163, v8
    v_accvgpr_read_b32 v5, a164
    v_mul_f32 v5, v5, v4
    v_accvgpr_write_b32 a164, v5
    v_accvgpr_read_b32 v6, a165
    v_mul_f32 v6, v6, v4
    v_accvgpr_write_b32 a165, v6
    v_accvgpr_read_b32 v7, a166
    v_mul_f32 v7, v7, v4
    v_accvgpr_write_b32 a166, v7
    v_accvgpr_read_b32 v8, a167
    v_mul_f32 v8, v8, v4
    v_accvgpr_write_b32 a167, v8
    v_accvgpr_read_b32 v5, a168
    v_mul_f32 v5, v5, v4
    v_accvgpr_write_b32 a168, v5
    v_accvgpr_read_b32 v6, a169
    v_mul_f32 v6, v6, v4
    v_accvgpr_write_b32 a169, v6
    v_accvgpr_read_b32 v7, a170
    v_mul_f32 v7, v7, v4
    v_accvgpr_write_b32 a170, v7
    v_accvgpr_read_b32 v8, a171
    v_mul_f32 v8, v8, v4
    v_accvgpr_write_b32 a171, v8
    v_accvgpr_read_b32 v5, a172
    v_mul_f32 v5, v5, v4
    v_accvgpr_write_b32 a172, v5
    v_accvgpr_read_b32 v6, a173
    v_mul_f32 v6, v6, v4
    v_accvgpr_write_b32 a173, v6
    v_accvgpr_read_b32 v7, a174
    v_mul_f32 v7, v7, v4
    v_accvgpr_write_b32 a174, v7
    v_accvgpr_read_b32 v8, a175
    v_mul_f32 v8, v8, v4
    v_accvgpr_write_b32 a175, v8
    v_accvgpr_read_b32 v5, a176
    v_mul_f32 v5, v5, v4
    v_accvgpr_write_b32 a176, v5
    v_accvgpr_read_b32 v6, a177
    v_mul_f32 v6, v6, v4
    v_accvgpr_write_b32 a177, v6
    v_accvgpr_read_b32 v7, a178
    v_mul_f32 v7, v7, v4
    v_accvgpr_write_b32 a178, v7
    v_accvgpr_read_b32 v8, a179
    v_mul_f32 v8, v8, v4
    v_accvgpr_write_b32 a179, v8
    v_accvgpr_read_b32 v5, a180
    v_mul_f32 v5, v5, v4
    v_accvgpr_write_b32 a180, v5
    v_accvgpr_read_b32 v6, a181
    v_mul_f32 v6, v6, v4
    v_accvgpr_write_b32 a181, v6
    v_accvgpr_read_b32 v7, a182
    v_mul_f32 v7, v7, v4
    v_accvgpr_write_b32 a182, v7
    v_accvgpr_read_b32 v8, a183
    v_mul_f32 v8, v8, v4
    v_accvgpr_write_b32 a183, v8
    v_accvgpr_read_b32 v5, a184
    v_mul_f32 v5, v5, v4
    v_accvgpr_write_b32 a184, v5
    v_accvgpr_read_b32 v6, a185
    v_mul_f32 v6, v6, v4
    v_accvgpr_write_b32 a185, v6
    v_accvgpr_read_b32 v7, a186
    v_mul_f32 v7, v7, v4
    v_accvgpr_write_b32 a186, v7
    v_accvgpr_read_b32 v8, a187
    v_mul_f32 v8, v8, v4
    v_accvgpr_write_b32 a187, v8
    v_accvgpr_read_b32 v5, a188
    v_mul_f32 v5, v5, v4
    v_accvgpr_write_b32 a188, v5
    v_accvgpr_read_b32 v6, a189
    v_mul_f32 v6, v6, v4
    v_accvgpr_write_b32 a189, v6
    v_accvgpr_read_b32 v7, a190
    v_mul_f32 v7, v7, v4
    v_accvgpr_write_b32 a190, v7
    v_accvgpr_read_b32 v8, a191
    v_mul_f32 v8, v8, v4
    v_accvgpr_write_b32 a191, v8
    v_accvgpr_read_b32 v5, a192
    v_mul_f32 v5, v5, v4
    v_accvgpr_write_b32 a192, v5
    v_accvgpr_read_b32 v6, a193
    v_mul_f32 v6, v6, v4
    v_accvgpr_write_b32 a193, v6
    v_accvgpr_read_b32 v7, a194
    v_mul_f32 v7, v7, v4
    v_accvgpr_write_b32 a194, v7
    v_accvgpr_read_b32 v8, a195
    v_mul_f32 v8, v8, v4
    v_accvgpr_write_b32 a195, v8
    v_accvgpr_read_b32 v5, a196
    v_mul_f32 v5, v5, v4
    v_accvgpr_write_b32 a196, v5
    v_accvgpr_read_b32 v6, a197
    v_mul_f32 v6, v6, v4
    v_accvgpr_write_b32 a197, v6
    v_accvgpr_read_b32 v7, a198
    v_mul_f32 v7, v7, v4
    v_accvgpr_write_b32 a198, v7
    v_accvgpr_read_b32 v8, a199
    v_mul_f32 v8, v8, v4
    v_accvgpr_write_b32 a199, v8
    v_accvgpr_read_b32 v5, a200
    v_mul_f32 v5, v5, v4
    v_accvgpr_write_b32 a200, v5
    v_accvgpr_read_b32 v6, a201
    v_mul_f32 v6, v6, v4
    v_accvgpr_write_b32 a201, v6
    v_accvgpr_read_b32 v7, a202
    v_mul_f32 v7, v7, v4
    v_accvgpr_write_b32 a202, v7
    v_accvgpr_read_b32 v8, a203
    v_mul_f32 v8, v8, v4
    v_accvgpr_write_b32 a203, v8
    v_accvgpr_read_b32 v5, a204
    v_mul_f32 v5, v5, v4
    v_accvgpr_write_b32 a204, v5
    v_accvgpr_read_b32 v6, a205
    v_mul_f32 v6, v6, v4
    v_accvgpr_write_b32 a205, v6
    v_accvgpr_read_b32 v7, a206
    v_mul_f32 v7, v7, v4
    v_accvgpr_write_b32 a206, v7
    v_accvgpr_read_b32 v8, a207
    v_mul_f32 v8, v8, v4
    v_accvgpr_write_b32 a207, v8
    v_accvgpr_read_b32 v5, a208
    v_mul_f32 v5, v5, v4
    v_accvgpr_write_b32 a208, v5
    v_accvgpr_read_b32 v6, a209
    v_mul_f32 v6, v6, v4
    v_accvgpr_write_b32 a209, v6
    v_accvgpr_read_b32 v7, a210
    v_mul_f32 v7, v7, v4
    v_accvgpr_write_b32 a210, v7
    v_accvgpr_read_b32 v8, a211
    v_mul_f32 v8, v8, v4
    v_accvgpr_write_b32 a211, v8
    v_accvgpr_read_b32 v5, a212
    v_mul_f32 v5, v5, v4
    v_accvgpr_write_b32 a212, v5
    v_accvgpr_read_b32 v6, a213
    v_mul_f32 v6, v6, v4
    v_accvgpr_write_b32 a213, v6
    v_accvgpr_read_b32 v7, a214
    v_mul_f32 v7, v7, v4
    v_accvgpr_write_b32 a214, v7
    v_accvgpr_read_b32 v8, a215
    v_mul_f32 v8, v8, v4
    v_accvgpr_write_b32 a215, v8
    v_accvgpr_read_b32 v5, a216
    v_mul_f32 v5, v5, v4
    v_accvgpr_write_b32 a216, v5
    v_accvgpr_read_b32 v6, a217
    v_mul_f32 v6, v6, v4
    v_accvgpr_write_b32 a217, v6
    v_accvgpr_read_b32 v7, a218
    v_mul_f32 v7, v7, v4
    v_accvgpr_write_b32 a218, v7
    v_accvgpr_read_b32 v8, a219
    v_mul_f32 v8, v8, v4
    v_accvgpr_write_b32 a219, v8
    v_accvgpr_read_b32 v5, a220
    v_mul_f32 v5, v5, v4
    v_accvgpr_write_b32 a220, v5
    v_accvgpr_read_b32 v6, a221
    v_mul_f32 v6, v6, v4
    v_accvgpr_write_b32 a221, v6
    v_accvgpr_read_b32 v7, a222
    v_mul_f32 v7, v7, v4
    v_accvgpr_write_b32 a222, v7
    v_accvgpr_read_b32 v8, a223
    v_mul_f32 v8, v8, v4
    v_accvgpr_write_b32 a223, v8
    v_accvgpr_read_b32 v5, a224
    v_mul_f32 v5, v5, v4
    v_accvgpr_write_b32 a224, v5
    v_accvgpr_read_b32 v6, a225
    v_mul_f32 v6, v6, v4
    v_accvgpr_write_b32 a225, v6
    v_accvgpr_read_b32 v7, a226
    v_mul_f32 v7, v7, v4
    v_accvgpr_write_b32 a226, v7
    v_accvgpr_read_b32 v8, a227
    v_mul_f32 v8, v8, v4
    v_accvgpr_write_b32 a227, v8
    v_accvgpr_read_b32 v5, a228
    v_mul_f32 v5, v5, v4
    v_accvgpr_write_b32 a228, v5
    v_accvgpr_read_b32 v6, a229
    v_mul_f32 v6, v6, v4
    v_accvgpr_write_b32 a229, v6
    v_accvgpr_read_b32 v7, a230
    v_mul_f32 v7, v7, v4
    v_accvgpr_write_b32 a230, v7
    v_accvgpr_read_b32 v8, a231
    v_mul_f32 v8, v8, v4
    v_accvgpr_write_b32 a231, v8
    v_accvgpr_read_b32 v5, a232
    v_mul_f32 v5, v5, v4
    v_accvgpr_write_b32 a232, v5
    v_accvgpr_read_b32 v6, a233
    v_mul_f32 v6, v6, v4
    v_accvgpr_write_b32 a233, v6
    v_accvgpr_read_b32 v7, a234
    v_mul_f32 v7, v7, v4
    v_accvgpr_write_b32 a234, v7
    v_accvgpr_read_b32 v8, a235
    v_mul_f32 v8, v8, v4
    v_accvgpr_write_b32 a235, v8
    v_accvgpr_read_b32 v5, a236
    v_mul_f32 v5, v5, v4
    v_accvgpr_write_b32 a236, v5
    v_accvgpr_read_b32 v6, a237
    v_mul_f32 v6, v6, v4
    v_accvgpr_write_b32 a237, v6
    v_accvgpr_read_b32 v7, a238
    v_mul_f32 v7, v7, v4
    v_accvgpr_write_b32 a238, v7
    v_accvgpr_read_b32 v8, a239
    v_mul_f32 v8, v8, v4
    v_accvgpr_write_b32 a239, v8
    v_accvgpr_read_b32 v5, a240
    v_mul_f32 v5, v5, v4
    v_accvgpr_write_b32 a240, v5
    v_accvgpr_read_b32 v6, a241
    v_mul_f32 v6, v6, v4
    v_accvgpr_write_b32 a241, v6
    v_accvgpr_read_b32 v7, a242
    v_mul_f32 v7, v7, v4
    v_accvgpr_write_b32 a242, v7
    v_accvgpr_read_b32 v8, a243
    v_mul_f32 v8, v8, v4
    v_accvgpr_write_b32 a243, v8
    v_accvgpr_read_b32 v5, a244
    v_mul_f32 v5, v5, v4
    v_accvgpr_write_b32 a244, v5
    v_accvgpr_read_b32 v6, a245
    v_mul_f32 v6, v6, v4
    v_accvgpr_write_b32 a245, v6
    v_accvgpr_read_b32 v7, a246
    v_mul_f32 v7, v7, v4
    v_accvgpr_write_b32 a246, v7
    v_accvgpr_read_b32 v8, a247
    v_mul_f32 v8, v8, v4
    v_accvgpr_write_b32 a247, v8
    v_accvgpr_read_b32 v5, a248
    v_mul_f32 v5, v5, v4
    v_accvgpr_write_b32 a248, v5
    v_accvgpr_read_b32 v6, a249
    v_mul_f32 v6, v6, v4
    v_accvgpr_write_b32 a249, v6
    v_accvgpr_read_b32 v7, a250
    v_mul_f32 v7, v7, v4
    v_accvgpr_write_b32 a250, v7
    v_accvgpr_read_b32 v8, a251
    v_mul_f32 v8, v8, v4
    v_accvgpr_write_b32 a251, v8
    v_accvgpr_read_b32 v5, a252
    v_mul_f32 v5, v5, v4
    v_accvgpr_write_b32 a252, v5
    v_accvgpr_read_b32 v6, a253
    v_mul_f32 v6, v6, v4
    v_accvgpr_write_b32 a253, v6
    v_accvgpr_read_b32 v7, a254
    v_mul_f32 v7, v7, v4
    v_accvgpr_write_b32 a254, v7
    v_accvgpr_read_b32 v8, a255
    v_mul_f32 v8, v8, v4
    v_accvgpr_write_b32 a255, v8
    s_nop 1
    s_branch LRB_70
LRS_77:
    v_max_f32 v3, v32, v2
    v_sub_f32 v4, v32, v3
    v_exp_f32 v4, v4
    v_mov_b32 v32, v3
    s_nop 0
    v_mul_f32 v33, v33, v4
    s_nop 15
    v_accvgpr_read_b32 v5, a0
    v_mul_f32 v5, v5, v4
    v_accvgpr_write_b32 a0, v5
    v_accvgpr_read_b32 v6, a1
    v_mul_f32 v6, v6, v4
    v_accvgpr_write_b32 a1, v6
    v_accvgpr_read_b32 v7, a2
    v_mul_f32 v7, v7, v4
    v_accvgpr_write_b32 a2, v7
    v_accvgpr_read_b32 v8, a3
    v_mul_f32 v8, v8, v4
    v_accvgpr_write_b32 a3, v8
    v_accvgpr_read_b32 v5, a4
    v_mul_f32 v5, v5, v4
    v_accvgpr_write_b32 a4, v5
    v_accvgpr_read_b32 v6, a5
    v_mul_f32 v6, v6, v4
    v_accvgpr_write_b32 a5, v6
    v_accvgpr_read_b32 v7, a6
    v_mul_f32 v7, v7, v4
    v_accvgpr_write_b32 a6, v7
    v_accvgpr_read_b32 v8, a7
    v_mul_f32 v8, v8, v4
    v_accvgpr_write_b32 a7, v8
    v_accvgpr_read_b32 v5, a8
    v_mul_f32 v5, v5, v4
    v_accvgpr_write_b32 a8, v5
    v_accvgpr_read_b32 v6, a9
    v_mul_f32 v6, v6, v4
    v_accvgpr_write_b32 a9, v6
    v_accvgpr_read_b32 v7, a10
    v_mul_f32 v7, v7, v4
    v_accvgpr_write_b32 a10, v7
    v_accvgpr_read_b32 v8, a11
    v_mul_f32 v8, v8, v4
    v_accvgpr_write_b32 a11, v8
    v_accvgpr_read_b32 v5, a12
    v_mul_f32 v5, v5, v4
    v_accvgpr_write_b32 a12, v5
    v_accvgpr_read_b32 v6, a13
    v_mul_f32 v6, v6, v4
    v_accvgpr_write_b32 a13, v6
    v_accvgpr_read_b32 v7, a14
    v_mul_f32 v7, v7, v4
    v_accvgpr_write_b32 a14, v7
    v_accvgpr_read_b32 v8, a15
    v_mul_f32 v8, v8, v4
    v_accvgpr_write_b32 a15, v8
    v_accvgpr_read_b32 v5, a16
    v_mul_f32 v5, v5, v4
    v_accvgpr_write_b32 a16, v5
    v_accvgpr_read_b32 v6, a17
    v_mul_f32 v6, v6, v4
    v_accvgpr_write_b32 a17, v6
    v_accvgpr_read_b32 v7, a18
    v_mul_f32 v7, v7, v4
    v_accvgpr_write_b32 a18, v7
    v_accvgpr_read_b32 v8, a19
    v_mul_f32 v8, v8, v4
    v_accvgpr_write_b32 a19, v8
    v_accvgpr_read_b32 v5, a20
    v_mul_f32 v5, v5, v4
    v_accvgpr_write_b32 a20, v5
    v_accvgpr_read_b32 v6, a21
    v_mul_f32 v6, v6, v4
    v_accvgpr_write_b32 a21, v6
    v_accvgpr_read_b32 v7, a22
    v_mul_f32 v7, v7, v4
    v_accvgpr_write_b32 a22, v7
    v_accvgpr_read_b32 v8, a23
    v_mul_f32 v8, v8, v4
    v_accvgpr_write_b32 a23, v8
    v_accvgpr_read_b32 v5, a24
    v_mul_f32 v5, v5, v4
    v_accvgpr_write_b32 a24, v5
    v_accvgpr_read_b32 v6, a25
    v_mul_f32 v6, v6, v4
    v_accvgpr_write_b32 a25, v6
    v_accvgpr_read_b32 v7, a26
    v_mul_f32 v7, v7, v4
    v_accvgpr_write_b32 a26, v7
    v_accvgpr_read_b32 v8, a27
    v_mul_f32 v8, v8, v4
    v_accvgpr_write_b32 a27, v8
    v_accvgpr_read_b32 v5, a28
    v_mul_f32 v5, v5, v4
    v_accvgpr_write_b32 a28, v5
    v_accvgpr_read_b32 v6, a29
    v_mul_f32 v6, v6, v4
    v_accvgpr_write_b32 a29, v6
    v_accvgpr_read_b32 v7, a30
    v_mul_f32 v7, v7, v4
    v_accvgpr_write_b32 a30, v7
    v_accvgpr_read_b32 v8, a31
    v_mul_f32 v8, v8, v4
    v_accvgpr_write_b32 a31, v8
    v_accvgpr_read_b32 v5, a32
    v_mul_f32 v5, v5, v4
    v_accvgpr_write_b32 a32, v5
    v_accvgpr_read_b32 v6, a33
    v_mul_f32 v6, v6, v4
    v_accvgpr_write_b32 a33, v6
    v_accvgpr_read_b32 v7, a34
    v_mul_f32 v7, v7, v4
    v_accvgpr_write_b32 a34, v7
    v_accvgpr_read_b32 v8, a35
    v_mul_f32 v8, v8, v4
    v_accvgpr_write_b32 a35, v8
    v_accvgpr_read_b32 v5, a36
    v_mul_f32 v5, v5, v4
    v_accvgpr_write_b32 a36, v5
    v_accvgpr_read_b32 v6, a37
    v_mul_f32 v6, v6, v4
    v_accvgpr_write_b32 a37, v6
    v_accvgpr_read_b32 v7, a38
    v_mul_f32 v7, v7, v4
    v_accvgpr_write_b32 a38, v7
    v_accvgpr_read_b32 v8, a39
    v_mul_f32 v8, v8, v4
    v_accvgpr_write_b32 a39, v8
    v_accvgpr_read_b32 v5, a40
    v_mul_f32 v5, v5, v4
    v_accvgpr_write_b32 a40, v5
    v_accvgpr_read_b32 v6, a41
    v_mul_f32 v6, v6, v4
    v_accvgpr_write_b32 a41, v6
    v_accvgpr_read_b32 v7, a42
    v_mul_f32 v7, v7, v4
    v_accvgpr_write_b32 a42, v7
    v_accvgpr_read_b32 v8, a43
    v_mul_f32 v8, v8, v4
    v_accvgpr_write_b32 a43, v8
    v_accvgpr_read_b32 v5, a44
    v_mul_f32 v5, v5, v4
    v_accvgpr_write_b32 a44, v5
    v_accvgpr_read_b32 v6, a45
    v_mul_f32 v6, v6, v4
    v_accvgpr_write_b32 a45, v6
    v_accvgpr_read_b32 v7, a46
    v_mul_f32 v7, v7, v4
    v_accvgpr_write_b32 a46, v7
    v_accvgpr_read_b32 v8, a47
    v_mul_f32 v8, v8, v4
    v_accvgpr_write_b32 a47, v8
    v_accvgpr_read_b32 v5, a48
    v_mul_f32 v5, v5, v4
    v_accvgpr_write_b32 a48, v5
    v_accvgpr_read_b32 v6, a49
    v_mul_f32 v6, v6, v4
    v_accvgpr_write_b32 a49, v6
    v_accvgpr_read_b32 v7, a50
    v_mul_f32 v7, v7, v4
    v_accvgpr_write_b32 a50, v7
    v_accvgpr_read_b32 v8, a51
    v_mul_f32 v8, v8, v4
    v_accvgpr_write_b32 a51, v8
    v_accvgpr_read_b32 v5, a52
    v_mul_f32 v5, v5, v4
    v_accvgpr_write_b32 a52, v5
    v_accvgpr_read_b32 v6, a53
    v_mul_f32 v6, v6, v4
    v_accvgpr_write_b32 a53, v6
    v_accvgpr_read_b32 v7, a54
    v_mul_f32 v7, v7, v4
    v_accvgpr_write_b32 a54, v7
    v_accvgpr_read_b32 v8, a55
    v_mul_f32 v8, v8, v4
    v_accvgpr_write_b32 a55, v8
    v_accvgpr_read_b32 v5, a56
    v_mul_f32 v5, v5, v4
    v_accvgpr_write_b32 a56, v5
    v_accvgpr_read_b32 v6, a57
    v_mul_f32 v6, v6, v4
    v_accvgpr_write_b32 a57, v6
    v_accvgpr_read_b32 v7, a58
    v_mul_f32 v7, v7, v4
    v_accvgpr_write_b32 a58, v7
    v_accvgpr_read_b32 v8, a59
    v_mul_f32 v8, v8, v4
    v_accvgpr_write_b32 a59, v8
    v_accvgpr_read_b32 v5, a60
    v_mul_f32 v5, v5, v4
    v_accvgpr_write_b32 a60, v5
    v_accvgpr_read_b32 v6, a61
    v_mul_f32 v6, v6, v4
    v_accvgpr_write_b32 a61, v6
    v_accvgpr_read_b32 v7, a62
    v_mul_f32 v7, v7, v4
    v_accvgpr_write_b32 a62, v7
    v_accvgpr_read_b32 v8, a63
    v_mul_f32 v8, v8, v4
    v_accvgpr_write_b32 a63, v8
    v_accvgpr_read_b32 v5, a64
    v_mul_f32 v5, v5, v4
    v_accvgpr_write_b32 a64, v5
    v_accvgpr_read_b32 v6, a65
    v_mul_f32 v6, v6, v4
    v_accvgpr_write_b32 a65, v6
    v_accvgpr_read_b32 v7, a66
    v_mul_f32 v7, v7, v4
    v_accvgpr_write_b32 a66, v7
    v_accvgpr_read_b32 v8, a67
    v_mul_f32 v8, v8, v4
    v_accvgpr_write_b32 a67, v8
    v_accvgpr_read_b32 v5, a68
    v_mul_f32 v5, v5, v4
    v_accvgpr_write_b32 a68, v5
    v_accvgpr_read_b32 v6, a69
    v_mul_f32 v6, v6, v4
    v_accvgpr_write_b32 a69, v6
    v_accvgpr_read_b32 v7, a70
    v_mul_f32 v7, v7, v4
    v_accvgpr_write_b32 a70, v7
    v_accvgpr_read_b32 v8, a71
    v_mul_f32 v8, v8, v4
    v_accvgpr_write_b32 a71, v8
    v_accvgpr_read_b32 v5, a72
    v_mul_f32 v5, v5, v4
    v_accvgpr_write_b32 a72, v5
    v_accvgpr_read_b32 v6, a73
    v_mul_f32 v6, v6, v4
    v_accvgpr_write_b32 a73, v6
    v_accvgpr_read_b32 v7, a74
    v_mul_f32 v7, v7, v4
    v_accvgpr_write_b32 a74, v7
    v_accvgpr_read_b32 v8, a75
    v_mul_f32 v8, v8, v4
    v_accvgpr_write_b32 a75, v8
    v_accvgpr_read_b32 v5, a76
    v_mul_f32 v5, v5, v4
    v_accvgpr_write_b32 a76, v5
    v_accvgpr_read_b32 v6, a77
    v_mul_f32 v6, v6, v4
    v_accvgpr_write_b32 a77, v6
    v_accvgpr_read_b32 v7, a78
    v_mul_f32 v7, v7, v4
    v_accvgpr_write_b32 a78, v7
    v_accvgpr_read_b32 v8, a79
    v_mul_f32 v8, v8, v4
    v_accvgpr_write_b32 a79, v8
    v_accvgpr_read_b32 v5, a80
    v_mul_f32 v5, v5, v4
    v_accvgpr_write_b32 a80, v5
    v_accvgpr_read_b32 v6, a81
    v_mul_f32 v6, v6, v4
    v_accvgpr_write_b32 a81, v6
    v_accvgpr_read_b32 v7, a82
    v_mul_f32 v7, v7, v4
    v_accvgpr_write_b32 a82, v7
    v_accvgpr_read_b32 v8, a83
    v_mul_f32 v8, v8, v4
    v_accvgpr_write_b32 a83, v8
    v_accvgpr_read_b32 v5, a84
    v_mul_f32 v5, v5, v4
    v_accvgpr_write_b32 a84, v5
    v_accvgpr_read_b32 v6, a85
    v_mul_f32 v6, v6, v4
    v_accvgpr_write_b32 a85, v6
    v_accvgpr_read_b32 v7, a86
    v_mul_f32 v7, v7, v4
    v_accvgpr_write_b32 a86, v7
    v_accvgpr_read_b32 v8, a87
    v_mul_f32 v8, v8, v4
    v_accvgpr_write_b32 a87, v8
    v_accvgpr_read_b32 v5, a88
    v_mul_f32 v5, v5, v4
    v_accvgpr_write_b32 a88, v5
    v_accvgpr_read_b32 v6, a89
    v_mul_f32 v6, v6, v4
    v_accvgpr_write_b32 a89, v6
    v_accvgpr_read_b32 v7, a90
    v_mul_f32 v7, v7, v4
    v_accvgpr_write_b32 a90, v7
    v_accvgpr_read_b32 v8, a91
    v_mul_f32 v8, v8, v4
    v_accvgpr_write_b32 a91, v8
    v_accvgpr_read_b32 v5, a92
    v_mul_f32 v5, v5, v4
    v_accvgpr_write_b32 a92, v5
    v_accvgpr_read_b32 v6, a93
    v_mul_f32 v6, v6, v4
    v_accvgpr_write_b32 a93, v6
    v_accvgpr_read_b32 v7, a94
    v_mul_f32 v7, v7, v4
    v_accvgpr_write_b32 a94, v7
    v_accvgpr_read_b32 v8, a95
    v_mul_f32 v8, v8, v4
    v_accvgpr_write_b32 a95, v8
    v_accvgpr_read_b32 v5, a96
    v_mul_f32 v5, v5, v4
    v_accvgpr_write_b32 a96, v5
    v_accvgpr_read_b32 v6, a97
    v_mul_f32 v6, v6, v4
    v_accvgpr_write_b32 a97, v6
    v_accvgpr_read_b32 v7, a98
    v_mul_f32 v7, v7, v4
    v_accvgpr_write_b32 a98, v7
    v_accvgpr_read_b32 v8, a99
    v_mul_f32 v8, v8, v4
    v_accvgpr_write_b32 a99, v8
    v_accvgpr_read_b32 v5, a100
    v_mul_f32 v5, v5, v4
    v_accvgpr_write_b32 a100, v5
    v_accvgpr_read_b32 v6, a101
    v_mul_f32 v6, v6, v4
    v_accvgpr_write_b32 a101, v6
    v_accvgpr_read_b32 v7, a102
    v_mul_f32 v7, v7, v4
    v_accvgpr_write_b32 a102, v7
    v_accvgpr_read_b32 v8, a103
    v_mul_f32 v8, v8, v4
    v_accvgpr_write_b32 a103, v8
    v_accvgpr_read_b32 v5, a104
    v_mul_f32 v5, v5, v4
    v_accvgpr_write_b32 a104, v5
    v_accvgpr_read_b32 v6, a105
    v_mul_f32 v6, v6, v4
    v_accvgpr_write_b32 a105, v6
    v_accvgpr_read_b32 v7, a106
    v_mul_f32 v7, v7, v4
    v_accvgpr_write_b32 a106, v7
    v_accvgpr_read_b32 v8, a107
    v_mul_f32 v8, v8, v4
    v_accvgpr_write_b32 a107, v8
    v_accvgpr_read_b32 v5, a108
    v_mul_f32 v5, v5, v4
    v_accvgpr_write_b32 a108, v5
    v_accvgpr_read_b32 v6, a109
    v_mul_f32 v6, v6, v4
    v_accvgpr_write_b32 a109, v6
    v_accvgpr_read_b32 v7, a110
    v_mul_f32 v7, v7, v4
    v_accvgpr_write_b32 a110, v7
    v_accvgpr_read_b32 v8, a111
    v_mul_f32 v8, v8, v4
    v_accvgpr_write_b32 a111, v8
    v_accvgpr_read_b32 v5, a112
    v_mul_f32 v5, v5, v4
    v_accvgpr_write_b32 a112, v5
    v_accvgpr_read_b32 v6, a113
    v_mul_f32 v6, v6, v4
    v_accvgpr_write_b32 a113, v6
    v_accvgpr_read_b32 v7, a114
    v_mul_f32 v7, v7, v4
    v_accvgpr_write_b32 a114, v7
    v_accvgpr_read_b32 v8, a115
    v_mul_f32 v8, v8, v4
    v_accvgpr_write_b32 a115, v8
    v_accvgpr_read_b32 v5, a116
    v_mul_f32 v5, v5, v4
    v_accvgpr_write_b32 a116, v5
    v_accvgpr_read_b32 v6, a117
    v_mul_f32 v6, v6, v4
    v_accvgpr_write_b32 a117, v6
    v_accvgpr_read_b32 v7, a118
    v_mul_f32 v7, v7, v4
    v_accvgpr_write_b32 a118, v7
    v_accvgpr_read_b32 v8, a119
    v_mul_f32 v8, v8, v4
    v_accvgpr_write_b32 a119, v8
    v_accvgpr_read_b32 v5, a120
    v_mul_f32 v5, v5, v4
    v_accvgpr_write_b32 a120, v5
    v_accvgpr_read_b32 v6, a121
    v_mul_f32 v6, v6, v4
    v_accvgpr_write_b32 a121, v6
    v_accvgpr_read_b32 v7, a122
    v_mul_f32 v7, v7, v4
    v_accvgpr_write_b32 a122, v7
    v_accvgpr_read_b32 v8, a123
    v_mul_f32 v8, v8, v4
    v_accvgpr_write_b32 a123, v8
    v_accvgpr_read_b32 v5, a124
    v_mul_f32 v5, v5, v4
    v_accvgpr_write_b32 a124, v5
    v_accvgpr_read_b32 v6, a125
    v_mul_f32 v6, v6, v4
    v_accvgpr_write_b32 a125, v6
    v_accvgpr_read_b32 v7, a126
    v_mul_f32 v7, v7, v4
    v_accvgpr_write_b32 a126, v7
    v_accvgpr_read_b32 v8, a127
    v_mul_f32 v8, v8, v4
    v_accvgpr_write_b32 a127, v8
    s_nop 1
    s_branch LRB_78
LRS_79:
    v_max_f32 v3, v32, v2
    v_sub_f32 v4, v32, v3
    v_exp_f32 v4, v4
    v_mov_b32 v32, v3
    s_nop 0
    v_mul_f32 v33, v33, v4
    s_nop 15
    v_accvgpr_read_b32 v5, a0
    v_mul_f32 v5, v5, v4
    v_accvgpr_write_b32 a0, v5
    v_accvgpr_read_b32 v6, a1
    v_mul_f32 v6, v6, v4
    v_accvgpr_write_b32 a1, v6
    v_accvgpr_read_b32 v7, a2
    v_mul_f32 v7, v7, v4
    v_accvgpr_write_b32 a2, v7
    v_accvgpr_read_b32 v8, a3
    v_mul_f32 v8, v8, v4
    v_accvgpr_write_b32 a3, v8
    v_accvgpr_read_b32 v5, a4
    v_mul_f32 v5, v5, v4
    v_accvgpr_write_b32 a4, v5
    v_accvgpr_read_b32 v6, a5
    v_mul_f32 v6, v6, v4
    v_accvgpr_write_b32 a5, v6
    v_accvgpr_read_b32 v7, a6
    v_mul_f32 v7, v7, v4
    v_accvgpr_write_b32 a6, v7
    v_accvgpr_read_b32 v8, a7
    v_mul_f32 v8, v8, v4
    v_accvgpr_write_b32 a7, v8
    v_accvgpr_read_b32 v5, a8
    v_mul_f32 v5, v5, v4
    v_accvgpr_write_b32 a8, v5
    v_accvgpr_read_b32 v6, a9
    v_mul_f32 v6, v6, v4
    v_accvgpr_write_b32 a9, v6
    v_accvgpr_read_b32 v7, a10
    v_mul_f32 v7, v7, v4
    v_accvgpr_write_b32 a10, v7
    v_accvgpr_read_b32 v8, a11
    v_mul_f32 v8, v8, v4
    v_accvgpr_write_b32 a11, v8
    v_accvgpr_read_b32 v5, a12
    v_mul_f32 v5, v5, v4
    v_accvgpr_write_b32 a12, v5
    v_accvgpr_read_b32 v6, a13
    v_mul_f32 v6, v6, v4
    v_accvgpr_write_b32 a13, v6
    v_accvgpr_read_b32 v7, a14
    v_mul_f32 v7, v7, v4
    v_accvgpr_write_b32 a14, v7
    v_accvgpr_read_b32 v8, a15
    v_mul_f32 v8, v8, v4
    v_accvgpr_write_b32 a15, v8
    v_accvgpr_read_b32 v5, a16
    v_mul_f32 v5, v5, v4
    v_accvgpr_write_b32 a16, v5
    v_accvgpr_read_b32 v6, a17
    v_mul_f32 v6, v6, v4
    v_accvgpr_write_b32 a17, v6
    v_accvgpr_read_b32 v7, a18
    v_mul_f32 v7, v7, v4
    v_accvgpr_write_b32 a18, v7
    v_accvgpr_read_b32 v8, a19
    v_mul_f32 v8, v8, v4
    v_accvgpr_write_b32 a19, v8
    v_accvgpr_read_b32 v5, a20
    v_mul_f32 v5, v5, v4
    v_accvgpr_write_b32 a20, v5
    v_accvgpr_read_b32 v6, a21
    v_mul_f32 v6, v6, v4
    v_accvgpr_write_b32 a21, v6
    v_accvgpr_read_b32 v7, a22
    v_mul_f32 v7, v7, v4
    v_accvgpr_write_b32 a22, v7
    v_accvgpr_read_b32 v8, a23
    v_mul_f32 v8, v8, v4
    v_accvgpr_write_b32 a23, v8
    v_accvgpr_read_b32 v5, a24
    v_mul_f32 v5, v5, v4
    v_accvgpr_write_b32 a24, v5
    v_accvgpr_read_b32 v6, a25
    v_mul_f32 v6, v6, v4
    v_accvgpr_write_b32 a25, v6
    v_accvgpr_read_b32 v7, a26
    v_mul_f32 v7, v7, v4
    v_accvgpr_write_b32 a26, v7
    v_accvgpr_read_b32 v8, a27
    v_mul_f32 v8, v8, v4
    v_accvgpr_write_b32 a27, v8
    v_accvgpr_read_b32 v5, a28
    v_mul_f32 v5, v5, v4
    v_accvgpr_write_b32 a28, v5
    v_accvgpr_read_b32 v6, a29
    v_mul_f32 v6, v6, v4
    v_accvgpr_write_b32 a29, v6
    v_accvgpr_read_b32 v7, a30
    v_mul_f32 v7, v7, v4
    v_accvgpr_write_b32 a30, v7
    v_accvgpr_read_b32 v8, a31
    v_mul_f32 v8, v8, v4
    v_accvgpr_write_b32 a31, v8
    v_accvgpr_read_b32 v5, a32
    v_mul_f32 v5, v5, v4
    v_accvgpr_write_b32 a32, v5
    v_accvgpr_read_b32 v6, a33
    v_mul_f32 v6, v6, v4
    v_accvgpr_write_b32 a33, v6
    v_accvgpr_read_b32 v7, a34
    v_mul_f32 v7, v7, v4
    v_accvgpr_write_b32 a34, v7
    v_accvgpr_read_b32 v8, a35
    v_mul_f32 v8, v8, v4
    v_accvgpr_write_b32 a35, v8
    v_accvgpr_read_b32 v5, a36
    v_mul_f32 v5, v5, v4
    v_accvgpr_write_b32 a36, v5
    v_accvgpr_read_b32 v6, a37
    v_mul_f32 v6, v6, v4
    v_accvgpr_write_b32 a37, v6
    v_accvgpr_read_b32 v7, a38
    v_mul_f32 v7, v7, v4
    v_accvgpr_write_b32 a38, v7
    v_accvgpr_read_b32 v8, a39
    v_mul_f32 v8, v8, v4
    v_accvgpr_write_b32 a39, v8
    v_accvgpr_read_b32 v5, a40
    v_mul_f32 v5, v5, v4
    v_accvgpr_write_b32 a40, v5
    v_accvgpr_read_b32 v6, a41
    v_mul_f32 v6, v6, v4
    v_accvgpr_write_b32 a41, v6
    v_accvgpr_read_b32 v7, a42
    v_mul_f32 v7, v7, v4
    v_accvgpr_write_b32 a42, v7
    v_accvgpr_read_b32 v8, a43
    v_mul_f32 v8, v8, v4
    v_accvgpr_write_b32 a43, v8
    v_accvgpr_read_b32 v5, a44
    v_mul_f32 v5, v5, v4
    v_accvgpr_write_b32 a44, v5
    v_accvgpr_read_b32 v6, a45
    v_mul_f32 v6, v6, v4
    v_accvgpr_write_b32 a45, v6
    v_accvgpr_read_b32 v7, a46
    v_mul_f32 v7, v7, v4
    v_accvgpr_write_b32 a46, v7
    v_accvgpr_read_b32 v8, a47
    v_mul_f32 v8, v8, v4
    v_accvgpr_write_b32 a47, v8
    v_accvgpr_read_b32 v5, a48
    v_mul_f32 v5, v5, v4
    v_accvgpr_write_b32 a48, v5
    v_accvgpr_read_b32 v6, a49
    v_mul_f32 v6, v6, v4
    v_accvgpr_write_b32 a49, v6
    v_accvgpr_read_b32 v7, a50
    v_mul_f32 v7, v7, v4
    v_accvgpr_write_b32 a50, v7
    v_accvgpr_read_b32 v8, a51
    v_mul_f32 v8, v8, v4
    v_accvgpr_write_b32 a51, v8
    v_accvgpr_read_b32 v5, a52
    v_mul_f32 v5, v5, v4
    v_accvgpr_write_b32 a52, v5
    v_accvgpr_read_b32 v6, a53
    v_mul_f32 v6, v6, v4
    v_accvgpr_write_b32 a53, v6
    v_accvgpr_read_b32 v7, a54
    v_mul_f32 v7, v7, v4
    v_accvgpr_write_b32 a54, v7
    v_accvgpr_read_b32 v8, a55
    v_mul_f32 v8, v8, v4
    v_accvgpr_write_b32 a55, v8
    v_accvgpr_read_b32 v5, a56
    v_mul_f32 v5, v5, v4
    v_accvgpr_write_b32 a56, v5
    v_accvgpr_read_b32 v6, a57
    v_mul_f32 v6, v6, v4
    v_accvgpr_write_b32 a57, v6
    v_accvgpr_read_b32 v7, a58
    v_mul_f32 v7, v7, v4
    v_accvgpr_write_b32 a58, v7
    v_accvgpr_read_b32 v8, a59
    v_mul_f32 v8, v8, v4
    v_accvgpr_write_b32 a59, v8
    v_accvgpr_read_b32 v5, a60
    v_mul_f32 v5, v5, v4
    v_accvgpr_write_b32 a60, v5
    v_accvgpr_read_b32 v6, a61
    v_mul_f32 v6, v6, v4
    v_accvgpr_write_b32 a61, v6
    v_accvgpr_read_b32 v7, a62
    v_mul_f32 v7, v7, v4
    v_accvgpr_write_b32 a62, v7
    v_accvgpr_read_b32 v8, a63
    v_mul_f32 v8, v8, v4
    v_accvgpr_write_b32 a63, v8
    v_accvgpr_read_b32 v5, a64
    v_mul_f32 v5, v5, v4
    v_accvgpr_write_b32 a64, v5
    v_accvgpr_read_b32 v6, a65
    v_mul_f32 v6, v6, v4
    v_accvgpr_write_b32 a65, v6
    v_accvgpr_read_b32 v7, a66
    v_mul_f32 v7, v7, v4
    v_accvgpr_write_b32 a66, v7
    v_accvgpr_read_b32 v8, a67
    v_mul_f32 v8, v8, v4
    v_accvgpr_write_b32 a67, v8
    v_accvgpr_read_b32 v5, a68
    v_mul_f32 v5, v5, v4
    v_accvgpr_write_b32 a68, v5
    v_accvgpr_read_b32 v6, a69
    v_mul_f32 v6, v6, v4
    v_accvgpr_write_b32 a69, v6
    v_accvgpr_read_b32 v7, a70
    v_mul_f32 v7, v7, v4
    v_accvgpr_write_b32 a70, v7
    v_accvgpr_read_b32 v8, a71
    v_mul_f32 v8, v8, v4
    v_accvgpr_write_b32 a71, v8
    v_accvgpr_read_b32 v5, a72
    v_mul_f32 v5, v5, v4
    v_accvgpr_write_b32 a72, v5
    v_accvgpr_read_b32 v6, a73
    v_mul_f32 v6, v6, v4
    v_accvgpr_write_b32 a73, v6
    v_accvgpr_read_b32 v7, a74
    v_mul_f32 v7, v7, v4
    v_accvgpr_write_b32 a74, v7
    v_accvgpr_read_b32 v8, a75
    v_mul_f32 v8, v8, v4
    v_accvgpr_write_b32 a75, v8
    v_accvgpr_read_b32 v5, a76
    v_mul_f32 v5, v5, v4
    v_accvgpr_write_b32 a76, v5
    v_accvgpr_read_b32 v6, a77
    v_mul_f32 v6, v6, v4
    v_accvgpr_write_b32 a77, v6
    v_accvgpr_read_b32 v7, a78
    v_mul_f32 v7, v7, v4
    v_accvgpr_write_b32 a78, v7
    v_accvgpr_read_b32 v8, a79
    v_mul_f32 v8, v8, v4
    v_accvgpr_write_b32 a79, v8
    v_accvgpr_read_b32 v5, a80
    v_mul_f32 v5, v5, v4
    v_accvgpr_write_b32 a80, v5
    v_accvgpr_read_b32 v6, a81
    v_mul_f32 v6, v6, v4
    v_accvgpr_write_b32 a81, v6
    v_accvgpr_read_b32 v7, a82
    v_mul_f32 v7, v7, v4
    v_accvgpr_write_b32 a82, v7
    v_accvgpr_read_b32 v8, a83
    v_mul_f32 v8, v8, v4
    v_accvgpr_write_b32 a83, v8
    v_accvgpr_read_b32 v5, a84
    v_mul_f32 v5, v5, v4
    v_accvgpr_write_b32 a84, v5
    v_accvgpr_read_b32 v6, a85
    v_mul_f32 v6, v6, v4
    v_accvgpr_write_b32 a85, v6
    v_accvgpr_read_b32 v7, a86
    v_mul_f32 v7, v7, v4
    v_accvgpr_write_b32 a86, v7
    v_accvgpr_read_b32 v8, a87
    v_mul_f32 v8, v8, v4
    v_accvgpr_write_b32 a87, v8
    v_accvgpr_read_b32 v5, a88
    v_mul_f32 v5, v5, v4
    v_accvgpr_write_b32 a88, v5
    v_accvgpr_read_b32 v6, a89
    v_mul_f32 v6, v6, v4
    v_accvgpr_write_b32 a89, v6
    v_accvgpr_read_b32 v7, a90
    v_mul_f32 v7, v7, v4
    v_accvgpr_write_b32 a90, v7
    v_accvgpr_read_b32 v8, a91
    v_mul_f32 v8, v8, v4
    v_accvgpr_write_b32 a91, v8
    v_accvgpr_read_b32 v5, a92
    v_mul_f32 v5, v5, v4
    v_accvgpr_write_b32 a92, v5
    v_accvgpr_read_b32 v6, a93
    v_mul_f32 v6, v6, v4
    v_accvgpr_write_b32 a93, v6
    v_accvgpr_read_b32 v7, a94
    v_mul_f32 v7, v7, v4
    v_accvgpr_write_b32 a94, v7
    v_accvgpr_read_b32 v8, a95
    v_mul_f32 v8, v8, v4
    v_accvgpr_write_b32 a95, v8
    v_accvgpr_read_b32 v5, a96
    v_mul_f32 v5, v5, v4
    v_accvgpr_write_b32 a96, v5
    v_accvgpr_read_b32 v6, a97
    v_mul_f32 v6, v6, v4
    v_accvgpr_write_b32 a97, v6
    v_accvgpr_read_b32 v7, a98
    v_mul_f32 v7, v7, v4
    v_accvgpr_write_b32 a98, v7
    v_accvgpr_read_b32 v8, a99
    v_mul_f32 v8, v8, v4
    v_accvgpr_write_b32 a99, v8
    v_accvgpr_read_b32 v5, a100
    v_mul_f32 v5, v5, v4
    v_accvgpr_write_b32 a100, v5
    v_accvgpr_read_b32 v6, a101
    v_mul_f32 v6, v6, v4
    v_accvgpr_write_b32 a101, v6
    v_accvgpr_read_b32 v7, a102
    v_mul_f32 v7, v7, v4
    v_accvgpr_write_b32 a102, v7
    v_accvgpr_read_b32 v8, a103
    v_mul_f32 v8, v8, v4
    v_accvgpr_write_b32 a103, v8
    v_accvgpr_read_b32 v5, a104
    v_mul_f32 v5, v5, v4
    v_accvgpr_write_b32 a104, v5
    v_accvgpr_read_b32 v6, a105
    v_mul_f32 v6, v6, v4
    v_accvgpr_write_b32 a105, v6
    v_accvgpr_read_b32 v7, a106
    v_mul_f32 v7, v7, v4
    v_accvgpr_write_b32 a106, v7
    v_accvgpr_read_b32 v8, a107
    v_mul_f32 v8, v8, v4
    v_accvgpr_write_b32 a107, v8
    v_accvgpr_read_b32 v5, a108
    v_mul_f32 v5, v5, v4
    v_accvgpr_write_b32 a108, v5
    v_accvgpr_read_b32 v6, a109
    v_mul_f32 v6, v6, v4
    v_accvgpr_write_b32 a109, v6
    v_accvgpr_read_b32 v7, a110
    v_mul_f32 v7, v7, v4
    v_accvgpr_write_b32 a110, v7
    v_accvgpr_read_b32 v8, a111
    v_mul_f32 v8, v8, v4
    v_accvgpr_write_b32 a111, v8
    v_accvgpr_read_b32 v5, a112
    v_mul_f32 v5, v5, v4
    v_accvgpr_write_b32 a112, v5
    v_accvgpr_read_b32 v6, a113
    v_mul_f32 v6, v6, v4
    v_accvgpr_write_b32 a113, v6
    v_accvgpr_read_b32 v7, a114
    v_mul_f32 v7, v7, v4
    v_accvgpr_write_b32 a114, v7
    v_accvgpr_read_b32 v8, a115
    v_mul_f32 v8, v8, v4
    v_accvgpr_write_b32 a115, v8
    v_accvgpr_read_b32 v5, a116
    v_mul_f32 v5, v5, v4
    v_accvgpr_write_b32 a116, v5
    v_accvgpr_read_b32 v6, a117
    v_mul_f32 v6, v6, v4
    v_accvgpr_write_b32 a117, v6
    v_accvgpr_read_b32 v7, a118
    v_mul_f32 v7, v7, v4
    v_accvgpr_write_b32 a118, v7
    v_accvgpr_read_b32 v8, a119
    v_mul_f32 v8, v8, v4
    v_accvgpr_write_b32 a119, v8
    v_accvgpr_read_b32 v5, a120
    v_mul_f32 v5, v5, v4
    v_accvgpr_write_b32 a120, v5
    v_accvgpr_read_b32 v6, a121
    v_mul_f32 v6, v6, v4
    v_accvgpr_write_b32 a121, v6
    v_accvgpr_read_b32 v7, a122
    v_mul_f32 v7, v7, v4
    v_accvgpr_write_b32 a122, v7
    v_accvgpr_read_b32 v8, a123
    v_mul_f32 v8, v8, v4
    v_accvgpr_write_b32 a123, v8
    v_accvgpr_read_b32 v5, a124
    v_mul_f32 v5, v5, v4
    v_accvgpr_write_b32 a124, v5
    v_accvgpr_read_b32 v6, a125
    v_mul_f32 v6, v6, v4
    v_accvgpr_write_b32 a125, v6
    v_accvgpr_read_b32 v7, a126
    v_mul_f32 v7, v7, v4
    v_accvgpr_write_b32 a126, v7
    v_accvgpr_read_b32 v8, a127
    v_mul_f32 v8, v8, v4
    v_accvgpr_write_b32 a127, v8
    s_nop 1
    s_branch LRB_80
LRS_81:
    v_max_f32 v3, v32, v2
    v_sub_f32 v4, v32, v3
    v_exp_f32 v4, v4
    v_mov_b32 v32, v3
    s_nop 0
    v_mul_f32 v33, v33, v4
    s_nop 15
    v_accvgpr_read_b32 v5, a0
    v_mul_f32 v5, v5, v4
    v_accvgpr_write_b32 a0, v5
    v_accvgpr_read_b32 v6, a1
    v_mul_f32 v6, v6, v4
    v_accvgpr_write_b32 a1, v6
    v_accvgpr_read_b32 v7, a2
    v_mul_f32 v7, v7, v4
    v_accvgpr_write_b32 a2, v7
    v_accvgpr_read_b32 v8, a3
    v_mul_f32 v8, v8, v4
    v_accvgpr_write_b32 a3, v8
    v_accvgpr_read_b32 v5, a4
    v_mul_f32 v5, v5, v4
    v_accvgpr_write_b32 a4, v5
    v_accvgpr_read_b32 v6, a5
    v_mul_f32 v6, v6, v4
    v_accvgpr_write_b32 a5, v6
    v_accvgpr_read_b32 v7, a6
    v_mul_f32 v7, v7, v4
    v_accvgpr_write_b32 a6, v7
    v_accvgpr_read_b32 v8, a7
    v_mul_f32 v8, v8, v4
    v_accvgpr_write_b32 a7, v8
    v_accvgpr_read_b32 v5, a8
    v_mul_f32 v5, v5, v4
    v_accvgpr_write_b32 a8, v5
    v_accvgpr_read_b32 v6, a9
    v_mul_f32 v6, v6, v4
    v_accvgpr_write_b32 a9, v6
    v_accvgpr_read_b32 v7, a10
    v_mul_f32 v7, v7, v4
    v_accvgpr_write_b32 a10, v7
    v_accvgpr_read_b32 v8, a11
    v_mul_f32 v8, v8, v4
    v_accvgpr_write_b32 a11, v8
    v_accvgpr_read_b32 v5, a12
    v_mul_f32 v5, v5, v4
    v_accvgpr_write_b32 a12, v5
    v_accvgpr_read_b32 v6, a13
    v_mul_f32 v6, v6, v4
    v_accvgpr_write_b32 a13, v6
    v_accvgpr_read_b32 v7, a14
    v_mul_f32 v7, v7, v4
    v_accvgpr_write_b32 a14, v7
    v_accvgpr_read_b32 v8, a15
    v_mul_f32 v8, v8, v4
    v_accvgpr_write_b32 a15, v8
    v_accvgpr_read_b32 v5, a16
    v_mul_f32 v5, v5, v4
    v_accvgpr_write_b32 a16, v5
    v_accvgpr_read_b32 v6, a17
    v_mul_f32 v6, v6, v4
    v_accvgpr_write_b32 a17, v6
    v_accvgpr_read_b32 v7, a18
    v_mul_f32 v7, v7, v4
    v_accvgpr_write_b32 a18, v7
    v_accvgpr_read_b32 v8, a19
    v_mul_f32 v8, v8, v4
    v_accvgpr_write_b32 a19, v8
    v_accvgpr_read_b32 v5, a20
    v_mul_f32 v5, v5, v4
    v_accvgpr_write_b32 a20, v5
    v_accvgpr_read_b32 v6, a21
    v_mul_f32 v6, v6, v4
    v_accvgpr_write_b32 a21, v6
    v_accvgpr_read_b32 v7, a22
    v_mul_f32 v7, v7, v4
    v_accvgpr_write_b32 a22, v7
    v_accvgpr_read_b32 v8, a23
    v_mul_f32 v8, v8, v4
    v_accvgpr_write_b32 a23, v8
    v_accvgpr_read_b32 v5, a24
    v_mul_f32 v5, v5, v4
    v_accvgpr_write_b32 a24, v5
    v_accvgpr_read_b32 v6, a25
    v_mul_f32 v6, v6, v4
    v_accvgpr_write_b32 a25, v6
    v_accvgpr_read_b32 v7, a26
    v_mul_f32 v7, v7, v4
    v_accvgpr_write_b32 a26, v7
    v_accvgpr_read_b32 v8, a27
    v_mul_f32 v8, v8, v4
    v_accvgpr_write_b32 a27, v8
    v_accvgpr_read_b32 v5, a28
    v_mul_f32 v5, v5, v4
    v_accvgpr_write_b32 a28, v5
    v_accvgpr_read_b32 v6, a29
    v_mul_f32 v6, v6, v4
    v_accvgpr_write_b32 a29, v6
    v_accvgpr_read_b32 v7, a30
    v_mul_f32 v7, v7, v4
    v_accvgpr_write_b32 a30, v7
    v_accvgpr_read_b32 v8, a31
    v_mul_f32 v8, v8, v4
    v_accvgpr_write_b32 a31, v8
    v_accvgpr_read_b32 v5, a32
    v_mul_f32 v5, v5, v4
    v_accvgpr_write_b32 a32, v5
    v_accvgpr_read_b32 v6, a33
    v_mul_f32 v6, v6, v4
    v_accvgpr_write_b32 a33, v6
    v_accvgpr_read_b32 v7, a34
    v_mul_f32 v7, v7, v4
    v_accvgpr_write_b32 a34, v7
    v_accvgpr_read_b32 v8, a35
    v_mul_f32 v8, v8, v4
    v_accvgpr_write_b32 a35, v8
    v_accvgpr_read_b32 v5, a36
    v_mul_f32 v5, v5, v4
    v_accvgpr_write_b32 a36, v5
    v_accvgpr_read_b32 v6, a37
    v_mul_f32 v6, v6, v4
    v_accvgpr_write_b32 a37, v6
    v_accvgpr_read_b32 v7, a38
    v_mul_f32 v7, v7, v4
    v_accvgpr_write_b32 a38, v7
    v_accvgpr_read_b32 v8, a39
    v_mul_f32 v8, v8, v4
    v_accvgpr_write_b32 a39, v8
    v_accvgpr_read_b32 v5, a40
    v_mul_f32 v5, v5, v4
    v_accvgpr_write_b32 a40, v5
    v_accvgpr_read_b32 v6, a41
    v_mul_f32 v6, v6, v4
    v_accvgpr_write_b32 a41, v6
    v_accvgpr_read_b32 v7, a42
    v_mul_f32 v7, v7, v4
    v_accvgpr_write_b32 a42, v7
    v_accvgpr_read_b32 v8, a43
    v_mul_f32 v8, v8, v4
    v_accvgpr_write_b32 a43, v8
    v_accvgpr_read_b32 v5, a44
    v_mul_f32 v5, v5, v4
    v_accvgpr_write_b32 a44, v5
    v_accvgpr_read_b32 v6, a45
    v_mul_f32 v6, v6, v4
    v_accvgpr_write_b32 a45, v6
    v_accvgpr_read_b32 v7, a46
    v_mul_f32 v7, v7, v4
    v_accvgpr_write_b32 a46, v7
    v_accvgpr_read_b32 v8, a47
    v_mul_f32 v8, v8, v4
    v_accvgpr_write_b32 a47, v8
    v_accvgpr_read_b32 v5, a48
    v_mul_f32 v5, v5, v4
    v_accvgpr_write_b32 a48, v5
    v_accvgpr_read_b32 v6, a49
    v_mul_f32 v6, v6, v4
    v_accvgpr_write_b32 a49, v6
    v_accvgpr_read_b32 v7, a50
    v_mul_f32 v7, v7, v4
    v_accvgpr_write_b32 a50, v7
    v_accvgpr_read_b32 v8, a51
    v_mul_f32 v8, v8, v4
    v_accvgpr_write_b32 a51, v8
    v_accvgpr_read_b32 v5, a52
    v_mul_f32 v5, v5, v4
    v_accvgpr_write_b32 a52, v5
    v_accvgpr_read_b32 v6, a53
    v_mul_f32 v6, v6, v4
    v_accvgpr_write_b32 a53, v6
    v_accvgpr_read_b32 v7, a54
    v_mul_f32 v7, v7, v4
    v_accvgpr_write_b32 a54, v7
    v_accvgpr_read_b32 v8, a55
    v_mul_f32 v8, v8, v4
    v_accvgpr_write_b32 a55, v8
    v_accvgpr_read_b32 v5, a56
    v_mul_f32 v5, v5, v4
    v_accvgpr_write_b32 a56, v5
    v_accvgpr_read_b32 v6, a57
    v_mul_f32 v6, v6, v4
    v_accvgpr_write_b32 a57, v6
    v_accvgpr_read_b32 v7, a58
    v_mul_f32 v7, v7, v4
    v_accvgpr_write_b32 a58, v7
    v_accvgpr_read_b32 v8, a59
    v_mul_f32 v8, v8, v4
    v_accvgpr_write_b32 a59, v8
    v_accvgpr_read_b32 v5, a60
    v_mul_f32 v5, v5, v4
    v_accvgpr_write_b32 a60, v5
    v_accvgpr_read_b32 v6, a61
    v_mul_f32 v6, v6, v4
    v_accvgpr_write_b32 a61, v6
    v_accvgpr_read_b32 v7, a62
    v_mul_f32 v7, v7, v4
    v_accvgpr_write_b32 a62, v7
    v_accvgpr_read_b32 v8, a63
    v_mul_f32 v8, v8, v4
    v_accvgpr_write_b32 a63, v8
    v_accvgpr_read_b32 v5, a64
    v_mul_f32 v5, v5, v4
    v_accvgpr_write_b32 a64, v5
    v_accvgpr_read_b32 v6, a65
    v_mul_f32 v6, v6, v4
    v_accvgpr_write_b32 a65, v6
    v_accvgpr_read_b32 v7, a66
    v_mul_f32 v7, v7, v4
    v_accvgpr_write_b32 a66, v7
    v_accvgpr_read_b32 v8, a67
    v_mul_f32 v8, v8, v4
    v_accvgpr_write_b32 a67, v8
    v_accvgpr_read_b32 v5, a68
    v_mul_f32 v5, v5, v4
    v_accvgpr_write_b32 a68, v5
    v_accvgpr_read_b32 v6, a69
    v_mul_f32 v6, v6, v4
    v_accvgpr_write_b32 a69, v6
    v_accvgpr_read_b32 v7, a70
    v_mul_f32 v7, v7, v4
    v_accvgpr_write_b32 a70, v7
    v_accvgpr_read_b32 v8, a71
    v_mul_f32 v8, v8, v4
    v_accvgpr_write_b32 a71, v8
    v_accvgpr_read_b32 v5, a72
    v_mul_f32 v5, v5, v4
    v_accvgpr_write_b32 a72, v5
    v_accvgpr_read_b32 v6, a73
    v_mul_f32 v6, v6, v4
    v_accvgpr_write_b32 a73, v6
    v_accvgpr_read_b32 v7, a74
    v_mul_f32 v7, v7, v4
    v_accvgpr_write_b32 a74, v7
    v_accvgpr_read_b32 v8, a75
    v_mul_f32 v8, v8, v4
    v_accvgpr_write_b32 a75, v8
    v_accvgpr_read_b32 v5, a76
    v_mul_f32 v5, v5, v4
    v_accvgpr_write_b32 a76, v5
    v_accvgpr_read_b32 v6, a77
    v_mul_f32 v6, v6, v4
    v_accvgpr_write_b32 a77, v6
    v_accvgpr_read_b32 v7, a78
    v_mul_f32 v7, v7, v4
    v_accvgpr_write_b32 a78, v7
    v_accvgpr_read_b32 v8, a79
    v_mul_f32 v8, v8, v4
    v_accvgpr_write_b32 a79, v8
    v_accvgpr_read_b32 v5, a80
    v_mul_f32 v5, v5, v4
    v_accvgpr_write_b32 a80, v5
    v_accvgpr_read_b32 v6, a81
    v_mul_f32 v6, v6, v4
    v_accvgpr_write_b32 a81, v6
    v_accvgpr_read_b32 v7, a82
    v_mul_f32 v7, v7, v4
    v_accvgpr_write_b32 a82, v7
    v_accvgpr_read_b32 v8, a83
    v_mul_f32 v8, v8, v4
    v_accvgpr_write_b32 a83, v8
    v_accvgpr_read_b32 v5, a84
    v_mul_f32 v5, v5, v4
    v_accvgpr_write_b32 a84, v5
    v_accvgpr_read_b32 v6, a85
    v_mul_f32 v6, v6, v4
    v_accvgpr_write_b32 a85, v6
    v_accvgpr_read_b32 v7, a86
    v_mul_f32 v7, v7, v4
    v_accvgpr_write_b32 a86, v7
    v_accvgpr_read_b32 v8, a87
    v_mul_f32 v8, v8, v4
    v_accvgpr_write_b32 a87, v8
    v_accvgpr_read_b32 v5, a88
    v_mul_f32 v5, v5, v4
    v_accvgpr_write_b32 a88, v5
    v_accvgpr_read_b32 v6, a89
    v_mul_f32 v6, v6, v4
    v_accvgpr_write_b32 a89, v6
    v_accvgpr_read_b32 v7, a90
    v_mul_f32 v7, v7, v4
    v_accvgpr_write_b32 a90, v7
    v_accvgpr_read_b32 v8, a91
    v_mul_f32 v8, v8, v4
    v_accvgpr_write_b32 a91, v8
    v_accvgpr_read_b32 v5, a92
    v_mul_f32 v5, v5, v4
    v_accvgpr_write_b32 a92, v5
    v_accvgpr_read_b32 v6, a93
    v_mul_f32 v6, v6, v4
    v_accvgpr_write_b32 a93, v6
    v_accvgpr_read_b32 v7, a94
    v_mul_f32 v7, v7, v4
    v_accvgpr_write_b32 a94, v7
    v_accvgpr_read_b32 v8, a95
    v_mul_f32 v8, v8, v4
    v_accvgpr_write_b32 a95, v8
    v_accvgpr_read_b32 v5, a96
    v_mul_f32 v5, v5, v4
    v_accvgpr_write_b32 a96, v5
    v_accvgpr_read_b32 v6, a97
    v_mul_f32 v6, v6, v4
    v_accvgpr_write_b32 a97, v6
    v_accvgpr_read_b32 v7, a98
    v_mul_f32 v7, v7, v4
    v_accvgpr_write_b32 a98, v7
    v_accvgpr_read_b32 v8, a99
    v_mul_f32 v8, v8, v4
    v_accvgpr_write_b32 a99, v8
    v_accvgpr_read_b32 v5, a100
    v_mul_f32 v5, v5, v4
    v_accvgpr_write_b32 a100, v5
    v_accvgpr_read_b32 v6, a101
    v_mul_f32 v6, v6, v4
    v_accvgpr_write_b32 a101, v6
    v_accvgpr_read_b32 v7, a102
    v_mul_f32 v7, v7, v4
    v_accvgpr_write_b32 a102, v7
    v_accvgpr_read_b32 v8, a103
    v_mul_f32 v8, v8, v4
    v_accvgpr_write_b32 a103, v8
    v_accvgpr_read_b32 v5, a104
    v_mul_f32 v5, v5, v4
    v_accvgpr_write_b32 a104, v5
    v_accvgpr_read_b32 v6, a105
    v_mul_f32 v6, v6, v4
    v_accvgpr_write_b32 a105, v6
    v_accvgpr_read_b32 v7, a106
    v_mul_f32 v7, v7, v4
    v_accvgpr_write_b32 a106, v7
    v_accvgpr_read_b32 v8, a107
    v_mul_f32 v8, v8, v4
    v_accvgpr_write_b32 a107, v8
    v_accvgpr_read_b32 v5, a108
    v_mul_f32 v5, v5, v4
    v_accvgpr_write_b32 a108, v5
    v_accvgpr_read_b32 v6, a109
    v_mul_f32 v6, v6, v4
    v_accvgpr_write_b32 a109, v6
    v_accvgpr_read_b32 v7, a110
    v_mul_f32 v7, v7, v4
    v_accvgpr_write_b32 a110, v7
    v_accvgpr_read_b32 v8, a111
    v_mul_f32 v8, v8, v4
    v_accvgpr_write_b32 a111, v8
    v_accvgpr_read_b32 v5, a112
    v_mul_f32 v5, v5, v4
    v_accvgpr_write_b32 a112, v5
    v_accvgpr_read_b32 v6, a113
    v_mul_f32 v6, v6, v4
    v_accvgpr_write_b32 a113, v6
    v_accvgpr_read_b32 v7, a114
    v_mul_f32 v7, v7, v4
    v_accvgpr_write_b32 a114, v7
    v_accvgpr_read_b32 v8, a115
    v_mul_f32 v8, v8, v4
    v_accvgpr_write_b32 a115, v8
    v_accvgpr_read_b32 v5, a116
    v_mul_f32 v5, v5, v4
    v_accvgpr_write_b32 a116, v5
    v_accvgpr_read_b32 v6, a117
    v_mul_f32 v6, v6, v4
    v_accvgpr_write_b32 a117, v6
    v_accvgpr_read_b32 v7, a118
    v_mul_f32 v7, v7, v4
    v_accvgpr_write_b32 a118, v7
    v_accvgpr_read_b32 v8, a119
    v_mul_f32 v8, v8, v4
    v_accvgpr_write_b32 a119, v8
    v_accvgpr_read_b32 v5, a120
    v_mul_f32 v5, v5, v4
    v_accvgpr_write_b32 a120, v5
    v_accvgpr_read_b32 v6, a121
    v_mul_f32 v6, v6, v4
    v_accvgpr_write_b32 a121, v6
    v_accvgpr_read_b32 v7, a122
    v_mul_f32 v7, v7, v4
    v_accvgpr_write_b32 a122, v7
    v_accvgpr_read_b32 v8, a123
    v_mul_f32 v8, v8, v4
    v_accvgpr_write_b32 a123, v8
    v_accvgpr_read_b32 v5, a124
    v_mul_f32 v5, v5, v4
    v_accvgpr_write_b32 a124, v5
    v_accvgpr_read_b32 v6, a125
    v_mul_f32 v6, v6, v4
    v_accvgpr_write_b32 a125, v6
    v_accvgpr_read_b32 v7, a126
    v_mul_f32 v7, v7, v4
    v_accvgpr_write_b32 a126, v7
    v_accvgpr_read_b32 v8, a127
    v_mul_f32 v8, v8, v4
    v_accvgpr_write_b32 a127, v8
    s_nop 1
    s_branch LRB_82
LRS_83:
    v_max_f32 v3, v34, v2
    v_sub_f32 v4, v34, v3
    v_exp_f32 v4, v4
    v_mov_b32 v34, v3
    s_nop 0
    v_mul_f32 v35, v35, v4
    s_nop 15
    v_accvgpr_read_b32 v5, a128
    v_mul_f32 v5, v5, v4
    v_accvgpr_write_b32 a128, v5
    v_accvgpr_read_b32 v6, a129
    v_mul_f32 v6, v6, v4
    v_accvgpr_write_b32 a129, v6
    v_accvgpr_read_b32 v7, a130
    v_mul_f32 v7, v7, v4
    v_accvgpr_write_b32 a130, v7
    v_accvgpr_read_b32 v8, a131
    v_mul_f32 v8, v8, v4
    v_accvgpr_write_b32 a131, v8
    v_accvgpr_read_b32 v5, a132
    v_mul_f32 v5, v5, v4
    v_accvgpr_write_b32 a132, v5
    v_accvgpr_read_b32 v6, a133
    v_mul_f32 v6, v6, v4
    v_accvgpr_write_b32 a133, v6
    v_accvgpr_read_b32 v7, a134
    v_mul_f32 v7, v7, v4
    v_accvgpr_write_b32 a134, v7
    v_accvgpr_read_b32 v8, a135
    v_mul_f32 v8, v8, v4
    v_accvgpr_write_b32 a135, v8
    v_accvgpr_read_b32 v5, a136
    v_mul_f32 v5, v5, v4
    v_accvgpr_write_b32 a136, v5
    v_accvgpr_read_b32 v6, a137
    v_mul_f32 v6, v6, v4
    v_accvgpr_write_b32 a137, v6
    v_accvgpr_read_b32 v7, a138
    v_mul_f32 v7, v7, v4
    v_accvgpr_write_b32 a138, v7
    v_accvgpr_read_b32 v8, a139
    v_mul_f32 v8, v8, v4
    v_accvgpr_write_b32 a139, v8
    v_accvgpr_read_b32 v5, a140
    v_mul_f32 v5, v5, v4
    v_accvgpr_write_b32 a140, v5
    v_accvgpr_read_b32 v6, a141
    v_mul_f32 v6, v6, v4
    v_accvgpr_write_b32 a141, v6
    v_accvgpr_read_b32 v7, a142
    v_mul_f32 v7, v7, v4
    v_accvgpr_write_b32 a142, v7
    v_accvgpr_read_b32 v8, a143
    v_mul_f32 v8, v8, v4
    v_accvgpr_write_b32 a143, v8
    v_accvgpr_read_b32 v5, a144
    v_mul_f32 v5, v5, v4
    v_accvgpr_write_b32 a144, v5
    v_accvgpr_read_b32 v6, a145
    v_mul_f32 v6, v6, v4
    v_accvgpr_write_b32 a145, v6
    v_accvgpr_read_b32 v7, a146
    v_mul_f32 v7, v7, v4
    v_accvgpr_write_b32 a146, v7
    v_accvgpr_read_b32 v8, a147
    v_mul_f32 v8, v8, v4
    v_accvgpr_write_b32 a147, v8
    v_accvgpr_read_b32 v5, a148
    v_mul_f32 v5, v5, v4
    v_accvgpr_write_b32 a148, v5
    v_accvgpr_read_b32 v6, a149
    v_mul_f32 v6, v6, v4
    v_accvgpr_write_b32 a149, v6
    v_accvgpr_read_b32 v7, a150
    v_mul_f32 v7, v7, v4
    v_accvgpr_write_b32 a150, v7
    v_accvgpr_read_b32 v8, a151
    v_mul_f32 v8, v8, v4
    v_accvgpr_write_b32 a151, v8
    v_accvgpr_read_b32 v5, a152
    v_mul_f32 v5, v5, v4
    v_accvgpr_write_b32 a152, v5
    v_accvgpr_read_b32 v6, a153
    v_mul_f32 v6, v6, v4
    v_accvgpr_write_b32 a153, v6
    v_accvgpr_read_b32 v7, a154
    v_mul_f32 v7, v7, v4
    v_accvgpr_write_b32 a154, v7
    v_accvgpr_read_b32 v8, a155
    v_mul_f32 v8, v8, v4
    v_accvgpr_write_b32 a155, v8
    v_accvgpr_read_b32 v5, a156
    v_mul_f32 v5, v5, v4
    v_accvgpr_write_b32 a156, v5
    v_accvgpr_read_b32 v6, a157
    v_mul_f32 v6, v6, v4
    v_accvgpr_write_b32 a157, v6
    v_accvgpr_read_b32 v7, a158
    v_mul_f32 v7, v7, v4
    v_accvgpr_write_b32 a158, v7
    v_accvgpr_read_b32 v8, a159
    v_mul_f32 v8, v8, v4
    v_accvgpr_write_b32 a159, v8
    v_accvgpr_read_b32 v5, a160
    v_mul_f32 v5, v5, v4
    v_accvgpr_write_b32 a160, v5
    v_accvgpr_read_b32 v6, a161
    v_mul_f32 v6, v6, v4
    v_accvgpr_write_b32 a161, v6
    v_accvgpr_read_b32 v7, a162
    v_mul_f32 v7, v7, v4
    v_accvgpr_write_b32 a162, v7
    v_accvgpr_read_b32 v8, a163
    v_mul_f32 v8, v8, v4
    v_accvgpr_write_b32 a163, v8
    v_accvgpr_read_b32 v5, a164
    v_mul_f32 v5, v5, v4
    v_accvgpr_write_b32 a164, v5
    v_accvgpr_read_b32 v6, a165
    v_mul_f32 v6, v6, v4
    v_accvgpr_write_b32 a165, v6
    v_accvgpr_read_b32 v7, a166
    v_mul_f32 v7, v7, v4
    v_accvgpr_write_b32 a166, v7
    v_accvgpr_read_b32 v8, a167
    v_mul_f32 v8, v8, v4
    v_accvgpr_write_b32 a167, v8
    v_accvgpr_read_b32 v5, a168
    v_mul_f32 v5, v5, v4
    v_accvgpr_write_b32 a168, v5
    v_accvgpr_read_b32 v6, a169
    v_mul_f32 v6, v6, v4
    v_accvgpr_write_b32 a169, v6
    v_accvgpr_read_b32 v7, a170
    v_mul_f32 v7, v7, v4
    v_accvgpr_write_b32 a170, v7
    v_accvgpr_read_b32 v8, a171
    v_mul_f32 v8, v8, v4
    v_accvgpr_write_b32 a171, v8
    v_accvgpr_read_b32 v5, a172
    v_mul_f32 v5, v5, v4
    v_accvgpr_write_b32 a172, v5
    v_accvgpr_read_b32 v6, a173
    v_mul_f32 v6, v6, v4
    v_accvgpr_write_b32 a173, v6
    v_accvgpr_read_b32 v7, a174
    v_mul_f32 v7, v7, v4
    v_accvgpr_write_b32 a174, v7
    v_accvgpr_read_b32 v8, a175
    v_mul_f32 v8, v8, v4
    v_accvgpr_write_b32 a175, v8
    v_accvgpr_read_b32 v5, a176
    v_mul_f32 v5, v5, v4
    v_accvgpr_write_b32 a176, v5
    v_accvgpr_read_b32 v6, a177
    v_mul_f32 v6, v6, v4
    v_accvgpr_write_b32 a177, v6
    v_accvgpr_read_b32 v7, a178
    v_mul_f32 v7, v7, v4
    v_accvgpr_write_b32 a178, v7
    v_accvgpr_read_b32 v8, a179
    v_mul_f32 v8, v8, v4
    v_accvgpr_write_b32 a179, v8
    v_accvgpr_read_b32 v5, a180
    v_mul_f32 v5, v5, v4
    v_accvgpr_write_b32 a180, v5
    v_accvgpr_read_b32 v6, a181
    v_mul_f32 v6, v6, v4
    v_accvgpr_write_b32 a181, v6
    v_accvgpr_read_b32 v7, a182
    v_mul_f32 v7, v7, v4
    v_accvgpr_write_b32 a182, v7
    v_accvgpr_read_b32 v8, a183
    v_mul_f32 v8, v8, v4
    v_accvgpr_write_b32 a183, v8
    v_accvgpr_read_b32 v5, a184
    v_mul_f32 v5, v5, v4
    v_accvgpr_write_b32 a184, v5
    v_accvgpr_read_b32 v6, a185
    v_mul_f32 v6, v6, v4
    v_accvgpr_write_b32 a185, v6
    v_accvgpr_read_b32 v7, a186
    v_mul_f32 v7, v7, v4
    v_accvgpr_write_b32 a186, v7
    v_accvgpr_read_b32 v8, a187
    v_mul_f32 v8, v8, v4
    v_accvgpr_write_b32 a187, v8
    v_accvgpr_read_b32 v5, a188
    v_mul_f32 v5, v5, v4
    v_accvgpr_write_b32 a188, v5
    v_accvgpr_read_b32 v6, a189
    v_mul_f32 v6, v6, v4
    v_accvgpr_write_b32 a189, v6
    v_accvgpr_read_b32 v7, a190
    v_mul_f32 v7, v7, v4
    v_accvgpr_write_b32 a190, v7
    v_accvgpr_read_b32 v8, a191
    v_mul_f32 v8, v8, v4
    v_accvgpr_write_b32 a191, v8
    v_accvgpr_read_b32 v5, a192
    v_mul_f32 v5, v5, v4
    v_accvgpr_write_b32 a192, v5
    v_accvgpr_read_b32 v6, a193
    v_mul_f32 v6, v6, v4
    v_accvgpr_write_b32 a193, v6
    v_accvgpr_read_b32 v7, a194
    v_mul_f32 v7, v7, v4
    v_accvgpr_write_b32 a194, v7
    v_accvgpr_read_b32 v8, a195
    v_mul_f32 v8, v8, v4
    v_accvgpr_write_b32 a195, v8
    v_accvgpr_read_b32 v5, a196
    v_mul_f32 v5, v5, v4
    v_accvgpr_write_b32 a196, v5
    v_accvgpr_read_b32 v6, a197
    v_mul_f32 v6, v6, v4
    v_accvgpr_write_b32 a197, v6
    v_accvgpr_read_b32 v7, a198
    v_mul_f32 v7, v7, v4
    v_accvgpr_write_b32 a198, v7
    v_accvgpr_read_b32 v8, a199
    v_mul_f32 v8, v8, v4
    v_accvgpr_write_b32 a199, v8
    v_accvgpr_read_b32 v5, a200
    v_mul_f32 v5, v5, v4
    v_accvgpr_write_b32 a200, v5
    v_accvgpr_read_b32 v6, a201
    v_mul_f32 v6, v6, v4
    v_accvgpr_write_b32 a201, v6
    v_accvgpr_read_b32 v7, a202
    v_mul_f32 v7, v7, v4
    v_accvgpr_write_b32 a202, v7
    v_accvgpr_read_b32 v8, a203
    v_mul_f32 v8, v8, v4
    v_accvgpr_write_b32 a203, v8
    v_accvgpr_read_b32 v5, a204
    v_mul_f32 v5, v5, v4
    v_accvgpr_write_b32 a204, v5
    v_accvgpr_read_b32 v6, a205
    v_mul_f32 v6, v6, v4
    v_accvgpr_write_b32 a205, v6
    v_accvgpr_read_b32 v7, a206
    v_mul_f32 v7, v7, v4
    v_accvgpr_write_b32 a206, v7
    v_accvgpr_read_b32 v8, a207
    v_mul_f32 v8, v8, v4
    v_accvgpr_write_b32 a207, v8
    v_accvgpr_read_b32 v5, a208
    v_mul_f32 v5, v5, v4
    v_accvgpr_write_b32 a208, v5
    v_accvgpr_read_b32 v6, a209
    v_mul_f32 v6, v6, v4
    v_accvgpr_write_b32 a209, v6
    v_accvgpr_read_b32 v7, a210
    v_mul_f32 v7, v7, v4
    v_accvgpr_write_b32 a210, v7
    v_accvgpr_read_b32 v8, a211
    v_mul_f32 v8, v8, v4
    v_accvgpr_write_b32 a211, v8
    v_accvgpr_read_b32 v5, a212
    v_mul_f32 v5, v5, v4
    v_accvgpr_write_b32 a212, v5
    v_accvgpr_read_b32 v6, a213
    v_mul_f32 v6, v6, v4
    v_accvgpr_write_b32 a213, v6
    v_accvgpr_read_b32 v7, a214
    v_mul_f32 v7, v7, v4
    v_accvgpr_write_b32 a214, v7
    v_accvgpr_read_b32 v8, a215
    v_mul_f32 v8, v8, v4
    v_accvgpr_write_b32 a215, v8
    v_accvgpr_read_b32 v5, a216
    v_mul_f32 v5, v5, v4
    v_accvgpr_write_b32 a216, v5
    v_accvgpr_read_b32 v6, a217
    v_mul_f32 v6, v6, v4
    v_accvgpr_write_b32 a217, v6
    v_accvgpr_read_b32 v7, a218
    v_mul_f32 v7, v7, v4
    v_accvgpr_write_b32 a218, v7
    v_accvgpr_read_b32 v8, a219
    v_mul_f32 v8, v8, v4
    v_accvgpr_write_b32 a219, v8
    v_accvgpr_read_b32 v5, a220
    v_mul_f32 v5, v5, v4
    v_accvgpr_write_b32 a220, v5
    v_accvgpr_read_b32 v6, a221
    v_mul_f32 v6, v6, v4
    v_accvgpr_write_b32 a221, v6
    v_accvgpr_read_b32 v7, a222
    v_mul_f32 v7, v7, v4
    v_accvgpr_write_b32 a222, v7
    v_accvgpr_read_b32 v8, a223
    v_mul_f32 v8, v8, v4
    v_accvgpr_write_b32 a223, v8
    v_accvgpr_read_b32 v5, a224
    v_mul_f32 v5, v5, v4
    v_accvgpr_write_b32 a224, v5
    v_accvgpr_read_b32 v6, a225
    v_mul_f32 v6, v6, v4
    v_accvgpr_write_b32 a225, v6
    v_accvgpr_read_b32 v7, a226
    v_mul_f32 v7, v7, v4
    v_accvgpr_write_b32 a226, v7
    v_accvgpr_read_b32 v8, a227
    v_mul_f32 v8, v8, v4
    v_accvgpr_write_b32 a227, v8
    v_accvgpr_read_b32 v5, a228
    v_mul_f32 v5, v5, v4
    v_accvgpr_write_b32 a228, v5
    v_accvgpr_read_b32 v6, a229
    v_mul_f32 v6, v6, v4
    v_accvgpr_write_b32 a229, v6
    v_accvgpr_read_b32 v7, a230
    v_mul_f32 v7, v7, v4
    v_accvgpr_write_b32 a230, v7
    v_accvgpr_read_b32 v8, a231
    v_mul_f32 v8, v8, v4
    v_accvgpr_write_b32 a231, v8
    v_accvgpr_read_b32 v5, a232
    v_mul_f32 v5, v5, v4
    v_accvgpr_write_b32 a232, v5
    v_accvgpr_read_b32 v6, a233
    v_mul_f32 v6, v6, v4
    v_accvgpr_write_b32 a233, v6
    v_accvgpr_read_b32 v7, a234
    v_mul_f32 v7, v7, v4
    v_accvgpr_write_b32 a234, v7
    v_accvgpr_read_b32 v8, a235
    v_mul_f32 v8, v8, v4
    v_accvgpr_write_b32 a235, v8
    v_accvgpr_read_b32 v5, a236
    v_mul_f32 v5, v5, v4
    v_accvgpr_write_b32 a236, v5
    v_accvgpr_read_b32 v6, a237
    v_mul_f32 v6, v6, v4
    v_accvgpr_write_b32 a237, v6
    v_accvgpr_read_b32 v7, a238
    v_mul_f32 v7, v7, v4
    v_accvgpr_write_b32 a238, v7
    v_accvgpr_read_b32 v8, a239
    v_mul_f32 v8, v8, v4
    v_accvgpr_write_b32 a239, v8
    v_accvgpr_read_b32 v5, a240
    v_mul_f32 v5, v5, v4
    v_accvgpr_write_b32 a240, v5
    v_accvgpr_read_b32 v6, a241
    v_mul_f32 v6, v6, v4
    v_accvgpr_write_b32 a241, v6
    v_accvgpr_read_b32 v7, a242
    v_mul_f32 v7, v7, v4
    v_accvgpr_write_b32 a242, v7
    v_accvgpr_read_b32 v8, a243
    v_mul_f32 v8, v8, v4
    v_accvgpr_write_b32 a243, v8
    v_accvgpr_read_b32 v5, a244
    v_mul_f32 v5, v5, v4
    v_accvgpr_write_b32 a244, v5
    v_accvgpr_read_b32 v6, a245
    v_mul_f32 v6, v6, v4
    v_accvgpr_write_b32 a245, v6
    v_accvgpr_read_b32 v7, a246
    v_mul_f32 v7, v7, v4
    v_accvgpr_write_b32 a246, v7
    v_accvgpr_read_b32 v8, a247
    v_mul_f32 v8, v8, v4
    v_accvgpr_write_b32 a247, v8
    v_accvgpr_read_b32 v5, a248
    v_mul_f32 v5, v5, v4
    v_accvgpr_write_b32 a248, v5
    v_accvgpr_read_b32 v6, a249
    v_mul_f32 v6, v6, v4
    v_accvgpr_write_b32 a249, v6
    v_accvgpr_read_b32 v7, a250
    v_mul_f32 v7, v7, v4
    v_accvgpr_write_b32 a250, v7
    v_accvgpr_read_b32 v8, a251
    v_mul_f32 v8, v8, v4
    v_accvgpr_write_b32 a251, v8
    v_accvgpr_read_b32 v5, a252
    v_mul_f32 v5, v5, v4
    v_accvgpr_write_b32 a252, v5
    v_accvgpr_read_b32 v6, a253
    v_mul_f32 v6, v6, v4
    v_accvgpr_write_b32 a253, v6
    v_accvgpr_read_b32 v7, a254
    v_mul_f32 v7, v7, v4
    v_accvgpr_write_b32 a254, v7
    v_accvgpr_read_b32 v8, a255
    v_mul_f32 v8, v8, v4
    v_accvgpr_write_b32 a255, v8
    s_nop 1
    s_branch LRB_84
LRS_91:
    v_max_f32 v3, v32, v2
    v_sub_f32 v4, v32, v3
    v_exp_f32 v4, v4
    v_mov_b32 v32, v3
    s_nop 0
    v_mul_f32 v33, v33, v4
    s_nop 15
    v_accvgpr_read_b32 v5, a0
    v_mul_f32 v5, v5, v4
    v_accvgpr_write_b32 a0, v5
    v_accvgpr_read_b32 v6, a1
    v_mul_f32 v6, v6, v4
    v_accvgpr_write_b32 a1, v6
    v_accvgpr_read_b32 v7, a2
    v_mul_f32 v7, v7, v4
    v_accvgpr_write_b32 a2, v7
    v_accvgpr_read_b32 v8, a3
    v_mul_f32 v8, v8, v4
    v_accvgpr_write_b32 a3, v8
    v_accvgpr_read_b32 v5, a4
    v_mul_f32 v5, v5, v4
    v_accvgpr_write_b32 a4, v5
    v_accvgpr_read_b32 v6, a5
    v_mul_f32 v6, v6, v4
    v_accvgpr_write_b32 a5, v6
    v_accvgpr_read_b32 v7, a6
    v_mul_f32 v7, v7, v4
    v_accvgpr_write_b32 a6, v7
    v_accvgpr_read_b32 v8, a7
    v_mul_f32 v8, v8, v4
    v_accvgpr_write_b32 a7, v8
    v_accvgpr_read_b32 v5, a8
    v_mul_f32 v5, v5, v4
    v_accvgpr_write_b32 a8, v5
    v_accvgpr_read_b32 v6, a9
    v_mul_f32 v6, v6, v4
    v_accvgpr_write_b32 a9, v6
    v_accvgpr_read_b32 v7, a10
    v_mul_f32 v7, v7, v4
    v_accvgpr_write_b32 a10, v7
    v_accvgpr_read_b32 v8, a11
    v_mul_f32 v8, v8, v4
    v_accvgpr_write_b32 a11, v8
    v_accvgpr_read_b32 v5, a12
    v_mul_f32 v5, v5, v4
    v_accvgpr_write_b32 a12, v5
    v_accvgpr_read_b32 v6, a13
    v_mul_f32 v6, v6, v4
    v_accvgpr_write_b32 a13, v6
    v_accvgpr_read_b32 v7, a14
    v_mul_f32 v7, v7, v4
    v_accvgpr_write_b32 a14, v7
    v_accvgpr_read_b32 v8, a15
    v_mul_f32 v8, v8, v4
    v_accvgpr_write_b32 a15, v8
    v_accvgpr_read_b32 v5, a16
    v_mul_f32 v5, v5, v4
    v_accvgpr_write_b32 a16, v5
    v_accvgpr_read_b32 v6, a17
    v_mul_f32 v6, v6, v4
    v_accvgpr_write_b32 a17, v6
    v_accvgpr_read_b32 v7, a18
    v_mul_f32 v7, v7, v4
    v_accvgpr_write_b32 a18, v7
    v_accvgpr_read_b32 v8, a19
    v_mul_f32 v8, v8, v4
    v_accvgpr_write_b32 a19, v8
    v_accvgpr_read_b32 v5, a20
    v_mul_f32 v5, v5, v4
    v_accvgpr_write_b32 a20, v5
    v_accvgpr_read_b32 v6, a21
    v_mul_f32 v6, v6, v4
    v_accvgpr_write_b32 a21, v6
    v_accvgpr_read_b32 v7, a22
    v_mul_f32 v7, v7, v4
    v_accvgpr_write_b32 a22, v7
    v_accvgpr_read_b32 v8, a23
    v_mul_f32 v8, v8, v4
    v_accvgpr_write_b32 a23, v8
    v_accvgpr_read_b32 v5, a24
    v_mul_f32 v5, v5, v4
    v_accvgpr_write_b32 a24, v5
    v_accvgpr_read_b32 v6, a25
    v_mul_f32 v6, v6, v4
    v_accvgpr_write_b32 a25, v6
    v_accvgpr_read_b32 v7, a26
    v_mul_f32 v7, v7, v4
    v_accvgpr_write_b32 a26, v7
    v_accvgpr_read_b32 v8, a27
    v_mul_f32 v8, v8, v4
    v_accvgpr_write_b32 a27, v8
    v_accvgpr_read_b32 v5, a28
    v_mul_f32 v5, v5, v4
    v_accvgpr_write_b32 a28, v5
    v_accvgpr_read_b32 v6, a29
    v_mul_f32 v6, v6, v4
    v_accvgpr_write_b32 a29, v6
    v_accvgpr_read_b32 v7, a30
    v_mul_f32 v7, v7, v4
    v_accvgpr_write_b32 a30, v7
    v_accvgpr_read_b32 v8, a31
    v_mul_f32 v8, v8, v4
    v_accvgpr_write_b32 a31, v8
    v_accvgpr_read_b32 v5, a32
    v_mul_f32 v5, v5, v4
    v_accvgpr_write_b32 a32, v5
    v_accvgpr_read_b32 v6, a33
    v_mul_f32 v6, v6, v4
    v_accvgpr_write_b32 a33, v6
    v_accvgpr_read_b32 v7, a34
    v_mul_f32 v7, v7, v4
    v_accvgpr_write_b32 a34, v7
    v_accvgpr_read_b32 v8, a35
    v_mul_f32 v8, v8, v4
    v_accvgpr_write_b32 a35, v8
    v_accvgpr_read_b32 v5, a36
    v_mul_f32 v5, v5, v4
    v_accvgpr_write_b32 a36, v5
    v_accvgpr_read_b32 v6, a37
    v_mul_f32 v6, v6, v4
    v_accvgpr_write_b32 a37, v6
    v_accvgpr_read_b32 v7, a38
    v_mul_f32 v7, v7, v4
    v_accvgpr_write_b32 a38, v7
    v_accvgpr_read_b32 v8, a39
    v_mul_f32 v8, v8, v4
    v_accvgpr_write_b32 a39, v8
    v_accvgpr_read_b32 v5, a40
    v_mul_f32 v5, v5, v4
    v_accvgpr_write_b32 a40, v5
    v_accvgpr_read_b32 v6, a41
    v_mul_f32 v6, v6, v4
    v_accvgpr_write_b32 a41, v6
    v_accvgpr_read_b32 v7, a42
    v_mul_f32 v7, v7, v4
    v_accvgpr_write_b32 a42, v7
    v_accvgpr_read_b32 v8, a43
    v_mul_f32 v8, v8, v4
    v_accvgpr_write_b32 a43, v8
    v_accvgpr_read_b32 v5, a44
    v_mul_f32 v5, v5, v4
    v_accvgpr_write_b32 a44, v5
    v_accvgpr_read_b32 v6, a45
    v_mul_f32 v6, v6, v4
    v_accvgpr_write_b32 a45, v6
    v_accvgpr_read_b32 v7, a46
    v_mul_f32 v7, v7, v4
    v_accvgpr_write_b32 a46, v7
    v_accvgpr_read_b32 v8, a47
    v_mul_f32 v8, v8, v4
    v_accvgpr_write_b32 a47, v8
    v_accvgpr_read_b32 v5, a48
    v_mul_f32 v5, v5, v4
    v_accvgpr_write_b32 a48, v5
    v_accvgpr_read_b32 v6, a49
    v_mul_f32 v6, v6, v4
    v_accvgpr_write_b32 a49, v6
    v_accvgpr_read_b32 v7, a50
    v_mul_f32 v7, v7, v4
    v_accvgpr_write_b32 a50, v7
    v_accvgpr_read_b32 v8, a51
    v_mul_f32 v8, v8, v4
    v_accvgpr_write_b32 a51, v8
    v_accvgpr_read_b32 v5, a52
    v_mul_f32 v5, v5, v4
    v_accvgpr_write_b32 a52, v5
    v_accvgpr_read_b32 v6, a53
    v_mul_f32 v6, v6, v4
    v_accvgpr_write_b32 a53, v6
    v_accvgpr_read_b32 v7, a54
    v_mul_f32 v7, v7, v4
    v_accvgpr_write_b32 a54, v7
    v_accvgpr_read_b32 v8, a55
    v_mul_f32 v8, v8, v4
    v_accvgpr_write_b32 a55, v8
    v_accvgpr_read_b32 v5, a56
    v_mul_f32 v5, v5, v4
    v_accvgpr_write_b32 a56, v5
    v_accvgpr_read_b32 v6, a57
    v_mul_f32 v6, v6, v4
    v_accvgpr_write_b32 a57, v6
    v_accvgpr_read_b32 v7, a58
    v_mul_f32 v7, v7, v4
    v_accvgpr_write_b32 a58, v7
    v_accvgpr_read_b32 v8, a59
    v_mul_f32 v8, v8, v4
    v_accvgpr_write_b32 a59, v8
    v_accvgpr_read_b32 v5, a60
    v_mul_f32 v5, v5, v4
    v_accvgpr_write_b32 a60, v5
    v_accvgpr_read_b32 v6, a61
    v_mul_f32 v6, v6, v4
    v_accvgpr_write_b32 a61, v6
    v_accvgpr_read_b32 v7, a62
    v_mul_f32 v7, v7, v4
    v_accvgpr_write_b32 a62, v7
    v_accvgpr_read_b32 v8, a63
    v_mul_f32 v8, v8, v4
    v_accvgpr_write_b32 a63, v8
    v_accvgpr_read_b32 v5, a64
    v_mul_f32 v5, v5, v4
    v_accvgpr_write_b32 a64, v5
    v_accvgpr_read_b32 v6, a65
    v_mul_f32 v6, v6, v4
    v_accvgpr_write_b32 a65, v6
    v_accvgpr_read_b32 v7, a66
    v_mul_f32 v7, v7, v4
    v_accvgpr_write_b32 a66, v7
    v_accvgpr_read_b32 v8, a67
    v_mul_f32 v8, v8, v4
    v_accvgpr_write_b32 a67, v8
    v_accvgpr_read_b32 v5, a68
    v_mul_f32 v5, v5, v4
    v_accvgpr_write_b32 a68, v5
    v_accvgpr_read_b32 v6, a69
    v_mul_f32 v6, v6, v4
    v_accvgpr_write_b32 a69, v6
    v_accvgpr_read_b32 v7, a70
    v_mul_f32 v7, v7, v4
    v_accvgpr_write_b32 a70, v7
    v_accvgpr_read_b32 v8, a71
    v_mul_f32 v8, v8, v4
    v_accvgpr_write_b32 a71, v8
    v_accvgpr_read_b32 v5, a72
    v_mul_f32 v5, v5, v4
    v_accvgpr_write_b32 a72, v5
    v_accvgpr_read_b32 v6, a73
    v_mul_f32 v6, v6, v4
    v_accvgpr_write_b32 a73, v6
    v_accvgpr_read_b32 v7, a74
    v_mul_f32 v7, v7, v4
    v_accvgpr_write_b32 a74, v7
    v_accvgpr_read_b32 v8, a75
    v_mul_f32 v8, v8, v4
    v_accvgpr_write_b32 a75, v8
    v_accvgpr_read_b32 v5, a76
    v_mul_f32 v5, v5, v4
    v_accvgpr_write_b32 a76, v5
    v_accvgpr_read_b32 v6, a77
    v_mul_f32 v6, v6, v4
    v_accvgpr_write_b32 a77, v6
    v_accvgpr_read_b32 v7, a78
    v_mul_f32 v7, v7, v4
    v_accvgpr_write_b32 a78, v7
    v_accvgpr_read_b32 v8, a79
    v_mul_f32 v8, v8, v4
    v_accvgpr_write_b32 a79, v8
    v_accvgpr_read_b32 v5, a80
    v_mul_f32 v5, v5, v4
    v_accvgpr_write_b32 a80, v5
    v_accvgpr_read_b32 v6, a81
    v_mul_f32 v6, v6, v4
    v_accvgpr_write_b32 a81, v6
    v_accvgpr_read_b32 v7, a82
    v_mul_f32 v7, v7, v4
    v_accvgpr_write_b32 a82, v7
    v_accvgpr_read_b32 v8, a83
    v_mul_f32 v8, v8, v4
    v_accvgpr_write_b32 a83, v8
    v_accvgpr_read_b32 v5, a84
    v_mul_f32 v5, v5, v4
    v_accvgpr_write_b32 a84, v5
    v_accvgpr_read_b32 v6, a85
    v_mul_f32 v6, v6, v4
    v_accvgpr_write_b32 a85, v6
    v_accvgpr_read_b32 v7, a86
    v_mul_f32 v7, v7, v4
    v_accvgpr_write_b32 a86, v7
    v_accvgpr_read_b32 v8, a87
    v_mul_f32 v8, v8, v4
    v_accvgpr_write_b32 a87, v8
    v_accvgpr_read_b32 v5, a88
    v_mul_f32 v5, v5, v4
    v_accvgpr_write_b32 a88, v5
    v_accvgpr_read_b32 v6, a89
    v_mul_f32 v6, v6, v4
    v_accvgpr_write_b32 a89, v6
    v_accvgpr_read_b32 v7, a90
    v_mul_f32 v7, v7, v4
    v_accvgpr_write_b32 a90, v7
    v_accvgpr_read_b32 v8, a91
    v_mul_f32 v8, v8, v4
    v_accvgpr_write_b32 a91, v8
    v_accvgpr_read_b32 v5, a92
    v_mul_f32 v5, v5, v4
    v_accvgpr_write_b32 a92, v5
    v_accvgpr_read_b32 v6, a93
    v_mul_f32 v6, v6, v4
    v_accvgpr_write_b32 a93, v6
    v_accvgpr_read_b32 v7, a94
    v_mul_f32 v7, v7, v4
    v_accvgpr_write_b32 a94, v7
    v_accvgpr_read_b32 v8, a95
    v_mul_f32 v8, v8, v4
    v_accvgpr_write_b32 a95, v8
    v_accvgpr_read_b32 v5, a96
    v_mul_f32 v5, v5, v4
    v_accvgpr_write_b32 a96, v5
    v_accvgpr_read_b32 v6, a97
    v_mul_f32 v6, v6, v4
    v_accvgpr_write_b32 a97, v6
    v_accvgpr_read_b32 v7, a98
    v_mul_f32 v7, v7, v4
    v_accvgpr_write_b32 a98, v7
    v_accvgpr_read_b32 v8, a99
    v_mul_f32 v8, v8, v4
    v_accvgpr_write_b32 a99, v8
    v_accvgpr_read_b32 v5, a100
    v_mul_f32 v5, v5, v4
    v_accvgpr_write_b32 a100, v5
    v_accvgpr_read_b32 v6, a101
    v_mul_f32 v6, v6, v4
    v_accvgpr_write_b32 a101, v6
    v_accvgpr_read_b32 v7, a102
    v_mul_f32 v7, v7, v4
    v_accvgpr_write_b32 a102, v7
    v_accvgpr_read_b32 v8, a103
    v_mul_f32 v8, v8, v4
    v_accvgpr_write_b32 a103, v8
    v_accvgpr_read_b32 v5, a104
    v_mul_f32 v5, v5, v4
    v_accvgpr_write_b32 a104, v5
    v_accvgpr_read_b32 v6, a105
    v_mul_f32 v6, v6, v4
    v_accvgpr_write_b32 a105, v6
    v_accvgpr_read_b32 v7, a106
    v_mul_f32 v7, v7, v4
    v_accvgpr_write_b32 a106, v7
    v_accvgpr_read_b32 v8, a107
    v_mul_f32 v8, v8, v4
    v_accvgpr_write_b32 a107, v8
    v_accvgpr_read_b32 v5, a108
    v_mul_f32 v5, v5, v4
    v_accvgpr_write_b32 a108, v5
    v_accvgpr_read_b32 v6, a109
    v_mul_f32 v6, v6, v4
    v_accvgpr_write_b32 a109, v6
    v_accvgpr_read_b32 v7, a110
    v_mul_f32 v7, v7, v4
    v_accvgpr_write_b32 a110, v7
    v_accvgpr_read_b32 v8, a111
    v_mul_f32 v8, v8, v4
    v_accvgpr_write_b32 a111, v8
    v_accvgpr_read_b32 v5, a112
    v_mul_f32 v5, v5, v4
    v_accvgpr_write_b32 a112, v5
    v_accvgpr_read_b32 v6, a113
    v_mul_f32 v6, v6, v4
    v_accvgpr_write_b32 a113, v6
    v_accvgpr_read_b32 v7, a114
    v_mul_f32 v7, v7, v4
    v_accvgpr_write_b32 a114, v7
    v_accvgpr_read_b32 v8, a115
    v_mul_f32 v8, v8, v4
    v_accvgpr_write_b32 a115, v8
    v_accvgpr_read_b32 v5, a116
    v_mul_f32 v5, v5, v4
    v_accvgpr_write_b32 a116, v5
    v_accvgpr_read_b32 v6, a117
    v_mul_f32 v6, v6, v4
    v_accvgpr_write_b32 a117, v6
    v_accvgpr_read_b32 v7, a118
    v_mul_f32 v7, v7, v4
    v_accvgpr_write_b32 a118, v7
    v_accvgpr_read_b32 v8, a119
    v_mul_f32 v8, v8, v4
    v_accvgpr_write_b32 a119, v8
    v_accvgpr_read_b32 v5, a120
    v_mul_f32 v5, v5, v4
    v_accvgpr_write_b32 a120, v5
    v_accvgpr_read_b32 v6, a121
    v_mul_f32 v6, v6, v4
    v_accvgpr_write_b32 a121, v6
    v_accvgpr_read_b32 v7, a122
    v_mul_f32 v7, v7, v4
    v_accvgpr_write_b32 a122, v7
    v_accvgpr_read_b32 v8, a123
    v_mul_f32 v8, v8, v4
    v_accvgpr_write_b32 a123, v8
    v_accvgpr_read_b32 v5, a124
    v_mul_f32 v5, v5, v4
    v_accvgpr_write_b32 a124, v5
    v_accvgpr_read_b32 v6, a125
    v_mul_f32 v6, v6, v4
    v_accvgpr_write_b32 a125, v6
    v_accvgpr_read_b32 v7, a126
    v_mul_f32 v7, v7, v4
    v_accvgpr_write_b32 a126, v7
    v_accvgpr_read_b32 v8, a127
    v_mul_f32 v8, v8, v4
    v_accvgpr_write_b32 a127, v8
    s_nop 1
    s_branch LRB_92
LRS_93:
    v_max_f32 v3, v32, v2
    v_sub_f32 v4, v32, v3
    v_exp_f32 v4, v4
    v_mov_b32 v32, v3
    s_nop 0
    v_mul_f32 v33, v33, v4
    s_nop 15
    v_accvgpr_read_b32 v5, a0
    v_mul_f32 v5, v5, v4
    v_accvgpr_write_b32 a0, v5
    v_accvgpr_read_b32 v6, a1
    v_mul_f32 v6, v6, v4
    v_accvgpr_write_b32 a1, v6
    v_accvgpr_read_b32 v7, a2
    v_mul_f32 v7, v7, v4
    v_accvgpr_write_b32 a2, v7
    v_accvgpr_read_b32 v8, a3
    v_mul_f32 v8, v8, v4
    v_accvgpr_write_b32 a3, v8
    v_accvgpr_read_b32 v5, a4
    v_mul_f32 v5, v5, v4
    v_accvgpr_write_b32 a4, v5
    v_accvgpr_read_b32 v6, a5
    v_mul_f32 v6, v6, v4
    v_accvgpr_write_b32 a5, v6
    v_accvgpr_read_b32 v7, a6
    v_mul_f32 v7, v7, v4
    v_accvgpr_write_b32 a6, v7
    v_accvgpr_read_b32 v8, a7
    v_mul_f32 v8, v8, v4
    v_accvgpr_write_b32 a7, v8
    v_accvgpr_read_b32 v5, a8
    v_mul_f32 v5, v5, v4
    v_accvgpr_write_b32 a8, v5
    v_accvgpr_read_b32 v6, a9
    v_mul_f32 v6, v6, v4
    v_accvgpr_write_b32 a9, v6
    v_accvgpr_read_b32 v7, a10
    v_mul_f32 v7, v7, v4
    v_accvgpr_write_b32 a10, v7
    v_accvgpr_read_b32 v8, a11
    v_mul_f32 v8, v8, v4
    v_accvgpr_write_b32 a11, v8
    v_accvgpr_read_b32 v5, a12
    v_mul_f32 v5, v5, v4
    v_accvgpr_write_b32 a12, v5
    v_accvgpr_read_b32 v6, a13
    v_mul_f32 v6, v6, v4
    v_accvgpr_write_b32 a13, v6
    v_accvgpr_read_b32 v7, a14
    v_mul_f32 v7, v7, v4
    v_accvgpr_write_b32 a14, v7
    v_accvgpr_read_b32 v8, a15
    v_mul_f32 v8, v8, v4
    v_accvgpr_write_b32 a15, v8
    v_accvgpr_read_b32 v5, a16
    v_mul_f32 v5, v5, v4
    v_accvgpr_write_b32 a16, v5
    v_accvgpr_read_b32 v6, a17
    v_mul_f32 v6, v6, v4
    v_accvgpr_write_b32 a17, v6
    v_accvgpr_read_b32 v7, a18
    v_mul_f32 v7, v7, v4
    v_accvgpr_write_b32 a18, v7
    v_accvgpr_read_b32 v8, a19
    v_mul_f32 v8, v8, v4
    v_accvgpr_write_b32 a19, v8
    v_accvgpr_read_b32 v5, a20
    v_mul_f32 v5, v5, v4
    v_accvgpr_write_b32 a20, v5
    v_accvgpr_read_b32 v6, a21
    v_mul_f32 v6, v6, v4
    v_accvgpr_write_b32 a21, v6
    v_accvgpr_read_b32 v7, a22
    v_mul_f32 v7, v7, v4
    v_accvgpr_write_b32 a22, v7
    v_accvgpr_read_b32 v8, a23
    v_mul_f32 v8, v8, v4
    v_accvgpr_write_b32 a23, v8
    v_accvgpr_read_b32 v5, a24
    v_mul_f32 v5, v5, v4
    v_accvgpr_write_b32 a24, v5
    v_accvgpr_read_b32 v6, a25
    v_mul_f32 v6, v6, v4
    v_accvgpr_write_b32 a25, v6
    v_accvgpr_read_b32 v7, a26
    v_mul_f32 v7, v7, v4
    v_accvgpr_write_b32 a26, v7
    v_accvgpr_read_b32 v8, a27
    v_mul_f32 v8, v8, v4
    v_accvgpr_write_b32 a27, v8
    v_accvgpr_read_b32 v5, a28
    v_mul_f32 v5, v5, v4
    v_accvgpr_write_b32 a28, v5
    v_accvgpr_read_b32 v6, a29
    v_mul_f32 v6, v6, v4
    v_accvgpr_write_b32 a29, v6
    v_accvgpr_read_b32 v7, a30
    v_mul_f32 v7, v7, v4
    v_accvgpr_write_b32 a30, v7
    v_accvgpr_read_b32 v8, a31
    v_mul_f32 v8, v8, v4
    v_accvgpr_write_b32 a31, v8
    v_accvgpr_read_b32 v5, a32
    v_mul_f32 v5, v5, v4
    v_accvgpr_write_b32 a32, v5
    v_accvgpr_read_b32 v6, a33
    v_mul_f32 v6, v6, v4
    v_accvgpr_write_b32 a33, v6
    v_accvgpr_read_b32 v7, a34
    v_mul_f32 v7, v7, v4
    v_accvgpr_write_b32 a34, v7
    v_accvgpr_read_b32 v8, a35
    v_mul_f32 v8, v8, v4
    v_accvgpr_write_b32 a35, v8
    v_accvgpr_read_b32 v5, a36
    v_mul_f32 v5, v5, v4
    v_accvgpr_write_b32 a36, v5
    v_accvgpr_read_b32 v6, a37
    v_mul_f32 v6, v6, v4
    v_accvgpr_write_b32 a37, v6
    v_accvgpr_read_b32 v7, a38
    v_mul_f32 v7, v7, v4
    v_accvgpr_write_b32 a38, v7
    v_accvgpr_read_b32 v8, a39
    v_mul_f32 v8, v8, v4
    v_accvgpr_write_b32 a39, v8
    v_accvgpr_read_b32 v5, a40
    v_mul_f32 v5, v5, v4
    v_accvgpr_write_b32 a40, v5
    v_accvgpr_read_b32 v6, a41
    v_mul_f32 v6, v6, v4
    v_accvgpr_write_b32 a41, v6
    v_accvgpr_read_b32 v7, a42
    v_mul_f32 v7, v7, v4
    v_accvgpr_write_b32 a42, v7
    v_accvgpr_read_b32 v8, a43
    v_mul_f32 v8, v8, v4
    v_accvgpr_write_b32 a43, v8
    v_accvgpr_read_b32 v5, a44
    v_mul_f32 v5, v5, v4
    v_accvgpr_write_b32 a44, v5
    v_accvgpr_read_b32 v6, a45
    v_mul_f32 v6, v6, v4
    v_accvgpr_write_b32 a45, v6
    v_accvgpr_read_b32 v7, a46
    v_mul_f32 v7, v7, v4
    v_accvgpr_write_b32 a46, v7
    v_accvgpr_read_b32 v8, a47
    v_mul_f32 v8, v8, v4
    v_accvgpr_write_b32 a47, v8
    v_accvgpr_read_b32 v5, a48
    v_mul_f32 v5, v5, v4
    v_accvgpr_write_b32 a48, v5
    v_accvgpr_read_b32 v6, a49
    v_mul_f32 v6, v6, v4
    v_accvgpr_write_b32 a49, v6
    v_accvgpr_read_b32 v7, a50
    v_mul_f32 v7, v7, v4
    v_accvgpr_write_b32 a50, v7
    v_accvgpr_read_b32 v8, a51
    v_mul_f32 v8, v8, v4
    v_accvgpr_write_b32 a51, v8
    v_accvgpr_read_b32 v5, a52
    v_mul_f32 v5, v5, v4
    v_accvgpr_write_b32 a52, v5
    v_accvgpr_read_b32 v6, a53
    v_mul_f32 v6, v6, v4
    v_accvgpr_write_b32 a53, v6
    v_accvgpr_read_b32 v7, a54
    v_mul_f32 v7, v7, v4
    v_accvgpr_write_b32 a54, v7
    v_accvgpr_read_b32 v8, a55
    v_mul_f32 v8, v8, v4
    v_accvgpr_write_b32 a55, v8
    v_accvgpr_read_b32 v5, a56
    v_mul_f32 v5, v5, v4
    v_accvgpr_write_b32 a56, v5
    v_accvgpr_read_b32 v6, a57
    v_mul_f32 v6, v6, v4
    v_accvgpr_write_b32 a57, v6
    v_accvgpr_read_b32 v7, a58
    v_mul_f32 v7, v7, v4
    v_accvgpr_write_b32 a58, v7
    v_accvgpr_read_b32 v8, a59
    v_mul_f32 v8, v8, v4
    v_accvgpr_write_b32 a59, v8
    v_accvgpr_read_b32 v5, a60
    v_mul_f32 v5, v5, v4
    v_accvgpr_write_b32 a60, v5
    v_accvgpr_read_b32 v6, a61
    v_mul_f32 v6, v6, v4
    v_accvgpr_write_b32 a61, v6
    v_accvgpr_read_b32 v7, a62
    v_mul_f32 v7, v7, v4
    v_accvgpr_write_b32 a62, v7
    v_accvgpr_read_b32 v8, a63
    v_mul_f32 v8, v8, v4
    v_accvgpr_write_b32 a63, v8
    v_accvgpr_read_b32 v5, a64
    v_mul_f32 v5, v5, v4
    v_accvgpr_write_b32 a64, v5
    v_accvgpr_read_b32 v6, a65
    v_mul_f32 v6, v6, v4
    v_accvgpr_write_b32 a65, v6
    v_accvgpr_read_b32 v7, a66
    v_mul_f32 v7, v7, v4
    v_accvgpr_write_b32 a66, v7
    v_accvgpr_read_b32 v8, a67
    v_mul_f32 v8, v8, v4
    v_accvgpr_write_b32 a67, v8
    v_accvgpr_read_b32 v5, a68
    v_mul_f32 v5, v5, v4
    v_accvgpr_write_b32 a68, v5
    v_accvgpr_read_b32 v6, a69
    v_mul_f32 v6, v6, v4
    v_accvgpr_write_b32 a69, v6
    v_accvgpr_read_b32 v7, a70
    v_mul_f32 v7, v7, v4
    v_accvgpr_write_b32 a70, v7
    v_accvgpr_read_b32 v8, a71
    v_mul_f32 v8, v8, v4
    v_accvgpr_write_b32 a71, v8
    v_accvgpr_read_b32 v5, a72
    v_mul_f32 v5, v5, v4
    v_accvgpr_write_b32 a72, v5
    v_accvgpr_read_b32 v6, a73
    v_mul_f32 v6, v6, v4
    v_accvgpr_write_b32 a73, v6
    v_accvgpr_read_b32 v7, a74
    v_mul_f32 v7, v7, v4
    v_accvgpr_write_b32 a74, v7
    v_accvgpr_read_b32 v8, a75
    v_mul_f32 v8, v8, v4
    v_accvgpr_write_b32 a75, v8
    v_accvgpr_read_b32 v5, a76
    v_mul_f32 v5, v5, v4
    v_accvgpr_write_b32 a76, v5
    v_accvgpr_read_b32 v6, a77
    v_mul_f32 v6, v6, v4
    v_accvgpr_write_b32 a77, v6
    v_accvgpr_read_b32 v7, a78
    v_mul_f32 v7, v7, v4
    v_accvgpr_write_b32 a78, v7
    v_accvgpr_read_b32 v8, a79
    v_mul_f32 v8, v8, v4
    v_accvgpr_write_b32 a79, v8
    v_accvgpr_read_b32 v5, a80
    v_mul_f32 v5, v5, v4
    v_accvgpr_write_b32 a80, v5
    v_accvgpr_read_b32 v6, a81
    v_mul_f32 v6, v6, v4
    v_accvgpr_write_b32 a81, v6
    v_accvgpr_read_b32 v7, a82
    v_mul_f32 v7, v7, v4
    v_accvgpr_write_b32 a82, v7
    v_accvgpr_read_b32 v8, a83
    v_mul_f32 v8, v8, v4
    v_accvgpr_write_b32 a83, v8
    v_accvgpr_read_b32 v5, a84
    v_mul_f32 v5, v5, v4
    v_accvgpr_write_b32 a84, v5
    v_accvgpr_read_b32 v6, a85
    v_mul_f32 v6, v6, v4
    v_accvgpr_write_b32 a85, v6
    v_accvgpr_read_b32 v7, a86
    v_mul_f32 v7, v7, v4
    v_accvgpr_write_b32 a86, v7
    v_accvgpr_read_b32 v8, a87
    v_mul_f32 v8, v8, v4
    v_accvgpr_write_b32 a87, v8
    v_accvgpr_read_b32 v5, a88
    v_mul_f32 v5, v5, v4
    v_accvgpr_write_b32 a88, v5
    v_accvgpr_read_b32 v6, a89
    v_mul_f32 v6, v6, v4
    v_accvgpr_write_b32 a89, v6
    v_accvgpr_read_b32 v7, a90
    v_mul_f32 v7, v7, v4
    v_accvgpr_write_b32 a90, v7
    v_accvgpr_read_b32 v8, a91
    v_mul_f32 v8, v8, v4
    v_accvgpr_write_b32 a91, v8
    v_accvgpr_read_b32 v5, a92
    v_mul_f32 v5, v5, v4
    v_accvgpr_write_b32 a92, v5
    v_accvgpr_read_b32 v6, a93
    v_mul_f32 v6, v6, v4
    v_accvgpr_write_b32 a93, v6
    v_accvgpr_read_b32 v7, a94
    v_mul_f32 v7, v7, v4
    v_accvgpr_write_b32 a94, v7
    v_accvgpr_read_b32 v8, a95
    v_mul_f32 v8, v8, v4
    v_accvgpr_write_b32 a95, v8
    v_accvgpr_read_b32 v5, a96
    v_mul_f32 v5, v5, v4
    v_accvgpr_write_b32 a96, v5
    v_accvgpr_read_b32 v6, a97
    v_mul_f32 v6, v6, v4
    v_accvgpr_write_b32 a97, v6
    v_accvgpr_read_b32 v7, a98
    v_mul_f32 v7, v7, v4
    v_accvgpr_write_b32 a98, v7
    v_accvgpr_read_b32 v8, a99
    v_mul_f32 v8, v8, v4
    v_accvgpr_write_b32 a99, v8
    v_accvgpr_read_b32 v5, a100
    v_mul_f32 v5, v5, v4
    v_accvgpr_write_b32 a100, v5
    v_accvgpr_read_b32 v6, a101
    v_mul_f32 v6, v6, v4
    v_accvgpr_write_b32 a101, v6
    v_accvgpr_read_b32 v7, a102
    v_mul_f32 v7, v7, v4
    v_accvgpr_write_b32 a102, v7
    v_accvgpr_read_b32 v8, a103
    v_mul_f32 v8, v8, v4
    v_accvgpr_write_b32 a103, v8
    v_accvgpr_read_b32 v5, a104
    v_mul_f32 v5, v5, v4
    v_accvgpr_write_b32 a104, v5
    v_accvgpr_read_b32 v6, a105
    v_mul_f32 v6, v6, v4
    v_accvgpr_write_b32 a105, v6
    v_accvgpr_read_b32 v7, a106
    v_mul_f32 v7, v7, v4
    v_accvgpr_write_b32 a106, v7
    v_accvgpr_read_b32 v8, a107
    v_mul_f32 v8, v8, v4
    v_accvgpr_write_b32 a107, v8
    v_accvgpr_read_b32 v5, a108
    v_mul_f32 v5, v5, v4
    v_accvgpr_write_b32 a108, v5
    v_accvgpr_read_b32 v6, a109
    v_mul_f32 v6, v6, v4
    v_accvgpr_write_b32 a109, v6
    v_accvgpr_read_b32 v7, a110
    v_mul_f32 v7, v7, v4
    v_accvgpr_write_b32 a110, v7
    v_accvgpr_read_b32 v8, a111
    v_mul_f32 v8, v8, v4
    v_accvgpr_write_b32 a111, v8
    v_accvgpr_read_b32 v5, a112
    v_mul_f32 v5, v5, v4
    v_accvgpr_write_b32 a112, v5
    v_accvgpr_read_b32 v6, a113
    v_mul_f32 v6, v6, v4
    v_accvgpr_write_b32 a113, v6
    v_accvgpr_read_b32 v7, a114
    v_mul_f32 v7, v7, v4
    v_accvgpr_write_b32 a114, v7
    v_accvgpr_read_b32 v8, a115
    v_mul_f32 v8, v8, v4
    v_accvgpr_write_b32 a115, v8
    v_accvgpr_read_b32 v5, a116
    v_mul_f32 v5, v5, v4
    v_accvgpr_write_b32 a116, v5
    v_accvgpr_read_b32 v6, a117
    v_mul_f32 v6, v6, v4
    v_accvgpr_write_b32 a117, v6
    v_accvgpr_read_b32 v7, a118
    v_mul_f32 v7, v7, v4
    v_accvgpr_write_b32 a118, v7
    v_accvgpr_read_b32 v8, a119
    v_mul_f32 v8, v8, v4
    v_accvgpr_write_b32 a119, v8
    v_accvgpr_read_b32 v5, a120
    v_mul_f32 v5, v5, v4
    v_accvgpr_write_b32 a120, v5
    v_accvgpr_read_b32 v6, a121
    v_mul_f32 v6, v6, v4
    v_accvgpr_write_b32 a121, v6
    v_accvgpr_read_b32 v7, a122
    v_mul_f32 v7, v7, v4
    v_accvgpr_write_b32 a122, v7
    v_accvgpr_read_b32 v8, a123
    v_mul_f32 v8, v8, v4
    v_accvgpr_write_b32 a123, v8
    v_accvgpr_read_b32 v5, a124
    v_mul_f32 v5, v5, v4
    v_accvgpr_write_b32 a124, v5
    v_accvgpr_read_b32 v6, a125
    v_mul_f32 v6, v6, v4
    v_accvgpr_write_b32 a125, v6
    v_accvgpr_read_b32 v7, a126
    v_mul_f32 v7, v7, v4
    v_accvgpr_write_b32 a126, v7
    v_accvgpr_read_b32 v8, a127
    v_mul_f32 v8, v8, v4
    v_accvgpr_write_b32 a127, v8
    s_nop 1
    s_branch LRB_94
LRS_95:
    v_max_f32 v3, v32, v2
    v_sub_f32 v4, v32, v3
    v_exp_f32 v4, v4
    v_mov_b32 v32, v3
    s_nop 0
    v_mul_f32 v33, v33, v4
    s_nop 15
    v_accvgpr_read_b32 v5, a0
    v_mul_f32 v5, v5, v4
    v_accvgpr_write_b32 a0, v5
    v_accvgpr_read_b32 v6, a1
    v_mul_f32 v6, v6, v4
    v_accvgpr_write_b32 a1, v6
    v_accvgpr_read_b32 v7, a2
    v_mul_f32 v7, v7, v4
    v_accvgpr_write_b32 a2, v7
    v_accvgpr_read_b32 v8, a3
    v_mul_f32 v8, v8, v4
    v_accvgpr_write_b32 a3, v8
    v_accvgpr_read_b32 v5, a4
    v_mul_f32 v5, v5, v4
    v_accvgpr_write_b32 a4, v5
    v_accvgpr_read_b32 v6, a5
    v_mul_f32 v6, v6, v4
    v_accvgpr_write_b32 a5, v6
    v_accvgpr_read_b32 v7, a6
    v_mul_f32 v7, v7, v4
    v_accvgpr_write_b32 a6, v7
    v_accvgpr_read_b32 v8, a7
    v_mul_f32 v8, v8, v4
    v_accvgpr_write_b32 a7, v8
    v_accvgpr_read_b32 v5, a8
    v_mul_f32 v5, v5, v4
    v_accvgpr_write_b32 a8, v5
    v_accvgpr_read_b32 v6, a9
    v_mul_f32 v6, v6, v4
    v_accvgpr_write_b32 a9, v6
    v_accvgpr_read_b32 v7, a10
    v_mul_f32 v7, v7, v4
    v_accvgpr_write_b32 a10, v7
    v_accvgpr_read_b32 v8, a11
    v_mul_f32 v8, v8, v4
    v_accvgpr_write_b32 a11, v8
    v_accvgpr_read_b32 v5, a12
    v_mul_f32 v5, v5, v4
    v_accvgpr_write_b32 a12, v5
    v_accvgpr_read_b32 v6, a13
    v_mul_f32 v6, v6, v4
    v_accvgpr_write_b32 a13, v6
    v_accvgpr_read_b32 v7, a14
    v_mul_f32 v7, v7, v4
    v_accvgpr_write_b32 a14, v7
    v_accvgpr_read_b32 v8, a15
    v_mul_f32 v8, v8, v4
    v_accvgpr_write_b32 a15, v8
    v_accvgpr_read_b32 v5, a16
    v_mul_f32 v5, v5, v4
    v_accvgpr_write_b32 a16, v5
    v_accvgpr_read_b32 v6, a17
    v_mul_f32 v6, v6, v4
    v_accvgpr_write_b32 a17, v6
    v_accvgpr_read_b32 v7, a18
    v_mul_f32 v7, v7, v4
    v_accvgpr_write_b32 a18, v7
    v_accvgpr_read_b32 v8, a19
    v_mul_f32 v8, v8, v4
    v_accvgpr_write_b32 a19, v8
    v_accvgpr_read_b32 v5, a20
    v_mul_f32 v5, v5, v4
    v_accvgpr_write_b32 a20, v5
    v_accvgpr_read_b32 v6, a21
    v_mul_f32 v6, v6, v4
    v_accvgpr_write_b32 a21, v6
    v_accvgpr_read_b32 v7, a22
    v_mul_f32 v7, v7, v4
    v_accvgpr_write_b32 a22, v7
    v_accvgpr_read_b32 v8, a23
    v_mul_f32 v8, v8, v4
    v_accvgpr_write_b32 a23, v8
    v_accvgpr_read_b32 v5, a24
    v_mul_f32 v5, v5, v4
    v_accvgpr_write_b32 a24, v5
    v_accvgpr_read_b32 v6, a25
    v_mul_f32 v6, v6, v4
    v_accvgpr_write_b32 a25, v6
    v_accvgpr_read_b32 v7, a26
    v_mul_f32 v7, v7, v4
    v_accvgpr_write_b32 a26, v7
    v_accvgpr_read_b32 v8, a27
    v_mul_f32 v8, v8, v4
    v_accvgpr_write_b32 a27, v8
    v_accvgpr_read_b32 v5, a28
    v_mul_f32 v5, v5, v4
    v_accvgpr_write_b32 a28, v5
    v_accvgpr_read_b32 v6, a29
    v_mul_f32 v6, v6, v4
    v_accvgpr_write_b32 a29, v6
    v_accvgpr_read_b32 v7, a30
    v_mul_f32 v7, v7, v4
    v_accvgpr_write_b32 a30, v7
    v_accvgpr_read_b32 v8, a31
    v_mul_f32 v8, v8, v4
    v_accvgpr_write_b32 a31, v8
    v_accvgpr_read_b32 v5, a32
    v_mul_f32 v5, v5, v4
    v_accvgpr_write_b32 a32, v5
    v_accvgpr_read_b32 v6, a33
    v_mul_f32 v6, v6, v4
    v_accvgpr_write_b32 a33, v6
    v_accvgpr_read_b32 v7, a34
    v_mul_f32 v7, v7, v4
    v_accvgpr_write_b32 a34, v7
    v_accvgpr_read_b32 v8, a35
    v_mul_f32 v8, v8, v4
    v_accvgpr_write_b32 a35, v8
    v_accvgpr_read_b32 v5, a36
    v_mul_f32 v5, v5, v4
    v_accvgpr_write_b32 a36, v5
    v_accvgpr_read_b32 v6, a37
    v_mul_f32 v6, v6, v4
    v_accvgpr_write_b32 a37, v6
    v_accvgpr_read_b32 v7, a38
    v_mul_f32 v7, v7, v4
    v_accvgpr_write_b32 a38, v7
    v_accvgpr_read_b32 v8, a39
    v_mul_f32 v8, v8, v4
    v_accvgpr_write_b32 a39, v8
    v_accvgpr_read_b32 v5, a40
    v_mul_f32 v5, v5, v4
    v_accvgpr_write_b32 a40, v5
    v_accvgpr_read_b32 v6, a41
    v_mul_f32 v6, v6, v4
    v_accvgpr_write_b32 a41, v6
    v_accvgpr_read_b32 v7, a42
    v_mul_f32 v7, v7, v4
    v_accvgpr_write_b32 a42, v7
    v_accvgpr_read_b32 v8, a43
    v_mul_f32 v8, v8, v4
    v_accvgpr_write_b32 a43, v8
    v_accvgpr_read_b32 v5, a44
    v_mul_f32 v5, v5, v4
    v_accvgpr_write_b32 a44, v5
    v_accvgpr_read_b32 v6, a45
    v_mul_f32 v6, v6, v4
    v_accvgpr_write_b32 a45, v6
    v_accvgpr_read_b32 v7, a46
    v_mul_f32 v7, v7, v4
    v_accvgpr_write_b32 a46, v7
    v_accvgpr_read_b32 v8, a47
    v_mul_f32 v8, v8, v4
    v_accvgpr_write_b32 a47, v8
    v_accvgpr_read_b32 v5, a48
    v_mul_f32 v5, v5, v4
    v_accvgpr_write_b32 a48, v5
    v_accvgpr_read_b32 v6, a49
    v_mul_f32 v6, v6, v4
    v_accvgpr_write_b32 a49, v6
    v_accvgpr_read_b32 v7, a50
    v_mul_f32 v7, v7, v4
    v_accvgpr_write_b32 a50, v7
    v_accvgpr_read_b32 v8, a51
    v_mul_f32 v8, v8, v4
    v_accvgpr_write_b32 a51, v8
    v_accvgpr_read_b32 v5, a52
    v_mul_f32 v5, v5, v4
    v_accvgpr_write_b32 a52, v5
    v_accvgpr_read_b32 v6, a53
    v_mul_f32 v6, v6, v4
    v_accvgpr_write_b32 a53, v6
    v_accvgpr_read_b32 v7, a54
    v_mul_f32 v7, v7, v4
    v_accvgpr_write_b32 a54, v7
    v_accvgpr_read_b32 v8, a55
    v_mul_f32 v8, v8, v4
    v_accvgpr_write_b32 a55, v8
    v_accvgpr_read_b32 v5, a56
    v_mul_f32 v5, v5, v4
    v_accvgpr_write_b32 a56, v5
    v_accvgpr_read_b32 v6, a57
    v_mul_f32 v6, v6, v4
    v_accvgpr_write_b32 a57, v6
    v_accvgpr_read_b32 v7, a58
    v_mul_f32 v7, v7, v4
    v_accvgpr_write_b32 a58, v7
    v_accvgpr_read_b32 v8, a59
    v_mul_f32 v8, v8, v4
    v_accvgpr_write_b32 a59, v8
    v_accvgpr_read_b32 v5, a60
    v_mul_f32 v5, v5, v4
    v_accvgpr_write_b32 a60, v5
    v_accvgpr_read_b32 v6, a61
    v_mul_f32 v6, v6, v4
    v_accvgpr_write_b32 a61, v6
    v_accvgpr_read_b32 v7, a62
    v_mul_f32 v7, v7, v4
    v_accvgpr_write_b32 a62, v7
    v_accvgpr_read_b32 v8, a63
    v_mul_f32 v8, v8, v4
    v_accvgpr_write_b32 a63, v8
    v_accvgpr_read_b32 v5, a64
    v_mul_f32 v5, v5, v4
    v_accvgpr_write_b32 a64, v5
    v_accvgpr_read_b32 v6, a65
    v_mul_f32 v6, v6, v4
    v_accvgpr_write_b32 a65, v6
    v_accvgpr_read_b32 v7, a66
    v_mul_f32 v7, v7, v4
    v_accvgpr_write_b32 a66, v7
    v_accvgpr_read_b32 v8, a67
    v_mul_f32 v8, v8, v4
    v_accvgpr_write_b32 a67, v8
    v_accvgpr_read_b32 v5, a68
    v_mul_f32 v5, v5, v4
    v_accvgpr_write_b32 a68, v5
    v_accvgpr_read_b32 v6, a69
    v_mul_f32 v6, v6, v4
    v_accvgpr_write_b32 a69, v6
    v_accvgpr_read_b32 v7, a70
    v_mul_f32 v7, v7, v4
    v_accvgpr_write_b32 a70, v7
    v_accvgpr_read_b32 v8, a71
    v_mul_f32 v8, v8, v4
    v_accvgpr_write_b32 a71, v8
    v_accvgpr_read_b32 v5, a72
    v_mul_f32 v5, v5, v4
    v_accvgpr_write_b32 a72, v5
    v_accvgpr_read_b32 v6, a73
    v_mul_f32 v6, v6, v4
    v_accvgpr_write_b32 a73, v6
    v_accvgpr_read_b32 v7, a74
    v_mul_f32 v7, v7, v4
    v_accvgpr_write_b32 a74, v7
    v_accvgpr_read_b32 v8, a75
    v_mul_f32 v8, v8, v4
    v_accvgpr_write_b32 a75, v8
    v_accvgpr_read_b32 v5, a76
    v_mul_f32 v5, v5, v4
    v_accvgpr_write_b32 a76, v5
    v_accvgpr_read_b32 v6, a77
    v_mul_f32 v6, v6, v4
    v_accvgpr_write_b32 a77, v6
    v_accvgpr_read_b32 v7, a78
    v_mul_f32 v7, v7, v4
    v_accvgpr_write_b32 a78, v7
    v_accvgpr_read_b32 v8, a79
    v_mul_f32 v8, v8, v4
    v_accvgpr_write_b32 a79, v8
    v_accvgpr_read_b32 v5, a80
    v_mul_f32 v5, v5, v4
    v_accvgpr_write_b32 a80, v5
    v_accvgpr_read_b32 v6, a81
    v_mul_f32 v6, v6, v4
    v_accvgpr_write_b32 a81, v6
    v_accvgpr_read_b32 v7, a82
    v_mul_f32 v7, v7, v4
    v_accvgpr_write_b32 a82, v7
    v_accvgpr_read_b32 v8, a83
    v_mul_f32 v8, v8, v4
    v_accvgpr_write_b32 a83, v8
    v_accvgpr_read_b32 v5, a84
    v_mul_f32 v5, v5, v4
    v_accvgpr_write_b32 a84, v5
    v_accvgpr_read_b32 v6, a85
    v_mul_f32 v6, v6, v4
    v_accvgpr_write_b32 a85, v6
    v_accvgpr_read_b32 v7, a86
    v_mul_f32 v7, v7, v4
    v_accvgpr_write_b32 a86, v7
    v_accvgpr_read_b32 v8, a87
    v_mul_f32 v8, v8, v4
    v_accvgpr_write_b32 a87, v8
    v_accvgpr_read_b32 v5, a88
    v_mul_f32 v5, v5, v4
    v_accvgpr_write_b32 a88, v5
    v_accvgpr_read_b32 v6, a89
    v_mul_f32 v6, v6, v4
    v_accvgpr_write_b32 a89, v6
    v_accvgpr_read_b32 v7, a90
    v_mul_f32 v7, v7, v4
    v_accvgpr_write_b32 a90, v7
    v_accvgpr_read_b32 v8, a91
    v_mul_f32 v8, v8, v4
    v_accvgpr_write_b32 a91, v8
    v_accvgpr_read_b32 v5, a92
    v_mul_f32 v5, v5, v4
    v_accvgpr_write_b32 a92, v5
    v_accvgpr_read_b32 v6, a93
    v_mul_f32 v6, v6, v4
    v_accvgpr_write_b32 a93, v6
    v_accvgpr_read_b32 v7, a94
    v_mul_f32 v7, v7, v4
    v_accvgpr_write_b32 a94, v7
    v_accvgpr_read_b32 v8, a95
    v_mul_f32 v8, v8, v4
    v_accvgpr_write_b32 a95, v8
    v_accvgpr_read_b32 v5, a96
    v_mul_f32 v5, v5, v4
    v_accvgpr_write_b32 a96, v5
    v_accvgpr_read_b32 v6, a97
    v_mul_f32 v6, v6, v4
    v_accvgpr_write_b32 a97, v6
    v_accvgpr_read_b32 v7, a98
    v_mul_f32 v7, v7, v4
    v_accvgpr_write_b32 a98, v7
    v_accvgpr_read_b32 v8, a99
    v_mul_f32 v8, v8, v4
    v_accvgpr_write_b32 a99, v8
    v_accvgpr_read_b32 v5, a100
    v_mul_f32 v5, v5, v4
    v_accvgpr_write_b32 a100, v5
    v_accvgpr_read_b32 v6, a101
    v_mul_f32 v6, v6, v4
    v_accvgpr_write_b32 a101, v6
    v_accvgpr_read_b32 v7, a102
    v_mul_f32 v7, v7, v4
    v_accvgpr_write_b32 a102, v7
    v_accvgpr_read_b32 v8, a103
    v_mul_f32 v8, v8, v4
    v_accvgpr_write_b32 a103, v8
    v_accvgpr_read_b32 v5, a104
    v_mul_f32 v5, v5, v4
    v_accvgpr_write_b32 a104, v5
    v_accvgpr_read_b32 v6, a105
    v_mul_f32 v6, v6, v4
    v_accvgpr_write_b32 a105, v6
    v_accvgpr_read_b32 v7, a106
    v_mul_f32 v7, v7, v4
    v_accvgpr_write_b32 a106, v7
    v_accvgpr_read_b32 v8, a107
    v_mul_f32 v8, v8, v4
    v_accvgpr_write_b32 a107, v8
    v_accvgpr_read_b32 v5, a108
    v_mul_f32 v5, v5, v4
    v_accvgpr_write_b32 a108, v5
    v_accvgpr_read_b32 v6, a109
    v_mul_f32 v6, v6, v4
    v_accvgpr_write_b32 a109, v6
    v_accvgpr_read_b32 v7, a110
    v_mul_f32 v7, v7, v4
    v_accvgpr_write_b32 a110, v7
    v_accvgpr_read_b32 v8, a111
    v_mul_f32 v8, v8, v4
    v_accvgpr_write_b32 a111, v8
    v_accvgpr_read_b32 v5, a112
    v_mul_f32 v5, v5, v4
    v_accvgpr_write_b32 a112, v5
    v_accvgpr_read_b32 v6, a113
    v_mul_f32 v6, v6, v4
    v_accvgpr_write_b32 a113, v6
    v_accvgpr_read_b32 v7, a114
    v_mul_f32 v7, v7, v4
    v_accvgpr_write_b32 a114, v7
    v_accvgpr_read_b32 v8, a115
    v_mul_f32 v8, v8, v4
    v_accvgpr_write_b32 a115, v8
    v_accvgpr_read_b32 v5, a116
    v_mul_f32 v5, v5, v4
    v_accvgpr_write_b32 a116, v5
    v_accvgpr_read_b32 v6, a117
    v_mul_f32 v6, v6, v4
    v_accvgpr_write_b32 a117, v6
    v_accvgpr_read_b32 v7, a118
    v_mul_f32 v7, v7, v4
    v_accvgpr_write_b32 a118, v7
    v_accvgpr_read_b32 v8, a119
    v_mul_f32 v8, v8, v4
    v_accvgpr_write_b32 a119, v8
    v_accvgpr_read_b32 v5, a120
    v_mul_f32 v5, v5, v4
    v_accvgpr_write_b32 a120, v5
    v_accvgpr_read_b32 v6, a121
    v_mul_f32 v6, v6, v4
    v_accvgpr_write_b32 a121, v6
    v_accvgpr_read_b32 v7, a122
    v_mul_f32 v7, v7, v4
    v_accvgpr_write_b32 a122, v7
    v_accvgpr_read_b32 v8, a123
    v_mul_f32 v8, v8, v4
    v_accvgpr_write_b32 a123, v8
    v_accvgpr_read_b32 v5, a124
    v_mul_f32 v5, v5, v4
    v_accvgpr_write_b32 a124, v5
    v_accvgpr_read_b32 v6, a125
    v_mul_f32 v6, v6, v4
    v_accvgpr_write_b32 a125, v6
    v_accvgpr_read_b32 v7, a126
    v_mul_f32 v7, v7, v4
    v_accvgpr_write_b32 a126, v7
    v_accvgpr_read_b32 v8, a127
    v_mul_f32 v8, v8, v4
    v_accvgpr_write_b32 a127, v8
    s_nop 1
    s_branch LRB_96
LRS_97:
    v_max_f32 v3, v34, v2
    v_sub_f32 v4, v34, v3
    v_exp_f32 v4, v4
    v_mov_b32 v34, v3
    s_nop 0
    v_mul_f32 v35, v35, v4
    s_nop 15
    v_accvgpr_read_b32 v5, a128
    v_mul_f32 v5, v5, v4
    v_accvgpr_write_b32 a128, v5
    v_accvgpr_read_b32 v6, a129
    v_mul_f32 v6, v6, v4
    v_accvgpr_write_b32 a129, v6
    v_accvgpr_read_b32 v7, a130
    v_mul_f32 v7, v7, v4
    v_accvgpr_write_b32 a130, v7
    v_accvgpr_read_b32 v8, a131
    v_mul_f32 v8, v8, v4
    v_accvgpr_write_b32 a131, v8
    v_accvgpr_read_b32 v5, a132
    v_mul_f32 v5, v5, v4
    v_accvgpr_write_b32 a132, v5
    v_accvgpr_read_b32 v6, a133
    v_mul_f32 v6, v6, v4
    v_accvgpr_write_b32 a133, v6
    v_accvgpr_read_b32 v7, a134
    v_mul_f32 v7, v7, v4
    v_accvgpr_write_b32 a134, v7
    v_accvgpr_read_b32 v8, a135
    v_mul_f32 v8, v8, v4
    v_accvgpr_write_b32 a135, v8
    v_accvgpr_read_b32 v5, a136
    v_mul_f32 v5, v5, v4
    v_accvgpr_write_b32 a136, v5
    v_accvgpr_read_b32 v6, a137
    v_mul_f32 v6, v6, v4
    v_accvgpr_write_b32 a137, v6
    v_accvgpr_read_b32 v7, a138
    v_mul_f32 v7, v7, v4
    v_accvgpr_write_b32 a138, v7
    v_accvgpr_read_b32 v8, a139
    v_mul_f32 v8, v8, v4
    v_accvgpr_write_b32 a139, v8
    v_accvgpr_read_b32 v5, a140
    v_mul_f32 v5, v5, v4
    v_accvgpr_write_b32 a140, v5
    v_accvgpr_read_b32 v6, a141
    v_mul_f32 v6, v6, v4
    v_accvgpr_write_b32 a141, v6
    v_accvgpr_read_b32 v7, a142
    v_mul_f32 v7, v7, v4
    v_accvgpr_write_b32 a142, v7
    v_accvgpr_read_b32 v8, a143
    v_mul_f32 v8, v8, v4
    v_accvgpr_write_b32 a143, v8
    v_accvgpr_read_b32 v5, a144
    v_mul_f32 v5, v5, v4
    v_accvgpr_write_b32 a144, v5
    v_accvgpr_read_b32 v6, a145
    v_mul_f32 v6, v6, v4
    v_accvgpr_write_b32 a145, v6
    v_accvgpr_read_b32 v7, a146
    v_mul_f32 v7, v7, v4
    v_accvgpr_write_b32 a146, v7
    v_accvgpr_read_b32 v8, a147
    v_mul_f32 v8, v8, v4
    v_accvgpr_write_b32 a147, v8
    v_accvgpr_read_b32 v5, a148
    v_mul_f32 v5, v5, v4
    v_accvgpr_write_b32 a148, v5
    v_accvgpr_read_b32 v6, a149
    v_mul_f32 v6, v6, v4
    v_accvgpr_write_b32 a149, v6
    v_accvgpr_read_b32 v7, a150
    v_mul_f32 v7, v7, v4
    v_accvgpr_write_b32 a150, v7
    v_accvgpr_read_b32 v8, a151
    v_mul_f32 v8, v8, v4
    v_accvgpr_write_b32 a151, v8
    v_accvgpr_read_b32 v5, a152
    v_mul_f32 v5, v5, v4
    v_accvgpr_write_b32 a152, v5
    v_accvgpr_read_b32 v6, a153
    v_mul_f32 v6, v6, v4
    v_accvgpr_write_b32 a153, v6
    v_accvgpr_read_b32 v7, a154
    v_mul_f32 v7, v7, v4
    v_accvgpr_write_b32 a154, v7
    v_accvgpr_read_b32 v8, a155
    v_mul_f32 v8, v8, v4
    v_accvgpr_write_b32 a155, v8
    v_accvgpr_read_b32 v5, a156
    v_mul_f32 v5, v5, v4
    v_accvgpr_write_b32 a156, v5
    v_accvgpr_read_b32 v6, a157
    v_mul_f32 v6, v6, v4
    v_accvgpr_write_b32 a157, v6
    v_accvgpr_read_b32 v7, a158
    v_mul_f32 v7, v7, v4
    v_accvgpr_write_b32 a158, v7
    v_accvgpr_read_b32 v8, a159
    v_mul_f32 v8, v8, v4
    v_accvgpr_write_b32 a159, v8
    v_accvgpr_read_b32 v5, a160
    v_mul_f32 v5, v5, v4
    v_accvgpr_write_b32 a160, v5
    v_accvgpr_read_b32 v6, a161
    v_mul_f32 v6, v6, v4
    v_accvgpr_write_b32 a161, v6
    v_accvgpr_read_b32 v7, a162
    v_mul_f32 v7, v7, v4
    v_accvgpr_write_b32 a162, v7
    v_accvgpr_read_b32 v8, a163
    v_mul_f32 v8, v8, v4
    v_accvgpr_write_b32 a163, v8
    v_accvgpr_read_b32 v5, a164
    v_mul_f32 v5, v5, v4
    v_accvgpr_write_b32 a164, v5
    v_accvgpr_read_b32 v6, a165
    v_mul_f32 v6, v6, v4
    v_accvgpr_write_b32 a165, v6
    v_accvgpr_read_b32 v7, a166
    v_mul_f32 v7, v7, v4
    v_accvgpr_write_b32 a166, v7
    v_accvgpr_read_b32 v8, a167
    v_mul_f32 v8, v8, v4
    v_accvgpr_write_b32 a167, v8
    v_accvgpr_read_b32 v5, a168
    v_mul_f32 v5, v5, v4
    v_accvgpr_write_b32 a168, v5
    v_accvgpr_read_b32 v6, a169
    v_mul_f32 v6, v6, v4
    v_accvgpr_write_b32 a169, v6
    v_accvgpr_read_b32 v7, a170
    v_mul_f32 v7, v7, v4
    v_accvgpr_write_b32 a170, v7
    v_accvgpr_read_b32 v8, a171
    v_mul_f32 v8, v8, v4
    v_accvgpr_write_b32 a171, v8
    v_accvgpr_read_b32 v5, a172
    v_mul_f32 v5, v5, v4
    v_accvgpr_write_b32 a172, v5
    v_accvgpr_read_b32 v6, a173
    v_mul_f32 v6, v6, v4
    v_accvgpr_write_b32 a173, v6
    v_accvgpr_read_b32 v7, a174
    v_mul_f32 v7, v7, v4
    v_accvgpr_write_b32 a174, v7
    v_accvgpr_read_b32 v8, a175
    v_mul_f32 v8, v8, v4
    v_accvgpr_write_b32 a175, v8
    v_accvgpr_read_b32 v5, a176
    v_mul_f32 v5, v5, v4
    v_accvgpr_write_b32 a176, v5
    v_accvgpr_read_b32 v6, a177
    v_mul_f32 v6, v6, v4
    v_accvgpr_write_b32 a177, v6
    v_accvgpr_read_b32 v7, a178
    v_mul_f32 v7, v7, v4
    v_accvgpr_write_b32 a178, v7
    v_accvgpr_read_b32 v8, a179
    v_mul_f32 v8, v8, v4
    v_accvgpr_write_b32 a179, v8
    v_accvgpr_read_b32 v5, a180
    v_mul_f32 v5, v5, v4
    v_accvgpr_write_b32 a180, v5
    v_accvgpr_read_b32 v6, a181
    v_mul_f32 v6, v6, v4
    v_accvgpr_write_b32 a181, v6
    v_accvgpr_read_b32 v7, a182
    v_mul_f32 v7, v7, v4
    v_accvgpr_write_b32 a182, v7
    v_accvgpr_read_b32 v8, a183
    v_mul_f32 v8, v8, v4
    v_accvgpr_write_b32 a183, v8
    v_accvgpr_read_b32 v5, a184
    v_mul_f32 v5, v5, v4
    v_accvgpr_write_b32 a184, v5
    v_accvgpr_read_b32 v6, a185
    v_mul_f32 v6, v6, v4
    v_accvgpr_write_b32 a185, v6
    v_accvgpr_read_b32 v7, a186
    v_mul_f32 v7, v7, v4
    v_accvgpr_write_b32 a186, v7
    v_accvgpr_read_b32 v8, a187
    v_mul_f32 v8, v8, v4
    v_accvgpr_write_b32 a187, v8
    v_accvgpr_read_b32 v5, a188
    v_mul_f32 v5, v5, v4
    v_accvgpr_write_b32 a188, v5
    v_accvgpr_read_b32 v6, a189
    v_mul_f32 v6, v6, v4
    v_accvgpr_write_b32 a189, v6
    v_accvgpr_read_b32 v7, a190
    v_mul_f32 v7, v7, v4
    v_accvgpr_write_b32 a190, v7
    v_accvgpr_read_b32 v8, a191
    v_mul_f32 v8, v8, v4
    v_accvgpr_write_b32 a191, v8
    v_accvgpr_read_b32 v5, a192
    v_mul_f32 v5, v5, v4
    v_accvgpr_write_b32 a192, v5
    v_accvgpr_read_b32 v6, a193
    v_mul_f32 v6, v6, v4
    v_accvgpr_write_b32 a193, v6
    v_accvgpr_read_b32 v7, a194
    v_mul_f32 v7, v7, v4
    v_accvgpr_write_b32 a194, v7
    v_accvgpr_read_b32 v8, a195
    v_mul_f32 v8, v8, v4
    v_accvgpr_write_b32 a195, v8
    v_accvgpr_read_b32 v5, a196
    v_mul_f32 v5, v5, v4
    v_accvgpr_write_b32 a196, v5
    v_accvgpr_read_b32 v6, a197
    v_mul_f32 v6, v6, v4
    v_accvgpr_write_b32 a197, v6
    v_accvgpr_read_b32 v7, a198
    v_mul_f32 v7, v7, v4
    v_accvgpr_write_b32 a198, v7
    v_accvgpr_read_b32 v8, a199
    v_mul_f32 v8, v8, v4
    v_accvgpr_write_b32 a199, v8
    v_accvgpr_read_b32 v5, a200
    v_mul_f32 v5, v5, v4
    v_accvgpr_write_b32 a200, v5
    v_accvgpr_read_b32 v6, a201
    v_mul_f32 v6, v6, v4
    v_accvgpr_write_b32 a201, v6
    v_accvgpr_read_b32 v7, a202
    v_mul_f32 v7, v7, v4
    v_accvgpr_write_b32 a202, v7
    v_accvgpr_read_b32 v8, a203
    v_mul_f32 v8, v8, v4
    v_accvgpr_write_b32 a203, v8
    v_accvgpr_read_b32 v5, a204
    v_mul_f32 v5, v5, v4
    v_accvgpr_write_b32 a204, v5
    v_accvgpr_read_b32 v6, a205
    v_mul_f32 v6, v6, v4
    v_accvgpr_write_b32 a205, v6
    v_accvgpr_read_b32 v7, a206
    v_mul_f32 v7, v7, v4
    v_accvgpr_write_b32 a206, v7
    v_accvgpr_read_b32 v8, a207
    v_mul_f32 v8, v8, v4
    v_accvgpr_write_b32 a207, v8
    v_accvgpr_read_b32 v5, a208
    v_mul_f32 v5, v5, v4
    v_accvgpr_write_b32 a208, v5
    v_accvgpr_read_b32 v6, a209
    v_mul_f32 v6, v6, v4
    v_accvgpr_write_b32 a209, v6
    v_accvgpr_read_b32 v7, a210
    v_mul_f32 v7, v7, v4
    v_accvgpr_write_b32 a210, v7
    v_accvgpr_read_b32 v8, a211
    v_mul_f32 v8, v8, v4
    v_accvgpr_write_b32 a211, v8
    v_accvgpr_read_b32 v5, a212
    v_mul_f32 v5, v5, v4
    v_accvgpr_write_b32 a212, v5
    v_accvgpr_read_b32 v6, a213
    v_mul_f32 v6, v6, v4
    v_accvgpr_write_b32 a213, v6
    v_accvgpr_read_b32 v7, a214
    v_mul_f32 v7, v7, v4
    v_accvgpr_write_b32 a214, v7
    v_accvgpr_read_b32 v8, a215
    v_mul_f32 v8, v8, v4
    v_accvgpr_write_b32 a215, v8
    v_accvgpr_read_b32 v5, a216
    v_mul_f32 v5, v5, v4
    v_accvgpr_write_b32 a216, v5
    v_accvgpr_read_b32 v6, a217
    v_mul_f32 v6, v6, v4
    v_accvgpr_write_b32 a217, v6
    v_accvgpr_read_b32 v7, a218
    v_mul_f32 v7, v7, v4
    v_accvgpr_write_b32 a218, v7
    v_accvgpr_read_b32 v8, a219
    v_mul_f32 v8, v8, v4
    v_accvgpr_write_b32 a219, v8
    v_accvgpr_read_b32 v5, a220
    v_mul_f32 v5, v5, v4
    v_accvgpr_write_b32 a220, v5
    v_accvgpr_read_b32 v6, a221
    v_mul_f32 v6, v6, v4
    v_accvgpr_write_b32 a221, v6
    v_accvgpr_read_b32 v7, a222
    v_mul_f32 v7, v7, v4
    v_accvgpr_write_b32 a222, v7
    v_accvgpr_read_b32 v8, a223
    v_mul_f32 v8, v8, v4
    v_accvgpr_write_b32 a223, v8
    v_accvgpr_read_b32 v5, a224
    v_mul_f32 v5, v5, v4
    v_accvgpr_write_b32 a224, v5
    v_accvgpr_read_b32 v6, a225
    v_mul_f32 v6, v6, v4
    v_accvgpr_write_b32 a225, v6
    v_accvgpr_read_b32 v7, a226
    v_mul_f32 v7, v7, v4
    v_accvgpr_write_b32 a226, v7
    v_accvgpr_read_b32 v8, a227
    v_mul_f32 v8, v8, v4
    v_accvgpr_write_b32 a227, v8
    v_accvgpr_read_b32 v5, a228
    v_mul_f32 v5, v5, v4
    v_accvgpr_write_b32 a228, v5
    v_accvgpr_read_b32 v6, a229
    v_mul_f32 v6, v6, v4
    v_accvgpr_write_b32 a229, v6
    v_accvgpr_read_b32 v7, a230
    v_mul_f32 v7, v7, v4
    v_accvgpr_write_b32 a230, v7
    v_accvgpr_read_b32 v8, a231
    v_mul_f32 v8, v8, v4
    v_accvgpr_write_b32 a231, v8
    v_accvgpr_read_b32 v5, a232
    v_mul_f32 v5, v5, v4
    v_accvgpr_write_b32 a232, v5
    v_accvgpr_read_b32 v6, a233
    v_mul_f32 v6, v6, v4
    v_accvgpr_write_b32 a233, v6
    v_accvgpr_read_b32 v7, a234
    v_mul_f32 v7, v7, v4
    v_accvgpr_write_b32 a234, v7
    v_accvgpr_read_b32 v8, a235
    v_mul_f32 v8, v8, v4
    v_accvgpr_write_b32 a235, v8
    v_accvgpr_read_b32 v5, a236
    v_mul_f32 v5, v5, v4
    v_accvgpr_write_b32 a236, v5
    v_accvgpr_read_b32 v6, a237
    v_mul_f32 v6, v6, v4
    v_accvgpr_write_b32 a237, v6
    v_accvgpr_read_b32 v7, a238
    v_mul_f32 v7, v7, v4
    v_accvgpr_write_b32 a238, v7
    v_accvgpr_read_b32 v8, a239
    v_mul_f32 v8, v8, v4
    v_accvgpr_write_b32 a239, v8
    v_accvgpr_read_b32 v5, a240
    v_mul_f32 v5, v5, v4
    v_accvgpr_write_b32 a240, v5
    v_accvgpr_read_b32 v6, a241
    v_mul_f32 v6, v6, v4
    v_accvgpr_write_b32 a241, v6
    v_accvgpr_read_b32 v7, a242
    v_mul_f32 v7, v7, v4
    v_accvgpr_write_b32 a242, v7
    v_accvgpr_read_b32 v8, a243
    v_mul_f32 v8, v8, v4
    v_accvgpr_write_b32 a243, v8
    v_accvgpr_read_b32 v5, a244
    v_mul_f32 v5, v5, v4
    v_accvgpr_write_b32 a244, v5
    v_accvgpr_read_b32 v6, a245
    v_mul_f32 v6, v6, v4
    v_accvgpr_write_b32 a245, v6
    v_accvgpr_read_b32 v7, a246
    v_mul_f32 v7, v7, v4
    v_accvgpr_write_b32 a246, v7
    v_accvgpr_read_b32 v8, a247
    v_mul_f32 v8, v8, v4
    v_accvgpr_write_b32 a247, v8
    v_accvgpr_read_b32 v5, a248
    v_mul_f32 v5, v5, v4
    v_accvgpr_write_b32 a248, v5
    v_accvgpr_read_b32 v6, a249
    v_mul_f32 v6, v6, v4
    v_accvgpr_write_b32 a249, v6
    v_accvgpr_read_b32 v7, a250
    v_mul_f32 v7, v7, v4
    v_accvgpr_write_b32 a250, v7
    v_accvgpr_read_b32 v8, a251
    v_mul_f32 v8, v8, v4
    v_accvgpr_write_b32 a251, v8
    v_accvgpr_read_b32 v5, a252
    v_mul_f32 v5, v5, v4
    v_accvgpr_write_b32 a252, v5
    v_accvgpr_read_b32 v6, a253
    v_mul_f32 v6, v6, v4
    v_accvgpr_write_b32 a253, v6
    v_accvgpr_read_b32 v7, a254
    v_mul_f32 v7, v7, v4
    v_accvgpr_write_b32 a254, v7
    v_accvgpr_read_b32 v8, a255
    v_mul_f32 v8, v8, v4
    v_accvgpr_write_b32 a255, v8
    s_nop 1
    s_branch LRB_98
LRS_105:
    v_max_f32 v3, v32, v2
    v_sub_f32 v4, v32, v3
    v_exp_f32 v4, v4
    v_mov_b32 v32, v3
    s_nop 0
    v_mul_f32 v33, v33, v4
    s_nop 15
    v_accvgpr_read_b32 v5, a0
    v_mul_f32 v5, v5, v4
    v_accvgpr_write_b32 a0, v5
    v_accvgpr_read_b32 v6, a1
    v_mul_f32 v6, v6, v4
    v_accvgpr_write_b32 a1, v6
    v_accvgpr_read_b32 v7, a2
    v_mul_f32 v7, v7, v4
    v_accvgpr_write_b32 a2, v7
    v_accvgpr_read_b32 v8, a3
    v_mul_f32 v8, v8, v4
    v_accvgpr_write_b32 a3, v8
    v_accvgpr_read_b32 v5, a4
    v_mul_f32 v5, v5, v4
    v_accvgpr_write_b32 a4, v5
    v_accvgpr_read_b32 v6, a5
    v_mul_f32 v6, v6, v4
    v_accvgpr_write_b32 a5, v6
    v_accvgpr_read_b32 v7, a6
    v_mul_f32 v7, v7, v4
    v_accvgpr_write_b32 a6, v7
    v_accvgpr_read_b32 v8, a7
    v_mul_f32 v8, v8, v4
    v_accvgpr_write_b32 a7, v8
    v_accvgpr_read_b32 v5, a8
    v_mul_f32 v5, v5, v4
    v_accvgpr_write_b32 a8, v5
    v_accvgpr_read_b32 v6, a9
    v_mul_f32 v6, v6, v4
    v_accvgpr_write_b32 a9, v6
    v_accvgpr_read_b32 v7, a10
    v_mul_f32 v7, v7, v4
    v_accvgpr_write_b32 a10, v7
    v_accvgpr_read_b32 v8, a11
    v_mul_f32 v8, v8, v4
    v_accvgpr_write_b32 a11, v8
    v_accvgpr_read_b32 v5, a12
    v_mul_f32 v5, v5, v4
    v_accvgpr_write_b32 a12, v5
    v_accvgpr_read_b32 v6, a13
    v_mul_f32 v6, v6, v4
    v_accvgpr_write_b32 a13, v6
    v_accvgpr_read_b32 v7, a14
    v_mul_f32 v7, v7, v4
    v_accvgpr_write_b32 a14, v7
    v_accvgpr_read_b32 v8, a15
    v_mul_f32 v8, v8, v4
    v_accvgpr_write_b32 a15, v8
    v_accvgpr_read_b32 v5, a16
    v_mul_f32 v5, v5, v4
    v_accvgpr_write_b32 a16, v5
    v_accvgpr_read_b32 v6, a17
    v_mul_f32 v6, v6, v4
    v_accvgpr_write_b32 a17, v6
    v_accvgpr_read_b32 v7, a18
    v_mul_f32 v7, v7, v4
    v_accvgpr_write_b32 a18, v7
    v_accvgpr_read_b32 v8, a19
    v_mul_f32 v8, v8, v4
    v_accvgpr_write_b32 a19, v8
    v_accvgpr_read_b32 v5, a20
    v_mul_f32 v5, v5, v4
    v_accvgpr_write_b32 a20, v5
    v_accvgpr_read_b32 v6, a21
    v_mul_f32 v6, v6, v4
    v_accvgpr_write_b32 a21, v6
    v_accvgpr_read_b32 v7, a22
    v_mul_f32 v7, v7, v4
    v_accvgpr_write_b32 a22, v7
    v_accvgpr_read_b32 v8, a23
    v_mul_f32 v8, v8, v4
    v_accvgpr_write_b32 a23, v8
    v_accvgpr_read_b32 v5, a24
    v_mul_f32 v5, v5, v4
    v_accvgpr_write_b32 a24, v5
    v_accvgpr_read_b32 v6, a25
    v_mul_f32 v6, v6, v4
    v_accvgpr_write_b32 a25, v6
    v_accvgpr_read_b32 v7, a26
    v_mul_f32 v7, v7, v4
    v_accvgpr_write_b32 a26, v7
    v_accvgpr_read_b32 v8, a27
    v_mul_f32 v8, v8, v4
    v_accvgpr_write_b32 a27, v8
    v_accvgpr_read_b32 v5, a28
    v_mul_f32 v5, v5, v4
    v_accvgpr_write_b32 a28, v5
    v_accvgpr_read_b32 v6, a29
    v_mul_f32 v6, v6, v4
    v_accvgpr_write_b32 a29, v6
    v_accvgpr_read_b32 v7, a30
    v_mul_f32 v7, v7, v4
    v_accvgpr_write_b32 a30, v7
    v_accvgpr_read_b32 v8, a31
    v_mul_f32 v8, v8, v4
    v_accvgpr_write_b32 a31, v8
    v_accvgpr_read_b32 v5, a32
    v_mul_f32 v5, v5, v4
    v_accvgpr_write_b32 a32, v5
    v_accvgpr_read_b32 v6, a33
    v_mul_f32 v6, v6, v4
    v_accvgpr_write_b32 a33, v6
    v_accvgpr_read_b32 v7, a34
    v_mul_f32 v7, v7, v4
    v_accvgpr_write_b32 a34, v7
    v_accvgpr_read_b32 v8, a35
    v_mul_f32 v8, v8, v4
    v_accvgpr_write_b32 a35, v8
    v_accvgpr_read_b32 v5, a36
    v_mul_f32 v5, v5, v4
    v_accvgpr_write_b32 a36, v5
    v_accvgpr_read_b32 v6, a37
    v_mul_f32 v6, v6, v4
    v_accvgpr_write_b32 a37, v6
    v_accvgpr_read_b32 v7, a38
    v_mul_f32 v7, v7, v4
    v_accvgpr_write_b32 a38, v7
    v_accvgpr_read_b32 v8, a39
    v_mul_f32 v8, v8, v4
    v_accvgpr_write_b32 a39, v8
    v_accvgpr_read_b32 v5, a40
    v_mul_f32 v5, v5, v4
    v_accvgpr_write_b32 a40, v5
    v_accvgpr_read_b32 v6, a41
    v_mul_f32 v6, v6, v4
    v_accvgpr_write_b32 a41, v6
    v_accvgpr_read_b32 v7, a42
    v_mul_f32 v7, v7, v4
    v_accvgpr_write_b32 a42, v7
    v_accvgpr_read_b32 v8, a43
    v_mul_f32 v8, v8, v4
    v_accvgpr_write_b32 a43, v8
    v_accvgpr_read_b32 v5, a44
    v_mul_f32 v5, v5, v4
    v_accvgpr_write_b32 a44, v5
    v_accvgpr_read_b32 v6, a45
    v_mul_f32 v6, v6, v4
    v_accvgpr_write_b32 a45, v6
    v_accvgpr_read_b32 v7, a46
    v_mul_f32 v7, v7, v4
    v_accvgpr_write_b32 a46, v7
    v_accvgpr_read_b32 v8, a47
    v_mul_f32 v8, v8, v4
    v_accvgpr_write_b32 a47, v8
    v_accvgpr_read_b32 v5, a48
    v_mul_f32 v5, v5, v4
    v_accvgpr_write_b32 a48, v5
    v_accvgpr_read_b32 v6, a49
    v_mul_f32 v6, v6, v4
    v_accvgpr_write_b32 a49, v6
    v_accvgpr_read_b32 v7, a50
    v_mul_f32 v7, v7, v4
    v_accvgpr_write_b32 a50, v7
    v_accvgpr_read_b32 v8, a51
    v_mul_f32 v8, v8, v4
    v_accvgpr_write_b32 a51, v8
    v_accvgpr_read_b32 v5, a52
    v_mul_f32 v5, v5, v4
    v_accvgpr_write_b32 a52, v5
    v_accvgpr_read_b32 v6, a53
    v_mul_f32 v6, v6, v4
    v_accvgpr_write_b32 a53, v6
    v_accvgpr_read_b32 v7, a54
    v_mul_f32 v7, v7, v4
    v_accvgpr_write_b32 a54, v7
    v_accvgpr_read_b32 v8, a55
    v_mul_f32 v8, v8, v4
    v_accvgpr_write_b32 a55, v8
    v_accvgpr_read_b32 v5, a56
    v_mul_f32 v5, v5, v4
    v_accvgpr_write_b32 a56, v5
    v_accvgpr_read_b32 v6, a57
    v_mul_f32 v6, v6, v4
    v_accvgpr_write_b32 a57, v6
    v_accvgpr_read_b32 v7, a58
    v_mul_f32 v7, v7, v4
    v_accvgpr_write_b32 a58, v7
    v_accvgpr_read_b32 v8, a59
    v_mul_f32 v8, v8, v4
    v_accvgpr_write_b32 a59, v8
    v_accvgpr_read_b32 v5, a60
    v_mul_f32 v5, v5, v4
    v_accvgpr_write_b32 a60, v5
    v_accvgpr_read_b32 v6, a61
    v_mul_f32 v6, v6, v4
    v_accvgpr_write_b32 a61, v6
    v_accvgpr_read_b32 v7, a62
    v_mul_f32 v7, v7, v4
    v_accvgpr_write_b32 a62, v7
    v_accvgpr_read_b32 v8, a63
    v_mul_f32 v8, v8, v4
    v_accvgpr_write_b32 a63, v8
    v_accvgpr_read_b32 v5, a64
    v_mul_f32 v5, v5, v4
    v_accvgpr_write_b32 a64, v5
    v_accvgpr_read_b32 v6, a65
    v_mul_f32 v6, v6, v4
    v_accvgpr_write_b32 a65, v6
    v_accvgpr_read_b32 v7, a66
    v_mul_f32 v7, v7, v4
    v_accvgpr_write_b32 a66, v7
    v_accvgpr_read_b32 v8, a67
    v_mul_f32 v8, v8, v4
    v_accvgpr_write_b32 a67, v8
    v_accvgpr_read_b32 v5, a68
    v_mul_f32 v5, v5, v4
    v_accvgpr_write_b32 a68, v5
    v_accvgpr_read_b32 v6, a69
    v_mul_f32 v6, v6, v4
    v_accvgpr_write_b32 a69, v6
    v_accvgpr_read_b32 v7, a70
    v_mul_f32 v7, v7, v4
    v_accvgpr_write_b32 a70, v7
    v_accvgpr_read_b32 v8, a71
    v_mul_f32 v8, v8, v4
    v_accvgpr_write_b32 a71, v8
    v_accvgpr_read_b32 v5, a72
    v_mul_f32 v5, v5, v4
    v_accvgpr_write_b32 a72, v5
    v_accvgpr_read_b32 v6, a73
    v_mul_f32 v6, v6, v4
    v_accvgpr_write_b32 a73, v6
    v_accvgpr_read_b32 v7, a74
    v_mul_f32 v7, v7, v4
    v_accvgpr_write_b32 a74, v7
    v_accvgpr_read_b32 v8, a75
    v_mul_f32 v8, v8, v4
    v_accvgpr_write_b32 a75, v8
    v_accvgpr_read_b32 v5, a76
    v_mul_f32 v5, v5, v4
    v_accvgpr_write_b32 a76, v5
    v_accvgpr_read_b32 v6, a77
    v_mul_f32 v6, v6, v4
    v_accvgpr_write_b32 a77, v6
    v_accvgpr_read_b32 v7, a78
    v_mul_f32 v7, v7, v4
    v_accvgpr_write_b32 a78, v7
    v_accvgpr_read_b32 v8, a79
    v_mul_f32 v8, v8, v4
    v_accvgpr_write_b32 a79, v8
    v_accvgpr_read_b32 v5, a80
    v_mul_f32 v5, v5, v4
    v_accvgpr_write_b32 a80, v5
    v_accvgpr_read_b32 v6, a81
    v_mul_f32 v6, v6, v4
    v_accvgpr_write_b32 a81, v6
    v_accvgpr_read_b32 v7, a82
    v_mul_f32 v7, v7, v4
    v_accvgpr_write_b32 a82, v7
    v_accvgpr_read_b32 v8, a83
    v_mul_f32 v8, v8, v4
    v_accvgpr_write_b32 a83, v8
    v_accvgpr_read_b32 v5, a84
    v_mul_f32 v5, v5, v4
    v_accvgpr_write_b32 a84, v5
    v_accvgpr_read_b32 v6, a85
    v_mul_f32 v6, v6, v4
    v_accvgpr_write_b32 a85, v6
    v_accvgpr_read_b32 v7, a86
    v_mul_f32 v7, v7, v4
    v_accvgpr_write_b32 a86, v7
    v_accvgpr_read_b32 v8, a87
    v_mul_f32 v8, v8, v4
    v_accvgpr_write_b32 a87, v8
    v_accvgpr_read_b32 v5, a88
    v_mul_f32 v5, v5, v4
    v_accvgpr_write_b32 a88, v5
    v_accvgpr_read_b32 v6, a89
    v_mul_f32 v6, v6, v4
    v_accvgpr_write_b32 a89, v6
    v_accvgpr_read_b32 v7, a90
    v_mul_f32 v7, v7, v4
    v_accvgpr_write_b32 a90, v7
    v_accvgpr_read_b32 v8, a91
    v_mul_f32 v8, v8, v4
    v_accvgpr_write_b32 a91, v8
    v_accvgpr_read_b32 v5, a92
    v_mul_f32 v5, v5, v4
    v_accvgpr_write_b32 a92, v5
    v_accvgpr_read_b32 v6, a93
    v_mul_f32 v6, v6, v4
    v_accvgpr_write_b32 a93, v6
    v_accvgpr_read_b32 v7, a94
    v_mul_f32 v7, v7, v4
    v_accvgpr_write_b32 a94, v7
    v_accvgpr_read_b32 v8, a95
    v_mul_f32 v8, v8, v4
    v_accvgpr_write_b32 a95, v8
    v_accvgpr_read_b32 v5, a96
    v_mul_f32 v5, v5, v4
    v_accvgpr_write_b32 a96, v5
    v_accvgpr_read_b32 v6, a97
    v_mul_f32 v6, v6, v4
    v_accvgpr_write_b32 a97, v6
    v_accvgpr_read_b32 v7, a98
    v_mul_f32 v7, v7, v4
    v_accvgpr_write_b32 a98, v7
    v_accvgpr_read_b32 v8, a99
    v_mul_f32 v8, v8, v4
    v_accvgpr_write_b32 a99, v8
    v_accvgpr_read_b32 v5, a100
    v_mul_f32 v5, v5, v4
    v_accvgpr_write_b32 a100, v5
    v_accvgpr_read_b32 v6, a101
    v_mul_f32 v6, v6, v4
    v_accvgpr_write_b32 a101, v6
    v_accvgpr_read_b32 v7, a102
    v_mul_f32 v7, v7, v4
    v_accvgpr_write_b32 a102, v7
    v_accvgpr_read_b32 v8, a103
    v_mul_f32 v8, v8, v4
    v_accvgpr_write_b32 a103, v8
    v_accvgpr_read_b32 v5, a104
    v_mul_f32 v5, v5, v4
    v_accvgpr_write_b32 a104, v5
    v_accvgpr_read_b32 v6, a105
    v_mul_f32 v6, v6, v4
    v_accvgpr_write_b32 a105, v6
    v_accvgpr_read_b32 v7, a106
    v_mul_f32 v7, v7, v4
    v_accvgpr_write_b32 a106, v7
    v_accvgpr_read_b32 v8, a107
    v_mul_f32 v8, v8, v4
    v_accvgpr_write_b32 a107, v8
    v_accvgpr_read_b32 v5, a108
    v_mul_f32 v5, v5, v4
    v_accvgpr_write_b32 a108, v5
    v_accvgpr_read_b32 v6, a109
    v_mul_f32 v6, v6, v4
    v_accvgpr_write_b32 a109, v6
    v_accvgpr_read_b32 v7, a110
    v_mul_f32 v7, v7, v4
    v_accvgpr_write_b32 a110, v7
    v_accvgpr_read_b32 v8, a111
    v_mul_f32 v8, v8, v4
    v_accvgpr_write_b32 a111, v8
    v_accvgpr_read_b32 v5, a112
    v_mul_f32 v5, v5, v4
    v_accvgpr_write_b32 a112, v5
    v_accvgpr_read_b32 v6, a113
    v_mul_f32 v6, v6, v4
    v_accvgpr_write_b32 a113, v6
    v_accvgpr_read_b32 v7, a114
    v_mul_f32 v7, v7, v4
    v_accvgpr_write_b32 a114, v7
    v_accvgpr_read_b32 v8, a115
    v_mul_f32 v8, v8, v4
    v_accvgpr_write_b32 a115, v8
    v_accvgpr_read_b32 v5, a116
    v_mul_f32 v5, v5, v4
    v_accvgpr_write_b32 a116, v5
    v_accvgpr_read_b32 v6, a117
    v_mul_f32 v6, v6, v4
    v_accvgpr_write_b32 a117, v6
    v_accvgpr_read_b32 v7, a118
    v_mul_f32 v7, v7, v4
    v_accvgpr_write_b32 a118, v7
    v_accvgpr_read_b32 v8, a119
    v_mul_f32 v8, v8, v4
    v_accvgpr_write_b32 a119, v8
    v_accvgpr_read_b32 v5, a120
    v_mul_f32 v5, v5, v4
    v_accvgpr_write_b32 a120, v5
    v_accvgpr_read_b32 v6, a121
    v_mul_f32 v6, v6, v4
    v_accvgpr_write_b32 a121, v6
    v_accvgpr_read_b32 v7, a122
    v_mul_f32 v7, v7, v4
    v_accvgpr_write_b32 a122, v7
    v_accvgpr_read_b32 v8, a123
    v_mul_f32 v8, v8, v4
    v_accvgpr_write_b32 a123, v8
    v_accvgpr_read_b32 v5, a124
    v_mul_f32 v5, v5, v4
    v_accvgpr_write_b32 a124, v5
    v_accvgpr_read_b32 v6, a125
    v_mul_f32 v6, v6, v4
    v_accvgpr_write_b32 a125, v6
    v_accvgpr_read_b32 v7, a126
    v_mul_f32 v7, v7, v4
    v_accvgpr_write_b32 a126, v7
    v_accvgpr_read_b32 v8, a127
    v_mul_f32 v8, v8, v4
    v_accvgpr_write_b32 a127, v8
    s_nop 1
    s_branch LRB_106
LRS_107:
    v_max_f32 v3, v32, v2
    v_sub_f32 v4, v32, v3
    v_exp_f32 v4, v4
    v_mov_b32 v32, v3
    s_nop 0
    v_mul_f32 v33, v33, v4
    s_nop 15
    v_accvgpr_read_b32 v5, a0
    v_mul_f32 v5, v5, v4
    v_accvgpr_write_b32 a0, v5
    v_accvgpr_read_b32 v6, a1
    v_mul_f32 v6, v6, v4
    v_accvgpr_write_b32 a1, v6
    v_accvgpr_read_b32 v7, a2
    v_mul_f32 v7, v7, v4
    v_accvgpr_write_b32 a2, v7
    v_accvgpr_read_b32 v8, a3
    v_mul_f32 v8, v8, v4
    v_accvgpr_write_b32 a3, v8
    v_accvgpr_read_b32 v5, a4
    v_mul_f32 v5, v5, v4
    v_accvgpr_write_b32 a4, v5
    v_accvgpr_read_b32 v6, a5
    v_mul_f32 v6, v6, v4
    v_accvgpr_write_b32 a5, v6
    v_accvgpr_read_b32 v7, a6
    v_mul_f32 v7, v7, v4
    v_accvgpr_write_b32 a6, v7
    v_accvgpr_read_b32 v8, a7
    v_mul_f32 v8, v8, v4
    v_accvgpr_write_b32 a7, v8
    v_accvgpr_read_b32 v5, a8
    v_mul_f32 v5, v5, v4
    v_accvgpr_write_b32 a8, v5
    v_accvgpr_read_b32 v6, a9
    v_mul_f32 v6, v6, v4
    v_accvgpr_write_b32 a9, v6
    v_accvgpr_read_b32 v7, a10
    v_mul_f32 v7, v7, v4
    v_accvgpr_write_b32 a10, v7
    v_accvgpr_read_b32 v8, a11
    v_mul_f32 v8, v8, v4
    v_accvgpr_write_b32 a11, v8
    v_accvgpr_read_b32 v5, a12
    v_mul_f32 v5, v5, v4
    v_accvgpr_write_b32 a12, v5
    v_accvgpr_read_b32 v6, a13
    v_mul_f32 v6, v6, v4
    v_accvgpr_write_b32 a13, v6
    v_accvgpr_read_b32 v7, a14
    v_mul_f32 v7, v7, v4
    v_accvgpr_write_b32 a14, v7
    v_accvgpr_read_b32 v8, a15
    v_mul_f32 v8, v8, v4
    v_accvgpr_write_b32 a15, v8
    v_accvgpr_read_b32 v5, a16
    v_mul_f32 v5, v5, v4
    v_accvgpr_write_b32 a16, v5
    v_accvgpr_read_b32 v6, a17
    v_mul_f32 v6, v6, v4
    v_accvgpr_write_b32 a17, v6
    v_accvgpr_read_b32 v7, a18
    v_mul_f32 v7, v7, v4
    v_accvgpr_write_b32 a18, v7
    v_accvgpr_read_b32 v8, a19
    v_mul_f32 v8, v8, v4
    v_accvgpr_write_b32 a19, v8
    v_accvgpr_read_b32 v5, a20
    v_mul_f32 v5, v5, v4
    v_accvgpr_write_b32 a20, v5
    v_accvgpr_read_b32 v6, a21
    v_mul_f32 v6, v6, v4
    v_accvgpr_write_b32 a21, v6
    v_accvgpr_read_b32 v7, a22
    v_mul_f32 v7, v7, v4
    v_accvgpr_write_b32 a22, v7
    v_accvgpr_read_b32 v8, a23
    v_mul_f32 v8, v8, v4
    v_accvgpr_write_b32 a23, v8
    v_accvgpr_read_b32 v5, a24
    v_mul_f32 v5, v5, v4
    v_accvgpr_write_b32 a24, v5
    v_accvgpr_read_b32 v6, a25
    v_mul_f32 v6, v6, v4
    v_accvgpr_write_b32 a25, v6
    v_accvgpr_read_b32 v7, a26
    v_mul_f32 v7, v7, v4
    v_accvgpr_write_b32 a26, v7
    v_accvgpr_read_b32 v8, a27
    v_mul_f32 v8, v8, v4
    v_accvgpr_write_b32 a27, v8
    v_accvgpr_read_b32 v5, a28
    v_mul_f32 v5, v5, v4
    v_accvgpr_write_b32 a28, v5
    v_accvgpr_read_b32 v6, a29
    v_mul_f32 v6, v6, v4
    v_accvgpr_write_b32 a29, v6
    v_accvgpr_read_b32 v7, a30
    v_mul_f32 v7, v7, v4
    v_accvgpr_write_b32 a30, v7
    v_accvgpr_read_b32 v8, a31
    v_mul_f32 v8, v8, v4
    v_accvgpr_write_b32 a31, v8
    v_accvgpr_read_b32 v5, a32
    v_mul_f32 v5, v5, v4
    v_accvgpr_write_b32 a32, v5
    v_accvgpr_read_b32 v6, a33
    v_mul_f32 v6, v6, v4
    v_accvgpr_write_b32 a33, v6
    v_accvgpr_read_b32 v7, a34
    v_mul_f32 v7, v7, v4
    v_accvgpr_write_b32 a34, v7
    v_accvgpr_read_b32 v8, a35
    v_mul_f32 v8, v8, v4
    v_accvgpr_write_b32 a35, v8
    v_accvgpr_read_b32 v5, a36
    v_mul_f32 v5, v5, v4
    v_accvgpr_write_b32 a36, v5
    v_accvgpr_read_b32 v6, a37
    v_mul_f32 v6, v6, v4
    v_accvgpr_write_b32 a37, v6
    v_accvgpr_read_b32 v7, a38
    v_mul_f32 v7, v7, v4
    v_accvgpr_write_b32 a38, v7
    v_accvgpr_read_b32 v8, a39
    v_mul_f32 v8, v8, v4
    v_accvgpr_write_b32 a39, v8
    v_accvgpr_read_b32 v5, a40
    v_mul_f32 v5, v5, v4
    v_accvgpr_write_b32 a40, v5
    v_accvgpr_read_b32 v6, a41
    v_mul_f32 v6, v6, v4
    v_accvgpr_write_b32 a41, v6
    v_accvgpr_read_b32 v7, a42
    v_mul_f32 v7, v7, v4
    v_accvgpr_write_b32 a42, v7
    v_accvgpr_read_b32 v8, a43
    v_mul_f32 v8, v8, v4
    v_accvgpr_write_b32 a43, v8
    v_accvgpr_read_b32 v5, a44
    v_mul_f32 v5, v5, v4
    v_accvgpr_write_b32 a44, v5
    v_accvgpr_read_b32 v6, a45
    v_mul_f32 v6, v6, v4
    v_accvgpr_write_b32 a45, v6
    v_accvgpr_read_b32 v7, a46
    v_mul_f32 v7, v7, v4
    v_accvgpr_write_b32 a46, v7
    v_accvgpr_read_b32 v8, a47
    v_mul_f32 v8, v8, v4
    v_accvgpr_write_b32 a47, v8
    v_accvgpr_read_b32 v5, a48
    v_mul_f32 v5, v5, v4
    v_accvgpr_write_b32 a48, v5
    v_accvgpr_read_b32 v6, a49
    v_mul_f32 v6, v6, v4
    v_accvgpr_write_b32 a49, v6
    v_accvgpr_read_b32 v7, a50
    v_mul_f32 v7, v7, v4
    v_accvgpr_write_b32 a50, v7
    v_accvgpr_read_b32 v8, a51
    v_mul_f32 v8, v8, v4
    v_accvgpr_write_b32 a51, v8
    v_accvgpr_read_b32 v5, a52
    v_mul_f32 v5, v5, v4
    v_accvgpr_write_b32 a52, v5
    v_accvgpr_read_b32 v6, a53
    v_mul_f32 v6, v6, v4
    v_accvgpr_write_b32 a53, v6
    v_accvgpr_read_b32 v7, a54
    v_mul_f32 v7, v7, v4
    v_accvgpr_write_b32 a54, v7
    v_accvgpr_read_b32 v8, a55
    v_mul_f32 v8, v8, v4
    v_accvgpr_write_b32 a55, v8
    v_accvgpr_read_b32 v5, a56
    v_mul_f32 v5, v5, v4
    v_accvgpr_write_b32 a56, v5
    v_accvgpr_read_b32 v6, a57
    v_mul_f32 v6, v6, v4
    v_accvgpr_write_b32 a57, v6
    v_accvgpr_read_b32 v7, a58
    v_mul_f32 v7, v7, v4
    v_accvgpr_write_b32 a58, v7
    v_accvgpr_read_b32 v8, a59
    v_mul_f32 v8, v8, v4
    v_accvgpr_write_b32 a59, v8
    v_accvgpr_read_b32 v5, a60
    v_mul_f32 v5, v5, v4
    v_accvgpr_write_b32 a60, v5
    v_accvgpr_read_b32 v6, a61
    v_mul_f32 v6, v6, v4
    v_accvgpr_write_b32 a61, v6
    v_accvgpr_read_b32 v7, a62
    v_mul_f32 v7, v7, v4
    v_accvgpr_write_b32 a62, v7
    v_accvgpr_read_b32 v8, a63
    v_mul_f32 v8, v8, v4
    v_accvgpr_write_b32 a63, v8
    v_accvgpr_read_b32 v5, a64
    v_mul_f32 v5, v5, v4
    v_accvgpr_write_b32 a64, v5
    v_accvgpr_read_b32 v6, a65
    v_mul_f32 v6, v6, v4
    v_accvgpr_write_b32 a65, v6
    v_accvgpr_read_b32 v7, a66
    v_mul_f32 v7, v7, v4
    v_accvgpr_write_b32 a66, v7
    v_accvgpr_read_b32 v8, a67
    v_mul_f32 v8, v8, v4
    v_accvgpr_write_b32 a67, v8
    v_accvgpr_read_b32 v5, a68
    v_mul_f32 v5, v5, v4
    v_accvgpr_write_b32 a68, v5
    v_accvgpr_read_b32 v6, a69
    v_mul_f32 v6, v6, v4
    v_accvgpr_write_b32 a69, v6
    v_accvgpr_read_b32 v7, a70
    v_mul_f32 v7, v7, v4
    v_accvgpr_write_b32 a70, v7
    v_accvgpr_read_b32 v8, a71
    v_mul_f32 v8, v8, v4
    v_accvgpr_write_b32 a71, v8
    v_accvgpr_read_b32 v5, a72
    v_mul_f32 v5, v5, v4
    v_accvgpr_write_b32 a72, v5
    v_accvgpr_read_b32 v6, a73
    v_mul_f32 v6, v6, v4
    v_accvgpr_write_b32 a73, v6
    v_accvgpr_read_b32 v7, a74
    v_mul_f32 v7, v7, v4
    v_accvgpr_write_b32 a74, v7
    v_accvgpr_read_b32 v8, a75
    v_mul_f32 v8, v8, v4
    v_accvgpr_write_b32 a75, v8
    v_accvgpr_read_b32 v5, a76
    v_mul_f32 v5, v5, v4
    v_accvgpr_write_b32 a76, v5
    v_accvgpr_read_b32 v6, a77
    v_mul_f32 v6, v6, v4
    v_accvgpr_write_b32 a77, v6
    v_accvgpr_read_b32 v7, a78
    v_mul_f32 v7, v7, v4
    v_accvgpr_write_b32 a78, v7
    v_accvgpr_read_b32 v8, a79
    v_mul_f32 v8, v8, v4
    v_accvgpr_write_b32 a79, v8
    v_accvgpr_read_b32 v5, a80
    v_mul_f32 v5, v5, v4
    v_accvgpr_write_b32 a80, v5
    v_accvgpr_read_b32 v6, a81
    v_mul_f32 v6, v6, v4
    v_accvgpr_write_b32 a81, v6
    v_accvgpr_read_b32 v7, a82
    v_mul_f32 v7, v7, v4
    v_accvgpr_write_b32 a82, v7
    v_accvgpr_read_b32 v8, a83
    v_mul_f32 v8, v8, v4
    v_accvgpr_write_b32 a83, v8
    v_accvgpr_read_b32 v5, a84
    v_mul_f32 v5, v5, v4
    v_accvgpr_write_b32 a84, v5
    v_accvgpr_read_b32 v6, a85
    v_mul_f32 v6, v6, v4
    v_accvgpr_write_b32 a85, v6
    v_accvgpr_read_b32 v7, a86
    v_mul_f32 v7, v7, v4
    v_accvgpr_write_b32 a86, v7
    v_accvgpr_read_b32 v8, a87
    v_mul_f32 v8, v8, v4
    v_accvgpr_write_b32 a87, v8
    v_accvgpr_read_b32 v5, a88
    v_mul_f32 v5, v5, v4
    v_accvgpr_write_b32 a88, v5
    v_accvgpr_read_b32 v6, a89
    v_mul_f32 v6, v6, v4
    v_accvgpr_write_b32 a89, v6
    v_accvgpr_read_b32 v7, a90
    v_mul_f32 v7, v7, v4
    v_accvgpr_write_b32 a90, v7
    v_accvgpr_read_b32 v8, a91
    v_mul_f32 v8, v8, v4
    v_accvgpr_write_b32 a91, v8
    v_accvgpr_read_b32 v5, a92
    v_mul_f32 v5, v5, v4
    v_accvgpr_write_b32 a92, v5
    v_accvgpr_read_b32 v6, a93
    v_mul_f32 v6, v6, v4
    v_accvgpr_write_b32 a93, v6
    v_accvgpr_read_b32 v7, a94
    v_mul_f32 v7, v7, v4
    v_accvgpr_write_b32 a94, v7
    v_accvgpr_read_b32 v8, a95
    v_mul_f32 v8, v8, v4
    v_accvgpr_write_b32 a95, v8
    v_accvgpr_read_b32 v5, a96
    v_mul_f32 v5, v5, v4
    v_accvgpr_write_b32 a96, v5
    v_accvgpr_read_b32 v6, a97
    v_mul_f32 v6, v6, v4
    v_accvgpr_write_b32 a97, v6
    v_accvgpr_read_b32 v7, a98
    v_mul_f32 v7, v7, v4
    v_accvgpr_write_b32 a98, v7
    v_accvgpr_read_b32 v8, a99
    v_mul_f32 v8, v8, v4
    v_accvgpr_write_b32 a99, v8
    v_accvgpr_read_b32 v5, a100
    v_mul_f32 v5, v5, v4
    v_accvgpr_write_b32 a100, v5
    v_accvgpr_read_b32 v6, a101
    v_mul_f32 v6, v6, v4
    v_accvgpr_write_b32 a101, v6
    v_accvgpr_read_b32 v7, a102
    v_mul_f32 v7, v7, v4
    v_accvgpr_write_b32 a102, v7
    v_accvgpr_read_b32 v8, a103
    v_mul_f32 v8, v8, v4
    v_accvgpr_write_b32 a103, v8
    v_accvgpr_read_b32 v5, a104
    v_mul_f32 v5, v5, v4
    v_accvgpr_write_b32 a104, v5
    v_accvgpr_read_b32 v6, a105
    v_mul_f32 v6, v6, v4
    v_accvgpr_write_b32 a105, v6
    v_accvgpr_read_b32 v7, a106
    v_mul_f32 v7, v7, v4
    v_accvgpr_write_b32 a106, v7
    v_accvgpr_read_b32 v8, a107
    v_mul_f32 v8, v8, v4
    v_accvgpr_write_b32 a107, v8
    v_accvgpr_read_b32 v5, a108
    v_mul_f32 v5, v5, v4
    v_accvgpr_write_b32 a108, v5
    v_accvgpr_read_b32 v6, a109
    v_mul_f32 v6, v6, v4
    v_accvgpr_write_b32 a109, v6
    v_accvgpr_read_b32 v7, a110
    v_mul_f32 v7, v7, v4
    v_accvgpr_write_b32 a110, v7
    v_accvgpr_read_b32 v8, a111
    v_mul_f32 v8, v8, v4
    v_accvgpr_write_b32 a111, v8
    v_accvgpr_read_b32 v5, a112
    v_mul_f32 v5, v5, v4
    v_accvgpr_write_b32 a112, v5
    v_accvgpr_read_b32 v6, a113
    v_mul_f32 v6, v6, v4
    v_accvgpr_write_b32 a113, v6
    v_accvgpr_read_b32 v7, a114
    v_mul_f32 v7, v7, v4
    v_accvgpr_write_b32 a114, v7
    v_accvgpr_read_b32 v8, a115
    v_mul_f32 v8, v8, v4
    v_accvgpr_write_b32 a115, v8
    v_accvgpr_read_b32 v5, a116
    v_mul_f32 v5, v5, v4
    v_accvgpr_write_b32 a116, v5
    v_accvgpr_read_b32 v6, a117
    v_mul_f32 v6, v6, v4
    v_accvgpr_write_b32 a117, v6
    v_accvgpr_read_b32 v7, a118
    v_mul_f32 v7, v7, v4
    v_accvgpr_write_b32 a118, v7
    v_accvgpr_read_b32 v8, a119
    v_mul_f32 v8, v8, v4
    v_accvgpr_write_b32 a119, v8
    v_accvgpr_read_b32 v5, a120
    v_mul_f32 v5, v5, v4
    v_accvgpr_write_b32 a120, v5
    v_accvgpr_read_b32 v6, a121
    v_mul_f32 v6, v6, v4
    v_accvgpr_write_b32 a121, v6
    v_accvgpr_read_b32 v7, a122
    v_mul_f32 v7, v7, v4
    v_accvgpr_write_b32 a122, v7
    v_accvgpr_read_b32 v8, a123
    v_mul_f32 v8, v8, v4
    v_accvgpr_write_b32 a123, v8
    v_accvgpr_read_b32 v5, a124
    v_mul_f32 v5, v5, v4
    v_accvgpr_write_b32 a124, v5
    v_accvgpr_read_b32 v6, a125
    v_mul_f32 v6, v6, v4
    v_accvgpr_write_b32 a125, v6
    v_accvgpr_read_b32 v7, a126
    v_mul_f32 v7, v7, v4
    v_accvgpr_write_b32 a126, v7
    v_accvgpr_read_b32 v8, a127
    v_mul_f32 v8, v8, v4
    v_accvgpr_write_b32 a127, v8
    s_nop 1
    s_branch LRB_108
LRS_109:
    v_max_f32 v3, v34, v2
    v_sub_f32 v4, v34, v3
    v_exp_f32 v4, v4
    v_mov_b32 v34, v3
    s_nop 0
    v_mul_f32 v35, v35, v4
    s_nop 15
    v_accvgpr_read_b32 v5, a128
    v_mul_f32 v5, v5, v4
    v_accvgpr_write_b32 a128, v5
    v_accvgpr_read_b32 v6, a129
    v_mul_f32 v6, v6, v4
    v_accvgpr_write_b32 a129, v6
    v_accvgpr_read_b32 v7, a130
    v_mul_f32 v7, v7, v4
    v_accvgpr_write_b32 a130, v7
    v_accvgpr_read_b32 v8, a131
    v_mul_f32 v8, v8, v4
    v_accvgpr_write_b32 a131, v8
    v_accvgpr_read_b32 v5, a132
    v_mul_f32 v5, v5, v4
    v_accvgpr_write_b32 a132, v5
    v_accvgpr_read_b32 v6, a133
    v_mul_f32 v6, v6, v4
    v_accvgpr_write_b32 a133, v6
    v_accvgpr_read_b32 v7, a134
    v_mul_f32 v7, v7, v4
    v_accvgpr_write_b32 a134, v7
    v_accvgpr_read_b32 v8, a135
    v_mul_f32 v8, v8, v4
    v_accvgpr_write_b32 a135, v8
    v_accvgpr_read_b32 v5, a136
    v_mul_f32 v5, v5, v4
    v_accvgpr_write_b32 a136, v5
    v_accvgpr_read_b32 v6, a137
    v_mul_f32 v6, v6, v4
    v_accvgpr_write_b32 a137, v6
    v_accvgpr_read_b32 v7, a138
    v_mul_f32 v7, v7, v4
    v_accvgpr_write_b32 a138, v7
    v_accvgpr_read_b32 v8, a139
    v_mul_f32 v8, v8, v4
    v_accvgpr_write_b32 a139, v8
    v_accvgpr_read_b32 v5, a140
    v_mul_f32 v5, v5, v4
    v_accvgpr_write_b32 a140, v5
    v_accvgpr_read_b32 v6, a141
    v_mul_f32 v6, v6, v4
    v_accvgpr_write_b32 a141, v6
    v_accvgpr_read_b32 v7, a142
    v_mul_f32 v7, v7, v4
    v_accvgpr_write_b32 a142, v7
    v_accvgpr_read_b32 v8, a143
    v_mul_f32 v8, v8, v4
    v_accvgpr_write_b32 a143, v8
    v_accvgpr_read_b32 v5, a144
    v_mul_f32 v5, v5, v4
    v_accvgpr_write_b32 a144, v5
    v_accvgpr_read_b32 v6, a145
    v_mul_f32 v6, v6, v4
    v_accvgpr_write_b32 a145, v6
    v_accvgpr_read_b32 v7, a146
    v_mul_f32 v7, v7, v4
    v_accvgpr_write_b32 a146, v7
    v_accvgpr_read_b32 v8, a147
    v_mul_f32 v8, v8, v4
    v_accvgpr_write_b32 a147, v8
    v_accvgpr_read_b32 v5, a148
    v_mul_f32 v5, v5, v4
    v_accvgpr_write_b32 a148, v5
    v_accvgpr_read_b32 v6, a149
    v_mul_f32 v6, v6, v4
    v_accvgpr_write_b32 a149, v6
    v_accvgpr_read_b32 v7, a150
    v_mul_f32 v7, v7, v4
    v_accvgpr_write_b32 a150, v7
    v_accvgpr_read_b32 v8, a151
    v_mul_f32 v8, v8, v4
    v_accvgpr_write_b32 a151, v8
    v_accvgpr_read_b32 v5, a152
    v_mul_f32 v5, v5, v4
    v_accvgpr_write_b32 a152, v5
    v_accvgpr_read_b32 v6, a153
    v_mul_f32 v6, v6, v4
    v_accvgpr_write_b32 a153, v6
    v_accvgpr_read_b32 v7, a154
    v_mul_f32 v7, v7, v4
    v_accvgpr_write_b32 a154, v7
    v_accvgpr_read_b32 v8, a155
    v_mul_f32 v8, v8, v4
    v_accvgpr_write_b32 a155, v8
    v_accvgpr_read_b32 v5, a156
    v_mul_f32 v5, v5, v4
    v_accvgpr_write_b32 a156, v5
    v_accvgpr_read_b32 v6, a157
    v_mul_f32 v6, v6, v4
    v_accvgpr_write_b32 a157, v6
    v_accvgpr_read_b32 v7, a158
    v_mul_f32 v7, v7, v4
    v_accvgpr_write_b32 a158, v7
    v_accvgpr_read_b32 v8, a159
    v_mul_f32 v8, v8, v4
    v_accvgpr_write_b32 a159, v8
    v_accvgpr_read_b32 v5, a160
    v_mul_f32 v5, v5, v4
    v_accvgpr_write_b32 a160, v5
    v_accvgpr_read_b32 v6, a161
    v_mul_f32 v6, v6, v4
    v_accvgpr_write_b32 a161, v6
    v_accvgpr_read_b32 v7, a162
    v_mul_f32 v7, v7, v4
    v_accvgpr_write_b32 a162, v7
    v_accvgpr_read_b32 v8, a163
    v_mul_f32 v8, v8, v4
    v_accvgpr_write_b32 a163, v8
    v_accvgpr_read_b32 v5, a164
    v_mul_f32 v5, v5, v4
    v_accvgpr_write_b32 a164, v5
    v_accvgpr_read_b32 v6, a165
    v_mul_f32 v6, v6, v4
    v_accvgpr_write_b32 a165, v6
    v_accvgpr_read_b32 v7, a166
    v_mul_f32 v7, v7, v4
    v_accvgpr_write_b32 a166, v7
    v_accvgpr_read_b32 v8, a167
    v_mul_f32 v8, v8, v4
    v_accvgpr_write_b32 a167, v8
    v_accvgpr_read_b32 v5, a168
    v_mul_f32 v5, v5, v4
    v_accvgpr_write_b32 a168, v5
    v_accvgpr_read_b32 v6, a169
    v_mul_f32 v6, v6, v4
    v_accvgpr_write_b32 a169, v6
    v_accvgpr_read_b32 v7, a170
    v_mul_f32 v7, v7, v4
    v_accvgpr_write_b32 a170, v7
    v_accvgpr_read_b32 v8, a171
    v_mul_f32 v8, v8, v4
    v_accvgpr_write_b32 a171, v8
    v_accvgpr_read_b32 v5, a172
    v_mul_f32 v5, v5, v4
    v_accvgpr_write_b32 a172, v5
    v_accvgpr_read_b32 v6, a173
    v_mul_f32 v6, v6, v4
    v_accvgpr_write_b32 a173, v6
    v_accvgpr_read_b32 v7, a174
    v_mul_f32 v7, v7, v4
    v_accvgpr_write_b32 a174, v7
    v_accvgpr_read_b32 v8, a175
    v_mul_f32 v8, v8, v4
    v_accvgpr_write_b32 a175, v8
    v_accvgpr_read_b32 v5, a176
    v_mul_f32 v5, v5, v4
    v_accvgpr_write_b32 a176, v5
    v_accvgpr_read_b32 v6, a177
    v_mul_f32 v6, v6, v4
    v_accvgpr_write_b32 a177, v6
    v_accvgpr_read_b32 v7, a178
    v_mul_f32 v7, v7, v4
    v_accvgpr_write_b32 a178, v7
    v_accvgpr_read_b32 v8, a179
    v_mul_f32 v8, v8, v4
    v_accvgpr_write_b32 a179, v8
    v_accvgpr_read_b32 v5, a180
    v_mul_f32 v5, v5, v4
    v_accvgpr_write_b32 a180, v5
    v_accvgpr_read_b32 v6, a181
    v_mul_f32 v6, v6, v4
    v_accvgpr_write_b32 a181, v6
    v_accvgpr_read_b32 v7, a182
    v_mul_f32 v7, v7, v4
    v_accvgpr_write_b32 a182, v7
    v_accvgpr_read_b32 v8, a183
    v_mul_f32 v8, v8, v4
    v_accvgpr_write_b32 a183, v8
    v_accvgpr_read_b32 v5, a184
    v_mul_f32 v5, v5, v4
    v_accvgpr_write_b32 a184, v5
    v_accvgpr_read_b32 v6, a185
    v_mul_f32 v6, v6, v4
    v_accvgpr_write_b32 a185, v6
    v_accvgpr_read_b32 v7, a186
    v_mul_f32 v7, v7, v4
    v_accvgpr_write_b32 a186, v7
    v_accvgpr_read_b32 v8, a187
    v_mul_f32 v8, v8, v4
    v_accvgpr_write_b32 a187, v8
    v_accvgpr_read_b32 v5, a188
    v_mul_f32 v5, v5, v4
    v_accvgpr_write_b32 a188, v5
    v_accvgpr_read_b32 v6, a189
    v_mul_f32 v6, v6, v4
    v_accvgpr_write_b32 a189, v6
    v_accvgpr_read_b32 v7, a190
    v_mul_f32 v7, v7, v4
    v_accvgpr_write_b32 a190, v7
    v_accvgpr_read_b32 v8, a191
    v_mul_f32 v8, v8, v4
    v_accvgpr_write_b32 a191, v8
    v_accvgpr_read_b32 v5, a192
    v_mul_f32 v5, v5, v4
    v_accvgpr_write_b32 a192, v5
    v_accvgpr_read_b32 v6, a193
    v_mul_f32 v6, v6, v4
    v_accvgpr_write_b32 a193, v6
    v_accvgpr_read_b32 v7, a194
    v_mul_f32 v7, v7, v4
    v_accvgpr_write_b32 a194, v7
    v_accvgpr_read_b32 v8, a195
    v_mul_f32 v8, v8, v4
    v_accvgpr_write_b32 a195, v8
    v_accvgpr_read_b32 v5, a196
    v_mul_f32 v5, v5, v4
    v_accvgpr_write_b32 a196, v5
    v_accvgpr_read_b32 v6, a197
    v_mul_f32 v6, v6, v4
    v_accvgpr_write_b32 a197, v6
    v_accvgpr_read_b32 v7, a198
    v_mul_f32 v7, v7, v4
    v_accvgpr_write_b32 a198, v7
    v_accvgpr_read_b32 v8, a199
    v_mul_f32 v8, v8, v4
    v_accvgpr_write_b32 a199, v8
    v_accvgpr_read_b32 v5, a200
    v_mul_f32 v5, v5, v4
    v_accvgpr_write_b32 a200, v5
    v_accvgpr_read_b32 v6, a201
    v_mul_f32 v6, v6, v4
    v_accvgpr_write_b32 a201, v6
    v_accvgpr_read_b32 v7, a202
    v_mul_f32 v7, v7, v4
    v_accvgpr_write_b32 a202, v7
    v_accvgpr_read_b32 v8, a203
    v_mul_f32 v8, v8, v4
    v_accvgpr_write_b32 a203, v8
    v_accvgpr_read_b32 v5, a204
    v_mul_f32 v5, v5, v4
    v_accvgpr_write_b32 a204, v5
    v_accvgpr_read_b32 v6, a205
    v_mul_f32 v6, v6, v4
    v_accvgpr_write_b32 a205, v6
    v_accvgpr_read_b32 v7, a206
    v_mul_f32 v7, v7, v4
    v_accvgpr_write_b32 a206, v7
    v_accvgpr_read_b32 v8, a207
    v_mul_f32 v8, v8, v4
    v_accvgpr_write_b32 a207, v8
    v_accvgpr_read_b32 v5, a208
    v_mul_f32 v5, v5, v4
    v_accvgpr_write_b32 a208, v5
    v_accvgpr_read_b32 v6, a209
    v_mul_f32 v6, v6, v4
    v_accvgpr_write_b32 a209, v6
    v_accvgpr_read_b32 v7, a210
    v_mul_f32 v7, v7, v4
    v_accvgpr_write_b32 a210, v7
    v_accvgpr_read_b32 v8, a211
    v_mul_f32 v8, v8, v4
    v_accvgpr_write_b32 a211, v8
    v_accvgpr_read_b32 v5, a212
    v_mul_f32 v5, v5, v4
    v_accvgpr_write_b32 a212, v5
    v_accvgpr_read_b32 v6, a213
    v_mul_f32 v6, v6, v4
    v_accvgpr_write_b32 a213, v6
    v_accvgpr_read_b32 v7, a214
    v_mul_f32 v7, v7, v4
    v_accvgpr_write_b32 a214, v7
    v_accvgpr_read_b32 v8, a215
    v_mul_f32 v8, v8, v4
    v_accvgpr_write_b32 a215, v8
    v_accvgpr_read_b32 v5, a216
    v_mul_f32 v5, v5, v4
    v_accvgpr_write_b32 a216, v5
    v_accvgpr_read_b32 v6, a217
    v_mul_f32 v6, v6, v4
    v_accvgpr_write_b32 a217, v6
    v_accvgpr_read_b32 v7, a218
    v_mul_f32 v7, v7, v4
    v_accvgpr_write_b32 a218, v7
    v_accvgpr_read_b32 v8, a219
    v_mul_f32 v8, v8, v4
    v_accvgpr_write_b32 a219, v8
    v_accvgpr_read_b32 v5, a220
    v_mul_f32 v5, v5, v4
    v_accvgpr_write_b32 a220, v5
    v_accvgpr_read_b32 v6, a221
    v_mul_f32 v6, v6, v4
    v_accvgpr_write_b32 a221, v6
    v_accvgpr_read_b32 v7, a222
    v_mul_f32 v7, v7, v4
    v_accvgpr_write_b32 a222, v7
    v_accvgpr_read_b32 v8, a223
    v_mul_f32 v8, v8, v4
    v_accvgpr_write_b32 a223, v8
    v_accvgpr_read_b32 v5, a224
    v_mul_f32 v5, v5, v4
    v_accvgpr_write_b32 a224, v5
    v_accvgpr_read_b32 v6, a225
    v_mul_f32 v6, v6, v4
    v_accvgpr_write_b32 a225, v6
    v_accvgpr_read_b32 v7, a226
    v_mul_f32 v7, v7, v4
    v_accvgpr_write_b32 a226, v7
    v_accvgpr_read_b32 v8, a227
    v_mul_f32 v8, v8, v4
    v_accvgpr_write_b32 a227, v8
    v_accvgpr_read_b32 v5, a228
    v_mul_f32 v5, v5, v4
    v_accvgpr_write_b32 a228, v5
    v_accvgpr_read_b32 v6, a229
    v_mul_f32 v6, v6, v4
    v_accvgpr_write_b32 a229, v6
    v_accvgpr_read_b32 v7, a230
    v_mul_f32 v7, v7, v4
    v_accvgpr_write_b32 a230, v7
    v_accvgpr_read_b32 v8, a231
    v_mul_f32 v8, v8, v4
    v_accvgpr_write_b32 a231, v8
    v_accvgpr_read_b32 v5, a232
    v_mul_f32 v5, v5, v4
    v_accvgpr_write_b32 a232, v5
    v_accvgpr_read_b32 v6, a233
    v_mul_f32 v6, v6, v4
    v_accvgpr_write_b32 a233, v6
    v_accvgpr_read_b32 v7, a234
    v_mul_f32 v7, v7, v4
    v_accvgpr_write_b32 a234, v7
    v_accvgpr_read_b32 v8, a235
    v_mul_f32 v8, v8, v4
    v_accvgpr_write_b32 a235, v8
    v_accvgpr_read_b32 v5, a236
    v_mul_f32 v5, v5, v4
    v_accvgpr_write_b32 a236, v5
    v_accvgpr_read_b32 v6, a237
    v_mul_f32 v6, v6, v4
    v_accvgpr_write_b32 a237, v6
    v_accvgpr_read_b32 v7, a238
    v_mul_f32 v7, v7, v4
    v_accvgpr_write_b32 a238, v7
    v_accvgpr_read_b32 v8, a239
    v_mul_f32 v8, v8, v4
    v_accvgpr_write_b32 a239, v8
    v_accvgpr_read_b32 v5, a240
    v_mul_f32 v5, v5, v4
    v_accvgpr_write_b32 a240, v5
    v_accvgpr_read_b32 v6, a241
    v_mul_f32 v6, v6, v4
    v_accvgpr_write_b32 a241, v6
    v_accvgpr_read_b32 v7, a242
    v_mul_f32 v7, v7, v4
    v_accvgpr_write_b32 a242, v7
    v_accvgpr_read_b32 v8, a243
    v_mul_f32 v8, v8, v4
    v_accvgpr_write_b32 a243, v8
    v_accvgpr_read_b32 v5, a244
    v_mul_f32 v5, v5, v4
    v_accvgpr_write_b32 a244, v5
    v_accvgpr_read_b32 v6, a245
    v_mul_f32 v6, v6, v4
    v_accvgpr_write_b32 a245, v6
    v_accvgpr_read_b32 v7, a246
    v_mul_f32 v7, v7, v4
    v_accvgpr_write_b32 a246, v7
    v_accvgpr_read_b32 v8, a247
    v_mul_f32 v8, v8, v4
    v_accvgpr_write_b32 a247, v8
    v_accvgpr_read_b32 v5, a248
    v_mul_f32 v5, v5, v4
    v_accvgpr_write_b32 a248, v5
    v_accvgpr_read_b32 v6, a249
    v_mul_f32 v6, v6, v4
    v_accvgpr_write_b32 a249, v6
    v_accvgpr_read_b32 v7, a250
    v_mul_f32 v7, v7, v4
    v_accvgpr_write_b32 a250, v7
    v_accvgpr_read_b32 v8, a251
    v_mul_f32 v8, v8, v4
    v_accvgpr_write_b32 a251, v8
    v_accvgpr_read_b32 v5, a252
    v_mul_f32 v5, v5, v4
    v_accvgpr_write_b32 a252, v5
    v_accvgpr_read_b32 v6, a253
    v_mul_f32 v6, v6, v4
    v_accvgpr_write_b32 a253, v6
    v_accvgpr_read_b32 v7, a254
    v_mul_f32 v7, v7, v4
    v_accvgpr_write_b32 a254, v7
    v_accvgpr_read_b32 v8, a255
    v_mul_f32 v8, v8, v4
    v_accvgpr_write_b32 a255, v8
    s_nop 1
    s_branch LRB_110
LOUT_113:
    s_barrier
    v_mov_b32 v2, v33
    s_nop 1
    v_permlane32_swap_b32 v33, v2
    v_add_f32 v33, v33, v2
    v_mov_b32 v2, v35
    s_nop 1
    v_permlane32_swap_b32 v35, v2
    v_add_f32 v35, v35, v2
    v_lshlrev_b32 v7, 2, v1
    v_add_u32 v7, 49152, v7
    s_lshl_b32 s43, s7, 8
    v_add_u32 v3, s43, v7
    ds_write_b32 v3, v34
    ds_write_b32 v3, v35 offset:1024
    v_rcp_f32 v4, v33
    s_waitcnt lgkmcnt(0)
    s_barrier
    ds_read_b32 v72, v7 offset:0
    ds_read_b32 v76, v7 offset:1024
    ds_read_b32 v73, v7 offset:256
    ds_read_b32 v77, v7 offset:1280
    ds_read_b32 v74, v7 offset:512
    ds_read_b32 v78, v7 offset:1536
    ds_read_b32 v75, v7 offset:768
    ds_read_b32 v79, v7 offset:1792
    v_accvgpr_read_b32 v2, a0
    v_accvgpr_read_b32 v3, a1
    v_mul_f32 v2, v2, v4
    v_mul_f32 v3, v3, v4
    v_cvt_pk_bf16_f32 v2, v2, v3
    v_accvgpr_write_b32 a0, v2
    v_accvgpr_read_b32 v2, a2
    v_accvgpr_read_b32 v3, a3
    v_mul_f32 v2, v2, v4
    v_mul_f32 v3, v3, v4
    v_cvt_pk_bf16_f32 v2, v2, v3
    v_accvgpr_write_b32 a1, v2
    v_accvgpr_read_b32 v2, a4
    v_accvgpr_read_b32 v3, a5
    v_mul_f32 v2, v2, v4
    v_mul_f32 v3, v3, v4
    v_cvt_pk_bf16_f32 v2, v2, v3
    v_accvgpr_write_b32 a2, v2
    v_accvgpr_read_b32 v2, a6
    v_accvgpr_read_b32 v3, a7
    v_mul_f32 v2, v2, v4
    v_mul_f32 v3, v3, v4
    v_cvt_pk_bf16_f32 v2, v2, v3
    v_accvgpr_write_b32 a3, v2
    v_accvgpr_read_b32 v2, a8
    v_accvgpr_read_b32 v3, a9
    v_mul_f32 v2, v2, v4
    v_mul_f32 v3, v3, v4
    v_cvt_pk_bf16_f32 v2, v2, v3
    v_accvgpr_write_b32 a4, v2
    v_accvgpr_read_b32 v2, a10
    v_accvgpr_read_b32 v3, a11
    v_mul_f32 v2, v2, v4
    v_mul_f32 v3, v3, v4
    v_cvt_pk_bf16_f32 v2, v2, v3
    v_accvgpr_write_b32 a5, v2
    v_accvgpr_read_b32 v2, a12
    v_accvgpr_read_b32 v3, a13
    v_mul_f32 v2, v2, v4
    v_mul_f32 v3, v3, v4
    v_cvt_pk_bf16_f32 v2, v2, v3
    v_accvgpr_write_b32 a6, v2
    v_accvgpr_read_b32 v2, a14
    v_accvgpr_read_b32 v3, a15
    v_mul_f32 v2, v2, v4
    v_mul_f32 v3, v3, v4
    v_cvt_pk_bf16_f32 v2, v2, v3
    v_accvgpr_write_b32 a7, v2
    v_accvgpr_read_b32 v2, a16
    v_accvgpr_read_b32 v3, a17
    v_mul_f32 v2, v2, v4
    v_mul_f32 v3, v3, v4
    v_cvt_pk_bf16_f32 v2, v2, v3
    v_accvgpr_write_b32 a8, v2
    v_accvgpr_read_b32 v2, a18
    v_accvgpr_read_b32 v3, a19
    v_mul_f32 v2, v2, v4
    v_mul_f32 v3, v3, v4
    v_cvt_pk_bf16_f32 v2, v2, v3
    v_accvgpr_write_b32 a9, v2
    v_accvgpr_read_b32 v2, a20
    v_accvgpr_read_b32 v3, a21
    v_mul_f32 v2, v2, v4
    v_mul_f32 v3, v3, v4
    v_cvt_pk_bf16_f32 v2, v2, v3
    v_accvgpr_write_b32 a10, v2
    v_accvgpr_read_b32 v2, a22
    v_accvgpr_read_b32 v3, a23
    v_mul_f32 v2, v2, v4
    v_mul_f32 v3, v3, v4
    v_cvt_pk_bf16_f32 v2, v2, v3
    v_accvgpr_write_b32 a11, v2
    v_accvgpr_read_b32 v2, a24
    v_accvgpr_read_b32 v3, a25
    v_mul_f32 v2, v2, v4
    v_mul_f32 v3, v3, v4
    v_cvt_pk_bf16_f32 v2, v2, v3
    v_accvgpr_write_b32 a12, v2
    v_accvgpr_read_b32 v2, a26
    v_accvgpr_read_b32 v3, a27
    v_mul_f32 v2, v2, v4
    v_mul_f32 v3, v3, v4
    v_cvt_pk_bf16_f32 v2, v2, v3
    v_accvgpr_write_b32 a13, v2
    v_accvgpr_read_b32 v2, a28
    v_accvgpr_read_b32 v3, a29
    v_mul_f32 v2, v2, v4
    v_mul_f32 v3, v3, v4
    v_cvt_pk_bf16_f32 v2, v2, v3
    v_accvgpr_write_b32 a14, v2
    v_accvgpr_read_b32 v2, a30
    v_accvgpr_read_b32 v3, a31
    v_mul_f32 v2, v2, v4
    v_mul_f32 v3, v3, v4
    v_cvt_pk_bf16_f32 v2, v2, v3
    v_accvgpr_write_b32 a15, v2
    v_accvgpr_read_b32 v2, a32
    v_accvgpr_read_b32 v3, a33
    v_mul_f32 v2, v2, v4
    v_mul_f32 v3, v3, v4
    v_cvt_pk_bf16_f32 v2, v2, v3
    v_accvgpr_write_b32 a16, v2
    v_accvgpr_read_b32 v2, a34
    v_accvgpr_read_b32 v3, a35
    v_mul_f32 v2, v2, v4
    v_mul_f32 v3, v3, v4
    v_cvt_pk_bf16_f32 v2, v2, v3
    v_accvgpr_write_b32 a17, v2
    v_accvgpr_read_b32 v2, a36
    v_accvgpr_read_b32 v3, a37
    v_mul_f32 v2, v2, v4
    v_mul_f32 v3, v3, v4
    v_cvt_pk_bf16_f32 v2, v2, v3
    v_accvgpr_write_b32 a18, v2
    v_accvgpr_read_b32 v2, a38
    v_accvgpr_read_b32 v3, a39
    v_mul_f32 v2, v2, v4
    v_mul_f32 v3, v3, v4
    v_cvt_pk_bf16_f32 v2, v2, v3
    v_accvgpr_write_b32 a19, v2
    v_accvgpr_read_b32 v2, a40
    v_accvgpr_read_b32 v3, a41
    v_mul_f32 v2, v2, v4
    v_mul_f32 v3, v3, v4
    v_cvt_pk_bf16_f32 v2, v2, v3
    v_accvgpr_write_b32 a20, v2
    v_accvgpr_read_b32 v2, a42
    v_accvgpr_read_b32 v3, a43
    v_mul_f32 v2, v2, v4
    v_mul_f32 v3, v3, v4
    v_cvt_pk_bf16_f32 v2, v2, v3
    v_accvgpr_write_b32 a21, v2
    v_accvgpr_read_b32 v2, a44
    v_accvgpr_read_b32 v3, a45
    v_mul_f32 v2, v2, v4
    v_mul_f32 v3, v3, v4
    v_cvt_pk_bf16_f32 v2, v2, v3
    v_accvgpr_write_b32 a22, v2
    v_accvgpr_read_b32 v2, a46
    v_accvgpr_read_b32 v3, a47
    v_mul_f32 v2, v2, v4
    v_mul_f32 v3, v3, v4
    v_cvt_pk_bf16_f32 v2, v2, v3
    v_accvgpr_write_b32 a23, v2
    v_accvgpr_read_b32 v2, a48
    v_accvgpr_read_b32 v3, a49
    v_mul_f32 v2, v2, v4
    v_mul_f32 v3, v3, v4
    v_cvt_pk_bf16_f32 v2, v2, v3
    v_accvgpr_write_b32 a24, v2
    v_accvgpr_read_b32 v2, a50
    v_accvgpr_read_b32 v3, a51
    v_mul_f32 v2, v2, v4
    v_mul_f32 v3, v3, v4
    v_cvt_pk_bf16_f32 v2, v2, v3
    v_accvgpr_write_b32 a25, v2
    v_accvgpr_read_b32 v2, a52
    v_accvgpr_read_b32 v3, a53
    v_mul_f32 v2, v2, v4
    v_mul_f32 v3, v3, v4
    v_cvt_pk_bf16_f32 v2, v2, v3
    v_accvgpr_write_b32 a26, v2
    v_accvgpr_read_b32 v2, a54
    v_accvgpr_read_b32 v3, a55
    v_mul_f32 v2, v2, v4
    v_mul_f32 v3, v3, v4
    v_cvt_pk_bf16_f32 v2, v2, v3
    v_accvgpr_write_b32 a27, v2
    v_accvgpr_read_b32 v2, a56
    v_accvgpr_read_b32 v3, a57
    v_mul_f32 v2, v2, v4
    v_mul_f32 v3, v3, v4
    v_cvt_pk_bf16_f32 v2, v2, v3
    v_accvgpr_write_b32 a28, v2
    v_accvgpr_read_b32 v2, a58
    v_accvgpr_read_b32 v3, a59
    v_mul_f32 v2, v2, v4
    v_mul_f32 v3, v3, v4
    v_cvt_pk_bf16_f32 v2, v2, v3
    v_accvgpr_write_b32 a29, v2
    v_accvgpr_read_b32 v2, a60
    v_accvgpr_read_b32 v3, a61
    v_mul_f32 v2, v2, v4
    v_mul_f32 v3, v3, v4
    v_cvt_pk_bf16_f32 v2, v2, v3
    v_accvgpr_write_b32 a30, v2
    v_accvgpr_read_b32 v2, a62
    v_accvgpr_read_b32 v3, a63
    v_mul_f32 v2, v2, v4
    v_mul_f32 v3, v3, v4
    v_cvt_pk_bf16_f32 v2, v2, v3
    v_accvgpr_write_b32 a31, v2
    v_accvgpr_read_b32 v2, a64
    v_accvgpr_read_b32 v3, a65
    v_mul_f32 v2, v2, v4
    v_mul_f32 v3, v3, v4
    v_cvt_pk_bf16_f32 v2, v2, v3
    v_accvgpr_write_b32 a32, v2
    v_accvgpr_read_b32 v2, a66
    v_accvgpr_read_b32 v3, a67
    v_mul_f32 v2, v2, v4
    v_mul_f32 v3, v3, v4
    v_cvt_pk_bf16_f32 v2, v2, v3
    v_accvgpr_write_b32 a33, v2
    v_accvgpr_read_b32 v2, a68
    v_accvgpr_read_b32 v3, a69
    v_mul_f32 v2, v2, v4
    v_mul_f32 v3, v3, v4
    v_cvt_pk_bf16_f32 v2, v2, v3
    v_accvgpr_write_b32 a34, v2
    v_accvgpr_read_b32 v2, a70
    v_accvgpr_read_b32 v3, a71
    v_mul_f32 v2, v2, v4
    v_mul_f32 v3, v3, v4
    v_cvt_pk_bf16_f32 v2, v2, v3
    v_accvgpr_write_b32 a35, v2
    v_accvgpr_read_b32 v2, a72
    v_accvgpr_read_b32 v3, a73
    v_mul_f32 v2, v2, v4
    v_mul_f32 v3, v3, v4
    v_cvt_pk_bf16_f32 v2, v2, v3
    v_accvgpr_write_b32 a36, v2
    v_accvgpr_read_b32 v2, a74
    v_accvgpr_read_b32 v3, a75
    v_mul_f32 v2, v2, v4
    v_mul_f32 v3, v3, v4
    v_cvt_pk_bf16_f32 v2, v2, v3
    v_accvgpr_write_b32 a37, v2
    v_accvgpr_read_b32 v2, a76
    v_accvgpr_read_b32 v3, a77
    v_mul_f32 v2, v2, v4
    v_mul_f32 v3, v3, v4
    v_cvt_pk_bf16_f32 v2, v2, v3
    v_accvgpr_write_b32 a38, v2
    v_accvgpr_read_b32 v2, a78
    v_accvgpr_read_b32 v3, a79
    v_mul_f32 v2, v2, v4
    v_mul_f32 v3, v3, v4
    v_cvt_pk_bf16_f32 v2, v2, v3
    v_accvgpr_write_b32 a39, v2
    v_accvgpr_read_b32 v2, a80
    v_accvgpr_read_b32 v3, a81
    v_mul_f32 v2, v2, v4
    v_mul_f32 v3, v3, v4
    v_cvt_pk_bf16_f32 v2, v2, v3
    v_accvgpr_write_b32 a40, v2
    v_accvgpr_read_b32 v2, a82
    v_accvgpr_read_b32 v3, a83
    v_mul_f32 v2, v2, v4
    v_mul_f32 v3, v3, v4
    v_cvt_pk_bf16_f32 v2, v2, v3
    v_accvgpr_write_b32 a41, v2
    v_accvgpr_read_b32 v2, a84
    v_accvgpr_read_b32 v3, a85
    v_mul_f32 v2, v2, v4
    v_mul_f32 v3, v3, v4
    v_cvt_pk_bf16_f32 v2, v2, v3
    v_accvgpr_write_b32 a42, v2
    v_accvgpr_read_b32 v2, a86
    v_accvgpr_read_b32 v3, a87
    v_mul_f32 v2, v2, v4
    v_mul_f32 v3, v3, v4
    v_cvt_pk_bf16_f32 v2, v2, v3
    v_accvgpr_write_b32 a43, v2
    v_accvgpr_read_b32 v2, a88
    v_accvgpr_read_b32 v3, a89
    v_mul_f32 v2, v2, v4
    v_mul_f32 v3, v3, v4
    v_cvt_pk_bf16_f32 v2, v2, v3
    v_accvgpr_write_b32 a44, v2
    v_accvgpr_read_b32 v2, a90
    v_accvgpr_read_b32 v3, a91
    v_mul_f32 v2, v2, v4
    v_mul_f32 v3, v3, v4
    v_cvt_pk_bf16_f32 v2, v2, v3
    v_accvgpr_write_b32 a45, v2
    v_accvgpr_read_b32 v2, a92
    v_accvgpr_read_b32 v3, a93
    v_mul_f32 v2, v2, v4
    v_mul_f32 v3, v3, v4
    v_cvt_pk_bf16_f32 v2, v2, v3
    v_accvgpr_write_b32 a46, v2
    v_accvgpr_read_b32 v2, a94
    v_accvgpr_read_b32 v3, a95
    v_mul_f32 v2, v2, v4
    v_mul_f32 v3, v3, v4
    v_cvt_pk_bf16_f32 v2, v2, v3
    v_accvgpr_write_b32 a47, v2
    v_accvgpr_read_b32 v2, a96
    v_accvgpr_read_b32 v3, a97
    v_mul_f32 v2, v2, v4
    v_mul_f32 v3, v3, v4
    v_cvt_pk_bf16_f32 v2, v2, v3
    v_accvgpr_write_b32 a48, v2
    v_accvgpr_read_b32 v2, a98
    v_accvgpr_read_b32 v3, a99
    v_mul_f32 v2, v2, v4
    v_mul_f32 v3, v3, v4
    v_cvt_pk_bf16_f32 v2, v2, v3
    v_accvgpr_write_b32 a49, v2
    v_accvgpr_read_b32 v2, a100
    v_accvgpr_read_b32 v3, a101
    v_mul_f32 v2, v2, v4
    v_mul_f32 v3, v3, v4
    v_cvt_pk_bf16_f32 v2, v2, v3
    v_accvgpr_write_b32 a50, v2
    v_accvgpr_read_b32 v2, a102
    v_accvgpr_read_b32 v3, a103
    v_mul_f32 v2, v2, v4
    v_mul_f32 v3, v3, v4
    v_cvt_pk_bf16_f32 v2, v2, v3
    v_accvgpr_write_b32 a51, v2
    v_accvgpr_read_b32 v2, a104
    v_accvgpr_read_b32 v3, a105
    v_mul_f32 v2, v2, v4
    v_mul_f32 v3, v3, v4
    v_cvt_pk_bf16_f32 v2, v2, v3
    v_accvgpr_write_b32 a52, v2
    v_accvgpr_read_b32 v2, a106
    v_accvgpr_read_b32 v3, a107
    v_mul_f32 v2, v2, v4
    v_mul_f32 v3, v3, v4
    v_cvt_pk_bf16_f32 v2, v2, v3
    v_accvgpr_write_b32 a53, v2
    v_accvgpr_read_b32 v2, a108
    v_accvgpr_read_b32 v3, a109
    v_mul_f32 v2, v2, v4
    v_mul_f32 v3, v3, v4
    v_cvt_pk_bf16_f32 v2, v2, v3
    v_accvgpr_write_b32 a54, v2
    v_accvgpr_read_b32 v2, a110
    v_accvgpr_read_b32 v3, a111
    v_mul_f32 v2, v2, v4
    v_mul_f32 v3, v3, v4
    v_cvt_pk_bf16_f32 v2, v2, v3
    v_accvgpr_write_b32 a55, v2
    v_accvgpr_read_b32 v2, a112
    v_accvgpr_read_b32 v3, a113
    v_mul_f32 v2, v2, v4
    v_mul_f32 v3, v3, v4
    v_cvt_pk_bf16_f32 v2, v2, v3
    v_accvgpr_write_b32 a56, v2
    v_accvgpr_read_b32 v2, a114
    v_accvgpr_read_b32 v3, a115
    v_mul_f32 v2, v2, v4
    v_mul_f32 v3, v3, v4
    v_cvt_pk_bf16_f32 v2, v2, v3
    v_accvgpr_write_b32 a57, v2
    v_accvgpr_read_b32 v2, a116
    v_accvgpr_read_b32 v3, a117
    v_mul_f32 v2, v2, v4
    v_mul_f32 v3, v3, v4
    v_cvt_pk_bf16_f32 v2, v2, v3
    v_accvgpr_write_b32 a58, v2
    v_accvgpr_read_b32 v2, a118
    v_accvgpr_read_b32 v3, a119
    v_mul_f32 v2, v2, v4
    v_mul_f32 v3, v3, v4
    v_cvt_pk_bf16_f32 v2, v2, v3
    v_accvgpr_write_b32 a59, v2
    v_accvgpr_read_b32 v2, a120
    v_accvgpr_read_b32 v3, a121
    v_mul_f32 v2, v2, v4
    v_mul_f32 v3, v3, v4
    v_cvt_pk_bf16_f32 v2, v2, v3
    v_accvgpr_write_b32 a60, v2
    v_accvgpr_read_b32 v2, a122
    v_accvgpr_read_b32 v3, a123
    v_mul_f32 v2, v2, v4
    v_mul_f32 v3, v3, v4
    v_cvt_pk_bf16_f32 v2, v2, v3
    v_accvgpr_write_b32 a61, v2
    v_accvgpr_read_b32 v2, a124
    v_accvgpr_read_b32 v3, a125
    v_mul_f32 v2, v2, v4
    v_mul_f32 v3, v3, v4
    v_cvt_pk_bf16_f32 v2, v2, v3
    v_accvgpr_write_b32 a62, v2
    v_accvgpr_read_b32 v2, a126
    v_accvgpr_read_b32 v3, a127
    v_mul_f32 v2, v2, v4
    v_mul_f32 v3, v3, v4
    v_cvt_pk_bf16_f32 v2, v2, v3
    v_accvgpr_write_b32 a63, v2
    s_waitcnt lgkmcnt(0)
    v_max_f32 v2, v72, v73
    v_max3_f32 v2, v2, v74, v75
    v_sub_f32 v72, v72, v2
    v_exp_f32 v72, v72
    v_sub_f32 v73, v73, v2
    v_exp_f32 v73, v73
    v_sub_f32 v74, v74, v2
    v_exp_f32 v74, v74
    v_sub_f32 v75, v75, v2
    v_exp_f32 v75, v75
    s_nop 0
    v_mul_f32 v3, v72, v76
    v_fma_f32 v3, v73, v77, v3
    v_fma_f32 v3, v74, v78, v3
    v_fma_f32 v3, v75, v79, v3
    v_rcp_f32 v3, v3
    v_sub_f32 v5, v34, v2
    v_exp_f32 v5, v5
    s_nop 0
    v_mul_f32 v8, v5, v3
    s_barrier
    v_and_b32 v6, 15, v1
    v_lshrrev_b32 v2, 5, v1
    v_lshl_add_u32 v6, v2, 4, v6
    v_lshlrev_b32 v6, 4, v6
    s_mov_b32 exec_lo, 0xffff
    s_mov_b32 exec_hi, 0xffff
    s_add_u32 s43, s32, 114688
    v_add_u32 v2, s43, v6
    v_accvgpr_read_b32 v40, a128
    v_mul_f32 v40, v40, v8
    v_accvgpr_read_b32 v41, a129
    v_mul_f32 v41, v41, v8
    v_accvgpr_read_b32 v42, a130
    v_mul_f32 v42, v42, v8
    v_accvgpr_read_b32 v43, a131
    v_mul_f32 v43, v43, v8
    ds_write_b128 v2, v[40:43] offset:0
    v_accvgpr_read_b32 v40, a132
    v_mul_f32 v40, v40, v8
    v_accvgpr_read_b32 v41, a133
    v_mul_f32 v41, v41, v8
    v_accvgpr_read_b32 v42, a134
    v_mul_f32 v42, v42, v8
    v_accvgpr_read_b32 v43, a135
    v_mul_f32 v43, v43, v8
    ds_write_b128 v2, v[40:43] offset:512
    v_accvgpr_read_b32 v40, a136
    v_mul_f32 v40, v40, v8
    v_accvgpr_read_b32 v41, a137
    v_mul_f32 v41, v41, v8
    v_accvgpr_read_b32 v42, a138
    v_mul_f32 v42, v42, v8
    v_accvgpr_read_b32 v43, a139
    v_mul_f32 v43, v43, v8
    ds_write_b128 v2, v[40:43] offset:1024
    v_accvgpr_read_b32 v40, a140
    v_mul_f32 v40, v40, v8
    v_accvgpr_read_b32 v41, a141
    v_mul_f32 v41, v41, v8
    v_accvgpr_read_b32 v42, a142
    v_mul_f32 v42, v42, v8
    v_accvgpr_read_b32 v43, a143
    v_mul_f32 v43, v43, v8
    ds_write_b128 v2, v[40:43] offset:1536
    v_accvgpr_read_b32 v40, a144
    v_mul_f32 v40, v40, v8
    v_accvgpr_read_b32 v41, a145
    v_mul_f32 v41, v41, v8
    v_accvgpr_read_b32 v42, a146
    v_mul_f32 v42, v42, v8
    v_accvgpr_read_b32 v43, a147
    v_mul_f32 v43, v43, v8
    ds_write_b128 v2, v[40:43] offset:2048
    v_accvgpr_read_b32 v40, a148
    v_mul_f32 v40, v40, v8
    v_accvgpr_read_b32 v41, a149
    v_mul_f32 v41, v41, v8
    v_accvgpr_read_b32 v42, a150
    v_mul_f32 v42, v42, v8
    v_accvgpr_read_b32 v43, a151
    v_mul_f32 v43, v43, v8
    ds_write_b128 v2, v[40:43] offset:2560
    v_accvgpr_read_b32 v40, a152
    v_mul_f32 v40, v40, v8
    v_accvgpr_read_b32 v41, a153
    v_mul_f32 v41, v41, v8
    v_accvgpr_read_b32 v42, a154
    v_mul_f32 v42, v42, v8
    v_accvgpr_read_b32 v43, a155
    v_mul_f32 v43, v43, v8
    ds_write_b128 v2, v[40:43] offset:3072
    v_accvgpr_read_b32 v40, a156
    v_mul_f32 v40, v40, v8
    v_accvgpr_read_b32 v41, a157
    v_mul_f32 v41, v41, v8
    v_accvgpr_read_b32 v42, a158
    v_mul_f32 v42, v42, v8
    v_accvgpr_read_b32 v43, a159
    v_mul_f32 v43, v43, v8
    ds_write_b128 v2, v[40:43] offset:3584
    s_add_u32 s43, s32, 131072
    v_add_u32 v2, s43, v6
    v_accvgpr_read_b32 v40, a160
    v_mul_f32 v40, v40, v8
    v_accvgpr_read_b32 v41, a161
    v_mul_f32 v41, v41, v8
    v_accvgpr_read_b32 v42, a162
    v_mul_f32 v42, v42, v8
    v_accvgpr_read_b32 v43, a163
    v_mul_f32 v43, v43, v8
    ds_write_b128 v2, v[40:43] offset:0
    v_accvgpr_read_b32 v40, a164
    v_mul_f32 v40, v40, v8
    v_accvgpr_read_b32 v41, a165
    v_mul_f32 v41, v41, v8
    v_accvgpr_read_b32 v42, a166
    v_mul_f32 v42, v42, v8
    v_accvgpr_read_b32 v43, a167
    v_mul_f32 v43, v43, v8
    ds_write_b128 v2, v[40:43] offset:512
    v_accvgpr_read_b32 v40, a168
    v_mul_f32 v40, v40, v8
    v_accvgpr_read_b32 v41, a169
    v_mul_f32 v41, v41, v8
    v_accvgpr_read_b32 v42, a170
    v_mul_f32 v42, v42, v8
    v_accvgpr_read_b32 v43, a171
    v_mul_f32 v43, v43, v8
    ds_write_b128 v2, v[40:43] offset:1024
    v_accvgpr_read_b32 v40, a172
    v_mul_f32 v40, v40, v8
    v_accvgpr_read_b32 v41, a173
    v_mul_f32 v41, v41, v8
    v_accvgpr_read_b32 v42, a174
    v_mul_f32 v42, v42, v8
    v_accvgpr_read_b32 v43, a175
    v_mul_f32 v43, v43, v8
    ds_write_b128 v2, v[40:43] offset:1536
    v_accvgpr_read_b32 v40, a176
    v_mul_f32 v40, v40, v8
    v_accvgpr_read_b32 v41, a177
    v_mul_f32 v41, v41, v8
    v_accvgpr_read_b32 v42, a178
    v_mul_f32 v42, v42, v8
    v_accvgpr_read_b32 v43, a179
    v_mul_f32 v43, v43, v8
    ds_write_b128 v2, v[40:43] offset:2048
    v_accvgpr_read_b32 v40, a180
    v_mul_f32 v40, v40, v8
    v_accvgpr_read_b32 v41, a181
    v_mul_f32 v41, v41, v8
    v_accvgpr_read_b32 v42, a182
    v_mul_f32 v42, v42, v8
    v_accvgpr_read_b32 v43, a183
    v_mul_f32 v43, v43, v8
    ds_write_b128 v2, v[40:43] offset:2560
    v_accvgpr_read_b32 v40, a184
    v_mul_f32 v40, v40, v8
    v_accvgpr_read_b32 v41, a185
    v_mul_f32 v41, v41, v8
    v_accvgpr_read_b32 v42, a186
    v_mul_f32 v42, v42, v8
    v_accvgpr_read_b32 v43, a187
    v_mul_f32 v43, v43, v8
    ds_write_b128 v2, v[40:43] offset:3072
    v_accvgpr_read_b32 v40, a188
    v_mul_f32 v40, v40, v8
    v_accvgpr_read_b32 v41, a189
    v_mul_f32 v41, v41, v8
    v_accvgpr_read_b32 v42, a190
    v_mul_f32 v42, v42, v8
    v_accvgpr_read_b32 v43, a191
    v_mul_f32 v43, v43, v8
    ds_write_b128 v2, v[40:43] offset:3584
    s_add_u32 s43, s32, 147456
    v_add_u32 v2, s43, v6
    v_accvgpr_read_b32 v40, a192
    v_mul_f32 v40, v40, v8
    v_accvgpr_read_b32 v41, a193
    v_mul_f32 v41, v41, v8
    v_accvgpr_read_b32 v42, a194
    v_mul_f32 v42, v42, v8
    v_accvgpr_read_b32 v43, a195
    v_mul_f32 v43, v43, v8
    ds_write_b128 v2, v[40:43] offset:0
    v_accvgpr_read_b32 v40, a196
    v_mul_f32 v40, v40, v8
    v_accvgpr_read_b32 v41, a197
    v_mul_f32 v41, v41, v8
    v_accvgpr_read_b32 v42, a198
    v_mul_f32 v42, v42, v8
    v_accvgpr_read_b32 v43, a199
    v_mul_f32 v43, v43, v8
    ds_write_b128 v2, v[40:43] offset:512
    v_accvgpr_read_b32 v40, a200
    v_mul_f32 v40, v40, v8
    v_accvgpr_read_b32 v41, a201
    v_mul_f32 v41, v41, v8
    v_accvgpr_read_b32 v42, a202
    v_mul_f32 v42, v42, v8
    v_accvgpr_read_b32 v43, a203
    v_mul_f32 v43, v43, v8
    ds_write_b128 v2, v[40:43] offset:1024
    v_accvgpr_read_b32 v40, a204
    v_mul_f32 v40, v40, v8
    v_accvgpr_read_b32 v41, a205
    v_mul_f32 v41, v41, v8
    v_accvgpr_read_b32 v42, a206
    v_mul_f32 v42, v42, v8
    v_accvgpr_read_b32 v43, a207
    v_mul_f32 v43, v43, v8
    ds_write_b128 v2, v[40:43] offset:1536
    v_accvgpr_read_b32 v40, a208
    v_mul_f32 v40, v40, v8
    v_accvgpr_read_b32 v41, a209
    v_mul_f32 v41, v41, v8
    v_accvgpr_read_b32 v42, a210
    v_mul_f32 v42, v42, v8
    v_accvgpr_read_b32 v43, a211
    v_mul_f32 v43, v43, v8
    ds_write_b128 v2, v[40:43] offset:2048
    v_accvgpr_read_b32 v40, a212
    v_mul_f32 v40, v40, v8
    v_accvgpr_read_b32 v41, a213
    v_mul_f32 v41, v41, v8
    v_accvgpr_read_b32 v42, a214
    v_mul_f32 v42, v42, v8
    v_accvgpr_read_b32 v43, a215
    v_mul_f32 v43, v43, v8
    ds_write_b128 v2, v[40:43] offset:2560
    v_accvgpr_read_b32 v40, a216
    v_mul_f32 v40, v40, v8
    v_accvgpr_read_b32 v41, a217
    v_mul_f32 v41, v41, v8
    v_accvgpr_read_b32 v42, a218
    v_mul_f32 v42, v42, v8
    v_accvgpr_read_b32 v43, a219
    v_mul_f32 v43, v43, v8
    ds_write_b128 v2, v[40:43] offset:3072
    v_accvgpr_read_b32 v40, a220
    v_mul_f32 v40, v40, v8
    v_accvgpr_read_b32 v41, a221
    v_mul_f32 v41, v41, v8
    v_accvgpr_read_b32 v42, a222
    v_mul_f32 v42, v42, v8
    v_accvgpr_read_b32 v43, a223
    v_mul_f32 v43, v43, v8
    ds_write_b128 v2, v[40:43] offset:3584
    s_add_u32 s43, s32, 49152
    v_add_u32 v2, s43, v6
    v_accvgpr_read_b32 v40, a224
    v_mul_f32 v40, v40, v8
    v_accvgpr_read_b32 v41, a225
    v_mul_f32 v41, v41, v8
    v_accvgpr_read_b32 v42, a226
    v_mul_f32 v42, v42, v8
    v_accvgpr_read_b32 v43, a227
    v_mul_f32 v43, v43, v8
    ds_write_b128 v2, v[40:43] offset:0
    v_accvgpr_read_b32 v40, a228
    v_mul_f32 v40, v40, v8
    v_accvgpr_read_b32 v41, a229
    v_mul_f32 v41, v41, v8
    v_accvgpr_read_b32 v42, a230
    v_mul_f32 v42, v42, v8
    v_accvgpr_read_b32 v43, a231
    v_mul_f32 v43, v43, v8
    ds_write_b128 v2, v[40:43] offset:512
    v_accvgpr_read_b32 v40, a232
    v_mul_f32 v40, v40, v8
    v_accvgpr_read_b32 v41, a233
    v_mul_f32 v41, v41, v8
    v_accvgpr_read_b32 v42, a234
    v_mul_f32 v42, v42, v8
    v_accvgpr_read_b32 v43, a235
    v_mul_f32 v43, v43, v8
    ds_write_b128 v2, v[40:43] offset:1024
    v_accvgpr_read_b32 v40, a236
    v_mul_f32 v40, v40, v8
    v_accvgpr_read_b32 v41, a237
    v_mul_f32 v41, v41, v8
    v_accvgpr_read_b32 v42, a238
    v_mul_f32 v42, v42, v8
    v_accvgpr_read_b32 v43, a239
    v_mul_f32 v43, v43, v8
    ds_write_b128 v2, v[40:43] offset:1536
    v_accvgpr_read_b32 v40, a240
    v_mul_f32 v40, v40, v8
    v_accvgpr_read_b32 v41, a241
    v_mul_f32 v41, v41, v8
    v_accvgpr_read_b32 v42, a242
    v_mul_f32 v42, v42, v8
    v_accvgpr_read_b32 v43, a243
    v_mul_f32 v43, v43, v8
    ds_write_b128 v2, v[40:43] offset:2048
    v_accvgpr_read_b32 v40, a244
    v_mul_f32 v40, v40, v8
    v_accvgpr_read_b32 v41, a245
    v_mul_f32 v41, v41, v8
    v_accvgpr_read_b32 v42, a246
    v_mul_f32 v42, v42, v8
    v_accvgpr_read_b32 v43, a247
    v_mul_f32 v43, v43, v8
    ds_write_b128 v2, v[40:43] offset:2560
    v_accvgpr_read_b32 v40, a248
    v_mul_f32 v40, v40, v8
    v_accvgpr_read_b32 v41, a249
    v_mul_f32 v41, v41, v8
    v_accvgpr_read_b32 v42, a250
    v_mul_f32 v42, v42, v8
    v_accvgpr_read_b32 v43, a251
    v_mul_f32 v43, v43, v8
    ds_write_b128 v2, v[40:43] offset:3072
    v_accvgpr_read_b32 v40, a252
    v_mul_f32 v40, v40, v8
    v_accvgpr_read_b32 v41, a253
    v_mul_f32 v41, v41, v8
    v_accvgpr_read_b32 v42, a254
    v_mul_f32 v42, v42, v8
    v_accvgpr_read_b32 v43, a255
    v_mul_f32 v43, v43, v8
    ds_write_b128 v2, v[40:43] offset:3584
    s_waitcnt lgkmcnt(0)
    s_barrier
    s_mov_b32 s43, 49152
    s_mul_i32 s44, s7, 16384
    s_add_u32 s44, s44, 114688
    s_cmp_lt_u32 s7, 3
    s_cselect_b32 s43, s44, s43
    v_add_u32 v2, s43, v6
    ds_read_b128 v[40:43], v2 offset:0
    ds_read_b128 v[44:47], v2 offset:4096
    ds_read_b128 v[48:51], v2 offset:8192
    ds_read_b128 v[52:55], v2 offset:12288
    s_waitcnt lgkmcnt(0)
    v_add_f32 v72, v40, v44
    v_add_f32 v48, v48, v52
    v_add_f32 v72, v72, v48
    v_add_f32 v73, v41, v45
    v_add_f32 v49, v49, v53
    v_add_f32 v73, v73, v49
    v_add_f32 v74, v42, v46
    v_add_f32 v50, v50, v54
    v_add_f32 v74, v74, v50
    v_add_f32 v75, v43, v47
    v_add_f32 v51, v51, v55
    v_add_f32 v75, v75, v51
    ds_read_b128 v[40:43], v2 offset:512
    ds_read_b128 v[44:47], v2 offset:4608
    ds_read_b128 v[48:51], v2 offset:8704
    ds_read_b128 v[52:55], v2 offset:12800
    s_waitcnt lgkmcnt(0)
    v_add_f32 v76, v40, v44
    v_add_f32 v48, v48, v52
    v_add_f32 v76, v76, v48
    v_add_f32 v77, v41, v45
    v_add_f32 v49, v49, v53
    v_add_f32 v77, v77, v49
    v_add_f32 v78, v42, v46
    v_add_f32 v50, v50, v54
    v_add_f32 v78, v78, v50
    v_add_f32 v79, v43, v47
    v_add_f32 v51, v51, v55
    v_add_f32 v79, v79, v51
    ds_read_b128 v[40:43], v2 offset:1024
    ds_read_b128 v[44:47], v2 offset:5120
    ds_read_b128 v[48:51], v2 offset:9216
    ds_read_b128 v[52:55], v2 offset:13312
    s_waitcnt lgkmcnt(0)
    v_add_f32 v80, v40, v44
    v_add_f32 v48, v48, v52
    v_add_f32 v80, v80, v48
    v_add_f32 v81, v41, v45
    v_add_f32 v49, v49, v53
    v_add_f32 v81, v81, v49
    v_add_f32 v82, v42, v46
    v_add_f32 v50, v50, v54
    v_add_f32 v82, v82, v50
    v_add_f32 v83, v43, v47
    v_add_f32 v51, v51, v55
    v_add_f32 v83, v83, v51
    ds_read_b128 v[40:43], v2 offset:1536
    ds_read_b128 v[44:47], v2 offset:5632
    ds_read_b128 v[48:51], v2 offset:9728
    ds_read_b128 v[52:55], v2 offset:13824
    s_waitcnt lgkmcnt(0)
    v_add_f32 v84, v40, v44
    v_add_f32 v48, v48, v52
    v_add_f32 v84, v84, v48
    v_add_f32 v85, v41, v45
    v_add_f32 v49, v49, v53
    v_add_f32 v85, v85, v49
    v_add_f32 v86, v42, v46
    v_add_f32 v50, v50, v54
    v_add_f32 v86, v86, v50
    v_add_f32 v87, v43, v47
    v_add_f32 v51, v51, v55
    v_add_f32 v87, v87, v51
    ds_read_b128 v[40:43], v2 offset:2048
    ds_read_b128 v[44:47], v2 offset:6144
    ds_read_b128 v[48:51], v2 offset:10240
    ds_read_b128 v[52:55], v2 offset:14336
    s_waitcnt lgkmcnt(0)
    v_add_f32 v88, v40, v44
    v_add_f32 v48, v48, v52
    v_add_f32 v88, v88, v48
    v_add_f32 v89, v41, v45
    v_add_f32 v49, v49, v53
    v_add_f32 v89, v89, v49
    v_add_f32 v90, v42, v46
    v_add_f32 v50, v50, v54
    v_add_f32 v90, v90, v50
    v_add_f32 v91, v43, v47
    v_add_f32 v51, v51, v55
    v_add_f32 v91, v91, v51
    ds_read_b128 v[40:43], v2 offset:2560
    ds_read_b128 v[44:47], v2 offset:6656
    ds_read_b128 v[48:51], v2 offset:10752
    ds_read_b128 v[52:55], v2 offset:14848
    s_waitcnt lgkmcnt(0)
    v_add_f32 v92, v40, v44
    v_add_f32 v48, v48, v52
    v_add_f32 v92, v92, v48
    v_add_f32 v93, v41, v45
    v_add_f32 v49, v49, v53
    v_add_f32 v93, v93, v49
    v_add_f32 v94, v42, v46
    v_add_f32 v50, v50, v54
    v_add_f32 v94, v94, v50
    v_add_f32 v95, v43, v47
    v_add_f32 v51, v51, v55
    v_add_f32 v95, v95, v51
    ds_read_b128 v[40:43], v2 offset:3072
    ds_read_b128 v[44:47], v2 offset:7168
    ds_read_b128 v[48:51], v2 offset:11264
    ds_read_b128 v[52:55], v2 offset:15360
    s_waitcnt lgkmcnt(0)
    v_add_f32 v96, v40, v44
    v_add_f32 v48, v48, v52
    v_add_f32 v96, v96, v48
    v_add_f32 v97, v41, v45
    v_add_f32 v49, v49, v53
    v_add_f32 v97, v97, v49
    v_add_f32 v98, v42, v46
    v_add_f32 v50, v50, v54
    v_add_f32 v98, v98, v50
    v_add_f32 v99, v43, v47
    v_add_f32 v51, v51, v55
    v_add_f32 v99, v99, v51
    ds_read_b128 v[40:43], v2 offset:3584
    ds_read_b128 v[44:47], v2 offset:7680
    ds_read_b128 v[48:51], v2 offset:11776
    ds_read_b128 v[52:55], v2 offset:15872
    s_waitcnt lgkmcnt(0)
    v_add_f32 v100, v40, v44
    v_add_f32 v48, v48, v52
    v_add_f32 v100, v100, v48
    v_add_f32 v101, v41, v45
    v_add_f32 v49, v49, v53
    v_add_f32 v101, v101, v49
    v_add_f32 v102, v42, v46
    v_add_f32 v50, v50, v54
    v_add_f32 v102, v102, v50
    v_add_f32 v103, v43, v47
    v_add_f32 v51, v51, v55
    v_add_f32 v103, v103, v51
    s_mov_b64 exec, -1
    v_cvt_pk_bf16_f32 v72, v72, v73
    v_cvt_pk_bf16_f32 v73, v74, v75
    v_cvt_pk_bf16_f32 v74, v76, v77
    v_cvt_pk_bf16_f32 v75, v78, v79
    v_cvt_pk_bf16_f32 v76, v80, v81
    v_cvt_pk_bf16_f32 v77, v82, v83
    v_cvt_pk_bf16_f32 v78, v84, v85
    v_cvt_pk_bf16_f32 v79, v86, v87
    v_cvt_pk_bf16_f32 v80, v88, v89
    v_cvt_pk_bf16_f32 v81, v90, v91
    v_cvt_pk_bf16_f32 v82, v92, v93
    v_cvt_pk_bf16_f32 v83, v94, v95
    v_cvt_pk_bf16_f32 v84, v96, v97
    v_cvt_pk_bf16_f32 v85, v98, v99
    v_cvt_pk_bf16_f32 v86, v100, v101
    v_cvt_pk_bf16_f32 v87, v102, v103
    s_barrier
    v_lshlrev_b32 v2, 4, v1
    v_add_u32 v2, 114688, v2
    v_add_u32 v3, s32, v2
    ds_write_b128 v3, v[72:75] offset:0
    ds_write_b128 v3, v[76:79] offset:1024
    ds_write_b128 v3, v[80:83] offset:2048
    ds_write_b128 v3, v[84:87] offset:3072
    s_waitcnt lgkmcnt(0)
    s_barrier
    ds_read_b128 a[128:131], v2 offset:0
    ds_read_b128 a[132:135], v2 offset:1024
    ds_read_b128 a[136:139], v2 offset:2048
    ds_read_b128 a[140:143], v2 offset:3072
    ds_read_b128 a[144:147], v2 offset:4096
    ds_read_b128 a[148:151], v2 offset:5120
    ds_read_b128 a[152:155], v2 offset:6144
    ds_read_b128 a[156:159], v2 offset:7168
    s_waitcnt lgkmcnt(0)
    ds_read_b128 a[160:163], v2 offset:8192
    ds_read_b128 a[164:167], v2 offset:9216
    ds_read_b128 a[168:171], v2 offset:10240
    ds_read_b128 a[172:175], v2 offset:11264
    ds_read_b128 a[176:179], v2 offset:12288
    ds_read_b128 a[180:183], v2 offset:13312
    ds_read_b128 a[184:187], v2 offset:14336
    ds_read_b128 a[188:191], v2 offset:15360
    s_waitcnt lgkmcnt(0)
    v_subrev_u32 v112, 49152, v18
    v_add_u32 v116, 0x10000, v112
    v_subrev_u32 v113, 49152, v19
    v_add_u32 v117, 0x10000, v113
    v_subrev_u32 v114, 49152, v20
    v_add_u32 v118, 0x10000, v114
    v_subrev_u32 v115, 49152, v21
    v_add_u32 v119, 0x10000, v115
    s_lshl_b32 s66, s7, 1
    s_add_u32 s67, s66, 1
    s_and_b32 s43, s66, 3
    s_lshl_b32 s43, s43, 6
    s_lshr_b32 s44, s66, 2
    s_lshl_b32 s44, s44, 8
    v_xor_b32 v120, s43, v112
    v_add_u32 v120, s44, v120
    v_add_u32 v122, 0x10000, v120
    s_and_b32 s43, s67, 3
    s_lshl_b32 s43, s43, 6
    s_lshr_b32 s44, s67, 2
    s_lshl_b32 s44, s44, 8
    v_xor_b32 v121, s43, v112
    v_add_u32 v121, s44, v121
    v_add_u32 v123, 0x10000, v121
    ds_read_b64_tr_b16 v[40:41], v116 offset:0
    ds_read_b64_tr_b16 v[42:43], v116 offset:4096
    ds_read_b64_tr_b16 v[44:45], v117 offset:0
    ds_read_b64_tr_b16 v[46:47], v117 offset:4096
    ds_read_b64_tr_b16 v[48:49], v118 offset:0
    ds_read_b64_tr_b16 v[50:51], v118 offset:4096
    ds_read_b64_tr_b16 v[52:53], v119 offset:0
    ds_read_b64_tr_b16 v[54:55], v119 offset:4096
    ds_read_b64_tr_b16 v[56:57], v116 offset:256
    ds_read_b64_tr_b16 v[58:59], v116 offset:4352
    ds_read_b64_tr_b16 v[60:61], v117 offset:256
    ds_read_b64_tr_b16 v[62:63], v117 offset:4352
    ds_read_b64_tr_b16 v[64:65], v118 offset:256
    ds_read_b64_tr_b16 v[66:67], v118 offset:4352
    ds_read_b64_tr_b16 v[68:69], v119 offset:256
    ds_read_b64_tr_b16 v[70:71], v119 offset:4352
    s_waitcnt vmcnt(36)
    s_barrier
    s_add_u32 s43, s32, 49152
    s_mov_b32 m0, s43
    s_add_u32 s44, s38, 172032
    buffer_load_dwordx4 v28, s[24:27], s44 offen offset:0 lds
    buffer_load_dwordx4 v29, s[24:27], s44 offen offset:1024 lds
    buffer_load_dwordx4 v30, s[24:27], s44 offen offset:2048 lds
    buffer_load_dwordx4 v31, s[24:27], s44 offen offset:3072 lds
    s_waitcnt lgkmcnt(12)
    v_mfma_f32_32x32x16_bf16 v[128:143], v[40:43], a[0:3], 0
    ds_read_b64_tr_b16 v[40:41], v122 offset:0
    ds_read_b64_tr_b16 v[42:43], v122 offset:4096
    v_mfma_f32_32x32x16_bf16 v[144:159], v[44:47], a[0:3], 0
    ds_read_b64_tr_b16 v[44:45], v123 offset:0
    ds_read_b64_tr_b16 v[46:47], v123 offset:4096
    s_waitcnt lgkmcnt(12)
    v_mfma_f32_32x32x16_bf16 v[160:175], v[48:51], a[0:3], 0
    ds_read_b64_tr_b16 v[48:49], v116 offset:8192
    ds_read_b64_tr_b16 v[50:51], v116 offset:12288
    v_mfma_f32_32x32x16_bf16 v[176:191], v[52:55], a[0:3], 0
    ds_read_b64_tr_b16 v[52:53], v117 offset:8192
    ds_read_b64_tr_b16 v[54:55], v117 offset:12288
    s_waitcnt lgkmcnt(12)
    v_mfma_f32_32x32x16_bf16 v[192:207], v[56:59], a[0:3], 0
    ds_read_b64_tr_b16 v[56:57], v118 offset:8192
    ds_read_b64_tr_b16 v[58:59], v118 offset:12288
    v_mfma_f32_32x32x16_bf16 v[208:223], v[60:63], a[0:3], 0
    ds_read_b64_tr_b16 v[60:61], v119 offset:8192
    ds_read_b64_tr_b16 v[62:63], v119 offset:12288
    s_waitcnt lgkmcnt(12)
    v_mfma_f32_32x32x16_bf16 v[224:239], v[64:67], a[0:3], 0
    ds_read_b64_tr_b16 v[64:65], v116 offset:8448
    ds_read_b64_tr_b16 v[66:67], v116 offset:12544
    v_mfma_f32_32x32x16_bf16 v[240:255], v[68:71], a[0:3], 0
    ds_read_b64_tr_b16 v[68:69], v117 offset:8448
    ds_read_b64_tr_b16 v[70:71], v117 offset:12544
    s_waitcnt lgkmcnt(12)
    v_mfma_f32_32x32x16_bf16 v[72:87], v[40:43], a[128:131], 0
    ds_read_b64_tr_b16 v[40:41], v118 offset:8448
    ds_read_b64_tr_b16 v[42:43], v118 offset:12544
    v_mfma_f32_32x32x16_bf16 v[88:103], v[44:47], a[128:131], 0
    ds_read_b64_tr_b16 v[44:45], v119 offset:8448
    ds_read_b64_tr_b16 v[46:47], v119 offset:12544
    s_waitcnt lgkmcnt(12)
    v_mfma_f32_32x32x16_bf16 v[128:143], v[48:51], a[4:7], v[128:143]
    ds_read_b64_tr_b16 v[48:49], v122 offset:8192
    ds_read_b64_tr_b16 v[50:51], v122 offset:12288
    v_mfma_f32_32x32x16_bf16 v[144:159], v[52:55], a[4:7], v[144:159]
    ds_read_b64_tr_b16 v[52:53], v123 offset:8192
    ds_read_b64_tr_b16 v[54:55], v123 offset:12288
    s_waitcnt lgkmcnt(12)
    v_mfma_f32_32x32x16_bf16 v[160:175], v[56:59], a[4:7], v[160:175]
    ds_read_b64_tr_b16 v[56:57], v116 offset:16384
    ds_read_b64_tr_b16 v[58:59], v116 offset:20480
    v_mfma_f32_32x32x16_bf16 v[176:191], v[60:63], a[4:7], v[176:191]
    ds_read_b64_tr_b16 v[60:61], v117 offset:16384
    ds_read_b64_tr_b16 v[62:63], v117 offset:20480
    s_waitcnt lgkmcnt(12)
    v_mfma_f32_32x32x16_bf16 v[192:207], v[64:67], a[4:7], v[192:207]
    ds_read_b64_tr_b16 v[64:65], v118 offset:16384
    ds_read_b64_tr_b16 v[66:67], v118 offset:20480
    v_mfma_f32_32x32x16_bf16 v[208:223], v[68:71], a[4:7], v[208:223]
    ds_read_b64_tr_b16 v[68:69], v119 offset:16384
    ds_read_b64_tr_b16 v[70:71], v119 offset:20480
    s_waitcnt lgkmcnt(12)
    v_mfma_f32_32x32x16_bf16 v[224:239], v[40:43], a[4:7], v[224:239]
    ds_read_b64_tr_b16 v[40:41], v116 offset:16640
    ds_read_b64_tr_b16 v[42:43], v116 offset:20736
    v_mfma_f32_32x32x16_bf16 v[240:255], v[44:47], a[4:7], v[240:255]
    ds_read_b64_tr_b16 v[44:45], v117 offset:16640
    ds_read_b64_tr_b16 v[46:47], v117 offset:20736
    s_waitcnt lgkmcnt(12)
    v_mfma_f32_32x32x16_bf16 v[72:87], v[48:51], a[132:135], v[72:87]
    ds_read_b64_tr_b16 v[48:49], v118 offset:16640
    ds_read_b64_tr_b16 v[50:51], v118 offset:20736
    v_mfma_f32_32x32x16_bf16 v[88:103], v[52:55], a[132:135], v[88:103]
    ds_read_b64_tr_b16 v[52:53], v119 offset:16640
    ds_read_b64_tr_b16 v[54:55], v119 offset:20736
    s_waitcnt vmcnt(32)
    s_barrier
    s_add_u32 s43, s32, 65536
    s_mov_b32 m0, s43
    s_add_u32 s44, s38, 200704
    buffer_load_dwordx4 v28, s[24:27], s44 offen offset:0 lds
    buffer_load_dwordx4 v29, s[24:27], s44 offen offset:1024 lds
    buffer_load_dwordx4 v30, s[24:27], s44 offen offset:2048 lds
    buffer_load_dwordx4 v31, s[24:27], s44 offen offset:3072 lds
    s_waitcnt lgkmcnt(12)
    v_mfma_f32_32x32x16_bf16 v[128:143], v[56:59], a[8:11], v[128:143]
    ds_read_b64_tr_b16 v[56:57], v122 offset:16384
    ds_read_b64_tr_b16 v[58:59], v122 offset:20480
    v_mfma_f32_32x32x16_bf16 v[144:159], v[60:63], a[8:11], v[144:159]
    ds_read_b64_tr_b16 v[60:61], v123 offset:16384
    ds_read_b64_tr_b16 v[62:63], v123 offset:20480
    s_waitcnt lgkmcnt(12)
    v_mfma_f32_32x32x16_bf16 v[160:175], v[64:67], a[8:11], v[160:175]
    ds_read_b64_tr_b16 v[64:65], v116 offset:24576
    ds_read_b64_tr_b16 v[66:67], v116 offset:28672
    v_mfma_f32_32x32x16_bf16 v[176:191], v[68:71], a[8:11], v[176:191]
    ds_read_b64_tr_b16 v[68:69], v117 offset:24576
    ds_read_b64_tr_b16 v[70:71], v117 offset:28672
    s_waitcnt lgkmcnt(12)
    v_mfma_f32_32x32x16_bf16 v[192:207], v[40:43], a[8:11], v[192:207]
    ds_read_b64_tr_b16 v[40:41], v118 offset:24576
    ds_read_b64_tr_b16 v[42:43], v118 offset:28672
    v_mfma_f32_32x32x16_bf16 v[208:223], v[44:47], a[8:11], v[208:223]
    ds_read_b64_tr_b16 v[44:45], v119 offset:24576
    ds_read_b64_tr_b16 v[46:47], v119 offset:28672
    s_waitcnt lgkmcnt(12)
    v_mfma_f32_32x32x16_bf16 v[224:239], v[48:51], a[8:11], v[224:239]
    ds_read_b64_tr_b16 v[48:49], v116 offset:24832
    ds_read_b64_tr_b16 v[50:51], v116 offset:28928
    v_mfma_f32_32x32x16_bf16 v[240:255], v[52:55], a[8:11], v[240:255]
    ds_read_b64_tr_b16 v[52:53], v117 offset:24832
    ds_read_b64_tr_b16 v[54:55], v117 offset:28928
    s_waitcnt lgkmcnt(12)
    v_mfma_f32_32x32x16_bf16 v[72:87], v[56:59], a[136:139], v[72:87]
    ds_read_b64_tr_b16 v[56:57], v118 offset:24832
    ds_read_b64_tr_b16 v[58:59], v118 offset:28928
    v_mfma_f32_32x32x16_bf16 v[88:103], v[60:63], a[136:139], v[88:103]
    ds_read_b64_tr_b16 v[60:61], v119 offset:24832
    ds_read_b64_tr_b16 v[62:63], v119 offset:28928
    s_waitcnt lgkmcnt(12)
    v_mfma_f32_32x32x16_bf16 v[128:143], v[64:67], a[12:15], v[128:143]
    ds_read_b64_tr_b16 v[64:65], v122 offset:24576
    ds_read_b64_tr_b16 v[66:67], v122 offset:28672
    v_mfma_f32_32x32x16_bf16 v[144:159], v[68:71], a[12:15], v[144:159]
    ds_read_b64_tr_b16 v[68:69], v123 offset:24576
    ds_read_b64_tr_b16 v[70:71], v123 offset:28672
    s_waitcnt lgkmcnt(12)
    v_mfma_f32_32x32x16_bf16 v[160:175], v[40:43], a[12:15], v[160:175]
    ds_read_b64_tr_b16 v[40:41], v116 offset:32768
    ds_read_b64_tr_b16 v[42:43], v116 offset:36864
    v_mfma_f32_32x32x16_bf16 v[176:191], v[44:47], a[12:15], v[176:191]
    ds_read_b64_tr_b16 v[44:45], v117 offset:32768
    ds_read_b64_tr_b16 v[46:47], v117 offset:36864
    s_waitcnt lgkmcnt(12)
    v_mfma_f32_32x32x16_bf16 v[192:207], v[48:51], a[12:15], v[192:207]
    ds_read_b64_tr_b16 v[48:49], v118 offset:32768
    ds_read_b64_tr_b16 v[50:51], v118 offset:36864
    v_mfma_f32_32x32x16_bf16 v[208:223], v[52:55], a[12:15], v[208:223]
    ds_read_b64_tr_b16 v[52:53], v119 offset:32768
    ds_read_b64_tr_b16 v[54:55], v119 offset:36864
    s_waitcnt lgkmcnt(12)
    v_mfma_f32_32x32x16_bf16 v[224:239], v[56:59], a[12:15], v[224:239]
    ds_read_b64_tr_b16 v[56:57], v116 offset:33024
    ds_read_b64_tr_b16 v[58:59], v116 offset:37120
    v_mfma_f32_32x32x16_bf16 v[240:255], v[60:63], a[12:15], v[240:255]
    ds_read_b64_tr_b16 v[60:61], v117 offset:33024
    ds_read_b64_tr_b16 v[62:63], v117 offset:37120
    s_waitcnt lgkmcnt(12)
    v_mfma_f32_32x32x16_bf16 v[72:87], v[64:67], a[140:143], v[72:87]
    ds_read_b64_tr_b16 v[64:65], v118 offset:33024
    ds_read_b64_tr_b16 v[66:67], v118 offset:37120
    v_mfma_f32_32x32x16_bf16 v[88:103], v[68:71], a[140:143], v[88:103]
    ds_read_b64_tr_b16 v[68:69], v119 offset:33024
    ds_read_b64_tr_b16 v[70:71], v119 offset:37120
    s_waitcnt vmcnt(24)
    s_barrier
    s_add_u32 s43, s32, 81920
    s_mov_b32 m0, s43
    s_add_u32 s44, s38, 512
    buffer_load_dwordx4 v28, s[24:27], s44 offen offset:0 lds
    buffer_load_dwordx4 v29, s[24:27], s44 offen offset:1024 lds
    buffer_load_dwordx4 v30, s[24:27], s44 offen offset:2048 lds
    buffer_load_dwordx4 v31, s[24:27], s44 offen offset:3072 lds
    s_waitcnt lgkmcnt(12)
    v_mfma_f32_32x32x16_bf16 v[128:143], v[40:43], a[16:19], v[128:143]
    ds_read_b64_tr_b16 v[40:41], v122 offset:32768
    ds_read_b64_tr_b16 v[42:43], v122 offset:36864
    v_mfma_f32_32x32x16_bf16 v[144:159], v[44:47], a[16:19], v[144:159]
    ds_read_b64_tr_b16 v[44:45], v123 offset:32768
    ds_read_b64_tr_b16 v[46:47], v123 offset:36864
    s_waitcnt lgkmcnt(12)
    v_mfma_f32_32x32x16_bf16 v[160:175], v[48:51], a[16:19], v[160:175]
    ds_read_b64_tr_b16 v[48:49], v116 offset:40960
    ds_read_b64_tr_b16 v[50:51], v116 offset:45056
    v_mfma_f32_32x32x16_bf16 v[176:191], v[52:55], a[16:19], v[176:191]
    ds_read_b64_tr_b16 v[52:53], v117 offset:40960
    ds_read_b64_tr_b16 v[54:55], v117 offset:45056
    s_waitcnt lgkmcnt(12)
    v_mfma_f32_32x32x16_bf16 v[192:207], v[56:59], a[16:19], v[192:207]
    ds_read_b64_tr_b16 v[56:57], v118 offset:40960
    ds_read_b64_tr_b16 v[58:59], v118 offset:45056
    v_mfma_f32_32x32x16_bf16 v[208:223], v[60:63], a[16:19], v[208:223]
    ds_read_b64_tr_b16 v[60:61], v119 offset:40960
    ds_read_b64_tr_b16 v[62:63], v119 offset:45056
    s_waitcnt lgkmcnt(12)
    v_mfma_f32_32x32x16_bf16 v[224:239], v[64:67], a[16:19], v[224:239]
    ds_read_b64_tr_b16 v[64:65], v116 offset:41216
    ds_read_b64_tr_b16 v[66:67], v116 offset:45312
    v_mfma_f32_32x32x16_bf16 v[240:255], v[68:71], a[16:19], v[240:255]
    ds_read_b64_tr_b16 v[68:69], v117 offset:41216
    ds_read_b64_tr_b16 v[70:71], v117 offset:45312
    s_waitcnt lgkmcnt(12)
    v_mfma_f32_32x32x16_bf16 v[72:87], v[40:43], a[144:147], v[72:87]
    ds_read_b64_tr_b16 v[40:41], v118 offset:41216
    ds_read_b64_tr_b16 v[42:43], v118 offset:45312
    v_mfma_f32_32x32x16_bf16 v[88:103], v[44:47], a[144:147], v[88:103]
    ds_read_b64_tr_b16 v[44:45], v119 offset:41216
    ds_read_b64_tr_b16 v[46:47], v119 offset:45312
    s_waitcnt lgkmcnt(12)
    v_mfma_f32_32x32x16_bf16 v[128:143], v[48:51], a[20:23], v[128:143]
    ds_read_b64_tr_b16 v[48:49], v122 offset:40960
    ds_read_b64_tr_b16 v[50:51], v122 offset:45056
    v_mfma_f32_32x32x16_bf16 v[144:159], v[52:55], a[20:23], v[144:159]
    ds_read_b64_tr_b16 v[52:53], v123 offset:40960
    ds_read_b64_tr_b16 v[54:55], v123 offset:45056
    s_waitcnt lgkmcnt(12)
    v_mfma_f32_32x32x16_bf16 v[160:175], v[56:59], a[20:23], v[160:175]
    ds_read_b64_tr_b16 v[56:57], v112 offset:0
    ds_read_b64_tr_b16 v[58:59], v112 offset:4096
    v_mfma_f32_32x32x16_bf16 v[176:191], v[60:63], a[20:23], v[176:191]
    ds_read_b64_tr_b16 v[60:61], v113 offset:0
    ds_read_b64_tr_b16 v[62:63], v113 offset:4096
    s_waitcnt lgkmcnt(12)
    v_mfma_f32_32x32x16_bf16 v[192:207], v[64:67], a[20:23], v[192:207]
    ds_read_b64_tr_b16 v[64:65], v114 offset:0
    ds_read_b64_tr_b16 v[66:67], v114 offset:4096
    v_mfma_f32_32x32x16_bf16 v[208:223], v[68:71], a[20:23], v[208:223]
    ds_read_b64_tr_b16 v[68:69], v115 offset:0
    ds_read_b64_tr_b16 v[70:71], v115 offset:4096
    s_waitcnt lgkmcnt(12)
    v_mfma_f32_32x32x16_bf16 v[224:239], v[40:43], a[20:23], v[224:239]
    ds_read_b64_tr_b16 v[40:41], v112 offset:256
    ds_read_b64_tr_b16 v[42:43], v112 offset:4352
    v_mfma_f32_32x32x16_bf16 v[240:255], v[44:47], a[20:23], v[240:255]
    ds_read_b64_tr_b16 v[44:45], v113 offset:256
    ds_read_b64_tr_b16 v[46:47], v113 offset:4352
    s_waitcnt lgkmcnt(12)
    v_mfma_f32_32x32x16_bf16 v[72:87], v[48:51], a[148:151], v[72:87]
    ds_read_b64_tr_b16 v[48:49], v114 offset:256
    ds_read_b64_tr_b16 v[50:51], v114 offset:4352
    v_mfma_f32_32x32x16_bf16 v[88:103], v[52:55], a[148:151], v[88:103]
    ds_read_b64_tr_b16 v[52:53], v115 offset:256
    ds_read_b64_tr_b16 v[54:55], v115 offset:4352
    s_waitcnt vmcnt(20)
    s_barrier
    s_add_u32 s43, s32, 98304
    s_mov_b32 m0, s43
    s_add_u32 s44, s38, 29184
    buffer_load_dwordx4 v28, s[24:27], s44 offen offset:0 lds
    buffer_load_dwordx4 v29, s[24:27], s44 offen offset:1024 lds
    buffer_load_dwordx4 v30, s[24:27], s44 offen offset:2048 lds
    buffer_load_dwordx4 v31, s[24:27], s44 offen offset:3072 lds
    s_waitcnt lgkmcnt(12)
    v_mfma_f32_32x32x16_bf16 v[128:143], v[56:59], a[24:27], v[128:143]
    ds_read_b64_tr_b16 v[56:57], v120 offset:0
    ds_read_b64_tr_b16 v[58:59], v120 offset:4096
    v_mfma_f32_32x32x16_bf16 v[144:159], v[60:63], a[24:27], v[144:159]
    ds_read_b64_tr_b16 v[60:61], v121 offset:0
    ds_read_b64_tr_b16 v[62:63], v121 offset:4096
    s_waitcnt lgkmcnt(12)
    v_mfma_f32_32x32x16_bf16 v[160:175], v[64:67], a[24:27], v[160:175]
    ds_read_b64_tr_b16 v[64:65], v112 offset:8192
    ds_read_b64_tr_b16 v[66:67], v112 offset:12288
    v_mfma_f32_32x32x16_bf16 v[176:191], v[68:71], a[24:27], v[176:191]
    ds_read_b64_tr_b16 v[68:69], v113 offset:8192
    ds_read_b64_tr_b16 v[70:71], v113 offset:12288
    s_waitcnt lgkmcnt(12)
    v_mfma_f32_32x32x16_bf16 v[192:207], v[40:43], a[24:27], v[192:207]
    ds_read_b64_tr_b16 v[40:41], v114 offset:8192
    ds_read_b64_tr_b16 v[42:43], v114 offset:12288
    v_mfma_f32_32x32x16_bf16 v[208:223], v[44:47], a[24:27], v[208:223]
    ds_read_b64_tr_b16 v[44:45], v115 offset:8192
    ds_read_b64_tr_b16 v[46:47], v115 offset:12288
    s_waitcnt lgkmcnt(12)
    v_mfma_f32_32x32x16_bf16 v[224:239], v[48:51], a[24:27], v[224:239]
    ds_read_b64_tr_b16 v[48:49], v112 offset:8448
    ds_read_b64_tr_b16 v[50:51], v112 offset:12544
    v_mfma_f32_32x32x16_bf16 v[240:255], v[52:55], a[24:27], v[240:255]
    ds_read_b64_tr_b16 v[52:53], v113 offset:8448
    ds_read_b64_tr_b16 v[54:55], v113 offset:12544
    s_waitcnt lgkmcnt(12)
    v_mfma_f32_32x32x16_bf16 v[72:87], v[56:59], a[152:155], v[72:87]
    ds_read_b64_tr_b16 v[56:57], v114 offset:8448
    ds_read_b64_tr_b16 v[58:59], v114 offset:12544
    v_mfma_f32_32x32x16_bf16 v[88:103], v[60:63], a[152:155], v[88:103]
    ds_read_b64_tr_b16 v[60:61], v115 offset:8448
    ds_read_b64_tr_b16 v[62:63], v115 offset:12544
    s_waitcnt lgkmcnt(12)
    v_mfma_f32_32x32x16_bf16 v[128:143], v[64:67], a[28:31], v[128:143]
    ds_read_b64_tr_b16 v[64:65], v120 offset:8192
    ds_read_b64_tr_b16 v[66:67], v120 offset:12288
    v_mfma_f32_32x32x16_bf16 v[144:159], v[68:71], a[28:31], v[144:159]
    ds_read_b64_tr_b16 v[68:69], v121 offset:8192
    ds_read_b64_tr_b16 v[70:71], v121 offset:12288
    s_waitcnt lgkmcnt(12)
    v_mfma_f32_32x32x16_bf16 v[160:175], v[40:43], a[28:31], v[160:175]
    ds_read_b64_tr_b16 v[40:41], v112 offset:16384
    ds_read_b64_tr_b16 v[42:43], v112 offset:20480
    v_mfma_f32_32x32x16_bf16 v[176:191], v[44:47], a[28:31], v[176:191]
    ds_read_b64_tr_b16 v[44:45], v113 offset:16384
    ds_read_b64_tr_b16 v[46:47], v113 offset:20480
    s_waitcnt lgkmcnt(12)
    v_mfma_f32_32x32x16_bf16 v[192:207], v[48:51], a[28:31], v[192:207]
    ds_read_b64_tr_b16 v[48:49], v114 offset:16384
    ds_read_b64_tr_b16 v[50:51], v114 offset:20480
    v_mfma_f32_32x32x16_bf16 v[208:223], v[52:55], a[28:31], v[208:223]
    ds_read_b64_tr_b16 v[52:53], v115 offset:16384
    ds_read_b64_tr_b16 v[54:55], v115 offset:20480
    s_waitcnt lgkmcnt(12)
    v_mfma_f32_32x32x16_bf16 v[224:239], v[56:59], a[28:31], v[224:239]
    ds_read_b64_tr_b16 v[56:57], v112 offset:16640
    ds_read_b64_tr_b16 v[58:59], v112 offset:20736
    v_mfma_f32_32x32x16_bf16 v[240:255], v[60:63], a[28:31], v[240:255]
    ds_read_b64_tr_b16 v[60:61], v113 offset:16640
    ds_read_b64_tr_b16 v[62:63], v113 offset:20736
    s_waitcnt lgkmcnt(12)
    v_mfma_f32_32x32x16_bf16 v[72:87], v[64:67], a[156:159], v[72:87]
    ds_read_b64_tr_b16 v[64:65], v114 offset:16640
    ds_read_b64_tr_b16 v[66:67], v114 offset:20736
    v_mfma_f32_32x32x16_bf16 v[88:103], v[68:71], a[156:159], v[88:103]
    ds_read_b64_tr_b16 v[68:69], v115 offset:16640
    ds_read_b64_tr_b16 v[70:71], v115 offset:20736
    s_waitcnt vmcnt(16)
    s_barrier
    s_add_u32 s43, s32, 0
    s_mov_b32 m0, s43
    s_add_u32 s44, s38, 57856
    buffer_load_dwordx4 v28, s[24:27], s44 offen offset:0 lds
    buffer_load_dwordx4 v29, s[24:27], s44 offen offset:1024 lds
    buffer_load_dwordx4 v30, s[24:27], s44 offen offset:2048 lds
    buffer_load_dwordx4 v31, s[24:27], s44 offen offset:3072 lds
    s_waitcnt lgkmcnt(12)
    v_mfma_f32_32x32x16_bf16 v[128:143], v[40:43], a[32:35], v[128:143]
    ds_read_b64_tr_b16 v[40:41], v120 offset:16384
    ds_read_b64_tr_b16 v[42:43], v120 offset:20480
    v_mfma_f32_32x32x16_bf16 v[144:159], v[44:47], a[32:35], v[144:159]
    ds_read_b64_tr_b16 v[44:45], v121 offset:16384
    ds_read_b64_tr_b16 v[46:47], v121 offset:20480
    s_waitcnt lgkmcnt(12)
    v_mfma_f32_32x32x16_bf16 v[160:175], v[48:51], a[32:35], v[160:175]
    ds_read_b64_tr_b16 v[48:49], v112 offset:24576
    ds_read_b64_tr_b16 v[50:51], v112 offset:28672
    v_mfma_f32_32x32x16_bf16 v[176:191], v[52:55], a[32:35], v[176:191]
    ds_read_b64_tr_b16 v[52:53], v113 offset:24576
    ds_read_b64_tr_b16 v[54:55], v113 offset:28672
    s_waitcnt lgkmcnt(12)
    v_mfma_f32_32x32x16_bf16 v[192:207], v[56:59], a[32:35], v[192:207]
    ds_read_b64_tr_b16 v[56:57], v114 offset:24576
    ds_read_b64_tr_b16 v[58:59], v114 offset:28672
    v_mfma_f32_32x32x16_bf16 v[208:223], v[60:63], a[32:35], v[208:223]
    ds_read_b64_tr_b16 v[60:61], v115 offset:24576
    ds_read_b64_tr_b16 v[62:63], v115 offset:28672
    s_waitcnt lgkmcnt(12)
    v_mfma_f32_32x32x16_bf16 v[224:239], v[64:67], a[32:35], v[224:239]
    ds_read_b64_tr_b16 v[64:65], v112 offset:24832
    ds_read_b64_tr_b16 v[66:67], v112 offset:28928
    v_mfma_f32_32x32x16_bf16 v[240:255], v[68:71], a[32:35], v[240:255]
    ds_read_b64_tr_b16 v[68:69], v113 offset:24832
    ds_read_b64_tr_b16 v[70:71], v113 offset:28928
    s_waitcnt lgkmcnt(12)
    v_mfma_f32_32x32x16_bf16 v[72:87], v[40:43], a[160:163], v[72:87]
    ds_read_b64_tr_b16 v[40:41], v114 offset:24832
    ds_read_b64_tr_b16 v[42:43], v114 offset:28928
    v_mfma_f32_32x32x16_bf16 v[88:103], v[44:47], a[160:163], v[88:103]
    ds_read_b64_tr_b16 v[44:45], v115 offset:24832
    ds_read_b64_tr_b16 v[46:47], v115 offset:28928
    s_waitcnt lgkmcnt(12)
    v_mfma_f32_32x32x16_bf16 v[128:143], v[48:51], a[36:39], v[128:143]
    ds_read_b64_tr_b16 v[48:49], v120 offset:24576
    ds_read_b64_tr_b16 v[50:51], v120 offset:28672
    v_mfma_f32_32x32x16_bf16 v[144:159], v[52:55], a[36:39], v[144:159]
    ds_read_b64_tr_b16 v[52:53], v121 offset:24576
    ds_read_b64_tr_b16 v[54:55], v121 offset:28672
    s_waitcnt lgkmcnt(12)
    v_mfma_f32_32x32x16_bf16 v[160:175], v[56:59], a[36:39], v[160:175]
    ds_read_b64_tr_b16 v[56:57], v112 offset:32768
    ds_read_b64_tr_b16 v[58:59], v112 offset:36864
    v_mfma_f32_32x32x16_bf16 v[176:191], v[60:63], a[36:39], v[176:191]
    ds_read_b64_tr_b16 v[60:61], v113 offset:32768
    ds_read_b64_tr_b16 v[62:63], v113 offset:36864
    s_waitcnt lgkmcnt(12)
    v_mfma_f32_32x32x16_bf16 v[192:207], v[64:67], a[36:39], v[192:207]
    ds_read_b64_tr_b16 v[64:65], v114 offset:32768
    ds_read_b64_tr_b16 v[66:67], v114 offset:36864
    v_mfma_f32_32x32x16_bf16 v[208:223], v[68:71], a[36:39], v[208:223]
    ds_read_b64_tr_b16 v[68:69], v115 offset:32768
    ds_read_b64_tr_b16 v[70:71], v115 offset:36864
    s_waitcnt lgkmcnt(12)
    v_mfma_f32_32x32x16_bf16 v[224:239], v[40:43], a[36:39], v[224:239]
    ds_read_b64_tr_b16 v[40:41], v112 offset:33024
    ds_read_b64_tr_b16 v[42:43], v112 offset:37120
    v_mfma_f32_32x32x16_bf16 v[240:255], v[44:47], a[36:39], v[240:255]
    ds_read_b64_tr_b16 v[44:45], v113 offset:33024
    ds_read_b64_tr_b16 v[46:47], v113 offset:37120
    s_waitcnt lgkmcnt(12)
    v_mfma_f32_32x32x16_bf16 v[72:87], v[48:51], a[164:167], v[72:87]
    ds_read_b64_tr_b16 v[48:49], v114 offset:33024
    ds_read_b64_tr_b16 v[50:51], v114 offset:37120
    v_mfma_f32_32x32x16_bf16 v[88:103], v[52:55], a[164:167], v[88:103]
    ds_read_b64_tr_b16 v[52:53], v115 offset:33024
    ds_read_b64_tr_b16 v[54:55], v115 offset:37120
    s_waitcnt vmcnt(16)
    s_barrier
    s_add_u32 s43, s32, 16384
    s_mov_b32 m0, s43
    s_add_u32 s44, s38, 86528
    buffer_load_dwordx4 v28, s[24:27], s44 offen offset:0 lds
    buffer_load_dwordx4 v29, s[24:27], s44 offen offset:1024 lds
    buffer_load_dwordx4 v30, s[24:27], s44 offen offset:2048 lds
    buffer_load_dwordx4 v31, s[24:27], s44 offen offset:3072 lds
    s_waitcnt lgkmcnt(12)
    v_mfma_f32_32x32x16_bf16 v[128:143], v[56:59], a[40:43], v[128:143]
    ds_read_b64_tr_b16 v[56:57], v120 offset:32768
    ds_read_b64_tr_b16 v[58:59], v120 offset:36864
    v_mfma_f32_32x32x16_bf16 v[144:159], v[60:63], a[40:43], v[144:159]
    ds_read_b64_tr_b16 v[60:61], v121 offset:32768
    ds_read_b64_tr_b16 v[62:63], v121 offset:36864
    s_waitcnt lgkmcnt(12)
    v_mfma_f32_32x32x16_bf16 v[160:175], v[64:67], a[40:43], v[160:175]
    ds_read_b64_tr_b16 v[64:65], v112 offset:40960
    ds_read_b64_tr_b16 v[66:67], v112 offset:45056
    v_mfma_f32_32x32x16_bf16 v[176:191], v[68:71], a[40:43], v[176:191]
    ds_read_b64_tr_b16 v[68:69], v113 offset:40960
    ds_read_b64_tr_b16 v[70:71], v113 offset:45056
    s_waitcnt lgkmcnt(12)
    v_mfma_f32_32x32x16_bf16 v[192:207], v[40:43], a[40:43], v[192:207]
    ds_read_b64_tr_b16 v[40:41], v114 offset:40960
    ds_read_b64_tr_b16 v[42:43], v114 offset:45056
    v_mfma_f32_32x32x16_bf16 v[208:223], v[44:47], a[40:43], v[208:223]
    ds_read_b64_tr_b16 v[44:45], v115 offset:40960
    ds_read_b64_tr_b16 v[46:47], v115 offset:45056
    s_waitcnt lgkmcnt(12)
    v_mfma_f32_32x32x16_bf16 v[224:239], v[48:51], a[40:43], v[224:239]
    ds_read_b64_tr_b16 v[48:49], v112 offset:41216
    ds_read_b64_tr_b16 v[50:51], v112 offset:45312
    v_mfma_f32_32x32x16_bf16 v[240:255], v[52:55], a[40:43], v[240:255]
    ds_read_b64_tr_b16 v[52:53], v113 offset:41216
    ds_read_b64_tr_b16 v[54:55], v113 offset:45312
    s_waitcnt lgkmcnt(12)
    v_mfma_f32_32x32x16_bf16 v[72:87], v[56:59], a[168:171], v[72:87]
    ds_read_b64_tr_b16 v[56:57], v114 offset:41216
    ds_read_b64_tr_b16 v[58:59], v114 offset:45312
    v_mfma_f32_32x32x16_bf16 v[88:103], v[60:63], a[168:171], v[88:103]
    ds_read_b64_tr_b16 v[60:61], v115 offset:41216
    ds_read_b64_tr_b16 v[62:63], v115 offset:45312
    s_waitcnt lgkmcnt(12)
    v_mfma_f32_32x32x16_bf16 v[128:143], v[64:67], a[44:47], v[128:143]
    ds_read_b64_tr_b16 v[64:65], v120 offset:40960
    ds_read_b64_tr_b16 v[66:67], v120 offset:45056
    v_mfma_f32_32x32x16_bf16 v[144:159], v[68:71], a[44:47], v[144:159]
    ds_read_b64_tr_b16 v[68:69], v121 offset:40960
    ds_read_b64_tr_b16 v[70:71], v121 offset:45056
    s_waitcnt lgkmcnt(12)
    v_mfma_f32_32x32x16_bf16 v[160:175], v[40:43], a[44:47], v[160:175]
    ds_read_b64_tr_b16 v[40:41], v112 offset:49152
    ds_read_b64_tr_b16 v[42:43], v112 offset:53248
    v_mfma_f32_32x32x16_bf16 v[176:191], v[44:47], a[44:47], v[176:191]
    ds_read_b64_tr_b16 v[44:45], v113 offset:49152
    ds_read_b64_tr_b16 v[46:47], v113 offset:53248
    s_waitcnt lgkmcnt(12)
    v_mfma_f32_32x32x16_bf16 v[192:207], v[48:51], a[44:47], v[192:207]
    ds_read_b64_tr_b16 v[48:49], v114 offset:49152
    ds_read_b64_tr_b16 v[50:51], v114 offset:53248
    v_mfma_f32_32x32x16_bf16 v[208:223], v[52:55], a[44:47], v[208:223]
    ds_read_b64_tr_b16 v[52:53], v115 offset:49152
    ds_read_b64_tr_b16 v[54:55], v115 offset:53248
    s_waitcnt lgkmcnt(12)
    v_mfma_f32_32x32x16_bf16 v[224:239], v[56:59], a[44:47], v[224:239]
    ds_read_b64_tr_b16 v[56:57], v112 offset:49408
    ds_read_b64_tr_b16 v[58:59], v112 offset:53504
    v_mfma_f32_32x32x16_bf16 v[240:255], v[60:63], a[44:47], v[240:255]
    ds_read_b64_tr_b16 v[60:61], v113 offset:49408
    ds_read_b64_tr_b16 v[62:63], v113 offset:53504
    s_waitcnt lgkmcnt(12)
    v_mfma_f32_32x32x16_bf16 v[72:87], v[64:67], a[172:175], v[72:87]
    ds_read_b64_tr_b16 v[64:65], v114 offset:49408
    ds_read_b64_tr_b16 v[66:67], v114 offset:53504
    v_mfma_f32_32x32x16_bf16 v[88:103], v[68:71], a[172:175], v[88:103]
    ds_read_b64_tr_b16 v[68:69], v115 offset:49408
    ds_read_b64_tr_b16 v[70:71], v115 offset:53504
    s_waitcnt vmcnt(16)
    s_barrier
    s_add_u32 s43, s32, 32768
    s_mov_b32 m0, s43
    s_add_u32 s44, s38, 115200
    buffer_load_dwordx4 v28, s[24:27], s44 offen offset:0 lds
    buffer_load_dwordx4 v29, s[24:27], s44 offen offset:1024 lds
    buffer_load_dwordx4 v30, s[24:27], s44 offen offset:2048 lds
    buffer_load_dwordx4 v31, s[24:27], s44 offen offset:3072 lds
    s_waitcnt lgkmcnt(12)
    v_mfma_f32_32x32x16_bf16 v[128:143], v[40:43], a[48:51], v[128:143]
    ds_read_b64_tr_b16 v[40:41], v120 offset:49152
    ds_read_b64_tr_b16 v[42:43], v120 offset:53248
    v_mfma_f32_32x32x16_bf16 v[144:159], v[44:47], a[48:51], v[144:159]
    ds_read_b64_tr_b16 v[44:45], v121 offset:49152
    ds_read_b64_tr_b16 v[46:47], v121 offset:53248
    s_waitcnt lgkmcnt(12)
    v_mfma_f32_32x32x16_bf16 v[160:175], v[48:51], a[48:51], v[160:175]
    ds_read_b64_tr_b16 v[48:49], v112 offset:57344
    ds_read_b64_tr_b16 v[50:51], v112 offset:61440
    v_mfma_f32_32x32x16_bf16 v[176:191], v[52:55], a[48:51], v[176:191]
    ds_read_b64_tr_b16 v[52:53], v113 offset:57344
    ds_read_b64_tr_b16 v[54:55], v113 offset:61440
    s_waitcnt lgkmcnt(12)
    v_mfma_f32_32x32x16_bf16 v[192:207], v[56:59], a[48:51], v[192:207]
    ds_read_b64_tr_b16 v[56:57], v114 offset:57344
    ds_read_b64_tr_b16 v[58:59], v114 offset:61440
    v_mfma_f32_32x32x16_bf16 v[208:223], v[60:63], a[48:51], v[208:223]
    ds_read_b64_tr_b16 v[60:61], v115 offset:57344
    ds_read_b64_tr_b16 v[62:63], v115 offset:61440
    s_waitcnt lgkmcnt(12)
    v_mfma_f32_32x32x16_bf16 v[224:239], v[64:67], a[48:51], v[224:239]
    ds_read_b64_tr_b16 v[64:65], v112 offset:57600
    ds_read_b64_tr_b16 v[66:67], v112 offset:61696
    v_mfma_f32_32x32x16_bf16 v[240:255], v[68:71], a[48:51], v[240:255]
    ds_read_b64_tr_b16 v[68:69], v113 offset:57600
    ds_read_b64_tr_b16 v[70:71], v113 offset:61696
    s_waitcnt lgkmcnt(12)
    v_mfma_f32_32x32x16_bf16 v[72:87], v[40:43], a[176:179], v[72:87]
    ds_read_b64_tr_b16 v[40:41], v114 offset:57600
    ds_read_b64_tr_b16 v[42:43], v114 offset:61696
    v_mfma_f32_32x32x16_bf16 v[88:103], v[44:47], a[176:179], v[88:103]
    ds_read_b64_tr_b16 v[44:45], v115 offset:57600
    ds_read_b64_tr_b16 v[46:47], v115 offset:61696
    s_waitcnt lgkmcnt(12)
    v_mfma_f32_32x32x16_bf16 v[128:143], v[48:51], a[52:55], v[128:143]
    ds_read_b64_tr_b16 v[48:49], v120 offset:57344
    ds_read_b64_tr_b16 v[50:51], v120 offset:61440
    v_mfma_f32_32x32x16_bf16 v[144:159], v[52:55], a[52:55], v[144:159]
    ds_read_b64_tr_b16 v[52:53], v121 offset:57344
    ds_read_b64_tr_b16 v[54:55], v121 offset:61440
    s_waitcnt lgkmcnt(12)
    v_mfma_f32_32x32x16_bf16 v[160:175], v[56:59], a[52:55], v[160:175]
    ds_read_b64_tr_b16 v[56:57], v116 offset:0
    ds_read_b64_tr_b16 v[58:59], v116 offset:4096
    v_mfma_f32_32x32x16_bf16 v[176:191], v[60:63], a[52:55], v[176:191]
    ds_read_b64_tr_b16 v[60:61], v117 offset:0
    ds_read_b64_tr_b16 v[62:63], v117 offset:4096
    s_waitcnt lgkmcnt(12)
    v_mfma_f32_32x32x16_bf16 v[192:207], v[64:67], a[52:55], v[192:207]
    ds_read_b64_tr_b16 v[64:65], v118 offset:0
    ds_read_b64_tr_b16 v[66:67], v118 offset:4096
    v_mfma_f32_32x32x16_bf16 v[208:223], v[68:71], a[52:55], v[208:223]
    ds_read_b64_tr_b16 v[68:69], v119 offset:0
    ds_read_b64_tr_b16 v[70:71], v119 offset:4096
    s_waitcnt lgkmcnt(12)
    v_mfma_f32_32x32x16_bf16 v[224:239], v[40:43], a[52:55], v[224:239]
    ds_read_b64_tr_b16 v[40:41], v116 offset:256
    ds_read_b64_tr_b16 v[42:43], v116 offset:4352
    v_mfma_f32_32x32x16_bf16 v[240:255], v[44:47], a[52:55], v[240:255]
    ds_read_b64_tr_b16 v[44:45], v117 offset:256
    ds_read_b64_tr_b16 v[46:47], v117 offset:4352
    s_waitcnt lgkmcnt(12)
    v_mfma_f32_32x32x16_bf16 v[72:87], v[48:51], a[180:183], v[72:87]
    ds_read_b64_tr_b16 v[48:49], v118 offset:256
    ds_read_b64_tr_b16 v[50:51], v118 offset:4352
    v_mfma_f32_32x32x16_bf16 v[88:103], v[52:55], a[180:183], v[88:103]
    ds_read_b64_tr_b16 v[52:53], v119 offset:256
    ds_read_b64_tr_b16 v[54:55], v119 offset:4352
    s_waitcnt vmcnt(16)
    s_barrier
    s_add_u32 s43, s32, 49152
    s_mov_b32 m0, s43
    s_add_u32 s44, s38, 143872
    buffer_load_dwordx4 v28, s[24:27], s44 offen offset:0 lds
    buffer_load_dwordx4 v29, s[24:27], s44 offen offset:1024 lds
    buffer_load_dwordx4 v30, s[24:27], s44 offen offset:2048 lds
    buffer_load_dwordx4 v31, s[24:27], s44 offen offset:3072 lds
    s_waitcnt lgkmcnt(12)
    v_mfma_f32_32x32x16_bf16 v[128:143], v[56:59], a[56:59], v[128:143]
    ds_read_b64_tr_b16 v[56:57], v122 offset:0
    ds_read_b64_tr_b16 v[58:59], v122 offset:4096
    v_mfma_f32_32x32x16_bf16 v[144:159], v[60:63], a[56:59], v[144:159]
    ds_read_b64_tr_b16 v[60:61], v123 offset:0
    ds_read_b64_tr_b16 v[62:63], v123 offset:4096
    s_waitcnt lgkmcnt(12)
    v_mfma_f32_32x32x16_bf16 v[160:175], v[64:67], a[56:59], v[160:175]
    ds_read_b64_tr_b16 v[64:65], v116 offset:8192
    ds_read_b64_tr_b16 v[66:67], v116 offset:12288
    v_mfma_f32_32x32x16_bf16 v[176:191], v[68:71], a[56:59], v[176:191]
    ds_read_b64_tr_b16 v[68:69], v117 offset:8192
    ds_read_b64_tr_b16 v[70:71], v117 offset:12288
    s_waitcnt lgkmcnt(12)
    v_mfma_f32_32x32x16_bf16 v[192:207], v[40:43], a[56:59], v[192:207]
    ds_read_b64_tr_b16 v[40:41], v118 offset:8192
    ds_read_b64_tr_b16 v[42:43], v118 offset:12288
    v_mfma_f32_32x32x16_bf16 v[208:223], v[44:47], a[56:59], v[208:223]
    ds_read_b64_tr_b16 v[44:45], v119 offset:8192
    ds_read_b64_tr_b16 v[46:47], v119 offset:12288
    s_waitcnt lgkmcnt(12)
    v_mfma_f32_32x32x16_bf16 v[224:239], v[48:51], a[56:59], v[224:239]
    ds_read_b64_tr_b16 v[48:49], v116 offset:8448
    ds_read_b64_tr_b16 v[50:51], v116 offset:12544
    v_mfma_f32_32x32x16_bf16 v[240:255], v[52:55], a[56:59], v[240:255]
    ds_read_b64_tr_b16 v[52:53], v117 offset:8448
    ds_read_b64_tr_b16 v[54:55], v117 offset:12544
    s_waitcnt lgkmcnt(12)
    v_mfma_f32_32x32x16_bf16 v[72:87], v[56:59], a[184:187], v[72:87]
    ds_read_b64_tr_b16 v[56:57], v118 offset:8448
    ds_read_b64_tr_b16 v[58:59], v118 offset:12544
    v_mfma_f32_32x32x16_bf16 v[88:103], v[60:63], a[184:187], v[88:103]
    ds_read_b64_tr_b16 v[60:61], v119 offset:8448
    ds_read_b64_tr_b16 v[62:63], v119 offset:12544
    s_waitcnt lgkmcnt(12)
    v_mfma_f32_32x32x16_bf16 v[128:143], v[64:67], a[60:63], v[128:143]
    ds_read_b64_tr_b16 v[64:65], v122 offset:8192
    ds_read_b64_tr_b16 v[66:67], v122 offset:12288
    v_mfma_f32_32x32x16_bf16 v[144:159], v[68:71], a[60:63], v[144:159]
    ds_read_b64_tr_b16 v[68:69], v123 offset:8192
    ds_read_b64_tr_b16 v[70:71], v123 offset:12288
    s_waitcnt lgkmcnt(12)
    v_mfma_f32_32x32x16_bf16 v[160:175], v[40:43], a[60:63], v[160:175]
    v_mfma_f32_32x32x16_bf16 v[176:191], v[44:47], a[60:63], v[176:191]
    s_waitcnt lgkmcnt(8)
    v_mfma_f32_32x32x16_bf16 v[192:207], v[48:51], a[60:63], v[192:207]
    v_mfma_f32_32x32x16_bf16 v[208:223], v[52:55], a[60:63], v[208:223]
    s_waitcnt lgkmcnt(4)
    v_mfma_f32_32x32x16_bf16 v[224:239], v[56:59], a[60:63], v[224:239]
    v_mfma_f32_32x32x16_bf16 v[240:255], v[60:63], a[60:63], v[240:255]
    s_waitcnt lgkmcnt(0)
    v_mfma_f32_32x32x16_bf16 v[72:87], v[64:67], a[188:191], v[72:87]
    v_mfma_f32_32x32x16_bf16 v[88:103], v[68:71], a[188:191], v[88:103]
    s_nop 15
    s_nop 7
    v_lshlrev_b32 v2, 4, v1
    s_mul_i32 s45, s7, 28672
    s_add_u32 s45, s45, s39
    v_cvt_pk_bf16_f32 v128, v128, v129
    v_cvt_pk_bf16_f32 v129, v130, v131
    v_cvt_pk_bf16_f32 v130, v132, v133
    v_cvt_pk_bf16_f32 v131, v134, v135
    s_add_u32 s43, s45, 0
    buffer_store_dwordx4 v[128:131], v2, s[28:31], s43 offen
    v_cvt_pk_bf16_f32 v136, v136, v137
    v_cvt_pk_bf16_f32 v137, v138, v139
    v_cvt_pk_bf16_f32 v138, v140, v141
    v_cvt_pk_bf16_f32 v139, v142, v143
    s_add_u32 s43, s45, 1024
    buffer_store_dwordx4 v[136:139], v2, s[28:31], s43 offen
    v_cvt_pk_bf16_f32 v144, v144, v145
    v_cvt_pk_bf16_f32 v145, v146, v147
    v_cvt_pk_bf16_f32 v146, v148, v149
    v_cvt_pk_bf16_f32 v147, v150, v151
    s_add_u32 s43, s45, 2048
    buffer_store_dwordx4 v[144:147], v2, s[28:31], s43 offen
    v_cvt_pk_bf16_f32 v152, v152, v153
    v_cvt_pk_bf16_f32 v153, v154, v155
    v_cvt_pk_bf16_f32 v154, v156, v157
    v_cvt_pk_bf16_f32 v155, v158, v159
    s_add_u32 s43, s45, 3072
    buffer_store_dwordx4 v[152:155], v2, s[28:31], s43 offen
    v_cvt_pk_bf16_f32 v160, v160, v161
    v_cvt_pk_bf16_f32 v161, v162, v163
    v_cvt_pk_bf16_f32 v162, v164, v165
    v_cvt_pk_bf16_f32 v163, v166, v167
    s_add_u32 s43, s45, 4096
    buffer_store_dwordx4 v[160:163], v2, s[28:31], s43 offen
    v_cvt_pk_bf16_f32 v168, v168, v169
    v_cvt_pk_bf16_f32 v169, v170, v171
    v_cvt_pk_bf16_f32 v170, v172, v173
    v_cvt_pk_bf16_f32 v171, v174, v175
    s_add_u32 s43, s45, 5120
    buffer_store_dwordx4 v[168:171], v2, s[28:31], s43 offen
    v_cvt_pk_bf16_f32 v176, v176, v177
    v_cvt_pk_bf16_f32 v177, v178, v179
    v_cvt_pk_bf16_f32 v178, v180, v181
    v_cvt_pk_bf16_f32 v179, v182, v183
    s_add_u32 s43, s45, 6144
    buffer_store_dwordx4 v[176:179], v2, s[28:31], s43 offen
    v_cvt_pk_bf16_f32 v184, v184, v185
    v_cvt_pk_bf16_f32 v185, v186, v187
    v_cvt_pk_bf16_f32 v186, v188, v189
    v_cvt_pk_bf16_f32 v187, v190, v191
    s_add_u32 s43, s45, 7168
    buffer_store_dwordx4 v[184:187], v2, s[28:31], s43 offen
    v_cvt_pk_bf16_f32 v192, v192, v193
    v_cvt_pk_bf16_f32 v193, v194, v195
    v_cvt_pk_bf16_f32 v194, v196, v197
    v_cvt_pk_bf16_f32 v195, v198, v199
    s_add_u32 s43, s45, 8192
    buffer_store_dwordx4 v[192:195], v2, s[28:31], s43 offen
    v_cvt_pk_bf16_f32 v200, v200, v201
    v_cvt_pk_bf16_f32 v201, v202, v203
    v_cvt_pk_bf16_f32 v202, v204, v205
    v_cvt_pk_bf16_f32 v203, v206, v207
    s_add_u32 s43, s45, 9216
    buffer_store_dwordx4 v[200:203], v2, s[28:31], s43 offen
    v_cvt_pk_bf16_f32 v208, v208, v209
    v_cvt_pk_bf16_f32 v209, v210, v211
    v_cvt_pk_bf16_f32 v210, v212, v213
    v_cvt_pk_bf16_f32 v211, v214, v215
    s_add_u32 s43, s45, 10240
    buffer_store_dwordx4 v[208:211], v2, s[28:31], s43 offen
    v_cvt_pk_bf16_f32 v216, v216, v217
    v_cvt_pk_bf16_f32 v217, v218, v219
    v_cvt_pk_bf16_f32 v218, v220, v221
    v_cvt_pk_bf16_f32 v219, v222, v223
    s_add_u32 s43, s45, 11264
    buffer_store_dwordx4 v[216:219], v2, s[28:31], s43 offen
    v_cvt_pk_bf16_f32 v224, v224, v225
    v_cvt_pk_bf16_f32 v225, v226, v227
    v_cvt_pk_bf16_f32 v226, v228, v229
    v_cvt_pk_bf16_f32 v227, v230, v231
    s_add_u32 s43, s45, 12288
    buffer_store_dwordx4 v[224:227], v2, s[28:31], s43 offen
    v_cvt_pk_bf16_f32 v232, v232, v233
    v_cvt_pk_bf16_f32 v233, v234, v235
    v_cvt_pk_bf16_f32 v234, v236, v237
    v_cvt_pk_bf16_f32 v235, v238, v239
    s_add_u32 s43, s45, 13312
    buffer_store_dwordx4 v[232:235], v2, s[28:31], s43 offen
    v_cvt_pk_bf16_f32 v240, v240, v241
    v_cvt_pk_bf16_f32 v241, v242, v243
    v_cvt_pk_bf16_f32 v242, v244, v245
    v_cvt_pk_bf16_f32 v243, v246, v247
    s_add_u32 s43, s45, 14336
    buffer_store_dwordx4 v[240:243], v2, s[28:31], s43 offen
    v_cvt_pk_bf16_f32 v248, v248, v249
    v_cvt_pk_bf16_f32 v249, v250, v251
    v_cvt_pk_bf16_f32 v250, v252, v253
    v_cvt_pk_bf16_f32 v251, v254, v255
    s_add_u32 s43, s45, 15360
    buffer_store_dwordx4 v[248:251], v2, s[28:31], s43 offen
    v_cvt_pk_bf16_f32 v72, v72, v73
    v_cvt_pk_bf16_f32 v73, v74, v75
    v_cvt_pk_bf16_f32 v74, v76, v77
    v_cvt_pk_bf16_f32 v75, v78, v79
    s_lshl_b32 s43, s66, 11
    s_add_u32 s43, s43, 114688
    s_add_u32 s43, s43, s39
    buffer_store_dwordx4 v[72:75], v2, s[28:31], s43 offen
    v_cvt_pk_bf16_f32 v80, v80, v81
    v_cvt_pk_bf16_f32 v81, v82, v83
    v_cvt_pk_bf16_f32 v82, v84, v85
    v_cvt_pk_bf16_f32 v83, v86, v87
    s_lshl_b32 s43, s66, 11
    s_add_u32 s43, s43, 115712
    s_add_u32 s43, s43, s39
    buffer_store_dwordx4 v[80:83], v2, s[28:31], s43 offen
    v_cvt_pk_bf16_f32 v88, v88, v89
    v_cvt_pk_bf16_f32 v89, v90, v91
    v_cvt_pk_bf16_f32 v90, v92, v93
    v_cvt_pk_bf16_f32 v91, v94, v95
    s_lshl_b32 s43, s67, 11
    s_add_u32 s43, s43, 114688
    s_add_u32 s43, s43, s39
    buffer_store_dwordx4 v[88:91], v2, s[28:31], s43 offen
    v_cvt_pk_bf16_f32 v96, v96, v97
    v_cvt_pk_bf16_f32 v97, v98, v99
    v_cvt_pk_bf16_f32 v98, v100, v101
    v_cvt_pk_bf16_f32 v99, v102, v103
    s_lshl_b32 s43, s67, 11
    s_add_u32 s43, s43, 115712
    s_add_u32 s43, s43, s39
    buffer_store_dwordx4 v[96:99], v2, s[28:31], s43 offen
    s_lshl_b32 s43, s7, 1
    s_add_u32 s44, s43, 1
    s_add_u32 s45, s7, 2
    s_cmp_lt_u32 s7, 2
    s_cselect_b32 s66, s43, s45
    s_cselect_b32 s67, s44, s45
    s_and_b32 s43, s66, 3
    s_lshl_b32 s43, s43, 6
    s_lshr_b32 s44, s66, 2
    s_lshl_b32 s44, s44, 8
    v_xor_b32 v120, s43, v112
    v_add_u32 v120, s44, v120
    v_add_u32 v122, 0x10000, v120
    s_and_b32 s43, s67, 3
    s_lshl_b32 s43, s43, 6
    s_lshr_b32 s44, s67, 2
    s_lshl_b32 s44, s44, 8
    v_xor_b32 v121, s43, v112
    v_add_u32 v121, s44, v121
    v_add_u32 v123, 0x10000, v121
    ds_read_b64_tr_b16 v[40:41], v116 offset:16384
    ds_read_b64_tr_b16 v[42:43], v116 offset:20480
    ds_read_b64_tr_b16 v[44:45], v117 offset:16384
    ds_read_b64_tr_b16 v[46:47], v117 offset:20480
    ds_read_b64_tr_b16 v[48:49], v118 offset:16384
    ds_read_b64_tr_b16 v[50:51], v118 offset:20480
    ds_read_b64_tr_b16 v[52:53], v119 offset:16384
    ds_read_b64_tr_b16 v[54:55], v119 offset:20480
    ds_read_b64_tr_b16 v[56:57], v116 offset:16640
    ds_read_b64_tr_b16 v[58:59], v116 offset:20736
    ds_read_b64_tr_b16 v[60:61], v117 offset:16640
    ds_read_b64_tr_b16 v[62:63], v117 offset:20736
    ds_read_b64_tr_b16 v[64:65], v122 offset:16384
    ds_read_b64_tr_b16 v[66:67], v122 offset:20480
    ds_read_b64_tr_b16 v[68:69], v123 offset:16384
    ds_read_b64_tr_b16 v[70:71], v123 offset:20480
    s_waitcnt vmcnt(36)
    s_barrier
    s_add_u32 s43, s32, 65536
    s_mov_b32 m0, s43
    s_add_u32 s44, s38, 172544
    buffer_load_dwordx4 v28, s[24:27], s44 offen offset:0 lds
    buffer_load_dwordx4 v29, s[24:27], s44 offen offset:1024 lds
    buffer_load_dwordx4 v30, s[24:27], s44 offen offset:2048 lds
    buffer_load_dwordx4 v31, s[24:27], s44 offen offset:3072 lds
    s_waitcnt lgkmcnt(12)
    v_mfma_f32_32x32x16_bf16 v[128:143], v[40:43], a[0:3], 0
    ds_read_b64_tr_b16 v[40:41], v116 offset:24576
    ds_read_b64_tr_b16 v[42:43], v116 offset:28672
    v_mfma_f32_32x32x16_bf16 v[144:159], v[44:47], a[0:3], 0
    ds_read_b64_tr_b16 v[44:45], v117 offset:24576
    ds_read_b64_tr_b16 v[46:47], v117 offset:28672
    s_waitcnt lgkmcnt(12)
    v_mfma_f32_32x32x16_bf16 v[160:175], v[48:51], a[0:3], 0
    ds_read_b64_tr_b16 v[48:49], v118 offset:24576
    ds_read_b64_tr_b16 v[50:51], v118 offset:28672
    v_mfma_f32_32x32x16_bf16 v[176:191], v[52:55], a[0:3], 0
    ds_read_b64_tr_b16 v[52:53], v119 offset:24576
    ds_read_b64_tr_b16 v[54:55], v119 offset:28672
    s_waitcnt lgkmcnt(12)
    v_mfma_f32_32x32x16_bf16 v[192:207], v[56:59], a[0:3], 0
    ds_read_b64_tr_b16 v[56:57], v116 offset:24832
    ds_read_b64_tr_b16 v[58:59], v116 offset:28928
    v_mfma_f32_32x32x16_bf16 v[208:223], v[60:63], a[0:3], 0
    ds_read_b64_tr_b16 v[60:61], v117 offset:24832
    ds_read_b64_tr_b16 v[62:63], v117 offset:28928
    s_waitcnt lgkmcnt(12)
    v_mfma_f32_32x32x16_bf16 v[72:87], v[64:67], a[128:131], 0
    ds_read_b64_tr_b16 v[64:65], v122 offset:24576
    ds_read_b64_tr_b16 v[66:67], v122 offset:28672
    v_mfma_f32_32x32x16_bf16 v[88:103], v[68:71], a[128:131], 0
    ds_read_b64_tr_b16 v[68:69], v123 offset:24576
    ds_read_b64_tr_b16 v[70:71], v123 offset:28672
    s_waitcnt lgkmcnt(12)
    v_mfma_f32_32x32x16_bf16 v[128:143], v[40:43], a[4:7], v[128:143]
    ds_read_b64_tr_b16 v[40:41], v116 offset:32768
    ds_read_b64_tr_b16 v[42:43], v116 offset:36864
    v_mfma_f32_32x32x16_bf16 v[144:159], v[44:47], a[4:7], v[144:159]
    ds_read_b64_tr_b16 v[44:45], v117 offset:32768
    ds_read_b64_tr_b16 v[46:47], v117 offset:36864
    s_waitcnt lgkmcnt(12)
    v_mfma_f32_32x32x16_bf16 v[160:175], v[48:51], a[4:7], v[160:175]
    ds_read_b64_tr_b16 v[48:49], v118 offset:32768
    ds_read_b64_tr_b16 v[50:51], v118 offset:36864
    v_mfma_f32_32x32x16_bf16 v[176:191], v[52:55], a[4:7], v[176:191]
    ds_read_b64_tr_b16 v[52:53], v119 offset:32768
    ds_read_b64_tr_b16 v[54:55], v119 offset:36864
    s_waitcnt lgkmcnt(12)
    v_mfma_f32_32x32x16_bf16 v[192:207], v[56:59], a[4:7], v[192:207]
    ds_read_b64_tr_b16 v[56:57], v116 offset:33024
    ds_read_b64_tr_b16 v[58:59], v116 offset:37120
    v_mfma_f32_32x32x16_bf16 v[208:223], v[60:63], a[4:7], v[208:223]
    ds_read_b64_tr_b16 v[60:61], v117 offset:33024
    ds_read_b64_tr_b16 v[62:63], v117 offset:37120
    s_waitcnt lgkmcnt(12)
    v_mfma_f32_32x32x16_bf16 v[72:87], v[64:67], a[132:135], v[72:87]
    ds_read_b64_tr_b16 v[64:65], v122 offset:32768
    ds_read_b64_tr_b16 v[66:67], v122 offset:36864
    v_mfma_f32_32x32x16_bf16 v[88:103], v[68:71], a[132:135], v[88:103]
    ds_read_b64_tr_b16 v[68:69], v123 offset:32768
    ds_read_b64_tr_b16 v[70:71], v123 offset:36864
    s_waitcnt vmcnt(36)
    s_barrier
    s_add_u32 s43, s32, 81920
    s_mov_b32 m0, s43
    s_add_u32 s44, s38, 201216
    buffer_load_dwordx4 v28, s[24:27], s44 offen offset:0 lds
    buffer_load_dwordx4 v29, s[24:27], s44 offen offset:1024 lds
    buffer_load_dwordx4 v30, s[24:27], s44 offen offset:2048 lds
    buffer_load_dwordx4 v31, s[24:27], s44 offen offset:3072 lds
    s_waitcnt lgkmcnt(12)
    v_mfma_f32_32x32x16_bf16 v[128:143], v[40:43], a[8:11], v[128:143]
    ds_read_b64_tr_b16 v[40:41], v116 offset:40960
    ds_read_b64_tr_b16 v[42:43], v116 offset:45056
    v_mfma_f32_32x32x16_bf16 v[144:159], v[44:47], a[8:11], v[144:159]
    ds_read_b64_tr_b16 v[44:45], v117 offset:40960
    ds_read_b64_tr_b16 v[46:47], v117 offset:45056
    s_waitcnt lgkmcnt(12)
    v_mfma_f32_32x32x16_bf16 v[160:175], v[48:51], a[8:11], v[160:175]
    ds_read_b64_tr_b16 v[48:49], v118 offset:40960
    ds_read_b64_tr_b16 v[50:51], v118 offset:45056
    v_mfma_f32_32x32x16_bf16 v[176:191], v[52:55], a[8:11], v[176:191]
    ds_read_b64_tr_b16 v[52:53], v119 offset:40960
    ds_read_b64_tr_b16 v[54:55], v119 offset:45056
    s_waitcnt lgkmcnt(12)
    v_mfma_f32_32x32x16_bf16 v[192:207], v[56:59], a[8:11], v[192:207]
    ds_read_b64_tr_b16 v[56:57], v116 offset:41216
    ds_read_b64_tr_b16 v[58:59], v116 offset:45312
    v_mfma_f32_32x32x16_bf16 v[208:223], v[60:63], a[8:11], v[208:223]
    ds_read_b64_tr_b16 v[60:61], v117 offset:41216
    ds_read_b64_tr_b16 v[62:63], v117 offset:45312
    s_waitcnt lgkmcnt(12)
    v_mfma_f32_32x32x16_bf16 v[72:87], v[64:67], a[136:139], v[72:87]
    ds_read_b64_tr_b16 v[64:65], v122 offset:40960
    ds_read_b64_tr_b16 v[66:67], v122 offset:45056
    v_mfma_f32_32x32x16_bf16 v[88:103], v[68:71], a[136:139], v[88:103]
    ds_read_b64_tr_b16 v[68:69], v123 offset:40960
    ds_read_b64_tr_b16 v[70:71], v123 offset:45056
    s_waitcnt lgkmcnt(12)
    v_mfma_f32_32x32x16_bf16 v[128:143], v[40:43], a[12:15], v[128:143]
    ds_read_b64_tr_b16 v[40:41], v112 offset:0
    ds_read_b64_tr_b16 v[42:43], v112 offset:4096
    v_mfma_f32_32x32x16_bf16 v[144:159], v[44:47], a[12:15], v[144:159]
    ds_read_b64_tr_b16 v[44:45], v113 offset:0
    ds_read_b64_tr_b16 v[46:47], v113 offset:4096
    s_waitcnt lgkmcnt(12)
    v_mfma_f32_32x32x16_bf16 v[160:175], v[48:51], a[12:15], v[160:175]
    ds_read_b64_tr_b16 v[48:49], v114 offset:0
    ds_read_b64_tr_b16 v[50:51], v114 offset:4096
    v_mfma_f32_32x32x16_bf16 v[176:191], v[52:55], a[12:15], v[176:191]
    ds_read_b64_tr_b16 v[52:53], v115 offset:0
    ds_read_b64_tr_b16 v[54:55], v115 offset:4096
    s_waitcnt lgkmcnt(12)
    v_mfma_f32_32x32x16_bf16 v[192:207], v[56:59], a[12:15], v[192:207]
    ds_read_b64_tr_b16 v[56:57], v112 offset:256
    ds_read_b64_tr_b16 v[58:59], v112 offset:4352
    v_mfma_f32_32x32x16_bf16 v[208:223], v[60:63], a[12:15], v[208:223]
    ds_read_b64_tr_b16 v[60:61], v113 offset:256
    ds_read_b64_tr_b16 v[62:63], v113 offset:4352
    s_waitcnt lgkmcnt(12)
    v_mfma_f32_32x32x16_bf16 v[72:87], v[64:67], a[140:143], v[72:87]
    ds_read_b64_tr_b16 v[64:65], v120 offset:0
    ds_read_b64_tr_b16 v[66:67], v120 offset:4096
    v_mfma_f32_32x32x16_bf16 v[88:103], v[68:71], a[140:143], v[88:103]
    ds_read_b64_tr_b16 v[68:69], v121 offset:0
    ds_read_b64_tr_b16 v[70:71], v121 offset:4096
    s_waitcnt vmcnt(36)
    s_barrier
    s_waitcnt lgkmcnt(12)
    v_mfma_f32_32x32x16_bf16 v[128:143], v[40:43], a[16:19], v[128:143]
    ds_read_b64_tr_b16 v[40:41], v112 offset:8192
    ds_read_b64_tr_b16 v[42:43], v112 offset:12288
    v_mfma_f32_32x32x16_bf16 v[144:159], v[44:47], a[16:19], v[144:159]
    ds_read_b64_tr_b16 v[44:45], v113 offset:8192
    ds_read_b64_tr_b16 v[46:47], v113 offset:12288
    s_waitcnt lgkmcnt(12)
    v_mfma_f32_32x32x16_bf16 v[160:175], v[48:51], a[16:19], v[160:175]
    ds_read_b64_tr_b16 v[48:49], v114 offset:8192
    ds_read_b64_tr_b16 v[50:51], v114 offset:12288
    v_mfma_f32_32x32x16_bf16 v[176:191], v[52:55], a[16:19], v[176:191]
    ds_read_b64_tr_b16 v[52:53], v115 offset:8192
    ds_read_b64_tr_b16 v[54:55], v115 offset:12288
    s_waitcnt lgkmcnt(12)
    v_mfma_f32_32x32x16_bf16 v[192:207], v[56:59], a[16:19], v[192:207]
    ds_read_b64_tr_b16 v[56:57], v112 offset:8448
    ds_read_b64_tr_b16 v[58:59], v112 offset:12544
    v_mfma_f32_32x32x16_bf16 v[208:223], v[60:63], a[16:19], v[208:223]
    ds_read_b64_tr_b16 v[60:61], v113 offset:8448
    ds_read_b64_tr_b16 v[62:63], v113 offset:12544
    s_waitcnt lgkmcnt(12)
    v_mfma_f32_32x32x16_bf16 v[72:87], v[64:67], a[144:147], v[72:87]
    ds_read_b64_tr_b16 v[64:65], v120 offset:8192
    ds_read_b64_tr_b16 v[66:67], v120 offset:12288
    v_mfma_f32_32x32x16_bf16 v[88:103], v[68:71], a[144:147], v[88:103]
    ds_read_b64_tr_b16 v[68:69], v121 offset:8192
    ds_read_b64_tr_b16 v[70:71], v121 offset:12288
    s_waitcnt lgkmcnt(12)
    v_mfma_f32_32x32x16_bf16 v[128:143], v[40:43], a[20:23], v[128:143]
    ds_read_b64_tr_b16 v[40:41], v112 offset:16384
    ds_read_b64_tr_b16 v[42:43], v112 offset:20480
    v_mfma_f32_32x32x16_bf16 v[144:159], v[44:47], a[20:23], v[144:159]
    ds_read_b64_tr_b16 v[44:45], v113 offset:16384
    ds_read_b64_tr_b16 v[46:47], v113 offset:20480
    s_waitcnt lgkmcnt(12)
    v_mfma_f32_32x32x16_bf16 v[160:175], v[48:51], a[20:23], v[160:175]
    ds_read_b64_tr_b16 v[48:49], v114 offset:16384
    ds_read_b64_tr_b16 v[50:51], v114 offset:20480
    v_mfma_f32_32x32x16_bf16 v[176:191], v[52:55], a[20:23], v[176:191]
    ds_read_b64_tr_b16 v[52:53], v115 offset:16384
    ds_read_b64_tr_b16 v[54:55], v115 offset:20480
    s_waitcnt lgkmcnt(12)
    v_mfma_f32_32x32x16_bf16 v[192:207], v[56:59], a[20:23], v[192:207]
    ds_read_b64_tr_b16 v[56:57], v112 offset:16640
    ds_read_b64_tr_b16 v[58:59], v112 offset:20736
    v_mfma_f32_32x32x16_bf16 v[208:223], v[60:63], a[20:23], v[208:223]
    ds_read_b64_tr_b16 v[60:61], v113 offset:16640
    ds_read_b64_tr_b16 v[62:63], v113 offset:20736
    s_waitcnt lgkmcnt(12)
    v_mfma_f32_32x32x16_bf16 v[72:87], v[64:67], a[148:151], v[72:87]
    ds_read_b64_tr_b16 v[64:65], v120 offset:16384
    ds_read_b64_tr_b16 v[66:67], v120 offset:20480
    v_mfma_f32_32x32x16_bf16 v[88:103], v[68:71], a[148:151], v[88:103]
    ds_read_b64_tr_b16 v[68:69], v121 offset:16384
    ds_read_b64_tr_b16 v[70:71], v121 offset:20480
    s_waitcnt vmcnt(32)
    s_barrier
    s_waitcnt lgkmcnt(12)
    v_mfma_f32_32x32x16_bf16 v[128:143], v[40:43], a[24:27], v[128:143]
    ds_read_b64_tr_b16 v[40:41], v112 offset:24576
    ds_read_b64_tr_b16 v[42:43], v112 offset:28672
    v_mfma_f32_32x32x16_bf16 v[144:159], v[44:47], a[24:27], v[144:159]
    ds_read_b64_tr_b16 v[44:45], v113 offset:24576
    ds_read_b64_tr_b16 v[46:47], v113 offset:28672
    s_waitcnt lgkmcnt(12)
    v_mfma_f32_32x32x16_bf16 v[160:175], v[48:51], a[24:27], v[160:175]
    ds_read_b64_tr_b16 v[48:49], v114 offset:24576
    ds_read_b64_tr_b16 v[50:51], v114 offset:28672
    v_mfma_f32_32x32x16_bf16 v[176:191], v[52:55], a[24:27], v[176:191]
    ds_read_b64_tr_b16 v[52:53], v115 offset:24576
    ds_read_b64_tr_b16 v[54:55], v115 offset:28672
    s_waitcnt lgkmcnt(12)
    v_mfma_f32_32x32x16_bf16 v[192:207], v[56:59], a[24:27], v[192:207]
    ds_read_b64_tr_b16 v[56:57], v112 offset:24832
    ds_read_b64_tr_b16 v[58:59], v112 offset:28928
    v_mfma_f32_32x32x16_bf16 v[208:223], v[60:63], a[24:27], v[208:223]
    ds_read_b64_tr_b16 v[60:61], v113 offset:24832
    ds_read_b64_tr_b16 v[62:63], v113 offset:28928
    s_waitcnt lgkmcnt(12)
    v_mfma_f32_32x32x16_bf16 v[72:87], v[64:67], a[152:155], v[72:87]
    ds_read_b64_tr_b16 v[64:65], v120 offset:24576
    ds_read_b64_tr_b16 v[66:67], v120 offset:28672
    v_mfma_f32_32x32x16_bf16 v[88:103], v[68:71], a[152:155], v[88:103]
    ds_read_b64_tr_b16 v[68:69], v121 offset:24576
    ds_read_b64_tr_b16 v[70:71], v121 offset:28672
    s_waitcnt lgkmcnt(12)
    v_mfma_f32_32x32x16_bf16 v[128:143], v[40:43], a[28:31], v[128:143]
    ds_read_b64_tr_b16 v[40:41], v112 offset:32768
    ds_read_b64_tr_b16 v[42:43], v112 offset:36864
    v_mfma_f32_32x32x16_bf16 v[144:159], v[44:47], a[28:31], v[144:159]
    ds_read_b64_tr_b16 v[44:45], v113 offset:32768
    ds_read_b64_tr_b16 v[46:47], v113 offset:36864
    s_waitcnt lgkmcnt(12)
    v_mfma_f32_32x32x16_bf16 v[160:175], v[48:51], a[28:31], v[160:175]
    ds_read_b64_tr_b16 v[48:49], v114 offset:32768
    ds_read_b64_tr_b16 v[50:51], v114 offset:36864
    v_mfma_f32_32x32x16_bf16 v[176:191], v[52:55], a[28:31], v[176:191]
    ds_read_b64_tr_b16 v[52:53], v115 offset:32768
    ds_read_b64_tr_b16 v[54:55], v115 offset:36864
    s_waitcnt lgkmcnt(12)
    v_mfma_f32_32x32x16_bf16 v[192:207], v[56:59], a[28:31], v[192:207]
    ds_read_b64_tr_b16 v[56:57], v112 offset:33024
    ds_read_b64_tr_b16 v[58:59], v112 offset:37120
    v_mfma_f32_32x32x16_bf16 v[208:223], v[60:63], a[28:31], v[208:223]
    ds_read_b64_tr_b16 v[60:61], v113 offset:33024
    ds_read_b64_tr_b16 v[62:63], v113 offset:37120
    s_waitcnt lgkmcnt(12)
    v_mfma_f32_32x32x16_bf16 v[72:87], v[64:67], a[156:159], v[72:87]
    ds_read_b64_tr_b16 v[64:65], v120 offset:32768
    ds_read_b64_tr_b16 v[66:67], v120 offset:36864
    v_mfma_f32_32x32x16_bf16 v[88:103], v[68:71], a[156:159], v[88:103]
    ds_read_b64_tr_b16 v[68:69], v121 offset:32768
    ds_read_b64_tr_b16 v[70:71], v121 offset:36864
    s_waitcnt vmcnt(28)
    s_barrier
    s_waitcnt lgkmcnt(12)
    v_mfma_f32_32x32x16_bf16 v[128:143], v[40:43], a[32:35], v[128:143]
    ds_read_b64_tr_b16 v[40:41], v112 offset:40960
    ds_read_b64_tr_b16 v[42:43], v112 offset:45056
    v_mfma_f32_32x32x16_bf16 v[144:159], v[44:47], a[32:35], v[144:159]
    ds_read_b64_tr_b16 v[44:45], v113 offset:40960
    ds_read_b64_tr_b16 v[46:47], v113 offset:45056
    s_waitcnt lgkmcnt(12)
    v_mfma_f32_32x32x16_bf16 v[160:175], v[48:51], a[32:35], v[160:175]
    ds_read_b64_tr_b16 v[48:49], v114 offset:40960
    ds_read_b64_tr_b16 v[50:51], v114 offset:45056
    v_mfma_f32_32x32x16_bf16 v[176:191], v[52:55], a[32:35], v[176:191]
    ds_read_b64_tr_b16 v[52:53], v115 offset:40960
    ds_read_b64_tr_b16 v[54:55], v115 offset:45056
    s_waitcnt lgkmcnt(12)
    v_mfma_f32_32x32x16_bf16 v[192:207], v[56:59], a[32:35], v[192:207]
    ds_read_b64_tr_b16 v[56:57], v112 offset:41216
    ds_read_b64_tr_b16 v[58:59], v112 offset:45312
    v_mfma_f32_32x32x16_bf16 v[208:223], v[60:63], a[32:35], v[208:223]
    ds_read_b64_tr_b16 v[60:61], v113 offset:41216
    ds_read_b64_tr_b16 v[62:63], v113 offset:45312
    s_waitcnt lgkmcnt(12)
    v_mfma_f32_32x32x16_bf16 v[72:87], v[64:67], a[160:163], v[72:87]
    ds_read_b64_tr_b16 v[64:65], v120 offset:40960
    ds_read_b64_tr_b16 v[66:67], v120 offset:45056
    v_mfma_f32_32x32x16_bf16 v[88:103], v[68:71], a[160:163], v[88:103]
    ds_read_b64_tr_b16 v[68:69], v121 offset:40960
    ds_read_b64_tr_b16 v[70:71], v121 offset:45056
    s_waitcnt lgkmcnt(12)
    v_mfma_f32_32x32x16_bf16 v[128:143], v[40:43], a[36:39], v[128:143]
    ds_read_b64_tr_b16 v[40:41], v112 offset:49152
    ds_read_b64_tr_b16 v[42:43], v112 offset:53248
    v_mfma_f32_32x32x16_bf16 v[144:159], v[44:47], a[36:39], v[144:159]
    ds_read_b64_tr_b16 v[44:45], v113 offset:49152
    ds_read_b64_tr_b16 v[46:47], v113 offset:53248
    s_waitcnt lgkmcnt(12)
    v_mfma_f32_32x32x16_bf16 v[160:175], v[48:51], a[36:39], v[160:175]
    ds_read_b64_tr_b16 v[48:49], v114 offset:49152
    ds_read_b64_tr_b16 v[50:51], v114 offset:53248
    v_mfma_f32_32x32x16_bf16 v[176:191], v[52:55], a[36:39], v[176:191]
    ds_read_b64_tr_b16 v[52:53], v115 offset:49152
    ds_read_b64_tr_b16 v[54:55], v115 offset:53248
    s_waitcnt lgkmcnt(12)
    v_mfma_f32_32x32x16_bf16 v[192:207], v[56:59], a[36:39], v[192:207]
    ds_read_b64_tr_b16 v[56:57], v112 offset:49408
    ds_read_b64_tr_b16 v[58:59], v112 offset:53504
    v_mfma_f32_32x32x16_bf16 v[208:223], v[60:63], a[36:39], v[208:223]
    ds_read_b64_tr_b16 v[60:61], v113 offset:49408
    ds_read_b64_tr_b16 v[62:63], v113 offset:53504
    s_waitcnt lgkmcnt(12)
    v_mfma_f32_32x32x16_bf16 v[72:87], v[64:67], a[164:167], v[72:87]
    ds_read_b64_tr_b16 v[64:65], v120 offset:49152
    ds_read_b64_tr_b16 v[66:67], v120 offset:53248
    v_mfma_f32_32x32x16_bf16 v[88:103], v[68:71], a[164:167], v[88:103]
    ds_read_b64_tr_b16 v[68:69], v121 offset:49152
    ds_read_b64_tr_b16 v[70:71], v121 offset:53248
    s_waitcnt vmcnt(4)
    s_barrier
    s_waitcnt lgkmcnt(12)
    v_mfma_f32_32x32x16_bf16 v[128:143], v[40:43], a[40:43], v[128:143]
    ds_read_b64_tr_b16 v[40:41], v112 offset:57344
    ds_read_b64_tr_b16 v[42:43], v112 offset:61440
    v_mfma_f32_32x32x16_bf16 v[144:159], v[44:47], a[40:43], v[144:159]
    ds_read_b64_tr_b16 v[44:45], v113 offset:57344
    ds_read_b64_tr_b16 v[46:47], v113 offset:61440
    s_waitcnt lgkmcnt(12)
    v_mfma_f32_32x32x16_bf16 v[160:175], v[48:51], a[40:43], v[160:175]
    ds_read_b64_tr_b16 v[48:49], v114 offset:57344
    ds_read_b64_tr_b16 v[50:51], v114 offset:61440
    v_mfma_f32_32x32x16_bf16 v[176:191], v[52:55], a[40:43], v[176:191]
    ds_read_b64_tr_b16 v[52:53], v115 offset:57344
    ds_read_b64_tr_b16 v[54:55], v115 offset:61440
    s_waitcnt lgkmcnt(12)
    v_mfma_f32_32x32x16_bf16 v[192:207], v[56:59], a[40:43], v[192:207]
    ds_read_b64_tr_b16 v[56:57], v112 offset:57600
    ds_read_b64_tr_b16 v[58:59], v112 offset:61696
    v_mfma_f32_32x32x16_bf16 v[208:223], v[60:63], a[40:43], v[208:223]
    ds_read_b64_tr_b16 v[60:61], v113 offset:57600
    ds_read_b64_tr_b16 v[62:63], v113 offset:61696
    s_waitcnt lgkmcnt(12)
    v_mfma_f32_32x32x16_bf16 v[72:87], v[64:67], a[168:171], v[72:87]
    ds_read_b64_tr_b16 v[64:65], v120 offset:57344
    ds_read_b64_tr_b16 v[66:67], v120 offset:61440
    v_mfma_f32_32x32x16_bf16 v[88:103], v[68:71], a[168:171], v[88:103]
    ds_read_b64_tr_b16 v[68:69], v121 offset:57344
    ds_read_b64_tr_b16 v[70:71], v121 offset:61440
    s_waitcnt lgkmcnt(12)
    v_mfma_f32_32x32x16_bf16 v[128:143], v[40:43], a[44:47], v[128:143]
    ds_read_b64_tr_b16 v[40:41], v116 offset:0
    ds_read_b64_tr_b16 v[42:43], v116 offset:4096
    v_mfma_f32_32x32x16_bf16 v[144:159], v[44:47], a[44:47], v[144:159]
    ds_read_b64_tr_b16 v[44:45], v117 offset:0
    ds_read_b64_tr_b16 v[46:47], v117 offset:4096
    s_waitcnt lgkmcnt(12)
    v_mfma_f32_32x32x16_bf16 v[160:175], v[48:51], a[44:47], v[160:175]
    ds_read_b64_tr_b16 v[48:49], v118 offset:0
    ds_read_b64_tr_b16 v[50:51], v118 offset:4096
    v_mfma_f32_32x32x16_bf16 v[176:191], v[52:55], a[44:47], v[176:191]
    ds_read_b64_tr_b16 v[52:53], v119 offset:0
    ds_read_b64_tr_b16 v[54:55], v119 offset:4096
    s_waitcnt lgkmcnt(12)
    v_mfma_f32_32x32x16_bf16 v[192:207], v[56:59], a[44:47], v[192:207]
    ds_read_b64_tr_b16 v[56:57], v116 offset:256
    ds_read_b64_tr_b16 v[58:59], v116 offset:4352
    v_mfma_f32_32x32x16_bf16 v[208:223], v[60:63], a[44:47], v[208:223]
    ds_read_b64_tr_b16 v[60:61], v117 offset:256
    ds_read_b64_tr_b16 v[62:63], v117 offset:4352
    s_waitcnt lgkmcnt(12)
    v_mfma_f32_32x32x16_bf16 v[72:87], v[64:67], a[172:175], v[72:87]
    ds_read_b64_tr_b16 v[64:65], v122 offset:0
    ds_read_b64_tr_b16 v[66:67], v122 offset:4096
    v_mfma_f32_32x32x16_bf16 v[88:103], v[68:71], a[172:175], v[88:103]
    ds_read_b64_tr_b16 v[68:69], v123 offset:0
    ds_read_b64_tr_b16 v[70:71], v123 offset:4096
    s_waitcnt vmcnt(0)
    s_barrier
    s_waitcnt lgkmcnt(12)
    v_mfma_f32_32x32x16_bf16 v[128:143], v[40:43], a[48:51], v[128:143]
    ds_read_b64_tr_b16 v[40:41], v116 offset:8192
    ds_read_b64_tr_b16 v[42:43], v116 offset:12288
    v_mfma_f32_32x32x16_bf16 v[144:159], v[44:47], a[48:51], v[144:159]
    ds_read_b64_tr_b16 v[44:45], v117 offset:8192
    ds_read_b64_tr_b16 v[46:47], v117 offset:12288
    s_waitcnt lgkmcnt(12)
    v_mfma_f32_32x32x16_bf16 v[160:175], v[48:51], a[48:51], v[160:175]
    ds_read_b64_tr_b16 v[48:49], v118 offset:8192
    ds_read_b64_tr_b16 v[50:51], v118 offset:12288
    v_mfma_f32_32x32x16_bf16 v[176:191], v[52:55], a[48:51], v[176:191]
    ds_read_b64_tr_b16 v[52:53], v119 offset:8192
    ds_read_b64_tr_b16 v[54:55], v119 offset:12288
    s_waitcnt lgkmcnt(12)
    v_mfma_f32_32x32x16_bf16 v[192:207], v[56:59], a[48:51], v[192:207]
    ds_read_b64_tr_b16 v[56:57], v116 offset:8448
    ds_read_b64_tr_b16 v[58:59], v116 offset:12544
    v_mfma_f32_32x32x16_bf16 v[208:223], v[60:63], a[48:51], v[208:223]
    ds_read_b64_tr_b16 v[60:61], v117 offset:8448
    ds_read_b64_tr_b16 v[62:63], v117 offset:12544
    s_waitcnt lgkmcnt(12)
    v_mfma_f32_32x32x16_bf16 v[72:87], v[64:67], a[176:179], v[72:87]
    ds_read_b64_tr_b16 v[64:65], v122 offset:8192
    ds_read_b64_tr_b16 v[66:67], v122 offset:12288
    v_mfma_f32_32x32x16_bf16 v[88:103], v[68:71], a[176:179], v[88:103]
    ds_read_b64_tr_b16 v[68:69], v123 offset:8192
    ds_read_b64_tr_b16 v[70:71], v123 offset:12288
    s_waitcnt lgkmcnt(12)
    v_mfma_f32_32x32x16_bf16 v[128:143], v[40:43], a[52:55], v[128:143]
    ds_read_b64_tr_b16 v[40:41], v116 offset:16384
    ds_read_b64_tr_b16 v[42:43], v116 offset:20480
    v_mfma_f32_32x32x16_bf16 v[144:159], v[44:47], a[52:55], v[144:159]
    ds_read_b64_tr_b16 v[44:45], v117 offset:16384
    ds_read_b64_tr_b16 v[46:47], v117 offset:20480
    s_waitcnt lgkmcnt(12)
    v_mfma_f32_32x32x16_bf16 v[160:175], v[48:51], a[52:55], v[160:175]
    ds_read_b64_tr_b16 v[48:49], v118 offset:16384
    ds_read_b64_tr_b16 v[50:51], v118 offset:20480
    v_mfma_f32_32x32x16_bf16 v[176:191], v[52:55], a[52:55], v[176:191]
    ds_read_b64_tr_b16 v[52:53], v119 offset:16384
    ds_read_b64_tr_b16 v[54:55], v119 offset:20480
    s_waitcnt lgkmcnt(12)
    v_mfma_f32_32x32x16_bf16 v[192:207], v[56:59], a[52:55], v[192:207]
    ds_read_b64_tr_b16 v[56:57], v116 offset:16640
    ds_read_b64_tr_b16 v[58:59], v116 offset:20736
    v_mfma_f32_32x32x16_bf16 v[208:223], v[60:63], a[52:55], v[208:223]
    ds_read_b64_tr_b16 v[60:61], v117 offset:16640
    ds_read_b64_tr_b16 v[62:63], v117 offset:20736
    s_waitcnt lgkmcnt(12)
    v_mfma_f32_32x32x16_bf16 v[72:87], v[64:67], a[180:183], v[72:87]
    ds_read_b64_tr_b16 v[64:65], v122 offset:16384
    ds_read_b64_tr_b16 v[66:67], v122 offset:20480
    v_mfma_f32_32x32x16_bf16 v[88:103], v[68:71], a[180:183], v[88:103]
    ds_read_b64_tr_b16 v[68:69], v123 offset:16384
    ds_read_b64_tr_b16 v[70:71], v123 offset:20480
    s_waitcnt vmcnt(0)
    s_barrier
    s_waitcnt lgkmcnt(12)
    v_mfma_f32_32x32x16_bf16 v[128:143], v[40:43], a[56:59], v[128:143]
    ds_read_b64_tr_b16 v[40:41], v116 offset:24576
    ds_read_b64_tr_b16 v[42:43], v116 offset:28672
    v_mfma_f32_32x32x16_bf16 v[144:159], v[44:47], a[56:59], v[144:159]
    ds_read_b64_tr_b16 v[44:45], v117 offset:24576
    ds_read_b64_tr_b16 v[46:47], v117 offset:28672
    s_waitcnt lgkmcnt(12)
    v_mfma_f32_32x32x16_bf16 v[160:175], v[48:51], a[56:59], v[160:175]
    ds_read_b64_tr_b16 v[48:49], v118 offset:24576
    ds_read_b64_tr_b16 v[50:51], v118 offset:28672
    v_mfma_f32_32x32x16_bf16 v[176:191], v[52:55], a[56:59], v[176:191]
    ds_read_b64_tr_b16 v[52:53], v119 offset:24576
    ds_read_b64_tr_b16 v[54:55], v119 offset:28672
    s_waitcnt lgkmcnt(12)
    v_mfma_f32_32x32x16_bf16 v[192:207], v[56:59], a[56:59], v[192:207]
    ds_read_b64_tr_b16 v[56:57], v116 offset:24832
    ds_read_b64_tr_b16 v[58:59], v116 offset:28928
    v_mfma_f32_32x32x16_bf16 v[208:223], v[60:63], a[56:59], v[208:223]
    ds_read_b64_tr_b16 v[60:61], v117 offset:24832
    ds_read_b64_tr_b16 v[62:63], v117 offset:28928
    s_waitcnt lgkmcnt(12)
    v_mfma_f32_32x32x16_bf16 v[72:87], v[64:67], a[184:187], v[72:87]
    ds_read_b64_tr_b16 v[64:65], v122 offset:24576
    ds_read_b64_tr_b16 v[66:67], v122 offset:28672
    v_mfma_f32_32x32x16_bf16 v[88:103], v[68:71], a[184:187], v[88:103]
    ds_read_b64_tr_b16 v[68:69], v123 offset:24576
    ds_read_b64_tr_b16 v[70:71], v123 offset:28672
    s_waitcnt lgkmcnt(12)
    v_mfma_f32_32x32x16_bf16 v[128:143], v[40:43], a[60:63], v[128:143]
    v_mfma_f32_32x32x16_bf16 v[144:159], v[44:47], a[60:63], v[144:159]
    s_waitcnt lgkmcnt(8)
    v_mfma_f32_32x32x16_bf16 v[160:175], v[48:51], a[60:63], v[160:175]
    v_mfma_f32_32x32x16_bf16 v[176:191], v[52:55], a[60:63], v[176:191]
    s_waitcnt lgkmcnt(4)
    v_mfma_f32_32x32x16_bf16 v[192:207], v[56:59], a[60:63], v[192:207]
    v_mfma_f32_32x32x16_bf16 v[208:223], v[60:63], a[60:63], v[208:223]
    s_waitcnt lgkmcnt(0)
    v_mfma_f32_32x32x16_bf16 v[72:87], v[64:67], a[188:191], v[72:87]
    v_mfma_f32_32x32x16_bf16 v[88:103], v[68:71], a[188:191], v[88:103]
    s_nop 15
    s_nop 7
    v_lshlrev_b32 v2, 4, v1
    s_mul_i32 s45, s7, 28672
    s_add_u32 s45, s45, s39
    v_cvt_pk_bf16_f32 v128, v128, v129
    v_cvt_pk_bf16_f32 v129, v130, v131
    v_cvt_pk_bf16_f32 v130, v132, v133
    v_cvt_pk_bf16_f32 v131, v134, v135
    s_add_u32 s43, s45, 16384
    buffer_store_dwordx4 v[128:131], v2, s[28:31], s43 offen
    v_cvt_pk_bf16_f32 v136, v136, v137
    v_cvt_pk_bf16_f32 v137, v138, v139
    v_cvt_pk_bf16_f32 v138, v140, v141
    v_cvt_pk_bf16_f32 v139, v142, v143
    s_add_u32 s43, s45, 17408
    buffer_store_dwordx4 v[136:139], v2, s[28:31], s43 offen
    v_cvt_pk_bf16_f32 v144, v144, v145
    v_cvt_pk_bf16_f32 v145, v146, v147
    v_cvt_pk_bf16_f32 v146, v148, v149
    v_cvt_pk_bf16_f32 v147, v150, v151
    s_add_u32 s43, s45, 18432
    buffer_store_dwordx4 v[144:147], v2, s[28:31], s43 offen
    v_cvt_pk_bf16_f32 v152, v152, v153
    v_cvt_pk_bf16_f32 v153, v154, v155
    v_cvt_pk_bf16_f32 v154, v156, v157
    v_cvt_pk_bf16_f32 v155, v158, v159
    s_add_u32 s43, s45, 19456
    buffer_store_dwordx4 v[152:155], v2, s[28:31], s43 offen
    v_cvt_pk_bf16_f32 v160, v160, v161
    v_cvt_pk_bf16_f32 v161, v162, v163
    v_cvt_pk_bf16_f32 v162, v164, v165
    v_cvt_pk_bf16_f32 v163, v166, v167
    s_add_u32 s43, s45, 20480
    buffer_store_dwordx4 v[160:163], v2, s[28:31], s43 offen
    v_cvt_pk_bf16_f32 v168, v168, v169
    v_cvt_pk_bf16_f32 v169, v170, v171
    v_cvt_pk_bf16_f32 v170, v172, v173
    v_cvt_pk_bf16_f32 v171, v174, v175
    s_add_u32 s43, s45, 21504
    buffer_store_dwordx4 v[168:171], v2, s[28:31], s43 offen
    v_cvt_pk_bf16_f32 v176, v176, v177
    v_cvt_pk_bf16_f32 v177, v178, v179
    v_cvt_pk_bf16_f32 v178, v180, v181
    v_cvt_pk_bf16_f32 v179, v182, v183
    s_add_u32 s43, s45, 22528
    buffer_store_dwordx4 v[176:179], v2, s[28:31], s43 offen
    v_cvt_pk_bf16_f32 v184, v184, v185
    v_cvt_pk_bf16_f32 v185, v186, v187
    v_cvt_pk_bf16_f32 v186, v188, v189
    v_cvt_pk_bf16_f32 v187, v190, v191
    s_add_u32 s43, s45, 23552
    buffer_store_dwordx4 v[184:187], v2, s[28:31], s43 offen
    v_cvt_pk_bf16_f32 v192, v192, v193
    v_cvt_pk_bf16_f32 v193, v194, v195
    v_cvt_pk_bf16_f32 v194, v196, v197
    v_cvt_pk_bf16_f32 v195, v198, v199
    s_add_u32 s43, s45, 24576
    buffer_store_dwordx4 v[192:195], v2, s[28:31], s43 offen
    v_cvt_pk_bf16_f32 v200, v200, v201
    v_cvt_pk_bf16_f32 v201, v202, v203
    v_cvt_pk_bf16_f32 v202, v204, v205
    v_cvt_pk_bf16_f32 v203, v206, v207
    s_add_u32 s43, s45, 25600
    buffer_store_dwordx4 v[200:203], v2, s[28:31], s43 offen
    v_cvt_pk_bf16_f32 v208, v208, v209
    v_cvt_pk_bf16_f32 v209, v210, v211
    v_cvt_pk_bf16_f32 v210, v212, v213
    v_cvt_pk_bf16_f32 v211, v214, v215
    s_add_u32 s43, s45, 26624
    buffer_store_dwordx4 v[208:211], v2, s[28:31], s43 offen
    v_cvt_pk_bf16_f32 v216, v216, v217
    v_cvt_pk_bf16_f32 v217, v218, v219
    v_cvt_pk_bf16_f32 v218, v220, v221
    v_cvt_pk_bf16_f32 v219, v222, v223
    s_add_u32 s43, s45, 27648
    buffer_store_dwordx4 v[216:219], v2, s[28:31], s43 offen
    v_cvt_pk_bf16_f32 v72, v72, v73
    v_cvt_pk_bf16_f32 v73, v74, v75
    v_cvt_pk_bf16_f32 v74, v76, v77
    v_cvt_pk_bf16_f32 v75, v78, v79
    s_lshl_b32 s43, s66, 11
    s_add_u32 s43, s43, 131072
    s_add_u32 s43, s43, s39
    buffer_store_dwordx4 v[72:75], v2, s[28:31], s43 offen
    v_cvt_pk_bf16_f32 v80, v80, v81
    v_cvt_pk_bf16_f32 v81, v82, v83
    v_cvt_pk_bf16_f32 v82, v84, v85
    v_cvt_pk_bf16_f32 v83, v86, v87
    s_lshl_b32 s43, s66, 11
    s_add_u32 s43, s43, 132096
    s_add_u32 s43, s43, s39
    buffer_store_dwordx4 v[80:83], v2, s[28:31], s43 offen
    v_cvt_pk_bf16_f32 v88, v88, v89
    v_cvt_pk_bf16_f32 v89, v90, v91
    v_cvt_pk_bf16_f32 v90, v92, v93
    v_cvt_pk_bf16_f32 v91, v94, v95
    s_lshl_b32 s43, s67, 11
    s_add_u32 s43, s43, 131072
    s_add_u32 s43, s43, s39
    buffer_store_dwordx4 v[88:91], v2, s[28:31], s43 offen
    v_cvt_pk_bf16_f32 v96, v96, v97
    v_cvt_pk_bf16_f32 v97, v98, v99
    v_cvt_pk_bf16_f32 v98, v100, v101
    v_cvt_pk_bf16_f32 v99, v102, v103
    s_lshl_b32 s43, s67, 11
    s_add_u32 s43, s43, 132096
    s_add_u32 s43, s43, s39
    buffer_store_dwordx4 v[96:99], v2, s[28:31], s43 offen
L_end:
    s_endpgm
.p2align 8
reduce_kernel:
    s_load_dwordx2 s[4:5], s[0:1], 96
    s_load_dwordx2 s[6:7], s[0:1], 80
    v_lshrrev_b32 v1, 6, v0
    v_and_b32 v2, 63, v0
    s_nop 1
    v_readfirstlane_b32 s3, v1
    s_lshl_b32 s8, s2, 2
    s_add_u32 s8, s8, s3
    s_cmp_ge_u32 s8, 2240
    s_cbranch_scc1 L_rend
    s_mul_i32 s9, s8, 7490
    s_lshr_b32 s9, s9, 20
    s_mul_i32 s10, s9, 140
    s_sub_u32 s10, s8, s10
    s_waitcnt lgkmcnt(0)
    s_mov_b32 s12, s4
    s_and_b32 s13, s5, 0xffff
    s_mov_b32 s14, 268435456
    s_mov_b32 s15, 0x20000
    s_mov_b32 s16, s6
    s_and_b32 s17, s7, 0xffff
    s_mov_b32 s18, 2064384
    s_mov_b32 s19, 0x20000
    s_mul_i32 s11, s9, 2293760
    s_lshl_b32 s20, s10, 10
    s_add_u32 s11, s11, s20
    v_lshlrev_b32 v3, 4, v2
    buffer_load_dwordx4 v[16:19], v3, s[12:15], s11 offen
    s_add_u32 s11, s11, 143360
    buffer_load_dwordx4 v[20:23], v3, s[12:15], s11 offen
    s_add_u32 s11, s11, 143360
    buffer_load_dwordx4 v[24:27], v3, s[12:15], s11 offen
    s_add_u32 s11, s11, 143360
    buffer_load_dwordx4 v[28:31], v3, s[12:15], s11 offen
    s_add_u32 s11, s11, 143360
    buffer_load_dwordx4 v[32:35], v3, s[12:15], s11 offen
    s_add_u32 s11, s11, 143360
    buffer_load_dwordx4 v[36:39], v3, s[12:15], s11 offen
    s_add_u32 s11, s11, 143360
    buffer_load_dwordx4 v[40:43], v3, s[12:15], s11 offen
    s_add_u32 s11, s11, 143360
    buffer_load_dwordx4 v[44:47], v3, s[12:15], s11 offen
    s_add_u32 s11, s11, 143360
    buffer_load_dwordx4 v[48:51], v3, s[12:15], s11 offen
    s_add_u32 s11, s11, 143360
    buffer_load_dwordx4 v[52:55], v3, s[12:15], s11 offen
    s_add_u32 s11, s11, 143360
    buffer_load_dwordx4 v[56:59], v3, s[12:15], s11 offen
    s_add_u32 s11, s11, 143360
    buffer_load_dwordx4 v[60:63], v3, s[12:15], s11 offen
    s_add_u32 s11, s11, 143360
    buffer_load_dwordx4 v[64:67], v3, s[12:15], s11 offen
    s_add_u32 s11, s11, 143360
    buffer_load_dwordx4 v[68:71], v3, s[12:15], s11 offen
    s_add_u32 s11, s11, 143360
    buffer_load_dwordx4 v[72:75], v3, s[12:15], s11 offen
    s_add_u32 s11, s11, 143360
    buffer_load_dwordx4 v[76:79], v3, s[12:15], s11 offen
    v_mov_b32 v4, 0
    v_mov_b32 v5, 0
    v_mov_b32 v6, 0
    v_mov_b32 v7, 0
    v_mov_b32 v8, 0
    v_mov_b32 v9, 0
    v_mov_b32 v10, 0
    v_mov_b32 v11, 0
    s_waitcnt vmcnt(15)
    v_lshlrev_b32 v12, 16, v16
    v_and_b32 v13, 0xffff0000, v16
    v_add_f32 v4, v4, v12
    v_add_f32 v5, v5, v13
    v_lshlrev_b32 v12, 16, v17
    v_and_b32 v13, 0xffff0000, v17
    v_add_f32 v6, v6, v12
    v_add_f32 v7, v7, v13
    v_lshlrev_b32 v12, 16, v18
    v_and_b32 v13, 0xffff0000, v18
    v_add_f32 v8, v8, v12
    v_add_f32 v9, v9, v13
    v_lshlrev_b32 v12, 16, v19
    v_and_b32 v13, 0xffff0000, v19
    v_add_f32 v10, v10, v12
    v_add_f32 v11, v11, v13
    s_waitcnt vmcnt(14)
    v_lshlrev_b32 v12, 16, v20
    v_and_b32 v13, 0xffff0000, v20
    v_add_f32 v4, v4, v12
    v_add_f32 v5, v5, v13
    v_lshlrev_b32 v12, 16, v21
    v_and_b32 v13, 0xffff0000, v21
    v_add_f32 v6, v6, v12
    v_add_f32 v7, v7, v13
    v_lshlrev_b32 v12, 16, v22
    v_and_b32 v13, 0xffff0000, v22
    v_add_f32 v8, v8, v12
    v_add_f32 v9, v9, v13
    v_lshlrev_b32 v12, 16, v23
    v_and_b32 v13, 0xffff0000, v23
    v_add_f32 v10, v10, v12
    v_add_f32 v11, v11, v13
    s_waitcnt vmcnt(13)
    v_lshlrev_b32 v12, 16, v24
    v_and_b32 v13, 0xffff0000, v24
    v_add_f32 v4, v4, v12
    v_add_f32 v5, v5, v13
    v_lshlrev_b32 v12, 16, v25
    v_and_b32 v13, 0xffff0000, v25
    v_add_f32 v6, v6, v12
    v_add_f32 v7, v7, v13
    v_lshlrev_b32 v12, 16, v26
    v_and_b32 v13, 0xffff0000, v26
    v_add_f32 v8, v8, v12
    v_add_f32 v9, v9, v13
    v_lshlrev_b32 v12, 16, v27
    v_and_b32 v13, 0xffff0000, v27
    v_add_f32 v10, v10, v12
    v_add_f32 v11, v11, v13
    s_waitcnt vmcnt(12)
    v_lshlrev_b32 v12, 16, v28
    v_and_b32 v13, 0xffff0000, v28
    v_add_f32 v4, v4, v12
    v_add_f32 v5, v5, v13
    v_lshlrev_b32 v12, 16, v29
    v_and_b32 v13, 0xffff0000, v29
    v_add_f32 v6, v6, v12
    v_add_f32 v7, v7, v13
    v_lshlrev_b32 v12, 16, v30
    v_and_b32 v13, 0xffff0000, v30
    v_add_f32 v8, v8, v12
    v_add_f32 v9, v9, v13
    v_lshlrev_b32 v12, 16, v31
    v_and_b32 v13, 0xffff0000, v31
    v_add_f32 v10, v10, v12
    v_add_f32 v11, v11, v13
    s_waitcnt vmcnt(11)
    v_lshlrev_b32 v12, 16, v32
    v_and_b32 v13, 0xffff0000, v32
    v_add_f32 v4, v4, v12
    v_add_f32 v5, v5, v13
    v_lshlrev_b32 v12, 16, v33
    v_and_b32 v13, 0xffff0000, v33
    v_add_f32 v6, v6, v12
    v_add_f32 v7, v7, v13
    v_lshlrev_b32 v12, 16, v34
    v_and_b32 v13, 0xffff0000, v34
    v_add_f32 v8, v8, v12
    v_add_f32 v9, v9, v13
    v_lshlrev_b32 v12, 16, v35
    v_and_b32 v13, 0xffff0000, v35
    v_add_f32 v10, v10, v12
    v_add_f32 v11, v11, v13
    s_waitcnt vmcnt(10)
    v_lshlrev_b32 v12, 16, v36
    v_and_b32 v13, 0xffff0000, v36
    v_add_f32 v4, v4, v12
    v_add_f32 v5, v5, v13
    v_lshlrev_b32 v12, 16, v37
    v_and_b32 v13, 0xffff0000, v37
    v_add_f32 v6, v6, v12
    v_add_f32 v7, v7, v13
    v_lshlrev_b32 v12, 16, v38
    v_and_b32 v13, 0xffff0000, v38
    v_add_f32 v8, v8, v12
    v_add_f32 v9, v9, v13
    v_lshlrev_b32 v12, 16, v39
    v_and_b32 v13, 0xffff0000, v39
    v_add_f32 v10, v10, v12
    v_add_f32 v11, v11, v13
    s_waitcnt vmcnt(9)
    v_lshlrev_b32 v12, 16, v40
    v_and_b32 v13, 0xffff0000, v40
    v_add_f32 v4, v4, v12
    v_add_f32 v5, v5, v13
    v_lshlrev_b32 v12, 16, v41
    v_and_b32 v13, 0xffff0000, v41
    v_add_f32 v6, v6, v12
    v_add_f32 v7, v7, v13
    v_lshlrev_b32 v12, 16, v42
    v_and_b32 v13, 0xffff0000, v42
    v_add_f32 v8, v8, v12
    v_add_f32 v9, v9, v13
    v_lshlrev_b32 v12, 16, v43
    v_and_b32 v13, 0xffff0000, v43
    v_add_f32 v10, v10, v12
    v_add_f32 v11, v11, v13
    s_waitcnt vmcnt(8)
    v_lshlrev_b32 v12, 16, v44
    v_and_b32 v13, 0xffff0000, v44
    v_add_f32 v4, v4, v12
    v_add_f32 v5, v5, v13
    v_lshlrev_b32 v12, 16, v45
    v_and_b32 v13, 0xffff0000, v45
    v_add_f32 v6, v6, v12
    v_add_f32 v7, v7, v13
    v_lshlrev_b32 v12, 16, v46
    v_and_b32 v13, 0xffff0000, v46
    v_add_f32 v8, v8, v12
    v_add_f32 v9, v9, v13
    v_lshlrev_b32 v12, 16, v47
    v_and_b32 v13, 0xffff0000, v47
    v_add_f32 v10, v10, v12
    v_add_f32 v11, v11, v13
    s_waitcnt vmcnt(7)
    v_lshlrev_b32 v12, 16, v48
    v_and_b32 v13, 0xffff0000, v48
    v_add_f32 v4, v4, v12
    v_add_f32 v5, v5, v13
    v_lshlrev_b32 v12, 16, v49
    v_and_b32 v13, 0xffff0000, v49
    v_add_f32 v6, v6, v12
    v_add_f32 v7, v7, v13
    v_lshlrev_b32 v12, 16, v50
    v_and_b32 v13, 0xffff0000, v50
    v_add_f32 v8, v8, v12
    v_add_f32 v9, v9, v13
    v_lshlrev_b32 v12, 16, v51
    v_and_b32 v13, 0xffff0000, v51
    v_add_f32 v10, v10, v12
    v_add_f32 v11, v11, v13
    s_waitcnt vmcnt(6)
    v_lshlrev_b32 v12, 16, v52
    v_and_b32 v13, 0xffff0000, v52
    v_add_f32 v4, v4, v12
    v_add_f32 v5, v5, v13
    v_lshlrev_b32 v12, 16, v53
    v_and_b32 v13, 0xffff0000, v53
    v_add_f32 v6, v6, v12
    v_add_f32 v7, v7, v13
    v_lshlrev_b32 v12, 16, v54
    v_and_b32 v13, 0xffff0000, v54
    v_add_f32 v8, v8, v12
    v_add_f32 v9, v9, v13
    v_lshlrev_b32 v12, 16, v55
    v_and_b32 v13, 0xffff0000, v55
    v_add_f32 v10, v10, v12
    v_add_f32 v11, v11, v13
    s_waitcnt vmcnt(5)
    v_lshlrev_b32 v12, 16, v56
    v_and_b32 v13, 0xffff0000, v56
    v_add_f32 v4, v4, v12
    v_add_f32 v5, v5, v13
    v_lshlrev_b32 v12, 16, v57
    v_and_b32 v13, 0xffff0000, v57
    v_add_f32 v6, v6, v12
    v_add_f32 v7, v7, v13
    v_lshlrev_b32 v12, 16, v58
    v_and_b32 v13, 0xffff0000, v58
    v_add_f32 v8, v8, v12
    v_add_f32 v9, v9, v13
    v_lshlrev_b32 v12, 16, v59
    v_and_b32 v13, 0xffff0000, v59
    v_add_f32 v10, v10, v12
    v_add_f32 v11, v11, v13
    s_waitcnt vmcnt(4)
    v_lshlrev_b32 v12, 16, v60
    v_and_b32 v13, 0xffff0000, v60
    v_add_f32 v4, v4, v12
    v_add_f32 v5, v5, v13
    v_lshlrev_b32 v12, 16, v61
    v_and_b32 v13, 0xffff0000, v61
    v_add_f32 v6, v6, v12
    v_add_f32 v7, v7, v13
    v_lshlrev_b32 v12, 16, v62
    v_and_b32 v13, 0xffff0000, v62
    v_add_f32 v8, v8, v12
    v_add_f32 v9, v9, v13
    v_lshlrev_b32 v12, 16, v63
    v_and_b32 v13, 0xffff0000, v63
    v_add_f32 v10, v10, v12
    v_add_f32 v11, v11, v13
    s_waitcnt vmcnt(3)
    v_lshlrev_b32 v12, 16, v64
    v_and_b32 v13, 0xffff0000, v64
    v_add_f32 v4, v4, v12
    v_add_f32 v5, v5, v13
    v_lshlrev_b32 v12, 16, v65
    v_and_b32 v13, 0xffff0000, v65
    v_add_f32 v6, v6, v12
    v_add_f32 v7, v7, v13
    v_lshlrev_b32 v12, 16, v66
    v_and_b32 v13, 0xffff0000, v66
    v_add_f32 v8, v8, v12
    v_add_f32 v9, v9, v13
    v_lshlrev_b32 v12, 16, v67
    v_and_b32 v13, 0xffff0000, v67
    v_add_f32 v10, v10, v12
    v_add_f32 v11, v11, v13
    s_waitcnt vmcnt(2)
    v_lshlrev_b32 v12, 16, v68
    v_and_b32 v13, 0xffff0000, v68
    v_add_f32 v4, v4, v12
    v_add_f32 v5, v5, v13
    v_lshlrev_b32 v12, 16, v69
    v_and_b32 v13, 0xffff0000, v69
    v_add_f32 v6, v6, v12
    v_add_f32 v7, v7, v13
    v_lshlrev_b32 v12, 16, v70
    v_and_b32 v13, 0xffff0000, v70
    v_add_f32 v8, v8, v12
    v_add_f32 v9, v9, v13
    v_lshlrev_b32 v12, 16, v71
    v_and_b32 v13, 0xffff0000, v71
    v_add_f32 v10, v10, v12
    v_add_f32 v11, v11, v13
    s_waitcnt vmcnt(1)
    v_lshlrev_b32 v12, 16, v72
    v_and_b32 v13, 0xffff0000, v72
    v_add_f32 v4, v4, v12
    v_add_f32 v5, v5, v13
    v_lshlrev_b32 v12, 16, v73
    v_and_b32 v13, 0xffff0000, v73
    v_add_f32 v6, v6, v12
    v_add_f32 v7, v7, v13
    v_lshlrev_b32 v12, 16, v74
    v_and_b32 v13, 0xffff0000, v74
    v_add_f32 v8, v8, v12
    v_add_f32 v9, v9, v13
    v_lshlrev_b32 v12, 16, v75
    v_and_b32 v13, 0xffff0000, v75
    v_add_f32 v10, v10, v12
    v_add_f32 v11, v11, v13
    s_waitcnt vmcnt(0)
    v_lshlrev_b32 v12, 16, v76
    v_and_b32 v13, 0xffff0000, v76
    v_add_f32 v4, v4, v12
    v_add_f32 v5, v5, v13
    v_lshlrev_b32 v12, 16, v77
    v_and_b32 v13, 0xffff0000, v77
    v_add_f32 v6, v6, v12
    v_add_f32 v7, v7, v13
    v_lshlrev_b32 v12, 16, v78
    v_and_b32 v13, 0xffff0000, v78
    v_add_f32 v8, v8, v12
    v_add_f32 v9, v9, v13
    v_lshlrev_b32 v12, 16, v79
    v_and_b32 v13, 0xffff0000, v79
    v_add_f32 v10, v10, v12
    v_add_f32 v11, v11, v13
    v_cvt_pk_bf16_f32 v4, v4, v5
    v_cvt_pk_bf16_f32 v5, v6, v7
    v_cvt_pk_bf16_f32 v6, v8, v9
    v_cvt_pk_bf16_f32 v7, v10, v11
    s_and_b32 s21, s9, 7
    s_lshr_b32 s22, s9, 3
    s_cmp_ge_u32 s10, 112
    s_cbranch_scc1 L_rsh
    s_mul_i32 s23, s10, 9363
    s_lshr_b32 s23, s23, 18
    s_mul_i32 s24, s23, 28
    s_sub_u32 s24, s10, s24
    s_lshl_b32 s23, s23, 5
    s_branch L_rjoin
L_rsh:
    s_sub_u32 s24, s10, 112
    s_movk_i32 s23, 128
    v_and_b32 v12, 31, v2
    v_cmp_gt_u32 vcc, 16, v12
    s_and_b64 exec, exec, vcc
L_rjoin:
    s_lshl_b32 s25, s24, 4
    s_mul_i32 s26, s22, 448
    s_add_u32 s25, s25, s26
    s_mul_i32 s26, s21, 144
    s_add_u32 s26, s26, s23
    v_and_b32 v12, 31, v2
    v_add_u32 v12, s26, v12
    s_movk_i32 s27, 896
    v_mul_u32_u24 v12, v12, s27
    v_lshrrev_b32 v13, 5, v2
    v_lshl_add_u32 v12, v13, 2, v12
    v_add_u32 v12, s25, v12
    v_lshlrev_b32 v12, 1, v12
    buffer_store_dwordx2 v[4:5], v12, s[16:19], 0 offen
    buffer_store_dwordx2 v[6:7], v12, s[16:19], 0 offen offset:16
L_rend:
    s_endpgm
.section .rodata,"a"
.p2align 6
.amdhsa_kernel concat_heads__mha_block_cached__mha_block_cached__near_ridge_kernel
  .amdhsa_next_free_vgpr 512
  .amdhsa_next_free_sgpr 102
  .amdhsa_accum_offset 256
  .amdhsa_group_segment_fixed_size 0
  .amdhsa_kernarg_size 104
  .amdhsa_user_sgpr_count 2
  .amdhsa_user_sgpr_kernarg_segment_ptr 1
  .amdhsa_system_sgpr_workgroup_id_x 1
.end_amdhsa_kernel
.p2align 6
.amdhsa_kernel reduce_kernel
  .amdhsa_next_free_vgpr 80
  .amdhsa_next_free_sgpr 32
  .amdhsa_accum_offset 80
  .amdhsa_group_segment_fixed_size 0
  .amdhsa_kernarg_size 104
  .amdhsa_user_sgpr_count 2
  .amdhsa_user_sgpr_kernarg_segment_ptr 1
  .amdhsa_system_sgpr_workgroup_id_x 1
.end_amdhsa_kernel
```
